```python
import torch

def _softmax(x, axis=-1):
    return torch.softmax(x, dim=axis)
def _gelu(x):
    return torch.nn.functional.gelu(x, approximate="tanh")
def _silu(x):
    return torch.nn.functional.silu(x)
def _sigmoid(x):
    return torch.sigmoid(x)
def _layernorm(x, axis=-1, eps=1e-5):
    m = x.mean(dim=axis, keepdim=True)
    v = x.var(dim=axis, keepdim=True, unbiased=False)
    return (x - m) / torch.sqrt(v + eps)
def _scatter_add(tgt, idx, src, axis=0):
    return tgt.clone().index_add_(axis, idx, src)
def _segment_sum(src, seg, n):
    out = torch.zeros((n,) + src.shape[1:], dtype=src.dtype)
    return out.index_add_(0, seg, src)
def _pad(x, pw):
    flat = tuple(v for pair in reversed(pw) for v in pair)
    return torch.nn.functional.pad(x, flat)

kernel_name = 'recurrent_scan__mha_block_cached__dense_activation_silu__prompt'

def setup_inputs():

    _w = (lambda a: (lambda t: t.to(torch.bfloat16) if t.is_floating_point() else t)(torch.as_tensor(a)))
    def _A_setup():
        B, Sq, D = 1, 2048, 640
        H, Sk, Dh = 32, 2048, 128
        return {
            "x": _w((lambda *s: torch.randn(*s, dtype=torch.bfloat16) * 0.05)(B, Sq, D)),
            "k_cache": _w((lambda *s: torch.randn(*s, dtype=torch.bfloat16) * 3.2)(B, H, Sk, Dh)),
            "v_cache": _w((lambda *s: torch.randn(*s, dtype=torch.bfloat16) * 3.2)(B, H, Sk, Dh)),
            "wq": _w((lambda *s: torch.randn(*s, dtype=torch.bfloat16) * 3.2)(D, H * Dh) * (D ** -0.5)),
            "wo": _w((lambda *s: torch.randn(*s, dtype=torch.bfloat16) * 3.2)(H * Dh, D) * ((H * Dh) ** -0.5)),
        }
    _A_in = _A_setup()

    def _B_setup():
        B, S, D, F = 1, 2048, 640, 1728
        return {
            "x": _w((lambda *s: torch.randn(*s, dtype=torch.bfloat16) * 0.05)(B, S, D)),
            "w1": _w((lambda *s: torch.randn(*s, dtype=torch.bfloat16) * 3.2)(D, F) * (D ** -0.5)),
            "w2": _w((lambda *s: torch.randn(*s, dtype=torch.bfloat16) * 0.4)(F, D) * (F ** -0.5)),
        }
    _B_in = _B_setup()

    return {
        "A_x": _A_in["x"],
        "A_k_cache": _A_in["k_cache"],
        "A_v_cache": _A_in["v_cache"],
        "A_wq": _A_in["wq"],
        "A_wo": _A_in["wo"],
        "B_x": _B_in["x"],
        "B_w1": _B_in["w1"],
        "B_w2": _B_in["w2"],
    }

def reference(A_x, A_k_cache, A_v_cache, A_wq, A_wo, B_x, B_w1, B_w2):
    def _A_ref(x, k_cache, v_cache, wq, wo):
        B, Sq, D = x.shape
        H, Dh = 32, 128
        q = (lambda x, *d: x.permute(*d))((x @ wq).reshape(B, Sq, H, Dh), 0, 2, 1, 3)
        scores = torch.einsum("bhqd,bhkd->bhqk", q, k_cache) * (Dh ** -0.5)
        p = _softmax(scores, axis=-1)
        o = torch.einsum("bhqk,bhkd->bhqd", p, v_cache)
        return (lambda x, *d: x.permute(*d))(o, 0, 2, 1, 3).reshape(B, Sq, H * Dh) @ wo

    def _B_ref(x, w1, w2):
        h = torch.einsum("bsd,df->bsf", x, w1)
        h = _silu(h)
        out = torch.einsum("bsf,fd->bsd", h, w2)
        return out

    x = A_x
    xn = _layernorm(x, axis=-1)
    s = _A_ref(xn, A_k_cache, A_v_cache, A_wq, A_wo)
    g = _silu(_B_ref(xn, B_w1, B_w2))
    return x + s * g
```

```asm
; @launch kernel=pre_kernel grid=(192,1,1) block=(256,1,1) lds=0
; @launch kernel=attn_kernel grid=(256,1,1) block=(256,1,1) lds=151808
; @launch kernel=out_kernel grid=(256,1,1) block=(256,1,1) lds=122880
.amdgcn_target "amdgcn-amd-amdhsa--gfx950"
.text
.globl pre_kernel
.p2align 8
.type pre_kernel,@function
pre_kernel:
    s_load_dwordx16 s[64:79], s[0:1], 0
    s_load_dwordx2 s[80:81], s[0:1], 64
    s_load_dwordx2 s[82:83], s[0:1], 80
    v_lshrrev_b32 v1, 6, v0
    v_and_b32 v0, 63, v0
    s_nop 0
    v_readfirstlane_b32 s3, v1
    s_cmp_ge_u32 s2, 192
    s_cbranch_scc1 K0_END
    s_waitcnt lgkmcnt(0)
    s_mov_b32 s4, s64
    s_mov_b32 s5, s65
    s_mov_b32 s10, s82
    s_mov_b32 s11, s83
    s_cmp_lt_u32 s2, 64
    s_cbranch_scc1 K0_PF
    s_sub_u32 s2, s2, 64
    s_mov_b32 s12, s4
    s_mov_b32 s13, s5
    s_mov_b32 s14, 0x280000
    s_mov_b32 s15, 0x00020000
    s_mov_b32 s16, s10
    s_mov_b32 s17, s11
    s_mov_b32 s18, 0x280000
    s_mov_b32 s19, 0x00020000
    s_lshl_b32 s20, s2, 4
    s_lshl_b32 s21, s3, 2
    s_add_u32 s20, s20, s21
    v_lshrrev_b32 v1, 4, v0
    v_add_u32 v1, s20, v1
    v_and_b32 v2, 15, v0
    s_movk_i32 s22, 1280
    v_mul_lo_u32 v3, v1, s22
    v_lshl_add_u32 v3, v2, 4, v3
    v_lshrrev_b32 v4, 4, v1
    s_mov_b32 s22, 20480
    v_mul_lo_u32 v4, v4, s22
    v_lshl_add_u32 v4, v2, 8, v4
    v_and_b32 v5, 15, v1
    v_lshl_add_u32 v4, v5, 4, v4
    buffer_load_dwordx4 v[8:11], v3, s[12:15], 0 offen offset:0
    buffer_load_dwordx4 v[12:15], v3, s[12:15], 0 offen offset:256
    buffer_load_dwordx4 v[16:19], v3, s[12:15], 0 offen offset:512
    buffer_load_dwordx4 v[20:23], v3, s[12:15], 0 offen offset:768
    buffer_load_dwordx4 v[24:27], v3, s[12:15], 0 offen offset:1024
    s_waitcnt vmcnt(4)
    v_lshlrev_b32 v32, 16, v8
    v_and_b32 v33, 0xffff0000, v8
    v_lshlrev_b32 v34, 16, v9
    v_and_b32 v35, 0xffff0000, v9
    v_lshlrev_b32 v36, 16, v10
    v_and_b32 v37, 0xffff0000, v10
    v_lshlrev_b32 v38, 16, v11
    v_and_b32 v39, 0xffff0000, v11
    s_waitcnt vmcnt(3)
    v_lshlrev_b32 v40, 16, v12
    v_and_b32 v41, 0xffff0000, v12
    v_lshlrev_b32 v42, 16, v13
    v_and_b32 v43, 0xffff0000, v13
    v_lshlrev_b32 v44, 16, v14
    v_and_b32 v45, 0xffff0000, v14
    v_lshlrev_b32 v46, 16, v15
    v_and_b32 v47, 0xffff0000, v15
    s_waitcnt vmcnt(2)
    v_lshlrev_b32 v48, 16, v16
    v_and_b32 v49, 0xffff0000, v16
    v_lshlrev_b32 v50, 16, v17
    v_and_b32 v51, 0xffff0000, v17
    v_lshlrev_b32 v52, 16, v18
    v_and_b32 v53, 0xffff0000, v18
    v_lshlrev_b32 v54, 16, v19
    v_and_b32 v55, 0xffff0000, v19
    s_waitcnt vmcnt(1)
    v_lshlrev_b32 v56, 16, v20
    v_and_b32 v57, 0xffff0000, v20
    v_lshlrev_b32 v58, 16, v21
    v_and_b32 v59, 0xffff0000, v21
    v_lshlrev_b32 v60, 16, v22
    v_and_b32 v61, 0xffff0000, v22
    v_lshlrev_b32 v62, 16, v23
    v_and_b32 v63, 0xffff0000, v23
    s_waitcnt vmcnt(0)
    v_lshlrev_b32 v64, 16, v24
    v_and_b32 v65, 0xffff0000, v24
    v_lshlrev_b32 v66, 16, v25
    v_and_b32 v67, 0xffff0000, v25
    v_lshlrev_b32 v68, 16, v26
    v_and_b32 v69, 0xffff0000, v26
    v_lshlrev_b32 v70, 16, v27
    v_and_b32 v71, 0xffff0000, v27
    v_add_f32 v6, v32, v33
    v_add_f32 v7, v34, v35
    v_add_f32 v6, v6, v36
    v_add_f32 v7, v7, v37
    v_add_f32 v6, v6, v38
    v_add_f32 v7, v7, v39
    v_add_f32 v6, v6, v40
    v_add_f32 v7, v7, v41
    v_add_f32 v6, v6, v42
    v_add_f32 v7, v7, v43
    v_add_f32 v6, v6, v44
    v_add_f32 v7, v7, v45
    v_add_f32 v6, v6, v46
    v_add_f32 v7, v7, v47
    v_add_f32 v6, v6, v48
    v_add_f32 v7, v7, v49
    v_add_f32 v6, v6, v50
    v_add_f32 v7, v7, v51
    v_add_f32 v6, v6, v52
    v_add_f32 v7, v7, v53
    v_add_f32 v6, v6, v54
    v_add_f32 v7, v7, v55
    v_add_f32 v6, v6, v56
    v_add_f32 v7, v7, v57
    v_add_f32 v6, v6, v58
    v_add_f32 v7, v7, v59
    v_add_f32 v6, v6, v60
    v_add_f32 v7, v7, v61
    v_add_f32 v6, v6, v62
    v_add_f32 v7, v7, v63
    v_add_f32 v6, v6, v64
    v_add_f32 v7, v7, v65
    v_add_f32 v6, v6, v66
    v_add_f32 v7, v7, v67
    v_add_f32 v6, v6, v68
    v_add_f32 v7, v7, v69
    v_add_f32 v6, v6, v70
    v_add_f32 v7, v7, v71
    v_add_f32 v6, v6, v7
    s_nop 1
    v_add_f32_dpp v6, v6, v6 row_ror:8 row_mask:0xf bank_mask:0xf
    s_nop 1
    v_add_f32_dpp v6, v6, v6 row_ror:4 row_mask:0xf bank_mask:0xf
    s_nop 1
    v_add_f32_dpp v6, v6, v6 row_ror:2 row_mask:0xf bank_mask:0xf
    s_nop 1
    v_add_f32_dpp v6, v6, v6 row_ror:1 row_mask:0xf bank_mask:0xf
    v_mul_f32 v6, 0x3acccccd, v6
    v_sub_f32 v32, v32, v6
    v_sub_f32 v33, v33, v6
    v_sub_f32 v34, v34, v6
    v_sub_f32 v35, v35, v6
    v_sub_f32 v36, v36, v6
    v_sub_f32 v37, v37, v6
    v_sub_f32 v38, v38, v6
    v_sub_f32 v39, v39, v6
    v_sub_f32 v40, v40, v6
    v_sub_f32 v41, v41, v6
    v_sub_f32 v42, v42, v6
    v_sub_f32 v43, v43, v6
    v_sub_f32 v44, v44, v6
    v_sub_f32 v45, v45, v6
    v_sub_f32 v46, v46, v6
    v_sub_f32 v47, v47, v6
    v_sub_f32 v48, v48, v6
    v_sub_f32 v49, v49, v6
    v_sub_f32 v50, v50, v6
    v_sub_f32 v51, v51, v6
    v_sub_f32 v52, v52, v6
    v_sub_f32 v53, v53, v6
    v_sub_f32 v54, v54, v6
    v_sub_f32 v55, v55, v6
    v_sub_f32 v56, v56, v6
    v_sub_f32 v57, v57, v6
    v_sub_f32 v58, v58, v6
    v_sub_f32 v59, v59, v6
    v_sub_f32 v60, v60, v6
    v_sub_f32 v61, v61, v6
    v_sub_f32 v62, v62, v6
    v_sub_f32 v63, v63, v6
    v_sub_f32 v64, v64, v6
    v_sub_f32 v65, v65, v6
    v_sub_f32 v66, v66, v6
    v_sub_f32 v67, v67, v6
    v_sub_f32 v68, v68, v6
    v_sub_f32 v69, v69, v6
    v_sub_f32 v70, v70, v6
    v_sub_f32 v71, v71, v6
    v_mul_f32 v7, v32, v32
    v_mul_f32 v6, v33, v33
    v_fmac_f32 v7, v34, v34
    v_fmac_f32 v6, v35, v35
    v_fmac_f32 v7, v36, v36
    v_fmac_f32 v6, v37, v37
    v_fmac_f32 v7, v38, v38
    v_fmac_f32 v6, v39, v39
    v_fmac_f32 v7, v40, v40
    v_fmac_f32 v6, v41, v41
    v_fmac_f32 v7, v42, v42
    v_fmac_f32 v6, v43, v43
    v_fmac_f32 v7, v44, v44
    v_fmac_f32 v6, v45, v45
    v_fmac_f32 v7, v46, v46
    v_fmac_f32 v6, v47, v47
    v_fmac_f32 v7, v48, v48
    v_fmac_f32 v6, v49, v49
    v_fmac_f32 v7, v50, v50
    v_fmac_f32 v6, v51, v51
    v_fmac_f32 v7, v52, v52
    v_fmac_f32 v6, v53, v53
    v_fmac_f32 v7, v54, v54
    v_fmac_f32 v6, v55, v55
    v_fmac_f32 v7, v56, v56
    v_fmac_f32 v6, v57, v57
    v_fmac_f32 v7, v58, v58
    v_fmac_f32 v6, v59, v59
    v_fmac_f32 v7, v60, v60
    v_fmac_f32 v6, v61, v61
    v_fmac_f32 v7, v62, v62
    v_fmac_f32 v6, v63, v63
    v_fmac_f32 v7, v64, v64
    v_fmac_f32 v6, v65, v65
    v_fmac_f32 v7, v66, v66
    v_fmac_f32 v6, v67, v67
    v_fmac_f32 v7, v68, v68
    v_fmac_f32 v6, v69, v69
    v_fmac_f32 v7, v70, v70
    v_fmac_f32 v6, v71, v71
    v_add_f32 v7, v6, v7
    s_nop 1
    v_add_f32_dpp v7, v7, v7 row_ror:8 row_mask:0xf bank_mask:0xf
    s_nop 1
    v_add_f32_dpp v7, v7, v7 row_ror:4 row_mask:0xf bank_mask:0xf
    s_nop 1
    v_add_f32_dpp v7, v7, v7 row_ror:2 row_mask:0xf bank_mask:0xf
    s_nop 1
    v_add_f32_dpp v7, v7, v7 row_ror:1 row_mask:0xf bank_mask:0xf
    v_mov_b32 v6, 0x3727c5ac
    v_fmac_f32 v6, 0x3acccccd, v7
    v_rsq_f32 v6, v6
    s_nop 0
    v_mul_f32 v32, v32, v6
    v_mul_f32 v33, v33, v6
    v_mul_f32 v34, v34, v6
    v_mul_f32 v35, v35, v6
    v_mul_f32 v36, v36, v6
    v_mul_f32 v37, v37, v6
    v_mul_f32 v38, v38, v6
    v_mul_f32 v39, v39, v6
    v_mul_f32 v40, v40, v6
    v_mul_f32 v41, v41, v6
    v_mul_f32 v42, v42, v6
    v_mul_f32 v43, v43, v6
    v_mul_f32 v44, v44, v6
    v_mul_f32 v45, v45, v6
    v_mul_f32 v46, v46, v6
    v_mul_f32 v47, v47, v6
    v_mul_f32 v48, v48, v6
    v_mul_f32 v49, v49, v6
    v_mul_f32 v50, v50, v6
    v_mul_f32 v51, v51, v6
    v_mul_f32 v52, v52, v6
    v_mul_f32 v53, v53, v6
    v_mul_f32 v54, v54, v6
    v_mul_f32 v55, v55, v6
    v_mul_f32 v56, v56, v6
    v_mul_f32 v57, v57, v6
    v_mul_f32 v58, v58, v6
    v_mul_f32 v59, v59, v6
    v_mul_f32 v60, v60, v6
    v_mul_f32 v61, v61, v6
    v_mul_f32 v62, v62, v6
    v_mul_f32 v63, v63, v6
    v_mul_f32 v64, v64, v6
    v_mul_f32 v65, v65, v6
    v_mul_f32 v66, v66, v6
    v_mul_f32 v67, v67, v6
    v_mul_f32 v68, v68, v6
    v_mul_f32 v69, v69, v6
    v_mul_f32 v70, v70, v6
    v_mul_f32 v71, v71, v6
    v_cvt_pk_bf16_f32 v8, v32, v33
    v_cvt_pk_bf16_f32 v9, v34, v35
    v_cvt_pk_bf16_f32 v10, v36, v37
    v_cvt_pk_bf16_f32 v11, v38, v39
    s_mov_b32 s22, 0
    buffer_store_dwordx4 v[8:11], v4, s[16:19], s22 offen sc1
    v_cvt_pk_bf16_f32 v12, v40, v41
    v_cvt_pk_bf16_f32 v13, v42, v43
    v_cvt_pk_bf16_f32 v14, v44, v45
    v_cvt_pk_bf16_f32 v15, v46, v47
    s_mov_b32 s22, 4096
    buffer_store_dwordx4 v[12:15], v4, s[16:19], s22 offen sc1
    v_cvt_pk_bf16_f32 v16, v48, v49
    v_cvt_pk_bf16_f32 v17, v50, v51
    v_cvt_pk_bf16_f32 v18, v52, v53
    v_cvt_pk_bf16_f32 v19, v54, v55
    s_mov_b32 s22, 8192
    buffer_store_dwordx4 v[16:19], v4, s[16:19], s22 offen sc1
    v_cvt_pk_bf16_f32 v20, v56, v57
    v_cvt_pk_bf16_f32 v21, v58, v59
    v_cvt_pk_bf16_f32 v22, v60, v61
    v_cvt_pk_bf16_f32 v23, v62, v63
    s_mov_b32 s22, 12288
    buffer_store_dwordx4 v[20:23], v4, s[16:19], s22 offen sc1
    v_cvt_pk_bf16_f32 v24, v64, v65
    v_cvt_pk_bf16_f32 v25, v66, v67
    v_cvt_pk_bf16_f32 v26, v68, v69
    v_cvt_pk_bf16_f32 v27, v70, v71
    s_mov_b32 s22, 16384
    buffer_store_dwordx4 v[24:27], v4, s[16:19], s22 offen sc1
    s_endpgm
K0_PF:
    s_mov_b32 s16, s70
    s_mov_b32 s17, s71
    s_mov_b32 s20, s76
    s_mov_b32 s21, s77
    s_mov_b32 s24, s66
    s_mov_b32 s25, s67
    s_mov_b32 s28, s68
    s_mov_b32 s29, s69
    s_mov_b32 s32, s80
    s_mov_b32 s33, s81
    s_mov_b32 s36, s72
    s_mov_b32 s37, s73
    s_mov_b32 s40, s78
    s_mov_b32 s41, s79
    s_mov_b32 s44, s82
    s_mov_b32 s45, s83
    s_mov_b32 s48, s82
    s_mov_b32 s49, s83
    s_and_b32 s12, s2, 7
    s_lshl_b32 s12, s12, 21
    s_lshr_b32 s13, s2, 3
    s_lshl_b32 s13, s13, 8
    s_lshl_b32 s14, s3, 6
    s_add_u32 s13, s13, s14
    v_add_u32 v1, s13, v0
    s_mov_b32 s18, 0x500000
    s_mov_b32 s19, 0x00020000
    v_subrev_u32 v2, 0, v1
    s_mov_b32 s15, 65536
    v_mul_lo_u32 v8, v2, s15
    s_mov_b32 s22, 0x21c000
    s_mov_b32 s23, 0x00020000
    v_subrev_u32 v2, 80, v1
    s_mov_b32 s15, 65536
    v_mul_lo_u32 v9, v2, s15
    s_add_u32 s24, s24, s12
    s_addc_u32 s25, s25, 0
    s_mov_b32 s26, 0x200000
    s_mov_b32 s27, 0x00020000
    v_subrev_u32 v2, 114, v1
    s_mov_b32 s15, 65536
    v_mul_lo_u32 v10, v2, s15
    s_add_u32 s28, s28, s12
    s_addc_u32 s29, s29, 0
    s_mov_b32 s30, 0x200000
    s_mov_b32 s31, 0x00020000
    v_subrev_u32 v2, 146, v1
    s_mov_b32 s15, 65536
    v_mul_lo_u32 v11, v2, s15
    s_mov_b32 s34, 0x280000
    s_mov_b32 s35, 0x00020000
    v_subrev_u32 v2, 178, v1
    s_mov_b32 s15, 65536
    v_mul_lo_u32 v12, v2, s15
    s_mov_b32 s38, 0x500000
    s_mov_b32 s39, 0x00020000
    v_subrev_u32 v2, 218, v1
    s_mov_b32 s15, 65536
    v_mul_lo_u32 v13, v2, s15
    s_mov_b32 s42, 0x21c000
    s_mov_b32 s43, 0x00020000
    v_subrev_u32 v2, 298, v1
    s_mov_b32 s15, 65536
    v_mul_lo_u32 v14, v2, s15
    s_add_u32 s44, s44, 0xa00000
    s_addc_u32 s45, s45, 0
    s_mov_b32 s46, 0x16c0000
    s_mov_b32 s47, 0x00020000
    v_subrev_u32 v2, 332, v1
    s_mov_b32 s15, 65536
    v_mul_lo_u32 v15, v2, s15
    s_add_u32 s48, s48, 0x280000
    s_addc_u32 s49, s49, 0
    s_mov_b32 s50, 0x71c000
    s_mov_b32 s51, 0x00020000
    v_subrev_u32 v2, 696, v1
    s_mov_b32 s15, 65536
    v_mul_lo_u32 v16, v2, s15
    buffer_load_dword v24, v8, s[16:19], 0 offen
    buffer_load_dword v25, v9, s[20:23], 0 offen
    buffer_load_dword v26, v10, s[24:27], 0 offen
    buffer_load_dword v27, v11, s[28:31], 0 offen
    buffer_load_dword v28, v12, s[32:35], 0 offen
    buffer_load_dword v29, v13, s[36:39], 0 offen
    buffer_load_dword v30, v14, s[40:43], 0 offen
    buffer_load_dword v31, v15, s[44:47], 0 offen
    buffer_load_dword v32, v16, s[48:51], 0 offen
    s_waitcnt vmcnt(0)
K0_END:
    s_endpgm

.globl attn_kernel
.p2align 8
.type attn_kernel,@function
attn_kernel:
    s_load_dwordx2 s[40:41], s[0:1], 8
    s_load_dwordx2 s[42:43], s[0:1], 16
    s_load_dwordx2 s[44:45], s[0:1], 24
    s_load_dwordx2 s[46:47], s[0:1], 48
    s_load_dwordx2 s[48:49], s[0:1], 80
    s_load_dwordx2 s[90:91], s[0:1], 32
    s_load_dwordx2 s[92:93], s[0:1], 56
    v_lshrrev_b32 v1, 6, v0
    v_and_b32 v0, 63, v0
    s_nop 0
    v_readfirstlane_b32 s3, v1
    s_cmp_ge_u32 s2, 256
    s_cbranch_scc1 KA_END
    s_and_b32 s4, s2, 7
    s_lshr_b32 s5, s2, 3
    s_and_b32 s6, s5, 3
    s_lshl_b32 s4, s4, 2
    s_add_u32 s4, s4, s6
    s_lshr_b32 s5, s5, 2
    s_waitcnt lgkmcnt(0)
    s_lshl_b32 s6, s4, 19
    s_add_u32 s8, s40, s6
    s_addc_u32 s9, s41, 0
    s_mov_b32 s10, 0x80000
    s_mov_b32 s11, 0x00020000
    s_add_u32 s12, s42, s6
    s_addc_u32 s13, s43, 0
    s_mov_b32 s14, 0x80000
    s_mov_b32 s15, 0x00020000
    s_lshl_b32 s6, s4, 8
    s_add_u32 s20, s44, s6
    s_addc_u32 s21, s45, 0
    s_sub_u32 s22, 0x500000, s6
    s_mov_b32 s23, 0x00020000
    s_lshl_b32 s6, s4, 7
    s_add_u32 s24, s46, s6
    s_addc_u32 s25, s47, 0
    s_sub_u32 s26, 0x21c000, s6
    s_cmp_ge_u32 s4, 27
    s_cselect_b32 s26, 0, s26
    s_mov_b32 s27, 0x00020000
    s_mov_b32 s16, s48
    s_mov_b32 s17, s49
    s_mov_b32 s18, 0x280000
    s_mov_b32 s19, 0x00020000
    s_add_u32 s28, s48, 0xa00000
    s_addc_u32 s29, s49, 0
    s_mov_b32 s30, 0x16c0000
    s_mov_b32 s31, 0x00020000
    s_lshl_b32 s52, s5, 4
    s_lshl_b32 s51, s3, 2
    s_add_u32 s52, s52, s51
    s_mul_i32 s50, s52, 20480
    s_mul_i32 s52, s52, 186368
    s_lshl_b32 s53, s3, 12
    s_lshl_b32 s54, s3, 11
    v_and_b32 v1, 15, v0
    v_lshrrev_b32 v2, 4, v0
    v_lshrrev_b32 v4, 2, v1
    v_and_b32 v5, 3, v0
    s_lshl_b32 s6, s3, 4
    v_add_u32 v27, s6, v2
    v_lshlrev_b32 v7, 2, v2
    v_xor_b32 v7, v7, v1
    v_lshlrev_b32 v7, 4, v7
    v_lshl_add_u32 v232, v27, 13, v7
    v_lshrrev_b32 v6, 3, v0
    v_add_u32 v3, s6, v6
    s_movk_i32 s7, 3456
    v_mul_lo_u32 v3, v3, s7
    v_bfe_u32 v6, v0, 4, 1
    v_and_b32 v7, 7, v0
    v_lshlrev_b32 v6, 1, v6
    v_xor_b32 v7, v6, v7
    v_lshl_add_u32 v233, v7, 4, v3
    v_xor_b32 v7, 4, v7
    v_lshl_add_u32 v234, v7, 4, v3
    v_lshlrev_b32 v236, 4, v0
    v_add_u32 v237, 20480, v236
    v_add_u32 v238, 40960, v236
    v_add_u32 v239, 61440, v236
    v_lshlrev_b32 v240, 4, v0
    s_add_u32 m0, s53, 65536
    s_mov_b32 s55, 0
    buffer_load_dwordx4 v232, s[20:23], s55 offen lds
    s_add_u32 m0, s53, 66560
    s_mov_b32 s55, 32768
    buffer_load_dwordx4 v232, s[20:23], s55 offen lds
    s_add_u32 m0, s53, 67584
    s_mov_b32 s55, 65536
    buffer_load_dwordx4 v232, s[20:23], s55 offen lds
    s_add_u32 m0, s53, 68608
    s_mov_b32 s55, 98304
    buffer_load_dwordx4 v232, s[20:23], s55 offen lds
    s_add_u32 m0, s54, 0
    s_mov_b32 s55, 0
    buffer_load_dwordx4 v233, s[24:27], s55 offen lds
    s_add_u32 m0, s54, 1024
    s_mov_b32 s55, 27648
    buffer_load_dwordx4 v234, s[24:27], s55 offen lds
    s_add_u32 s56, s50, 0
    buffer_load_dwordx4 a[0:3], v236, s[16:19], s56 offen offset:0
    buffer_load_dwordx4 a[4:7], v237, s[16:19], s56 offen offset:0
    buffer_load_dwordx4 a[8:11], v238, s[16:19], s56 offen offset:0
    buffer_load_dwordx4 a[12:15], v239, s[16:19], s56 offen offset:0
    buffer_load_dwordx4 a[16:19], v236, s[16:19], s56 offen offset:1024
    buffer_load_dwordx4 a[20:23], v237, s[16:19], s56 offen offset:1024
    buffer_load_dwordx4 a[24:27], v238, s[16:19], s56 offen offset:1024
    buffer_load_dwordx4 a[28:31], v239, s[16:19], s56 offen offset:1024
    s_add_u32 m0, s53, 81920
    s_mov_b32 s55, 524288
    buffer_load_dwordx4 v232, s[20:23], s55 offen lds
    s_add_u32 m0, s53, 82944
    s_mov_b32 s55, 557056
    buffer_load_dwordx4 v232, s[20:23], s55 offen lds
    s_add_u32 m0, s53, 83968
    s_mov_b32 s55, 589824
    buffer_load_dwordx4 v232, s[20:23], s55 offen lds
    s_add_u32 m0, s53, 84992
    s_mov_b32 s55, 622592
    buffer_load_dwordx4 v232, s[20:23], s55 offen lds
    s_add_u32 m0, s54, 16384
    s_mov_b32 s55, 221184
    buffer_load_dwordx4 v233, s[24:27], s55 offen lds
    s_add_u32 m0, s54, 17408
    s_mov_b32 s55, 248832
    buffer_load_dwordx4 v234, s[24:27], s55 offen lds
    s_add_u32 s56, s50, 2048
    buffer_load_dwordx4 a[32:35], v236, s[16:19], s56 offen offset:0
    buffer_load_dwordx4 a[36:39], v237, s[16:19], s56 offen offset:0
    buffer_load_dwordx4 a[40:43], v238, s[16:19], s56 offen offset:0
    buffer_load_dwordx4 a[44:47], v239, s[16:19], s56 offen offset:0
    buffer_load_dwordx4 a[48:51], v236, s[16:19], s56 offen offset:1024
    buffer_load_dwordx4 a[52:55], v237, s[16:19], s56 offen offset:1024
    buffer_load_dwordx4 a[56:59], v238, s[16:19], s56 offen offset:1024
    buffer_load_dwordx4 a[60:63], v239, s[16:19], s56 offen offset:1024
    s_add_u32 m0, s53, 98304
    s_mov_b32 s55, 1048576
    buffer_load_dwordx4 v232, s[20:23], s55 offen lds
    s_add_u32 m0, s53, 99328
    s_mov_b32 s55, 1081344
    buffer_load_dwordx4 v232, s[20:23], s55 offen lds
    s_add_u32 m0, s53, 100352
    s_mov_b32 s55, 1114112
    buffer_load_dwordx4 v232, s[20:23], s55 offen lds
    s_add_u32 m0, s53, 101376
    s_mov_b32 s55, 1146880
    buffer_load_dwordx4 v232, s[20:23], s55 offen lds
    s_add_u32 m0, s54, 32768
    s_mov_b32 s55, 442368
    buffer_load_dwordx4 v233, s[24:27], s55 offen lds
    s_add_u32 m0, s54, 33792
    s_mov_b32 s55, 470016
    buffer_load_dwordx4 v234, s[24:27], s55 offen lds
    v_or_b32 v7, 0, v2
    v_xor_b32 v7, v7, v1
    v_lshlrev_b32 v7, 4, v7
    v_lshl_add_u32 v20, v27, 8, v7
    v_or_b32 v7, 4, v2
    v_xor_b32 v7, v7, v1
    v_lshlrev_b32 v7, 4, v7
    v_lshl_add_u32 v21, v27, 8, v7
    v_or_b32 v7, 8, v2
    v_xor_b32 v7, v7, v1
    v_lshlrev_b32 v7, 4, v7
    v_lshl_add_u32 v22, v27, 8, v7
    v_or_b32 v7, 12, v2
    v_xor_b32 v7, v7, v1
    v_lshlrev_b32 v7, 4, v7
    v_lshl_add_u32 v23, v27, 8, v7
    v_or_b32 v7, 0, v2
    v_lshlrev_b32 v7, 1, v7
    v_xor_b32 v7, v7, v1
    v_lshlrev_b32 v7, 4, v7
    v_lshl_add_u32 v24, v27, 8, v7
    v_or_b32 v7, 4, v2
    v_lshlrev_b32 v7, 1, v7
    v_xor_b32 v7, v7, v1
    v_lshlrev_b32 v7, 4, v7
    v_lshl_add_u32 v25, v27, 8, v7
    v_or_b32 v7, 0, v2
    v_xor_b32 v7, v7, v1
    v_lshlrev_b32 v7, 4, v7
    v_lshl_add_u32 v8, v1, 8, v7
    v_or_b32 v7, 4, v2
    v_xor_b32 v7, v7, v1
    v_lshlrev_b32 v7, 4, v7
    v_lshl_add_u32 v9, v1, 8, v7
    v_or_b32 v7, 8, v2
    v_xor_b32 v7, v7, v1
    v_lshlrev_b32 v7, 4, v7
    v_lshl_add_u32 v10, v1, 8, v7
    v_or_b32 v7, 12, v2
    v_xor_b32 v7, v7, v1
    v_lshlrev_b32 v7, 4, v7
    v_lshl_add_u32 v11, v1, 8, v7
    v_lshl_add_u32 v3, v2, 2, v4
    v_and_b32 v6, 7, v3
    v_lshlrev_b32 v3, 8, v3
    v_lshl_add_u32 v3, v5, 3, v3
    v_add_u32 v3, 0x10000, v3
    v_xor_b32 v7, 0, v6
    v_lshl_add_u32 v12, v7, 5, v3
    v_xor_b32 v7, 1, v6
    v_lshl_add_u32 v13, v7, 5, v3
    v_xor_b32 v7, 2, v6
    v_lshl_add_u32 v14, v7, 5, v3
    v_xor_b32 v7, 3, v6
    v_lshl_add_u32 v15, v7, 5, v3
    v_xor_b32 v7, 4, v6
    v_lshl_add_u32 v16, v7, 5, v3
    v_xor_b32 v7, 5, v6
    v_lshl_add_u32 v17, v7, 5, v3
    v_xor_b32 v7, 6, v6
    v_lshl_add_u32 v18, v7, 5, v3
    v_xor_b32 v7, 7, v6
    v_lshl_add_u32 v19, v7, 5, v3
    v_lshl_add_u32 v3, v2, 3, v4
    v_lshlrev_b32 v6, 8, v3
    v_lshl_add_u32 v6, v5, 4, v6
    v_add_u32 v6, 0x10000, v6
    v_xor_b32 v7, 0, v4
    v_lshl_add_u32 v224, v7, 6, v6
    v_xor_b32 v7, 1, v4
    v_lshl_add_u32 v225, v7, 6, v6
    v_xor_b32 v7, 2, v4
    v_lshl_add_u32 v226, v7, 6, v6
    v_xor_b32 v7, 3, v4
    v_lshl_add_u32 v227, v7, 6, v6
    v_bfe_u32 v6, v3, 1, 1
    v_bfe_u32 v7, v3, 3, 1
    v_lshl_or_b32 v6, v7, 1, v6
    v_lshlrev_b32 v3, 7, v3
    v_lshl_add_u32 v3, v5, 3, v3
    v_xor_b32 v7, 0, v6
    v_lshl_add_u32 v228, v7, 5, v3
    v_xor_b32 v7, 1, v6
    v_lshl_add_u32 v229, v7, 5, v3
    v_xor_b32 v7, 2, v6
    v_lshl_add_u32 v230, v7, 5, v3
    v_xor_b32 v7, 3, v6
    v_lshl_add_u32 v231, v7, 5, v3
    v_mov_b32 v28, 0x3f803f80
    v_mov_b32 v29, 0x3f803f80
    v_mov_b32 v30, 0x3f803f80
    v_mov_b32 v31, 0x3f803f80
    v_lshlrev_b32 v26, 8, v0
    s_waitcnt vmcnt(24)
    s_barrier
    ds_read_b64_tr_b16 a[128:129], v224 offset:0
    ds_read_b64_tr_b16 a[130:131], v224 offset:1024
    ds_read_b64_tr_b16 a[132:133], v224 offset:8
    ds_read_b64_tr_b16 a[134:135], v224 offset:1032
    ds_read_b64_tr_b16 a[136:137], v225 offset:0
    ds_read_b64_tr_b16 a[138:139], v225 offset:1024
    ds_read_b64_tr_b16 a[140:141], v225 offset:8
    ds_read_b64_tr_b16 a[142:143], v225 offset:1032
    ds_read_b64_tr_b16 a[144:145], v226 offset:0
    ds_read_b64_tr_b16 a[146:147], v226 offset:1024
    ds_read_b64_tr_b16 a[148:149], v226 offset:8
    ds_read_b64_tr_b16 a[150:151], v226 offset:1032
    ds_read_b64_tr_b16 a[152:153], v227 offset:0
    ds_read_b64_tr_b16 a[154:155], v227 offset:1024
    ds_read_b64_tr_b16 a[156:157], v227 offset:8
    ds_read_b64_tr_b16 a[158:159], v227 offset:1032
    ds_read_b64_tr_b16 a[160:161], v228 offset:0
    ds_read_b64_tr_b16 a[162:163], v228 offset:512
    ds_read_b64_tr_b16 a[164:165], v229 offset:0
    ds_read_b64_tr_b16 a[166:167], v229 offset:512
    ds_read_b64_tr_b16 a[168:169], v230 offset:0
    ds_read_b64_tr_b16 a[170:171], v230 offset:512
    ds_read_b64_tr_b16 a[172:173], v231 offset:0
    ds_read_b64_tr_b16 a[174:175], v231 offset:512
    s_waitcnt lgkmcnt(15)
    v_mfma_f32_16x16x32_bf16 v[32:35], a[128:131], a[0:3], 0
    ds_read_b64_tr_b16 a[176:177], v224 offset:8192
    v_mfma_f32_16x16x32_bf16 v[36:39], a[128:131], a[4:7], 0
    v_mfma_f32_16x16x32_bf16 v[40:43], a[128:131], a[8:11], 0
    ds_read_b64_tr_b16 a[178:179], v224 offset:9216
    v_mfma_f32_16x16x32_bf16 v[44:47], a[128:131], a[12:15], 0
    v_mfma_f32_16x16x32_bf16 v[48:51], a[132:135], a[0:3], 0
    ds_read_b64_tr_b16 a[180:181], v224 offset:8200
    v_mfma_f32_16x16x32_bf16 v[52:55], a[132:135], a[4:7], 0
    v_mfma_f32_16x16x32_bf16 v[56:59], a[132:135], a[8:11], 0
    ds_read_b64_tr_b16 a[182:183], v224 offset:9224
    v_mfma_f32_16x16x32_bf16 v[60:63], a[132:135], a[12:15], 0
    v_mfma_f32_16x16x32_bf16 v[64:67], a[136:139], a[0:3], 0
    ds_read_b64_tr_b16 a[184:185], v225 offset:8192
    v_mfma_f32_16x16x32_bf16 v[68:71], a[136:139], a[4:7], 0
    v_mfma_f32_16x16x32_bf16 v[72:75], a[136:139], a[8:11], 0
    ds_read_b64_tr_b16 a[186:187], v225 offset:9216
    v_mfma_f32_16x16x32_bf16 v[76:79], a[136:139], a[12:15], 0
    v_mfma_f32_16x16x32_bf16 v[80:83], a[140:143], a[0:3], 0
    ds_read_b64_tr_b16 a[188:189], v225 offset:8200
    v_mfma_f32_16x16x32_bf16 v[84:87], a[140:143], a[4:7], 0
    v_mfma_f32_16x16x32_bf16 v[88:91], a[140:143], a[8:11], 0
    ds_read_b64_tr_b16 a[190:191], v225 offset:9224
    v_mfma_f32_16x16x32_bf16 v[92:95], a[140:143], a[12:15], 0
    s_waitcnt lgkmcnt(6)
    v_mfma_f32_16x16x32_bf16 v[96:99], a[144:147], a[0:3], 0
    ds_read_b64_tr_b16 a[192:193], v226 offset:8192
    v_mfma_f32_16x16x32_bf16 v[100:103], a[144:147], a[4:7], 0
    v_mfma_f32_16x16x32_bf16 v[104:107], a[144:147], a[8:11], 0
    ds_read_b64_tr_b16 a[194:195], v226 offset:9216
    v_mfma_f32_16x16x32_bf16 v[108:111], a[144:147], a[12:15], 0
    v_mfma_f32_16x16x32_bf16 v[112:115], a[148:151], a[0:3], 0
    ds_read_b64_tr_b16 a[196:197], v226 offset:8200
    v_mfma_f32_16x16x32_bf16 v[116:119], a[148:151], a[4:7], 0
    v_mfma_f32_16x16x32_bf16 v[120:123], a[148:151], a[8:11], 0
    ds_read_b64_tr_b16 a[198:199], v226 offset:9224
    v_mfma_f32_16x16x32_bf16 v[124:127], a[148:151], a[12:15], 0
    v_mfma_f32_16x16x32_bf16 v[128:131], a[152:155], a[0:3], 0
    ds_read_b64_tr_b16 a[200:201], v227 offset:8192
    v_mfma_f32_16x16x32_bf16 v[132:135], a[152:155], a[4:7], 0
    v_mfma_f32_16x16x32_bf16 v[136:139], a[152:155], a[8:11], 0
    ds_read_b64_tr_b16 a[202:203], v227 offset:9216
    v_mfma_f32_16x16x32_bf16 v[140:143], a[152:155], a[12:15], 0
    v_mfma_f32_16x16x32_bf16 v[144:147], a[156:159], a[0:3], 0
    ds_read_b64_tr_b16 a[204:205], v227 offset:8200
    v_mfma_f32_16x16x32_bf16 v[148:151], a[156:159], a[4:7], 0
    v_mfma_f32_16x16x32_bf16 v[152:155], a[156:159], a[8:11], 0
    ds_read_b64_tr_b16 a[206:207], v227 offset:9224
    v_mfma_f32_16x16x32_bf16 v[156:159], a[156:159], a[12:15], 0
    v_mfma_f32_16x16x32_bf16 a[96:99], a[160:163], a[0:3], 0
    ds_read_b64_tr_b16 a[208:209], v228 offset:4096
    v_mfma_f32_16x16x32_bf16 a[100:103], a[160:163], a[4:7], 0
    v_mfma_f32_16x16x32_bf16 a[104:107], a[160:163], a[8:11], 0
    ds_read_b64_tr_b16 a[210:211], v228 offset:4608
    v_mfma_f32_16x16x32_bf16 a[108:111], a[160:163], a[12:15], 0
    v_mfma_f32_16x16x32_bf16 a[112:115], a[164:167], a[0:3], 0
    ds_read_b64_tr_b16 a[212:213], v229 offset:4096
    v_mfma_f32_16x16x32_bf16 a[116:119], a[164:167], a[4:7], 0
    v_mfma_f32_16x16x32_bf16 a[120:123], a[164:167], a[8:11], 0
    ds_read_b64_tr_b16 a[214:215], v229 offset:4608
    v_mfma_f32_16x16x32_bf16 a[124:127], a[164:167], a[12:15], 0
    v_mfma_f32_16x16x32_bf16 a[224:227], a[168:171], a[0:3], 0
    ds_read_b64_tr_b16 a[216:217], v230 offset:4096
    v_mfma_f32_16x16x32_bf16 a[228:231], a[168:171], a[4:7], 0
    v_mfma_f32_16x16x32_bf16 a[232:235], a[168:171], a[8:11], 0
    ds_read_b64_tr_b16 a[218:219], v230 offset:4608
    v_mfma_f32_16x16x32_bf16 a[236:239], a[168:171], a[12:15], 0
    v_mfma_f32_16x16x32_bf16 a[240:243], a[172:175], a[0:3], 0
    ds_read_b64_tr_b16 a[220:221], v231 offset:4096
    v_mfma_f32_16x16x32_bf16 a[244:247], a[172:175], a[4:7], 0
    v_mfma_f32_16x16x32_bf16 a[248:251], a[172:175], a[8:11], 0
    ds_read_b64_tr_b16 a[222:223], v231 offset:4608
    v_mfma_f32_16x16x32_bf16 a[252:255], a[172:175], a[12:15], 0
    s_waitcnt vmcnt(14)
    s_barrier
    v_mfma_f32_16x16x32_bf16 v[32:35], a[176:179], a[16:19], v[32:35]
    ds_read_b64_tr_b16 a[128:129], v224 offset:16384
    v_mfma_f32_16x16x32_bf16 v[36:39], a[176:179], a[20:23], v[36:39]
    s_add_u32 s56, s50, 4096
    buffer_load_dwordx4 a[64:67], v236, s[16:19], s56 offen offset:0
    v_mfma_f32_16x16x32_bf16 v[40:43], a[176:179], a[24:27], v[40:43]
    ds_read_b64_tr_b16 a[130:131], v224 offset:17408
    v_mfma_f32_16x16x32_bf16 v[44:47], a[176:179], a[28:31], v[44:47]
    s_waitcnt lgkmcnt(5)
    v_mfma_f32_16x16x32_bf16 v[48:51], a[180:183], a[16:19], v[48:51]
    ds_read_b64_tr_b16 a[132:133], v224 offset:16392
    v_mfma_f32_16x16x32_bf16 v[52:55], a[180:183], a[20:23], v[52:55]
    v_mfma_f32_16x16x32_bf16 v[56:59], a[180:183], a[24:27], v[56:59]
    ds_read_b64_tr_b16 a[134:135], v224 offset:17416
    v_mfma_f32_16x16x32_bf16 v[60:63], a[180:183], a[28:31], v[60:63]
    buffer_load_dwordx4 a[68:71], v237, s[16:19], s56 offen offset:0
    v_mfma_f32_16x16x32_bf16 v[64:67], a[184:187], a[16:19], v[64:67]
    ds_read_b64_tr_b16 a[136:137], v225 offset:16384
    v_mfma_f32_16x16x32_bf16 v[68:71], a[184:187], a[20:23], v[68:71]
    v_mfma_f32_16x16x32_bf16 v[72:75], a[184:187], a[24:27], v[72:75]
    ds_read_b64_tr_b16 a[138:139], v225 offset:17408
    v_mfma_f32_16x16x32_bf16 v[76:79], a[184:187], a[28:31], v[76:79]
    v_mfma_f32_16x16x32_bf16 v[80:83], a[188:191], a[16:19], v[80:83]
    ds_read_b64_tr_b16 a[140:141], v225 offset:16392
    v_mfma_f32_16x16x32_bf16 v[84:87], a[188:191], a[20:23], v[84:87]
    buffer_load_dwordx4 a[72:75], v238, s[16:19], s56 offen offset:0
    v_mfma_f32_16x16x32_bf16 v[88:91], a[188:191], a[24:27], v[88:91]
    ds_read_b64_tr_b16 a[142:143], v225 offset:17416
    v_mfma_f32_16x16x32_bf16 v[92:95], a[188:191], a[28:31], v[92:95]
    v_mfma_f32_16x16x32_bf16 v[96:99], a[192:195], a[16:19], v[96:99]
    ds_read_b64_tr_b16 a[144:145], v226 offset:16384
    v_mfma_f32_16x16x32_bf16 v[100:103], a[192:195], a[20:23], v[100:103]
    v_mfma_f32_16x16x32_bf16 v[104:107], a[192:195], a[24:27], v[104:107]
    ds_read_b64_tr_b16 a[146:147], v226 offset:17408
    v_mfma_f32_16x16x32_bf16 v[108:111], a[192:195], a[28:31], v[108:111]
    buffer_load_dwordx4 a[76:79], v239, s[16:19], s56 offen offset:0
    v_mfma_f32_16x16x32_bf16 v[112:115], a[196:199], a[16:19], v[112:115]
    ds_read_b64_tr_b16 a[148:149], v226 offset:16392
    v_mfma_f32_16x16x32_bf16 v[116:119], a[196:199], a[20:23], v[116:119]
    v_mfma_f32_16x16x32_bf16 v[120:123], a[196:199], a[24:27], v[120:123]
    ds_read_b64_tr_b16 a[150:151], v226 offset:17416
    v_mfma_f32_16x16x32_bf16 v[124:127], a[196:199], a[28:31], v[124:127]
    v_mfma_f32_16x16x32_bf16 v[128:131], a[200:203], a[16:19], v[128:131]
    ds_read_b64_tr_b16 a[152:153], v227 offset:16384
    v_mfma_f32_16x16x32_bf16 v[132:135], a[200:203], a[20:23], v[132:135]
    buffer_load_dwordx4 a[80:83], v236, s[16:19], s56 offen offset:1024
    v_mfma_f32_16x16x32_bf16 v[136:139], a[200:203], a[24:27], v[136:139]
    ds_read_b64_tr_b16 a[154:155], v227 offset:17408
    v_mfma_f32_16x16x32_bf16 v[140:143], a[200:203], a[28:31], v[140:143]
    v_mfma_f32_16x16x32_bf16 v[144:147], a[204:207], a[16:19], v[144:147]
    ds_read_b64_tr_b16 a[156:157], v227 offset:16392
    v_mfma_f32_16x16x32_bf16 v[148:151], a[204:207], a[20:23], v[148:151]
    v_mfma_f32_16x16x32_bf16 v[152:155], a[204:207], a[24:27], v[152:155]
    ds_read_b64_tr_b16 a[158:159], v227 offset:17416
    v_mfma_f32_16x16x32_bf16 v[156:159], a[204:207], a[28:31], v[156:159]
    buffer_load_dwordx4 a[84:87], v237, s[16:19], s56 offen offset:1024
    v_mfma_f32_16x16x32_bf16 a[96:99], a[208:211], a[16:19], a[96:99]
    ds_read_b64_tr_b16 a[160:161], v228 offset:16384
    v_mfma_f32_16x16x32_bf16 a[100:103], a[208:211], a[20:23], a[100:103]
    v_mfma_f32_16x16x32_bf16 a[104:107], a[208:211], a[24:27], a[104:107]
    ds_read_b64_tr_b16 a[162:163], v228 offset:16896
    v_mfma_f32_16x16x32_bf16 a[108:111], a[208:211], a[28:31], a[108:111]
    v_mfma_f32_16x16x32_bf16 a[112:115], a[212:215], a[16:19], a[112:115]
    ds_read_b64_tr_b16 a[164:165], v229 offset:16384
    v_mfma_f32_16x16x32_bf16 a[116:119], a[212:215], a[20:23], a[116:119]
    buffer_load_dwordx4 a[88:91], v238, s[16:19], s56 offen offset:1024
    v_mfma_f32_16x16x32_bf16 a[120:123], a[212:215], a[24:27], a[120:123]
    ds_read_b64_tr_b16 a[166:167], v229 offset:16896
    v_mfma_f32_16x16x32_bf16 a[124:127], a[212:215], a[28:31], a[124:127]
    s_waitcnt lgkmcnt(6)
    v_mfma_f32_16x16x32_bf16 a[224:227], a[216:219], a[16:19], a[224:227]
    ds_read_b64_tr_b16 a[168:169], v230 offset:16384
    v_mfma_f32_16x16x32_bf16 a[228:231], a[216:219], a[20:23], a[228:231]
    v_mfma_f32_16x16x32_bf16 a[232:235], a[216:219], a[24:27], a[232:235]
    ds_read_b64_tr_b16 a[170:171], v230 offset:16896
    v_mfma_f32_16x16x32_bf16 a[236:239], a[216:219], a[28:31], a[236:239]
    buffer_load_dwordx4 a[92:95], v239, s[16:19], s56 offen offset:1024
    v_mfma_f32_16x16x32_bf16 a[240:243], a[220:223], a[16:19], a[240:243]
    ds_read_b64_tr_b16 a[172:173], v231 offset:16384
    v_mfma_f32_16x16x32_bf16 a[244:247], a[220:223], a[20:23], a[244:247]
    v_mfma_f32_16x16x32_bf16 a[248:251], a[220:223], a[24:27], a[248:251]
    ds_read_b64_tr_b16 a[174:175], v231 offset:16896
    v_mfma_f32_16x16x32_bf16 a[252:255], a[220:223], a[28:31], a[252:255]
    s_waitcnt vmcnt(14)
    v_mfma_f32_16x16x32_bf16 v[32:35], a[128:131], a[32:35], v[32:35]
    ds_read_b64_tr_b16 a[176:177], v224 offset:24576
    v_mfma_f32_16x16x32_bf16 v[36:39], a[128:131], a[36:39], v[36:39]
    s_add_u32 m0, s53, 114688
    s_mov_b32 s55, 1572864
    buffer_load_dwordx4 v232, s[20:23], s55 offen lds
    v_mfma_f32_16x16x32_bf16 v[40:43], a[128:131], a[40:43], v[40:43]
    ds_read_b64_tr_b16 a[178:179], v224 offset:25600
    v_mfma_f32_16x16x32_bf16 v[44:47], a[128:131], a[44:47], v[44:47]
    v_mfma_f32_16x16x32_bf16 v[48:51], a[132:135], a[32:35], v[48:51]
    ds_read_b64_tr_b16 a[180:181], v224 offset:24584
    v_mfma_f32_16x16x32_bf16 v[52:55], a[132:135], a[36:39], v[52:55]
    v_mfma_f32_16x16x32_bf16 v[56:59], a[132:135], a[40:43], v[56:59]
    ds_read_b64_tr_b16 a[182:183], v224 offset:25608
    v_mfma_f32_16x16x32_bf16 v[60:63], a[132:135], a[44:47], v[60:63]
    s_add_u32 m0, s53, 115712
    s_mov_b32 s55, 1605632
    buffer_load_dwordx4 v232, s[20:23], s55 offen lds
    v_mfma_f32_16x16x32_bf16 v[64:67], a[136:139], a[32:35], v[64:67]
    ds_read_b64_tr_b16 a[184:185], v225 offset:24576
    v_mfma_f32_16x16x32_bf16 v[68:71], a[136:139], a[36:39], v[68:71]
    v_mfma_f32_16x16x32_bf16 v[72:75], a[136:139], a[40:43], v[72:75]
    ds_read_b64_tr_b16 a[186:187], v225 offset:25600
    v_mfma_f32_16x16x32_bf16 v[76:79], a[136:139], a[44:47], v[76:79]
    v_mfma_f32_16x16x32_bf16 v[80:83], a[140:143], a[32:35], v[80:83]
    ds_read_b64_tr_b16 a[188:189], v225 offset:24584
    v_mfma_f32_16x16x32_bf16 v[84:87], a[140:143], a[36:39], v[84:87]
    s_add_u32 m0, s53, 116736
    s_mov_b32 s55, 1638400
    buffer_load_dwordx4 v232, s[20:23], s55 offen lds
    v_mfma_f32_16x16x32_bf16 v[88:91], a[140:143], a[40:43], v[88:91]
    ds_read_b64_tr_b16 a[190:191], v225 offset:25608
    v_mfma_f32_16x16x32_bf16 v[92:95], a[140:143], a[44:47], v[92:95]
    v_mfma_f32_16x16x32_bf16 v[96:99], a[144:147], a[32:35], v[96:99]
    ds_read_b64_tr_b16 a[192:193], v226 offset:24576
    v_mfma_f32_16x16x32_bf16 v[100:103], a[144:147], a[36:39], v[100:103]
    v_mfma_f32_16x16x32_bf16 v[104:107], a[144:147], a[40:43], v[104:107]
    ds_read_b64_tr_b16 a[194:195], v226 offset:25600
    v_mfma_f32_16x16x32_bf16 v[108:111], a[144:147], a[44:47], v[108:111]
    s_add_u32 m0, s53, 117760
    s_mov_b32 s55, 1671168
    buffer_load_dwordx4 v232, s[20:23], s55 offen lds
    v_mfma_f32_16x16x32_bf16 v[112:115], a[148:151], a[32:35], v[112:115]
    ds_read_b64_tr_b16 a[196:197], v226 offset:24584
    v_mfma_f32_16x16x32_bf16 v[116:119], a[148:151], a[36:39], v[116:119]
    v_mfma_f32_16x16x32_bf16 v[120:123], a[148:151], a[40:43], v[120:123]
    ds_read_b64_tr_b16 a[198:199], v226 offset:25608
    v_mfma_f32_16x16x32_bf16 v[124:127], a[148:151], a[44:47], v[124:127]
    v_mfma_f32_16x16x32_bf16 v[128:131], a[152:155], a[32:35], v[128:131]
    ds_read_b64_tr_b16 a[200:201], v227 offset:24576
    v_mfma_f32_16x16x32_bf16 v[132:135], a[152:155], a[36:39], v[132:135]
    s_add_u32 m0, s54, 49152
    s_mov_b32 s55, 663552
    buffer_load_dwordx4 v233, s[24:27], s55 offen lds
    v_mfma_f32_16x16x32_bf16 v[136:139], a[152:155], a[40:43], v[136:139]
    ds_read_b64_tr_b16 a[202:203], v227 offset:25600
    v_mfma_f32_16x16x32_bf16 v[140:143], a[152:155], a[44:47], v[140:143]
    s_waitcnt lgkmcnt(4)
    v_mfma_f32_16x16x32_bf16 v[144:147], a[156:159], a[32:35], v[144:147]
    ds_read_b64_tr_b16 a[204:205], v227 offset:24584
    v_mfma_f32_16x16x32_bf16 v[148:151], a[156:159], a[36:39], v[148:151]
    v_mfma_f32_16x16x32_bf16 v[152:155], a[156:159], a[40:43], v[152:155]
    ds_read_b64_tr_b16 a[206:207], v227 offset:25608
    v_mfma_f32_16x16x32_bf16 v[156:159], a[156:159], a[44:47], v[156:159]
    s_add_u32 m0, s54, 50176
    s_mov_b32 s55, 691200
    buffer_load_dwordx4 v234, s[24:27], s55 offen lds
    v_mfma_f32_16x16x32_bf16 a[96:99], a[160:163], a[32:35], a[96:99]
    ds_read_b64_tr_b16 a[208:209], v228 offset:20480
    v_mfma_f32_16x16x32_bf16 a[100:103], a[160:163], a[36:39], a[100:103]
    v_mfma_f32_16x16x32_bf16 a[104:107], a[160:163], a[40:43], a[104:107]
    ds_read_b64_tr_b16 a[210:211], v228 offset:20992
    v_mfma_f32_16x16x32_bf16 a[108:111], a[160:163], a[44:47], a[108:111]
    v_mfma_f32_16x16x32_bf16 a[112:115], a[164:167], a[32:35], a[112:115]
    ds_read_b64_tr_b16 a[212:213], v229 offset:20480
    v_mfma_f32_16x16x32_bf16 a[116:119], a[164:167], a[36:39], a[116:119]
    v_mfma_f32_16x16x32_bf16 a[120:123], a[164:167], a[40:43], a[120:123]
    ds_read_b64_tr_b16 a[214:215], v229 offset:20992
    v_mfma_f32_16x16x32_bf16 a[124:127], a[164:167], a[44:47], a[124:127]
    v_mfma_f32_16x16x32_bf16 a[224:227], a[168:171], a[32:35], a[224:227]
    ds_read_b64_tr_b16 a[216:217], v230 offset:20480
    v_mfma_f32_16x16x32_bf16 a[228:231], a[168:171], a[36:39], a[228:231]
    v_mfma_f32_16x16x32_bf16 a[232:235], a[168:171], a[40:43], a[232:235]
    ds_read_b64_tr_b16 a[218:219], v230 offset:20992
    v_mfma_f32_16x16x32_bf16 a[236:239], a[168:171], a[44:47], a[236:239]
    v_mfma_f32_16x16x32_bf16 a[240:243], a[172:175], a[32:35], a[240:243]
    ds_read_b64_tr_b16 a[220:221], v231 offset:20480
    v_mfma_f32_16x16x32_bf16 a[244:247], a[172:175], a[36:39], a[244:247]
    v_mfma_f32_16x16x32_bf16 a[248:251], a[172:175], a[40:43], a[248:251]
    ds_read_b64_tr_b16 a[222:223], v231 offset:20992
    v_mfma_f32_16x16x32_bf16 a[252:255], a[172:175], a[44:47], a[252:255]
    s_waitcnt vmcnt(14)
    s_barrier
    v_mfma_f32_16x16x32_bf16 v[32:35], a[176:179], a[48:51], v[32:35]
    ds_read_b64_tr_b16 a[128:129], v224 offset:32768
    v_mfma_f32_16x16x32_bf16 v[36:39], a[176:179], a[52:55], v[36:39]
    s_add_u32 s56, s50, 6144
    buffer_load_dwordx4 a[0:3], v236, s[16:19], s56 offen offset:0
    v_mfma_f32_16x16x32_bf16 v[40:43], a[176:179], a[56:59], v[40:43]
    ds_read_b64_tr_b16 a[130:131], v224 offset:33792
    v_mfma_f32_16x16x32_bf16 v[44:47], a[176:179], a[60:63], v[44:47]
    v_mfma_f32_16x16x32_bf16 v[48:51], a[180:183], a[48:51], v[48:51]
    ds_read_b64_tr_b16 a[132:133], v224 offset:32776
    v_mfma_f32_16x16x32_bf16 v[52:55], a[180:183], a[52:55], v[52:55]
    v_mfma_f32_16x16x32_bf16 v[56:59], a[180:183], a[56:59], v[56:59]
    ds_read_b64_tr_b16 a[134:135], v224 offset:33800
    v_mfma_f32_16x16x32_bf16 v[60:63], a[180:183], a[60:63], v[60:63]
    buffer_load_dwordx4 a[4:7], v237, s[16:19], s56 offen offset:0
    v_mfma_f32_16x16x32_bf16 v[64:67], a[184:187], a[48:51], v[64:67]
    ds_read_b64_tr_b16 a[136:137], v225 offset:32768
    v_mfma_f32_16x16x32_bf16 v[68:71], a[184:187], a[52:55], v[68:71]
    v_mfma_f32_16x16x32_bf16 v[72:75], a[184:187], a[56:59], v[72:75]
    ds_read_b64_tr_b16 a[138:139], v225 offset:33792
    v_mfma_f32_16x16x32_bf16 v[76:79], a[184:187], a[60:63], v[76:79]
    v_mfma_f32_16x16x32_bf16 v[80:83], a[188:191], a[48:51], v[80:83]
    ds_read_b64_tr_b16 a[140:141], v225 offset:32776
    v_mfma_f32_16x16x32_bf16 v[84:87], a[188:191], a[52:55], v[84:87]
    buffer_load_dwordx4 a[8:11], v238, s[16:19], s56 offen offset:0
    v_mfma_f32_16x16x32_bf16 v[88:91], a[188:191], a[56:59], v[88:91]
    ds_read_b64_tr_b16 a[142:143], v225 offset:33800
    v_mfma_f32_16x16x32_bf16 v[92:95], a[188:191], a[60:63], v[92:95]
    v_mfma_f32_16x16x32_bf16 v[96:99], a[192:195], a[48:51], v[96:99]
    ds_read_b64_tr_b16 a[144:145], v226 offset:32768
    v_mfma_f32_16x16x32_bf16 v[100:103], a[192:195], a[52:55], v[100:103]
    v_mfma_f32_16x16x32_bf16 v[104:107], a[192:195], a[56:59], v[104:107]
    ds_read_b64_tr_b16 a[146:147], v226 offset:33792
    v_mfma_f32_16x16x32_bf16 v[108:111], a[192:195], a[60:63], v[108:111]
    buffer_load_dwordx4 a[12:15], v239, s[16:19], s56 offen offset:0
    s_waitcnt lgkmcnt(6)
    v_mfma_f32_16x16x32_bf16 v[112:115], a[196:199], a[48:51], v[112:115]
    ds_read_b64_tr_b16 a[148:149], v226 offset:32776
    v_mfma_f32_16x16x32_bf16 v[116:119], a[196:199], a[52:55], v[116:119]
    v_mfma_f32_16x16x32_bf16 v[120:123], a[196:199], a[56:59], v[120:123]
    ds_read_b64_tr_b16 a[150:151], v226 offset:33800
    v_mfma_f32_16x16x32_bf16 v[124:127], a[196:199], a[60:63], v[124:127]
    v_mfma_f32_16x16x32_bf16 v[128:131], a[200:203], a[48:51], v[128:131]
    ds_read_b64_tr_b16 a[152:153], v227 offset:32768
    v_mfma_f32_16x16x32_bf16 v[132:135], a[200:203], a[52:55], v[132:135]
    buffer_load_dwordx4 a[16:19], v236, s[16:19], s56 offen offset:1024
    v_mfma_f32_16x16x32_bf16 v[136:139], a[200:203], a[56:59], v[136:139]
    ds_read_b64_tr_b16 a[154:155], v227 offset:33792
    v_mfma_f32_16x16x32_bf16 v[140:143], a[200:203], a[60:63], v[140:143]
    v_mfma_f32_16x16x32_bf16 v[144:147], a[204:207], a[48:51], v[144:147]
    ds_read_b64_tr_b16 a[156:157], v227 offset:32776
    v_mfma_f32_16x16x32_bf16 v[148:151], a[204:207], a[52:55], v[148:151]
    v_mfma_f32_16x16x32_bf16 v[152:155], a[204:207], a[56:59], v[152:155]
    ds_read_b64_tr_b16 a[158:159], v227 offset:33800
    v_mfma_f32_16x16x32_bf16 v[156:159], a[204:207], a[60:63], v[156:159]
    buffer_load_dwordx4 a[20:23], v237, s[16:19], s56 offen offset:1024
    v_mfma_f32_16x16x32_bf16 a[96:99], a[208:211], a[48:51], a[96:99]
    ds_read_b64_tr_b16 a[160:161], v228 offset:32768
    v_mfma_f32_16x16x32_bf16 a[100:103], a[208:211], a[52:55], a[100:103]
    v_mfma_f32_16x16x32_bf16 a[104:107], a[208:211], a[56:59], a[104:107]
    ds_read_b64_tr_b16 a[162:163], v228 offset:33280
    v_mfma_f32_16x16x32_bf16 a[108:111], a[208:211], a[60:63], a[108:111]
    v_mfma_f32_16x16x32_bf16 a[112:115], a[212:215], a[48:51], a[112:115]
    ds_read_b64_tr_b16 a[164:165], v229 offset:32768
    v_mfma_f32_16x16x32_bf16 a[116:119], a[212:215], a[52:55], a[116:119]
    buffer_load_dwordx4 a[24:27], v238, s[16:19], s56 offen offset:1024
    v_mfma_f32_16x16x32_bf16 a[120:123], a[212:215], a[56:59], a[120:123]
    ds_read_b64_tr_b16 a[166:167], v229 offset:33280
    v_mfma_f32_16x16x32_bf16 a[124:127], a[212:215], a[60:63], a[124:127]
    v_mfma_f32_16x16x32_bf16 a[224:227], a[216:219], a[48:51], a[224:227]
    ds_read_b64_tr_b16 a[168:169], v230 offset:32768
    v_mfma_f32_16x16x32_bf16 a[228:231], a[216:219], a[52:55], a[228:231]
    v_mfma_f32_16x16x32_bf16 a[232:235], a[216:219], a[56:59], a[232:235]
    ds_read_b64_tr_b16 a[170:171], v230 offset:33280
    v_mfma_f32_16x16x32_bf16 a[236:239], a[216:219], a[60:63], a[236:239]
    buffer_load_dwordx4 a[28:31], v239, s[16:19], s56 offen offset:1024
    v_mfma_f32_16x16x32_bf16 a[240:243], a[220:223], a[48:51], a[240:243]
    ds_read_b64_tr_b16 a[172:173], v231 offset:32768
    v_mfma_f32_16x16x32_bf16 a[244:247], a[220:223], a[52:55], a[244:247]
    v_mfma_f32_16x16x32_bf16 a[248:251], a[220:223], a[56:59], a[248:251]
    ds_read_b64_tr_b16 a[174:175], v231 offset:33280
    v_mfma_f32_16x16x32_bf16 a[252:255], a[220:223], a[60:63], a[252:255]
    s_waitcnt vmcnt(14)
    v_mfma_f32_16x16x32_bf16 v[32:35], a[128:131], a[64:67], v[32:35]
    ds_read_b64_tr_b16 a[176:177], v224 offset:40960
    v_mfma_f32_16x16x32_bf16 v[36:39], a[128:131], a[68:71], v[36:39]
    s_add_u32 m0, s53, 65536
    s_mov_b32 s55, 2097152
    buffer_load_dwordx4 v232, s[20:23], s55 offen lds
    v_mfma_f32_16x16x32_bf16 v[40:43], a[128:131], a[72:75], v[40:43]
    ds_read_b64_tr_b16 a[178:179], v224 offset:41984
    v_mfma_f32_16x16x32_bf16 v[44:47], a[128:131], a[76:79], v[44:47]
    v_mfma_f32_16x16x32_bf16 v[48:51], a[132:135], a[64:67], v[48:51]
    ds_read_b64_tr_b16 a[180:181], v224 offset:40968
    v_mfma_f32_16x16x32_bf16 v[52:55], a[132:135], a[68:71], v[52:55]
    v_mfma_f32_16x16x32_bf16 v[56:59], a[132:135], a[72:75], v[56:59]
    ds_read_b64_tr_b16 a[182:183], v224 offset:41992
    v_mfma_f32_16x16x32_bf16 v[60:63], a[132:135], a[76:79], v[60:63]
    s_add_u32 m0, s53, 66560
    s_mov_b32 s55, 2129920
    buffer_load_dwordx4 v232, s[20:23], s55 offen lds
    s_waitcnt lgkmcnt(4)
    v_mfma_f32_16x16x32_bf16 v[64:67], a[136:139], a[64:67], v[64:67]
    ds_read_b64_tr_b16 a[184:185], v225 offset:40960
    v_mfma_f32_16x16x32_bf16 v[68:71], a[136:139], a[68:71], v[68:71]
    v_mfma_f32_16x16x32_bf16 v[72:75], a[136:139], a[72:75], v[72:75]
    ds_read_b64_tr_b16 a[186:187], v225 offset:41984
    v_mfma_f32_16x16x32_bf16 v[76:79], a[136:139], a[76:79], v[76:79]
    v_mfma_f32_16x16x32_bf16 v[80:83], a[140:143], a[64:67], v[80:83]
    ds_read_b64_tr_b16 a[188:189], v225 offset:40968
    v_mfma_f32_16x16x32_bf16 v[84:87], a[140:143], a[68:71], v[84:87]
    s_add_u32 m0, s53, 67584
    s_mov_b32 s55, 2162688
    buffer_load_dwordx4 v232, s[20:23], s55 offen lds
    v_mfma_f32_16x16x32_bf16 v[88:91], a[140:143], a[72:75], v[88:91]
    ds_read_b64_tr_b16 a[190:191], v225 offset:41992
    v_mfma_f32_16x16x32_bf16 v[92:95], a[140:143], a[76:79], v[92:95]
    v_mfma_f32_16x16x32_bf16 v[96:99], a[144:147], a[64:67], v[96:99]
    ds_read_b64_tr_b16 a[192:193], v226 offset:40960
    v_mfma_f32_16x16x32_bf16 v[100:103], a[144:147], a[68:71], v[100:103]
    v_mfma_f32_16x16x32_bf16 v[104:107], a[144:147], a[72:75], v[104:107]
    ds_read_b64_tr_b16 a[194:195], v226 offset:41984
    v_mfma_f32_16x16x32_bf16 v[108:111], a[144:147], a[76:79], v[108:111]
    s_add_u32 m0, s53, 68608
    s_mov_b32 s55, 2195456
    buffer_load_dwordx4 v232, s[20:23], s55 offen lds
    v_mfma_f32_16x16x32_bf16 v[112:115], a[148:151], a[64:67], v[112:115]
    ds_read_b64_tr_b16 a[196:197], v226 offset:40968
    v_mfma_f32_16x16x32_bf16 v[116:119], a[148:151], a[68:71], v[116:119]
    v_mfma_f32_16x16x32_bf16 v[120:123], a[148:151], a[72:75], v[120:123]
    ds_read_b64_tr_b16 a[198:199], v226 offset:41992
    v_mfma_f32_16x16x32_bf16 v[124:127], a[148:151], a[76:79], v[124:127]
    v_mfma_f32_16x16x32_bf16 v[128:131], a[152:155], a[64:67], v[128:131]
    ds_read_b64_tr_b16 a[200:201], v227 offset:40960
    v_mfma_f32_16x16x32_bf16 v[132:135], a[152:155], a[68:71], v[132:135]
    s_add_u32 m0, s54, 0
    s_mov_b32 s55, 884736
    buffer_load_dwordx4 v233, s[24:27], s55 offen lds
    v_mfma_f32_16x16x32_bf16 v[136:139], a[152:155], a[72:75], v[136:139]
    ds_read_b64_tr_b16 a[202:203], v227 offset:41984
    v_mfma_f32_16x16x32_bf16 v[140:143], a[152:155], a[76:79], v[140:143]
    v_mfma_f32_16x16x32_bf16 v[144:147], a[156:159], a[64:67], v[144:147]
    ds_read_b64_tr_b16 a[204:205], v227 offset:40968
    v_mfma_f32_16x16x32_bf16 v[148:151], a[156:159], a[68:71], v[148:151]
    v_mfma_f32_16x16x32_bf16 v[152:155], a[156:159], a[72:75], v[152:155]
    ds_read_b64_tr_b16 a[206:207], v227 offset:41992
    v_mfma_f32_16x16x32_bf16 v[156:159], a[156:159], a[76:79], v[156:159]
    s_add_u32 m0, s54, 1024
    s_mov_b32 s55, 912384
    buffer_load_dwordx4 v234, s[24:27], s55 offen lds
    v_mfma_f32_16x16x32_bf16 a[96:99], a[160:163], a[64:67], a[96:99]
    ds_read_b64_tr_b16 a[208:209], v228 offset:36864
    v_mfma_f32_16x16x32_bf16 a[100:103], a[160:163], a[68:71], a[100:103]
    v_mfma_f32_16x16x32_bf16 a[104:107], a[160:163], a[72:75], a[104:107]
    ds_read_b64_tr_b16 a[210:211], v228 offset:37376
    v_mfma_f32_16x16x32_bf16 a[108:111], a[160:163], a[76:79], a[108:111]
    v_mfma_f32_16x16x32_bf16 a[112:115], a[164:167], a[64:67], a[112:115]
    ds_read_b64_tr_b16 a[212:213], v229 offset:36864
    v_mfma_f32_16x16x32_bf16 a[116:119], a[164:167], a[68:71], a[116:119]
    v_mfma_f32_16x16x32_bf16 a[120:123], a[164:167], a[72:75], a[120:123]
    ds_read_b64_tr_b16 a[214:215], v229 offset:37376
    v_mfma_f32_16x16x32_bf16 a[124:127], a[164:167], a[76:79], a[124:127]
    v_mfma_f32_16x16x32_bf16 a[224:227], a[168:171], a[64:67], a[224:227]
    ds_read_b64_tr_b16 a[216:217], v230 offset:36864
    v_mfma_f32_16x16x32_bf16 a[228:231], a[168:171], a[68:71], a[228:231]
    v_mfma_f32_16x16x32_bf16 a[232:235], a[168:171], a[72:75], a[232:235]
    ds_read_b64_tr_b16 a[218:219], v230 offset:37376
    v_mfma_f32_16x16x32_bf16 a[236:239], a[168:171], a[76:79], a[236:239]
    v_mfma_f32_16x16x32_bf16 a[240:243], a[172:175], a[64:67], a[240:243]
    ds_read_b64_tr_b16 a[220:221], v231 offset:36864
    v_mfma_f32_16x16x32_bf16 a[244:247], a[172:175], a[68:71], a[244:247]
    v_mfma_f32_16x16x32_bf16 a[248:251], a[172:175], a[72:75], a[248:251]
    ds_read_b64_tr_b16 a[222:223], v231 offset:37376
    v_mfma_f32_16x16x32_bf16 a[252:255], a[172:175], a[76:79], a[252:255]
    s_waitcnt vmcnt(14)
    s_barrier
    s_waitcnt lgkmcnt(6)
    v_mfma_f32_16x16x32_bf16 v[32:35], a[176:179], a[80:83], v[32:35]
    ds_read_b64_tr_b16 a[128:129], v224 offset:49152
    v_mfma_f32_16x16x32_bf16 v[36:39], a[176:179], a[84:87], v[36:39]
    s_add_u32 s56, s50, 8192
    buffer_load_dwordx4 a[32:35], v236, s[16:19], s56 offen offset:0
    v_mfma_f32_16x16x32_bf16 v[40:43], a[176:179], a[88:91], v[40:43]
    ds_read_b64_tr_b16 a[130:131], v224 offset:50176
    v_mfma_f32_16x16x32_bf16 v[44:47], a[176:179], a[92:95], v[44:47]
    v_mfma_f32_16x16x32_bf16 v[48:51], a[180:183], a[80:83], v[48:51]
    ds_read_b64_tr_b16 a[132:133], v224 offset:49160
    v_mfma_f32_16x16x32_bf16 v[52:55], a[180:183], a[84:87], v[52:55]
    v_mfma_f32_16x16x32_bf16 v[56:59], a[180:183], a[88:91], v[56:59]
    ds_read_b64_tr_b16 a[134:135], v224 offset:50184
    v_mfma_f32_16x16x32_bf16 v[60:63], a[180:183], a[92:95], v[60:63]
    buffer_load_dwordx4 a[36:39], v237, s[16:19], s56 offen offset:0
    v_mfma_f32_16x16x32_bf16 v[64:67], a[184:187], a[80:83], v[64:67]
    ds_read_b64_tr_b16 a[136:137], v225 offset:49152
    v_mfma_f32_16x16x32_bf16 v[68:71], a[184:187], a[84:87], v[68:71]
    v_mfma_f32_16x16x32_bf16 v[72:75], a[184:187], a[88:91], v[72:75]
    ds_read_b64_tr_b16 a[138:139], v225 offset:50176
    v_mfma_f32_16x16x32_bf16 v[76:79], a[184:187], a[92:95], v[76:79]
    v_mfma_f32_16x16x32_bf16 v[80:83], a[188:191], a[80:83], v[80:83]
    ds_read_b64_tr_b16 a[140:141], v225 offset:49160
    v_mfma_f32_16x16x32_bf16 v[84:87], a[188:191], a[84:87], v[84:87]
    buffer_load_dwordx4 a[40:43], v238, s[16:19], s56 offen offset:0
    v_mfma_f32_16x16x32_bf16 v[88:91], a[188:191], a[88:91], v[88:91]
    ds_read_b64_tr_b16 a[142:143], v225 offset:50184
    v_mfma_f32_16x16x32_bf16 v[92:95], a[188:191], a[92:95], v[92:95]
    v_mfma_f32_16x16x32_bf16 v[96:99], a[192:195], a[80:83], v[96:99]
    ds_read_b64_tr_b16 a[144:145], v226 offset:49152
    v_mfma_f32_16x16x32_bf16 v[100:103], a[192:195], a[84:87], v[100:103]
    v_mfma_f32_16x16x32_bf16 v[104:107], a[192:195], a[88:91], v[104:107]
    ds_read_b64_tr_b16 a[146:147], v226 offset:50176
    v_mfma_f32_16x16x32_bf16 v[108:111], a[192:195], a[92:95], v[108:111]
    buffer_load_dwordx4 a[44:47], v239, s[16:19], s56 offen offset:0
    v_mfma_f32_16x16x32_bf16 v[112:115], a[196:199], a[80:83], v[112:115]
    ds_read_b64_tr_b16 a[148:149], v226 offset:49160
    v_mfma_f32_16x16x32_bf16 v[116:119], a[196:199], a[84:87], v[116:119]
    v_mfma_f32_16x16x32_bf16 v[120:123], a[196:199], a[88:91], v[120:123]
    ds_read_b64_tr_b16 a[150:151], v226 offset:50184
    v_mfma_f32_16x16x32_bf16 v[124:127], a[196:199], a[92:95], v[124:127]
    v_mfma_f32_16x16x32_bf16 v[128:131], a[200:203], a[80:83], v[128:131]
    ds_read_b64_tr_b16 a[152:153], v227 offset:49152
    v_mfma_f32_16x16x32_bf16 v[132:135], a[200:203], a[84:87], v[132:135]
    buffer_load_dwordx4 a[48:51], v236, s[16:19], s56 offen offset:1024
    v_mfma_f32_16x16x32_bf16 v[136:139], a[200:203], a[88:91], v[136:139]
    ds_read_b64_tr_b16 a[154:155], v227 offset:50176
    v_mfma_f32_16x16x32_bf16 v[140:143], a[200:203], a[92:95], v[140:143]
    v_mfma_f32_16x16x32_bf16 v[144:147], a[204:207], a[80:83], v[144:147]
    ds_read_b64_tr_b16 a[156:157], v227 offset:49160
    v_mfma_f32_16x16x32_bf16 v[148:151], a[204:207], a[84:87], v[148:151]
    v_mfma_f32_16x16x32_bf16 v[152:155], a[204:207], a[88:91], v[152:155]
    ds_read_b64_tr_b16 a[158:159], v227 offset:50184
    v_mfma_f32_16x16x32_bf16 v[156:159], a[204:207], a[92:95], v[156:159]
    buffer_load_dwordx4 a[52:55], v237, s[16:19], s56 offen offset:1024
    v_mfma_f32_16x16x32_bf16 a[96:99], a[208:211], a[80:83], a[96:99]
    ds_read_b64_tr_b16 a[160:161], v228 offset:49152
    v_mfma_f32_16x16x32_bf16 a[100:103], a[208:211], a[84:87], a[100:103]
    v_mfma_f32_16x16x32_bf16 a[104:107], a[208:211], a[88:91], a[104:107]
    ds_read_b64_tr_b16 a[162:163], v228 offset:49664
    v_mfma_f32_16x16x32_bf16 a[108:111], a[208:211], a[92:95], a[108:111]
    s_waitcnt lgkmcnt(6)
    v_mfma_f32_16x16x32_bf16 a[112:115], a[212:215], a[80:83], a[112:115]
    ds_read_b64_tr_b16 a[164:165], v229 offset:49152
    v_mfma_f32_16x16x32_bf16 a[116:119], a[212:215], a[84:87], a[116:119]
    buffer_load_dwordx4 a[56:59], v238, s[16:19], s56 offen offset:1024
    v_mfma_f32_16x16x32_bf16 a[120:123], a[212:215], a[88:91], a[120:123]
    ds_read_b64_tr_b16 a[166:167], v229 offset:49664
    v_mfma_f32_16x16x32_bf16 a[124:127], a[212:215], a[92:95], a[124:127]
    v_mfma_f32_16x16x32_bf16 a[224:227], a[216:219], a[80:83], a[224:227]
    ds_read_b64_tr_b16 a[168:169], v230 offset:49152
    v_mfma_f32_16x16x32_bf16 a[228:231], a[216:219], a[84:87], a[228:231]
    v_mfma_f32_16x16x32_bf16 a[232:235], a[216:219], a[88:91], a[232:235]
    ds_read_b64_tr_b16 a[170:171], v230 offset:49664
    v_mfma_f32_16x16x32_bf16 a[236:239], a[216:219], a[92:95], a[236:239]
    buffer_load_dwordx4 a[60:63], v239, s[16:19], s56 offen offset:1024
    v_mfma_f32_16x16x32_bf16 a[240:243], a[220:223], a[80:83], a[240:243]
    ds_read_b64_tr_b16 a[172:173], v231 offset:49152
    v_mfma_f32_16x16x32_bf16 a[244:247], a[220:223], a[84:87], a[244:247]
    v_mfma_f32_16x16x32_bf16 a[248:251], a[220:223], a[88:91], a[248:251]
    ds_read_b64_tr_b16 a[174:175], v231 offset:49664
    v_mfma_f32_16x16x32_bf16 a[252:255], a[220:223], a[92:95], a[252:255]
    s_waitcnt vmcnt(14)
    v_mfma_f32_16x16x32_bf16 v[32:35], a[128:131], a[0:3], v[32:35]
    ds_read_b64_tr_b16 a[176:177], v224 offset:57344
    v_mfma_f32_16x16x32_bf16 v[36:39], a[128:131], a[4:7], v[36:39]
    s_add_u32 m0, s53, 81920
    s_mov_b32 s55, 2621440
    buffer_load_dwordx4 v232, s[20:23], s55 offen lds
    v_mfma_f32_16x16x32_bf16 v[40:43], a[128:131], a[8:11], v[40:43]
    ds_read_b64_tr_b16 a[178:179], v224 offset:58368
    v_mfma_f32_16x16x32_bf16 v[44:47], a[128:131], a[12:15], v[44:47]
    v_mfma_f32_16x16x32_bf16 v[48:51], a[132:135], a[0:3], v[48:51]
    ds_read_b64_tr_b16 a[180:181], v224 offset:57352
    v_mfma_f32_16x16x32_bf16 v[52:55], a[132:135], a[4:7], v[52:55]
    v_mfma_f32_16x16x32_bf16 v[56:59], a[132:135], a[8:11], v[56:59]
    ds_read_b64_tr_b16 a[182:183], v224 offset:58376
    v_mfma_f32_16x16x32_bf16 v[60:63], a[132:135], a[12:15], v[60:63]
    s_add_u32 m0, s53, 82944
    s_mov_b32 s55, 2654208
    buffer_load_dwordx4 v232, s[20:23], s55 offen lds
    v_mfma_f32_16x16x32_bf16 v[64:67], a[136:139], a[0:3], v[64:67]
    ds_read_b64_tr_b16 a[184:185], v225 offset:57344
    v_mfma_f32_16x16x32_bf16 v[68:71], a[136:139], a[4:7], v[68:71]
    v_mfma_f32_16x16x32_bf16 v[72:75], a[136:139], a[8:11], v[72:75]
    ds_read_b64_tr_b16 a[186:187], v225 offset:58368
    v_mfma_f32_16x16x32_bf16 v[76:79], a[136:139], a[12:15], v[76:79]
    v_mfma_f32_16x16x32_bf16 v[80:83], a[140:143], a[0:3], v[80:83]
    ds_read_b64_tr_b16 a[188:189], v225 offset:57352
    v_mfma_f32_16x16x32_bf16 v[84:87], a[140:143], a[4:7], v[84:87]
    s_add_u32 m0, s53, 83968
    s_mov_b32 s55, 2686976
    buffer_load_dwordx4 v232, s[20:23], s55 offen lds
    v_mfma_f32_16x16x32_bf16 v[88:91], a[140:143], a[8:11], v[88:91]
    ds_read_b64_tr_b16 a[190:191], v225 offset:58376
    v_mfma_f32_16x16x32_bf16 v[92:95], a[140:143], a[12:15], v[92:95]
    v_mfma_f32_16x16x32_bf16 v[96:99], a[144:147], a[0:3], v[96:99]
    ds_read_b64_tr_b16 a[192:193], v226 offset:57344
    v_mfma_f32_16x16x32_bf16 v[100:103], a[144:147], a[4:7], v[100:103]
    v_mfma_f32_16x16x32_bf16 v[104:107], a[144:147], a[8:11], v[104:107]
    ds_read_b64_tr_b16 a[194:195], v226 offset:58368
    v_mfma_f32_16x16x32_bf16 v[108:111], a[144:147], a[12:15], v[108:111]
    s_add_u32 m0, s53, 84992
    s_mov_b32 s55, 2719744
    buffer_load_dwordx4 v232, s[20:23], s55 offen lds
    v_mfma_f32_16x16x32_bf16 v[112:115], a[148:151], a[0:3], v[112:115]
    ds_read_b64_tr_b16 a[196:197], v226 offset:57352
    v_mfma_f32_16x16x32_bf16 v[116:119], a[148:151], a[4:7], v[116:119]
    v_mfma_f32_16x16x32_bf16 v[120:123], a[148:151], a[8:11], v[120:123]
    ds_read_b64_tr_b16 a[198:199], v226 offset:58376
    v_mfma_f32_16x16x32_bf16 v[124:127], a[148:151], a[12:15], v[124:127]
    s_waitcnt lgkmcnt(5)
    v_mfma_f32_16x16x32_bf16 v[128:131], a[152:155], a[0:3], v[128:131]
    ds_read_b64_tr_b16 a[200:201], v227 offset:57344
    v_mfma_f32_16x16x32_bf16 v[132:135], a[152:155], a[4:7], v[132:135]
    s_add_u32 m0, s54, 16384
    s_mov_b32 s55, 1105920
    buffer_load_dwordx4 v233, s[24:27], s55 offen lds
    v_mfma_f32_16x16x32_bf16 v[136:139], a[152:155], a[8:11], v[136:139]
    ds_read_b64_tr_b16 a[202:203], v227 offset:58368
    v_mfma_f32_16x16x32_bf16 v[140:143], a[152:155], a[12:15], v[140:143]
    v_mfma_f32_16x16x32_bf16 v[144:147], a[156:159], a[0:3], v[144:147]
    ds_read_b64_tr_b16 a[204:205], v227 offset:57352
    v_mfma_f32_16x16x32_bf16 v[148:151], a[156:159], a[4:7], v[148:151]
    v_mfma_f32_16x16x32_bf16 v[152:155], a[156:159], a[8:11], v[152:155]
    ds_read_b64_tr_b16 a[206:207], v227 offset:58376
    v_mfma_f32_16x16x32_bf16 v[156:159], a[156:159], a[12:15], v[156:159]
    s_add_u32 m0, s54, 17408
    s_mov_b32 s55, 1133568
    buffer_load_dwordx4 v234, s[24:27], s55 offen lds
    v_mfma_f32_16x16x32_bf16 a[96:99], a[160:163], a[0:3], a[96:99]
    ds_read_b64_tr_b16 a[208:209], v228 offset:53248
    v_mfma_f32_16x16x32_bf16 a[100:103], a[160:163], a[4:7], a[100:103]
    v_mfma_f32_16x16x32_bf16 a[104:107], a[160:163], a[8:11], a[104:107]
    ds_read_b64_tr_b16 a[210:211], v228 offset:53760
    v_mfma_f32_16x16x32_bf16 a[108:111], a[160:163], a[12:15], a[108:111]
    v_mfma_f32_16x16x32_bf16 a[112:115], a[164:167], a[0:3], a[112:115]
    ds_read_b64_tr_b16 a[212:213], v229 offset:53248
    v_mfma_f32_16x16x32_bf16 a[116:119], a[164:167], a[4:7], a[116:119]
    v_mfma_f32_16x16x32_bf16 a[120:123], a[164:167], a[8:11], a[120:123]
    ds_read_b64_tr_b16 a[214:215], v229 offset:53760
    v_mfma_f32_16x16x32_bf16 a[124:127], a[164:167], a[12:15], a[124:127]
    v_mfma_f32_16x16x32_bf16 a[224:227], a[168:171], a[0:3], a[224:227]
    ds_read_b64_tr_b16 a[216:217], v230 offset:53248
    v_mfma_f32_16x16x32_bf16 a[228:231], a[168:171], a[4:7], a[228:231]
    v_mfma_f32_16x16x32_bf16 a[232:235], a[168:171], a[8:11], a[232:235]
    ds_read_b64_tr_b16 a[218:219], v230 offset:53760
    v_mfma_f32_16x16x32_bf16 a[236:239], a[168:171], a[12:15], a[236:239]
    v_mfma_f32_16x16x32_bf16 a[240:243], a[172:175], a[0:3], a[240:243]
    ds_read_b64_tr_b16 a[220:221], v231 offset:53248
    v_mfma_f32_16x16x32_bf16 a[244:247], a[172:175], a[4:7], a[244:247]
    v_mfma_f32_16x16x32_bf16 a[248:251], a[172:175], a[8:11], a[248:251]
    ds_read_b64_tr_b16 a[222:223], v231 offset:53760
    v_mfma_f32_16x16x32_bf16 a[252:255], a[172:175], a[12:15], a[252:255]
    s_waitcnt vmcnt(14)
    s_barrier
    v_mfma_f32_16x16x32_bf16 v[32:35], a[176:179], a[16:19], v[32:35]
    ds_read_b64_tr_b16 a[128:129], v224 offset:0
    v_mfma_f32_16x16x32_bf16 v[36:39], a[176:179], a[20:23], v[36:39]
    s_add_u32 s56, s50, 10240
    buffer_load_dwordx4 a[64:67], v236, s[16:19], s56 offen offset:0
    v_mfma_f32_16x16x32_bf16 v[40:43], a[176:179], a[24:27], v[40:43]
    ds_read_b64_tr_b16 a[130:131], v224 offset:1024
    v_mfma_f32_16x16x32_bf16 v[44:47], a[176:179], a[28:31], v[44:47]
    v_mfma_f32_16x16x32_bf16 v[48:51], a[180:183], a[16:19], v[48:51]
    ds_read_b64_tr_b16 a[132:133], v224 offset:8
    v_mfma_f32_16x16x32_bf16 v[52:55], a[180:183], a[20:23], v[52:55]
    v_mfma_f32_16x16x32_bf16 v[56:59], a[180:183], a[24:27], v[56:59]
    ds_read_b64_tr_b16 a[134:135], v224 offset:1032
    v_mfma_f32_16x16x32_bf16 v[60:63], a[180:183], a[28:31], v[60:63]
    buffer_load_dwordx4 a[68:71], v237, s[16:19], s56 offen offset:0
    v_mfma_f32_16x16x32_bf16 v[64:67], a[184:187], a[16:19], v[64:67]
    ds_read_b64_tr_b16 a[136:137], v225 offset:0
    v_mfma_f32_16x16x32_bf16 v[68:71], a[184:187], a[20:23], v[68:71]
    v_mfma_f32_16x16x32_bf16 v[72:75], a[184:187], a[24:27], v[72:75]
    ds_read_b64_tr_b16 a[138:139], v225 offset:1024
    v_mfma_f32_16x16x32_bf16 v[76:79], a[184:187], a[28:31], v[76:79]
    s_waitcnt lgkmcnt(5)
    v_mfma_f32_16x16x32_bf16 v[80:83], a[188:191], a[16:19], v[80:83]
    ds_read_b64_tr_b16 a[140:141], v225 offset:8
    v_mfma_f32_16x16x32_bf16 v[84:87], a[188:191], a[20:23], v[84:87]
    buffer_load_dwordx4 a[72:75], v238, s[16:19], s56 offen offset:0
    v_mfma_f32_16x16x32_bf16 v[88:91], a[188:191], a[24:27], v[88:91]
    ds_read_b64_tr_b16 a[142:143], v225 offset:1032
    v_mfma_f32_16x16x32_bf16 v[92:95], a[188:191], a[28:31], v[92:95]
    v_mfma_f32_16x16x32_bf16 v[96:99], a[192:195], a[16:19], v[96:99]
    ds_read_b64_tr_b16 a[144:145], v226 offset:0
    v_mfma_f32_16x16x32_bf16 v[100:103], a[192:195], a[20:23], v[100:103]
    v_mfma_f32_16x16x32_bf16 v[104:107], a[192:195], a[24:27], v[104:107]
    ds_read_b64_tr_b16 a[146:147], v226 offset:1024
    v_mfma_f32_16x16x32_bf16 v[108:111], a[192:195], a[28:31], v[108:111]
    buffer_load_dwordx4 a[76:79], v239, s[16:19], s56 offen offset:0
    v_mfma_f32_16x16x32_bf16 v[112:115], a[196:199], a[16:19], v[112:115]
    ds_read_b64_tr_b16 a[148:149], v226 offset:8
    v_mfma_f32_16x16x32_bf16 v[116:119], a[196:199], a[20:23], v[116:119]
    v_mfma_f32_16x16x32_bf16 v[120:123], a[196:199], a[24:27], v[120:123]
    ds_read_b64_tr_b16 a[150:151], v226 offset:1032
    v_mfma_f32_16x16x32_bf16 v[124:127], a[196:199], a[28:31], v[124:127]
    v_mfma_f32_16x16x32_bf16 v[128:131], a[200:203], a[16:19], v[128:131]
    ds_read_b64_tr_b16 a[152:153], v227 offset:0
    v_mfma_f32_16x16x32_bf16 v[132:135], a[200:203], a[20:23], v[132:135]
    buffer_load_dwordx4 a[80:83], v236, s[16:19], s56 offen offset:1024
    v_mfma_f32_16x16x32_bf16 v[136:139], a[200:203], a[24:27], v[136:139]
    ds_read_b64_tr_b16 a[154:155], v227 offset:1024
    v_mfma_f32_16x16x32_bf16 v[140:143], a[200:203], a[28:31], v[140:143]
    v_mfma_f32_16x16x32_bf16 v[144:147], a[204:207], a[16:19], v[144:147]
    ds_read_b64_tr_b16 a[156:157], v227 offset:8
    v_mfma_f32_16x16x32_bf16 v[148:151], a[204:207], a[20:23], v[148:151]
    v_mfma_f32_16x16x32_bf16 v[152:155], a[204:207], a[24:27], v[152:155]
    ds_read_b64_tr_b16 a[158:159], v227 offset:1032
    v_mfma_f32_16x16x32_bf16 v[156:159], a[204:207], a[28:31], v[156:159]
    buffer_load_dwordx4 a[84:87], v237, s[16:19], s56 offen offset:1024
    v_mfma_f32_16x16x32_bf16 a[96:99], a[208:211], a[16:19], a[96:99]
    ds_read_b64_tr_b16 a[160:161], v228 offset:0
    v_mfma_f32_16x16x32_bf16 a[100:103], a[208:211], a[20:23], a[100:103]
    v_mfma_f32_16x16x32_bf16 a[104:107], a[208:211], a[24:27], a[104:107]
    ds_read_b64_tr_b16 a[162:163], v228 offset:512
    v_mfma_f32_16x16x32_bf16 a[108:111], a[208:211], a[28:31], a[108:111]
    v_mfma_f32_16x16x32_bf16 a[112:115], a[212:215], a[16:19], a[112:115]
    ds_read_b64_tr_b16 a[164:165], v229 offset:0
    v_mfma_f32_16x16x32_bf16 a[116:119], a[212:215], a[20:23], a[116:119]
    buffer_load_dwordx4 a[88:91], v238, s[16:19], s56 offen offset:1024
    v_mfma_f32_16x16x32_bf16 a[120:123], a[212:215], a[24:27], a[120:123]
    ds_read_b64_tr_b16 a[166:167], v229 offset:512
    v_mfma_f32_16x16x32_bf16 a[124:127], a[212:215], a[28:31], a[124:127]
    v_mfma_f32_16x16x32_bf16 a[224:227], a[216:219], a[16:19], a[224:227]
    ds_read_b64_tr_b16 a[168:169], v230 offset:0
    v_mfma_f32_16x16x32_bf16 a[228:231], a[216:219], a[20:23], a[228:231]
    v_mfma_f32_16x16x32_bf16 a[232:235], a[216:219], a[24:27], a[232:235]
    ds_read_b64_tr_b16 a[170:171], v230 offset:512
    v_mfma_f32_16x16x32_bf16 a[236:239], a[216:219], a[28:31], a[236:239]
    buffer_load_dwordx4 a[92:95], v239, s[16:19], s56 offen offset:1024
    v_mfma_f32_16x16x32_bf16 a[240:243], a[220:223], a[16:19], a[240:243]
    ds_read_b64_tr_b16 a[172:173], v231 offset:0
    v_mfma_f32_16x16x32_bf16 a[244:247], a[220:223], a[20:23], a[244:247]
    v_mfma_f32_16x16x32_bf16 a[248:251], a[220:223], a[24:27], a[248:251]
    ds_read_b64_tr_b16 a[174:175], v231 offset:512
    v_mfma_f32_16x16x32_bf16 a[252:255], a[220:223], a[28:31], a[252:255]
    s_waitcnt vmcnt(14)
    s_waitcnt lgkmcnt(5)
    v_mfma_f32_16x16x32_bf16 v[32:35], a[128:131], a[32:35], v[32:35]
    ds_read_b64_tr_b16 a[176:177], v224 offset:8192
    v_mfma_f32_16x16x32_bf16 v[36:39], a[128:131], a[36:39], v[36:39]
    s_add_u32 m0, s53, 98304
    s_mov_b32 s55, 3145728
    buffer_load_dwordx4 v232, s[20:23], s55 offen lds
    v_mfma_f32_16x16x32_bf16 v[40:43], a[128:131], a[40:43], v[40:43]
    ds_read_b64_tr_b16 a[178:179], v224 offset:9216
    v_mfma_f32_16x16x32_bf16 v[44:47], a[128:131], a[44:47], v[44:47]
    v_mfma_f32_16x16x32_bf16 v[48:51], a[132:135], a[32:35], v[48:51]
    ds_read_b64_tr_b16 a[180:181], v224 offset:8200
    v_mfma_f32_16x16x32_bf16 v[52:55], a[132:135], a[36:39], v[52:55]
    v_mfma_f32_16x16x32_bf16 v[56:59], a[132:135], a[40:43], v[56:59]
    ds_read_b64_tr_b16 a[182:183], v224 offset:9224
    v_mfma_f32_16x16x32_bf16 v[60:63], a[132:135], a[44:47], v[60:63]
    s_add_u32 m0, s53, 99328
    s_mov_b32 s55, 3178496
    buffer_load_dwordx4 v232, s[20:23], s55 offen lds
    v_mfma_f32_16x16x32_bf16 v[64:67], a[136:139], a[32:35], v[64:67]
    ds_read_b64_tr_b16 a[184:185], v225 offset:8192
    v_mfma_f32_16x16x32_bf16 v[68:71], a[136:139], a[36:39], v[68:71]
    v_mfma_f32_16x16x32_bf16 v[72:75], a[136:139], a[40:43], v[72:75]
    ds_read_b64_tr_b16 a[186:187], v225 offset:9216
    v_mfma_f32_16x16x32_bf16 v[76:79], a[136:139], a[44:47], v[76:79]
    v_mfma_f32_16x16x32_bf16 v[80:83], a[140:143], a[32:35], v[80:83]
    ds_read_b64_tr_b16 a[188:189], v225 offset:8200
    v_mfma_f32_16x16x32_bf16 v[84:87], a[140:143], a[36:39], v[84:87]
    s_add_u32 m0, s53, 100352
    s_mov_b32 s55, 3211264
    buffer_load_dwordx4 v232, s[20:23], s55 offen lds
    v_mfma_f32_16x16x32_bf16 v[88:91], a[140:143], a[40:43], v[88:91]
    ds_read_b64_tr_b16 a[190:191], v225 offset:9224
    v_mfma_f32_16x16x32_bf16 v[92:95], a[140:143], a[44:47], v[92:95]
    v_mfma_f32_16x16x32_bf16 v[96:99], a[144:147], a[32:35], v[96:99]
    ds_read_b64_tr_b16 a[192:193], v226 offset:8192
    v_mfma_f32_16x16x32_bf16 v[100:103], a[144:147], a[36:39], v[100:103]
    v_mfma_f32_16x16x32_bf16 v[104:107], a[144:147], a[40:43], v[104:107]
    ds_read_b64_tr_b16 a[194:195], v226 offset:9216
    v_mfma_f32_16x16x32_bf16 v[108:111], a[144:147], a[44:47], v[108:111]
    s_add_u32 m0, s53, 101376
    s_mov_b32 s55, 3244032
    buffer_load_dwordx4 v232, s[20:23], s55 offen lds
    v_mfma_f32_16x16x32_bf16 v[112:115], a[148:151], a[32:35], v[112:115]
    ds_read_b64_tr_b16 a[196:197], v226 offset:8200
    v_mfma_f32_16x16x32_bf16 v[116:119], a[148:151], a[36:39], v[116:119]
    v_mfma_f32_16x16x32_bf16 v[120:123], a[148:151], a[40:43], v[120:123]
    ds_read_b64_tr_b16 a[198:199], v226 offset:9224
    v_mfma_f32_16x16x32_bf16 v[124:127], a[148:151], a[44:47], v[124:127]
    v_mfma_f32_16x16x32_bf16 v[128:131], a[152:155], a[32:35], v[128:131]
    ds_read_b64_tr_b16 a[200:201], v227 offset:8192
    v_mfma_f32_16x16x32_bf16 v[132:135], a[152:155], a[36:39], v[132:135]
    s_add_u32 m0, s54, 32768
    s_mov_b32 s55, 1327104
    buffer_load_dwordx4 v233, s[24:27], s55 offen lds
    v_mfma_f32_16x16x32_bf16 v[136:139], a[152:155], a[40:43], v[136:139]
    ds_read_b64_tr_b16 a[202:203], v227 offset:9216
    v_mfma_f32_16x16x32_bf16 v[140:143], a[152:155], a[44:47], v[140:143]
    v_mfma_f32_16x16x32_bf16 v[144:147], a[156:159], a[32:35], v[144:147]
    ds_read_b64_tr_b16 a[204:205], v227 offset:8200
    v_mfma_f32_16x16x32_bf16 v[148:151], a[156:159], a[36:39], v[148:151]
    v_mfma_f32_16x16x32_bf16 v[152:155], a[156:159], a[40:43], v[152:155]
    ds_read_b64_tr_b16 a[206:207], v227 offset:9224
    v_mfma_f32_16x16x32_bf16 v[156:159], a[156:159], a[44:47], v[156:159]
    s_add_u32 m0, s54, 33792
    s_mov_b32 s55, 1354752
    buffer_load_dwordx4 v234, s[24:27], s55 offen lds
    v_mfma_f32_16x16x32_bf16 a[96:99], a[160:163], a[32:35], a[96:99]
    ds_read_b64_tr_b16 a[208:209], v228 offset:4096
    v_mfma_f32_16x16x32_bf16 a[100:103], a[160:163], a[36:39], a[100:103]
    v_mfma_f32_16x16x32_bf16 a[104:107], a[160:163], a[40:43], a[104:107]
    ds_read_b64_tr_b16 a[210:211], v228 offset:4608
    v_mfma_f32_16x16x32_bf16 a[108:111], a[160:163], a[44:47], a[108:111]
    s_waitcnt lgkmcnt(5)
    v_mfma_f32_16x16x32_bf16 a[112:115], a[164:167], a[32:35], a[112:115]
    ds_read_b64_tr_b16 a[212:213], v229 offset:4096
    v_mfma_f32_16x16x32_bf16 a[116:119], a[164:167], a[36:39], a[116:119]
    v_mfma_f32_16x16x32_bf16 a[120:123], a[164:167], a[40:43], a[120:123]
    ds_read_b64_tr_b16 a[214:215], v229 offset:4608
    v_mfma_f32_16x16x32_bf16 a[124:127], a[164:167], a[44:47], a[124:127]
    v_mfma_f32_16x16x32_bf16 a[224:227], a[168:171], a[32:35], a[224:227]
    ds_read_b64_tr_b16 a[216:217], v230 offset:4096
    v_mfma_f32_16x16x32_bf16 a[228:231], a[168:171], a[36:39], a[228:231]
    v_mfma_f32_16x16x32_bf16 a[232:235], a[168:171], a[40:43], a[232:235]
    ds_read_b64_tr_b16 a[218:219], v230 offset:4608
    v_mfma_f32_16x16x32_bf16 a[236:239], a[168:171], a[44:47], a[236:239]
    v_mfma_f32_16x16x32_bf16 a[240:243], a[172:175], a[32:35], a[240:243]
    ds_read_b64_tr_b16 a[220:221], v231 offset:4096
    v_mfma_f32_16x16x32_bf16 a[244:247], a[172:175], a[36:39], a[244:247]
    v_mfma_f32_16x16x32_bf16 a[248:251], a[172:175], a[40:43], a[248:251]
    ds_read_b64_tr_b16 a[222:223], v231 offset:4608
    v_mfma_f32_16x16x32_bf16 a[252:255], a[172:175], a[44:47], a[252:255]
    s_waitcnt vmcnt(14)
    s_barrier
    v_mfma_f32_16x16x32_bf16 v[32:35], a[176:179], a[48:51], v[32:35]
    ds_read_b64_tr_b16 a[128:129], v224 offset:16384
    v_mfma_f32_16x16x32_bf16 v[36:39], a[176:179], a[52:55], v[36:39]
    s_add_u32 s56, s50, 12288
    buffer_load_dwordx4 a[0:3], v236, s[16:19], s56 offen offset:0
    v_mfma_f32_16x16x32_bf16 v[40:43], a[176:179], a[56:59], v[40:43]
    ds_read_b64_tr_b16 a[130:131], v224 offset:17408
    v_mfma_f32_16x16x32_bf16 v[44:47], a[176:179], a[60:63], v[44:47]
    v_mfma_f32_16x16x32_bf16 v[48:51], a[180:183], a[48:51], v[48:51]
    ds_read_b64_tr_b16 a[132:133], v224 offset:16392
    v_mfma_f32_16x16x32_bf16 v[52:55], a[180:183], a[52:55], v[52:55]
    v_mfma_f32_16x16x32_bf16 v[56:59], a[180:183], a[56:59], v[56:59]
    ds_read_b64_tr_b16 a[134:135], v224 offset:17416
    v_mfma_f32_16x16x32_bf16 v[60:63], a[180:183], a[60:63], v[60:63]
    buffer_load_dwordx4 a[4:7], v237, s[16:19], s56 offen offset:0
    v_mfma_f32_16x16x32_bf16 v[64:67], a[184:187], a[48:51], v[64:67]
    ds_read_b64_tr_b16 a[136:137], v225 offset:16384
    v_mfma_f32_16x16x32_bf16 v[68:71], a[184:187], a[52:55], v[68:71]
    v_mfma_f32_16x16x32_bf16 v[72:75], a[184:187], a[56:59], v[72:75]
    ds_read_b64_tr_b16 a[138:139], v225 offset:17408
    v_mfma_f32_16x16x32_bf16 v[76:79], a[184:187], a[60:63], v[76:79]
    v_mfma_f32_16x16x32_bf16 v[80:83], a[188:191], a[48:51], v[80:83]
    ds_read_b64_tr_b16 a[140:141], v225 offset:16392
    v_mfma_f32_16x16x32_bf16 v[84:87], a[188:191], a[52:55], v[84:87]
    buffer_load_dwordx4 a[8:11], v238, s[16:19], s56 offen offset:0
    v_mfma_f32_16x16x32_bf16 v[88:91], a[188:191], a[56:59], v[88:91]
    ds_read_b64_tr_b16 a[142:143], v225 offset:17416
    v_mfma_f32_16x16x32_bf16 v[92:95], a[188:191], a[60:63], v[92:95]
    v_mfma_f32_16x16x32_bf16 v[96:99], a[192:195], a[48:51], v[96:99]
    ds_read_b64_tr_b16 a[144:145], v226 offset:16384
    v_mfma_f32_16x16x32_bf16 v[100:103], a[192:195], a[52:55], v[100:103]
    v_mfma_f32_16x16x32_bf16 v[104:107], a[192:195], a[56:59], v[104:107]
    ds_read_b64_tr_b16 a[146:147], v226 offset:17408
    v_mfma_f32_16x16x32_bf16 v[108:111], a[192:195], a[60:63], v[108:111]
    buffer_load_dwordx4 a[12:15], v239, s[16:19], s56 offen offset:0
    v_mfma_f32_16x16x32_bf16 v[112:115], a[196:199], a[48:51], v[112:115]
    ds_read_b64_tr_b16 a[148:149], v226 offset:16392
    v_mfma_f32_16x16x32_bf16 v[116:119], a[196:199], a[52:55], v[116:119]
    v_mfma_f32_16x16x32_bf16 v[120:123], a[196:199], a[56:59], v[120:123]
    ds_read_b64_tr_b16 a[150:151], v226 offset:17416
    v_mfma_f32_16x16x32_bf16 v[124:127], a[196:199], a[60:63], v[124:127]
    s_waitcnt lgkmcnt(6)
    v_mfma_f32_16x16x32_bf16 v[128:131], a[200:203], a[48:51], v[128:131]
    ds_read_b64_tr_b16 a[152:153], v227 offset:16384
    v_mfma_f32_16x16x32_bf16 v[132:135], a[200:203], a[52:55], v[132:135]
    buffer_load_dwordx4 a[16:19], v236, s[16:19], s56 offen offset:1024
    v_mfma_f32_16x16x32_bf16 v[136:139], a[200:203], a[56:59], v[136:139]
    ds_read_b64_tr_b16 a[154:155], v227 offset:17408
    v_mfma_f32_16x16x32_bf16 v[140:143], a[200:203], a[60:63], v[140:143]
    v_mfma_f32_16x16x32_bf16 v[144:147], a[204:207], a[48:51], v[144:147]
    ds_read_b64_tr_b16 a[156:157], v227 offset:16392
    v_mfma_f32_16x16x32_bf16 v[148:151], a[204:207], a[52:55], v[148:151]
    v_mfma_f32_16x16x32_bf16 v[152:155], a[204:207], a[56:59], v[152:155]
    ds_read_b64_tr_b16 a[158:159], v227 offset:17416
    v_mfma_f32_16x16x32_bf16 v[156:159], a[204:207], a[60:63], v[156:159]
    buffer_load_dwordx4 a[20:23], v237, s[16:19], s56 offen offset:1024
    v_mfma_f32_16x16x32_bf16 a[96:99], a[208:211], a[48:51], a[96:99]
    ds_read_b64_tr_b16 a[160:161], v228 offset:16384
    v_mfma_f32_16x16x32_bf16 a[100:103], a[208:211], a[52:55], a[100:103]
    v_mfma_f32_16x16x32_bf16 a[104:107], a[208:211], a[56:59], a[104:107]
    ds_read_b64_tr_b16 a[162:163], v228 offset:16896
    v_mfma_f32_16x16x32_bf16 a[108:111], a[208:211], a[60:63], a[108:111]
    v_mfma_f32_16x16x32_bf16 a[112:115], a[212:215], a[48:51], a[112:115]
    ds_read_b64_tr_b16 a[164:165], v229 offset:16384
    v_mfma_f32_16x16x32_bf16 a[116:119], a[212:215], a[52:55], a[116:119]
    buffer_load_dwordx4 a[24:27], v238, s[16:19], s56 offen offset:1024
    v_mfma_f32_16x16x32_bf16 a[120:123], a[212:215], a[56:59], a[120:123]
    ds_read_b64_tr_b16 a[166:167], v229 offset:16896
    v_mfma_f32_16x16x32_bf16 a[124:127], a[212:215], a[60:63], a[124:127]
    v_mfma_f32_16x16x32_bf16 a[224:227], a[216:219], a[48:51], a[224:227]
    ds_read_b64_tr_b16 a[168:169], v230 offset:16384
    v_mfma_f32_16x16x32_bf16 a[228:231], a[216:219], a[52:55], a[228:231]
    v_mfma_f32_16x16x32_bf16 a[232:235], a[216:219], a[56:59], a[232:235]
    ds_read_b64_tr_b16 a[170:171], v230 offset:16896
    v_mfma_f32_16x16x32_bf16 a[236:239], a[216:219], a[60:63], a[236:239]
    buffer_load_dwordx4 a[28:31], v239, s[16:19], s56 offen offset:1024
    v_mfma_f32_16x16x32_bf16 a[240:243], a[220:223], a[48:51], a[240:243]
    ds_read_b64_tr_b16 a[172:173], v231 offset:16384
    v_mfma_f32_16x16x32_bf16 a[244:247], a[220:223], a[52:55], a[244:247]
    v_mfma_f32_16x16x32_bf16 a[248:251], a[220:223], a[56:59], a[248:251]
    ds_read_b64_tr_b16 a[174:175], v231 offset:16896
    v_mfma_f32_16x16x32_bf16 a[252:255], a[220:223], a[60:63], a[252:255]
    s_waitcnt vmcnt(14)
    v_mfma_f32_16x16x32_bf16 v[32:35], a[128:131], a[64:67], v[32:35]
    ds_read_b64_tr_b16 a[176:177], v224 offset:24576
    v_mfma_f32_16x16x32_bf16 v[36:39], a[128:131], a[68:71], v[36:39]
    s_add_u32 m0, s53, 114688
    s_mov_b32 s55, 3670016
    buffer_load_dwordx4 v232, s[20:23], s55 offen lds
    v_mfma_f32_16x16x32_bf16 v[40:43], a[128:131], a[72:75], v[40:43]
    ds_read_b64_tr_b16 a[178:179], v224 offset:25600
    v_mfma_f32_16x16x32_bf16 v[44:47], a[128:131], a[76:79], v[44:47]
    v_mfma_f32_16x16x32_bf16 v[48:51], a[132:135], a[64:67], v[48:51]
    ds_read_b64_tr_b16 a[180:181], v224 offset:24584
    v_mfma_f32_16x16x32_bf16 v[52:55], a[132:135], a[68:71], v[52:55]
    v_mfma_f32_16x16x32_bf16 v[56:59], a[132:135], a[72:75], v[56:59]
    ds_read_b64_tr_b16 a[182:183], v224 offset:25608
    v_mfma_f32_16x16x32_bf16 v[60:63], a[132:135], a[76:79], v[60:63]
    s_add_u32 m0, s53, 115712
    s_mov_b32 s55, 3702784
    buffer_load_dwordx4 v232, s[20:23], s55 offen lds
    v_mfma_f32_16x16x32_bf16 v[64:67], a[136:139], a[64:67], v[64:67]
    ds_read_b64_tr_b16 a[184:185], v225 offset:24576
    v_mfma_f32_16x16x32_bf16 v[68:71], a[136:139], a[68:71], v[68:71]
    v_mfma_f32_16x16x32_bf16 v[72:75], a[136:139], a[72:75], v[72:75]
    ds_read_b64_tr_b16 a[186:187], v225 offset:25600
    v_mfma_f32_16x16x32_bf16 v[76:79], a[136:139], a[76:79], v[76:79]
    s_waitcnt lgkmcnt(5)
    v_mfma_f32_16x16x32_bf16 v[80:83], a[140:143], a[64:67], v[80:83]
    ds_read_b64_tr_b16 a[188:189], v225 offset:24584
    v_mfma_f32_16x16x32_bf16 v[84:87], a[140:143], a[68:71], v[84:87]
    s_add_u32 m0, s53, 116736
    s_mov_b32 s55, 3735552
    buffer_load_dwordx4 v232, s[20:23], s55 offen lds
    v_mfma_f32_16x16x32_bf16 v[88:91], a[140:143], a[72:75], v[88:91]
    ds_read_b64_tr_b16 a[190:191], v225 offset:25608
    v_mfma_f32_16x16x32_bf16 v[92:95], a[140:143], a[76:79], v[92:95]
    v_mfma_f32_16x16x32_bf16 v[96:99], a[144:147], a[64:67], v[96:99]
    ds_read_b64_tr_b16 a[192:193], v226 offset:24576
    v_mfma_f32_16x16x32_bf16 v[100:103], a[144:147], a[68:71], v[100:103]
    v_mfma_f32_16x16x32_bf16 v[104:107], a[144:147], a[72:75], v[104:107]
    ds_read_b64_tr_b16 a[194:195], v226 offset:25600
    v_mfma_f32_16x16x32_bf16 v[108:111], a[144:147], a[76:79], v[108:111]
    s_add_u32 m0, s53, 117760
    s_mov_b32 s55, 3768320
    buffer_load_dwordx4 v232, s[20:23], s55 offen lds
    v_mfma_f32_16x16x32_bf16 v[112:115], a[148:151], a[64:67], v[112:115]
    ds_read_b64_tr_b16 a[196:197], v226 offset:24584
    v_mfma_f32_16x16x32_bf16 v[116:119], a[148:151], a[68:71], v[116:119]
    v_mfma_f32_16x16x32_bf16 v[120:123], a[148:151], a[72:75], v[120:123]
    ds_read_b64_tr_b16 a[198:199], v226 offset:25608
    v_mfma_f32_16x16x32_bf16 v[124:127], a[148:151], a[76:79], v[124:127]
    v_mfma_f32_16x16x32_bf16 v[128:131], a[152:155], a[64:67], v[128:131]
    ds_read_b64_tr_b16 a[200:201], v227 offset:24576
    v_mfma_f32_16x16x32_bf16 v[132:135], a[152:155], a[68:71], v[132:135]
    s_add_u32 m0, s54, 49152
    s_mov_b32 s55, 1548288
    buffer_load_dwordx4 v233, s[24:27], s55 offen lds
    v_mfma_f32_16x16x32_bf16 v[136:139], a[152:155], a[72:75], v[136:139]
    ds_read_b64_tr_b16 a[202:203], v227 offset:25600
    v_mfma_f32_16x16x32_bf16 v[140:143], a[152:155], a[76:79], v[140:143]
    v_mfma_f32_16x16x32_bf16 v[144:147], a[156:159], a[64:67], v[144:147]
    ds_read_b64_tr_b16 a[204:205], v227 offset:24584
    v_mfma_f32_16x16x32_bf16 v[148:151], a[156:159], a[68:71], v[148:151]
    v_mfma_f32_16x16x32_bf16 v[152:155], a[156:159], a[72:75], v[152:155]
    ds_read_b64_tr_b16 a[206:207], v227 offset:25608
    v_mfma_f32_16x16x32_bf16 v[156:159], a[156:159], a[76:79], v[156:159]
    s_add_u32 m0, s54, 50176
    s_mov_b32 s55, 1575936
    buffer_load_dwordx4 v234, s[24:27], s55 offen lds
    v_mfma_f32_16x16x32_bf16 a[96:99], a[160:163], a[64:67], a[96:99]
    ds_read_b64_tr_b16 a[208:209], v228 offset:20480
    v_mfma_f32_16x16x32_bf16 a[100:103], a[160:163], a[68:71], a[100:103]
    v_mfma_f32_16x16x32_bf16 a[104:107], a[160:163], a[72:75], a[104:107]
    ds_read_b64_tr_b16 a[210:211], v228 offset:20992
    v_mfma_f32_16x16x32_bf16 a[108:111], a[160:163], a[76:79], a[108:111]
    v_mfma_f32_16x16x32_bf16 a[112:115], a[164:167], a[64:67], a[112:115]
    ds_read_b64_tr_b16 a[212:213], v229 offset:20480
    v_mfma_f32_16x16x32_bf16 a[116:119], a[164:167], a[68:71], a[116:119]
    v_mfma_f32_16x16x32_bf16 a[120:123], a[164:167], a[72:75], a[120:123]
    ds_read_b64_tr_b16 a[214:215], v229 offset:20992
    v_mfma_f32_16x16x32_bf16 a[124:127], a[164:167], a[76:79], a[124:127]
    v_mfma_f32_16x16x32_bf16 a[224:227], a[168:171], a[64:67], a[224:227]
    ds_read_b64_tr_b16 a[216:217], v230 offset:20480
    v_mfma_f32_16x16x32_bf16 a[228:231], a[168:171], a[68:71], a[228:231]
    v_mfma_f32_16x16x32_bf16 a[232:235], a[168:171], a[72:75], a[232:235]
    ds_read_b64_tr_b16 a[218:219], v230 offset:20992
    v_mfma_f32_16x16x32_bf16 a[236:239], a[168:171], a[76:79], a[236:239]
    v_mfma_f32_16x16x32_bf16 a[240:243], a[172:175], a[64:67], a[240:243]
    ds_read_b64_tr_b16 a[220:221], v231 offset:20480
    v_mfma_f32_16x16x32_bf16 a[244:247], a[172:175], a[68:71], a[244:247]
    v_mfma_f32_16x16x32_bf16 a[248:251], a[172:175], a[72:75], a[248:251]
    ds_read_b64_tr_b16 a[222:223], v231 offset:20992
    v_mfma_f32_16x16x32_bf16 a[252:255], a[172:175], a[76:79], a[252:255]
    s_waitcnt vmcnt(14)
    s_barrier
    s_waitcnt lgkmcnt(6)
    v_mfma_f32_16x16x32_bf16 v[32:35], a[176:179], a[80:83], v[32:35]
    ds_read_b64_tr_b16 a[128:129], v224 offset:32768
    v_mfma_f32_16x16x32_bf16 v[36:39], a[176:179], a[84:87], v[36:39]
    s_add_u32 s56, s50, 14336
    buffer_load_dwordx4 a[32:35], v236, s[16:19], s56 offen offset:0
    v_mfma_f32_16x16x32_bf16 v[40:43], a[176:179], a[88:91], v[40:43]
    ds_read_b64_tr_b16 a[130:131], v224 offset:33792
    v_mfma_f32_16x16x32_bf16 v[44:47], a[176:179], a[92:95], v[44:47]
    v_mfma_f32_16x16x32_bf16 v[48:51], a[180:183], a[80:83], v[48:51]
    ds_read_b64_tr_b16 a[132:133], v224 offset:32776
    v_mfma_f32_16x16x32_bf16 v[52:55], a[180:183], a[84:87], v[52:55]
    v_mfma_f32_16x16x32_bf16 v[56:59], a[180:183], a[88:91], v[56:59]
    ds_read_b64_tr_b16 a[134:135], v224 offset:33800
    v_mfma_f32_16x16x32_bf16 v[60:63], a[180:183], a[92:95], v[60:63]
    buffer_load_dwordx4 a[36:39], v237, s[16:19], s56 offen offset:0
    v_mfma_f32_16x16x32_bf16 v[64:67], a[184:187], a[80:83], v[64:67]
    ds_read_b64_tr_b16 a[136:137], v225 offset:32768
    v_mfma_f32_16x16x32_bf16 v[68:71], a[184:187], a[84:87], v[68:71]
    v_mfma_f32_16x16x32_bf16 v[72:75], a[184:187], a[88:91], v[72:75]
    ds_read_b64_tr_b16 a[138:139], v225 offset:33792
    v_mfma_f32_16x16x32_bf16 v[76:79], a[184:187], a[92:95], v[76:79]
    v_mfma_f32_16x16x32_bf16 v[80:83], a[188:191], a[80:83], v[80:83]
    ds_read_b64_tr_b16 a[140:141], v225 offset:32776
    v_mfma_f32_16x16x32_bf16 v[84:87], a[188:191], a[84:87], v[84:87]
    buffer_load_dwordx4 a[40:43], v238, s[16:19], s56 offen offset:0
    v_mfma_f32_16x16x32_bf16 v[88:91], a[188:191], a[88:91], v[88:91]
    ds_read_b64_tr_b16 a[142:143], v225 offset:33800
    v_mfma_f32_16x16x32_bf16 v[92:95], a[188:191], a[92:95], v[92:95]
    v_mfma_f32_16x16x32_bf16 v[96:99], a[192:195], a[80:83], v[96:99]
    ds_read_b64_tr_b16 a[144:145], v226 offset:32768
    v_mfma_f32_16x16x32_bf16 v[100:103], a[192:195], a[84:87], v[100:103]
    v_mfma_f32_16x16x32_bf16 v[104:107], a[192:195], a[88:91], v[104:107]
    ds_read_b64_tr_b16 a[146:147], v226 offset:33792
    v_mfma_f32_16x16x32_bf16 v[108:111], a[192:195], a[92:95], v[108:111]
    buffer_load_dwordx4 a[44:47], v239, s[16:19], s56 offen offset:0
    v_mfma_f32_16x16x32_bf16 v[112:115], a[196:199], a[80:83], v[112:115]
    ds_read_b64_tr_b16 a[148:149], v226 offset:32776
    v_mfma_f32_16x16x32_bf16 v[116:119], a[196:199], a[84:87], v[116:119]
    v_mfma_f32_16x16x32_bf16 v[120:123], a[196:199], a[88:91], v[120:123]
    ds_read_b64_tr_b16 a[150:151], v226 offset:33800
    v_mfma_f32_16x16x32_bf16 v[124:127], a[196:199], a[92:95], v[124:127]
    v_mfma_f32_16x16x32_bf16 v[128:131], a[200:203], a[80:83], v[128:131]
    ds_read_b64_tr_b16 a[152:153], v227 offset:32768
    v_mfma_f32_16x16x32_bf16 v[132:135], a[200:203], a[84:87], v[132:135]
    buffer_load_dwordx4 a[48:51], v236, s[16:19], s56 offen offset:1024
    v_mfma_f32_16x16x32_bf16 v[136:139], a[200:203], a[88:91], v[136:139]
    ds_read_b64_tr_b16 a[154:155], v227 offset:33792
    v_mfma_f32_16x16x32_bf16 v[140:143], a[200:203], a[92:95], v[140:143]
    v_mfma_f32_16x16x32_bf16 v[144:147], a[204:207], a[80:83], v[144:147]
    ds_read_b64_tr_b16 a[156:157], v227 offset:32776
    v_mfma_f32_16x16x32_bf16 v[148:151], a[204:207], a[84:87], v[148:151]
    v_mfma_f32_16x16x32_bf16 v[152:155], a[204:207], a[88:91], v[152:155]
    ds_read_b64_tr_b16 a[158:159], v227 offset:33800
    v_mfma_f32_16x16x32_bf16 v[156:159], a[204:207], a[92:95], v[156:159]
    buffer_load_dwordx4 a[52:55], v237, s[16:19], s56 offen offset:1024
    v_mfma_f32_16x16x32_bf16 a[96:99], a[208:211], a[80:83], a[96:99]
    ds_read_b64_tr_b16 a[160:161], v228 offset:32768
    v_mfma_f32_16x16x32_bf16 a[100:103], a[208:211], a[84:87], a[100:103]
    v_mfma_f32_16x16x32_bf16 a[104:107], a[208:211], a[88:91], a[104:107]
    ds_read_b64_tr_b16 a[162:163], v228 offset:33280
    v_mfma_f32_16x16x32_bf16 a[108:111], a[208:211], a[92:95], a[108:111]
    s_waitcnt lgkmcnt(6)
    v_mfma_f32_16x16x32_bf16 a[112:115], a[212:215], a[80:83], a[112:115]
    ds_read_b64_tr_b16 a[164:165], v229 offset:32768
    v_mfma_f32_16x16x32_bf16 a[116:119], a[212:215], a[84:87], a[116:119]
    buffer_load_dwordx4 a[56:59], v238, s[16:19], s56 offen offset:1024
    v_mfma_f32_16x16x32_bf16 a[120:123], a[212:215], a[88:91], a[120:123]
    ds_read_b64_tr_b16 a[166:167], v229 offset:33280
    v_mfma_f32_16x16x32_bf16 a[124:127], a[212:215], a[92:95], a[124:127]
    v_mfma_f32_16x16x32_bf16 a[224:227], a[216:219], a[80:83], a[224:227]
    ds_read_b64_tr_b16 a[168:169], v230 offset:32768
    v_mfma_f32_16x16x32_bf16 a[228:231], a[216:219], a[84:87], a[228:231]
    v_mfma_f32_16x16x32_bf16 a[232:235], a[216:219], a[88:91], a[232:235]
    ds_read_b64_tr_b16 a[170:171], v230 offset:33280
    v_mfma_f32_16x16x32_bf16 a[236:239], a[216:219], a[92:95], a[236:239]
    buffer_load_dwordx4 a[60:63], v239, s[16:19], s56 offen offset:1024
    v_mfma_f32_16x16x32_bf16 a[240:243], a[220:223], a[80:83], a[240:243]
    ds_read_b64_tr_b16 a[172:173], v231 offset:32768
    v_mfma_f32_16x16x32_bf16 a[244:247], a[220:223], a[84:87], a[244:247]
    v_mfma_f32_16x16x32_bf16 a[248:251], a[220:223], a[88:91], a[248:251]
    ds_read_b64_tr_b16 a[174:175], v231 offset:33280
    v_mfma_f32_16x16x32_bf16 a[252:255], a[220:223], a[92:95], a[252:255]
    s_waitcnt vmcnt(14)
    v_mfma_f32_16x16x32_bf16 v[32:35], a[128:131], a[0:3], v[32:35]
    ds_read_b64_tr_b16 a[176:177], v224 offset:40960
    v_mfma_f32_16x16x32_bf16 v[36:39], a[128:131], a[4:7], v[36:39]
    s_add_u32 m0, s53, 65536
    s_mov_b32 s55, 4194304
    buffer_load_dwordx4 v232, s[20:23], s55 offen lds
    v_mfma_f32_16x16x32_bf16 v[40:43], a[128:131], a[8:11], v[40:43]
    ds_read_b64_tr_b16 a[178:179], v224 offset:41984
    v_mfma_f32_16x16x32_bf16 v[44:47], a[128:131], a[12:15], v[44:47]
    v_mfma_f32_16x16x32_bf16 v[48:51], a[132:135], a[0:3], v[48:51]
    ds_read_b64_tr_b16 a[180:181], v224 offset:40968
    v_mfma_f32_16x16x32_bf16 v[52:55], a[132:135], a[4:7], v[52:55]
    v_mfma_f32_16x16x32_bf16 v[56:59], a[132:135], a[8:11], v[56:59]
    ds_read_b64_tr_b16 a[182:183], v224 offset:41992
    v_mfma_f32_16x16x32_bf16 v[60:63], a[132:135], a[12:15], v[60:63]
    s_add_u32 m0, s53, 66560
    s_mov_b32 s55, 4227072
    buffer_load_dwordx4 v232, s[20:23], s55 offen lds
    v_mfma_f32_16x16x32_bf16 v[64:67], a[136:139], a[0:3], v[64:67]
    ds_read_b64_tr_b16 a[184:185], v225 offset:40960
    v_mfma_f32_16x16x32_bf16 v[68:71], a[136:139], a[4:7], v[68:71]
    v_mfma_f32_16x16x32_bf16 v[72:75], a[136:139], a[8:11], v[72:75]
    ds_read_b64_tr_b16 a[186:187], v225 offset:41984
    v_mfma_f32_16x16x32_bf16 v[76:79], a[136:139], a[12:15], v[76:79]
    v_mfma_f32_16x16x32_bf16 v[80:83], a[140:143], a[0:3], v[80:83]
    ds_read_b64_tr_b16 a[188:189], v225 offset:40968
    v_mfma_f32_16x16x32_bf16 v[84:87], a[140:143], a[4:7], v[84:87]
    s_add_u32 m0, s53, 67584
    s_mov_b32 s55, 4259840
    buffer_load_dwordx4 v232, s[20:23], s55 offen lds
    v_mfma_f32_16x16x32_bf16 v[88:91], a[140:143], a[8:11], v[88:91]
    ds_read_b64_tr_b16 a[190:191], v225 offset:41992
    v_mfma_f32_16x16x32_bf16 v[92:95], a[140:143], a[12:15], v[92:95]
    v_mfma_f32_16x16x32_bf16 v[96:99], a[144:147], a[0:3], v[96:99]
    ds_read_b64_tr_b16 a[192:193], v226 offset:40960
    v_mfma_f32_16x16x32_bf16 v[100:103], a[144:147], a[4:7], v[100:103]
    v_mfma_f32_16x16x32_bf16 v[104:107], a[144:147], a[8:11], v[104:107]
    ds_read_b64_tr_b16 a[194:195], v226 offset:41984
    v_mfma_f32_16x16x32_bf16 v[108:111], a[144:147], a[12:15], v[108:111]
    s_add_u32 m0, s53, 68608
    s_mov_b32 s55, 4292608
    buffer_load_dwordx4 v232, s[20:23], s55 offen lds
    v_mfma_f32_16x16x32_bf16 v[112:115], a[148:151], a[0:3], v[112:115]
    ds_read_b64_tr_b16 a[196:197], v226 offset:40968
    v_mfma_f32_16x16x32_bf16 v[116:119], a[148:151], a[4:7], v[116:119]
    v_mfma_f32_16x16x32_bf16 v[120:123], a[148:151], a[8:11], v[120:123]
    ds_read_b64_tr_b16 a[198:199], v226 offset:41992
    v_mfma_f32_16x16x32_bf16 v[124:127], a[148:151], a[12:15], v[124:127]
    s_waitcnt lgkmcnt(5)
    v_mfma_f32_16x16x32_bf16 v[128:131], a[152:155], a[0:3], v[128:131]
    ds_read_b64_tr_b16 a[200:201], v227 offset:40960
    v_mfma_f32_16x16x32_bf16 v[132:135], a[152:155], a[4:7], v[132:135]
    s_add_u32 m0, s54, 0
    s_mov_b32 s55, 1769472
    buffer_load_dwordx4 v233, s[24:27], s55 offen lds
    v_mfma_f32_16x16x32_bf16 v[136:139], a[152:155], a[8:11], v[136:139]
    ds_read_b64_tr_b16 a[202:203], v227 offset:41984
    v_mfma_f32_16x16x32_bf16 v[140:143], a[152:155], a[12:15], v[140:143]
    v_mfma_f32_16x16x32_bf16 v[144:147], a[156:159], a[0:3], v[144:147]
    ds_read_b64_tr_b16 a[204:205], v227 offset:40968
    v_mfma_f32_16x16x32_bf16 v[148:151], a[156:159], a[4:7], v[148:151]
    v_mfma_f32_16x16x32_bf16 v[152:155], a[156:159], a[8:11], v[152:155]
    ds_read_b64_tr_b16 a[206:207], v227 offset:41992
    v_mfma_f32_16x16x32_bf16 v[156:159], a[156:159], a[12:15], v[156:159]
    s_add_u32 m0, s54, 1024
    s_mov_b32 s55, 1797120
    buffer_load_dwordx4 v234, s[24:27], s55 offen lds
    v_mfma_f32_16x16x32_bf16 a[96:99], a[160:163], a[0:3], a[96:99]
    ds_read_b64_tr_b16 a[208:209], v228 offset:36864
    v_mfma_f32_16x16x32_bf16 a[100:103], a[160:163], a[4:7], a[100:103]
    v_mfma_f32_16x16x32_bf16 a[104:107], a[160:163], a[8:11], a[104:107]
    ds_read_b64_tr_b16 a[210:211], v228 offset:37376
    v_mfma_f32_16x16x32_bf16 a[108:111], a[160:163], a[12:15], a[108:111]
    v_mfma_f32_16x16x32_bf16 a[112:115], a[164:167], a[0:3], a[112:115]
    ds_read_b64_tr_b16 a[212:213], v229 offset:36864
    v_mfma_f32_16x16x32_bf16 a[116:119], a[164:167], a[4:7], a[116:119]
    v_mfma_f32_16x16x32_bf16 a[120:123], a[164:167], a[8:11], a[120:123]
    ds_read_b64_tr_b16 a[214:215], v229 offset:37376
    v_mfma_f32_16x16x32_bf16 a[124:127], a[164:167], a[12:15], a[124:127]
    v_mfma_f32_16x16x32_bf16 a[224:227], a[168:171], a[0:3], a[224:227]
    ds_read_b64_tr_b16 a[216:217], v230 offset:36864
    v_mfma_f32_16x16x32_bf16 a[228:231], a[168:171], a[4:7], a[228:231]
    v_mfma_f32_16x16x32_bf16 a[232:235], a[168:171], a[8:11], a[232:235]
    ds_read_b64_tr_b16 a[218:219], v230 offset:37376
    v_mfma_f32_16x16x32_bf16 a[236:239], a[168:171], a[12:15], a[236:239]
    v_mfma_f32_16x16x32_bf16 a[240:243], a[172:175], a[0:3], a[240:243]
    ds_read_b64_tr_b16 a[220:221], v231 offset:36864
    v_mfma_f32_16x16x32_bf16 a[244:247], a[172:175], a[4:7], a[244:247]
    v_mfma_f32_16x16x32_bf16 a[248:251], a[172:175], a[8:11], a[248:251]
    ds_read_b64_tr_b16 a[222:223], v231 offset:37376
    v_mfma_f32_16x16x32_bf16 a[252:255], a[172:175], a[12:15], a[252:255]
    s_waitcnt vmcnt(14)
    s_barrier
    v_mfma_f32_16x16x32_bf16 v[32:35], a[176:179], a[16:19], v[32:35]
    ds_read_b64_tr_b16 a[128:129], v224 offset:49152
    v_mfma_f32_16x16x32_bf16 v[36:39], a[176:179], a[20:23], v[36:39]
    s_add_u32 s56, s50, 16384
    buffer_load_dwordx4 a[64:67], v236, s[16:19], s56 offen offset:0
    v_mfma_f32_16x16x32_bf16 v[40:43], a[176:179], a[24:27], v[40:43]
    ds_read_b64_tr_b16 a[130:131], v224 offset:50176
    v_mfma_f32_16x16x32_bf16 v[44:47], a[176:179], a[28:31], v[44:47]
    v_mfma_f32_16x16x32_bf16 v[48:51], a[180:183], a[16:19], v[48:51]
    ds_read_b64_tr_b16 a[132:133], v224 offset:49160
    v_mfma_f32_16x16x32_bf16 v[52:55], a[180:183], a[20:23], v[52:55]
    v_mfma_f32_16x16x32_bf16 v[56:59], a[180:183], a[24:27], v[56:59]
    ds_read_b64_tr_b16 a[134:135], v224 offset:50184
    v_mfma_f32_16x16x32_bf16 v[60:63], a[180:183], a[28:31], v[60:63]
    buffer_load_dwordx4 a[68:71], v237, s[16:19], s56 offen offset:0
    v_mfma_f32_16x16x32_bf16 v[64:67], a[184:187], a[16:19], v[64:67]
    ds_read_b64_tr_b16 a[136:137], v225 offset:49152
    v_mfma_f32_16x16x32_bf16 v[68:71], a[184:187], a[20:23], v[68:71]
    v_mfma_f32_16x16x32_bf16 v[72:75], a[184:187], a[24:27], v[72:75]
    ds_read_b64_tr_b16 a[138:139], v225 offset:50176
    v_mfma_f32_16x16x32_bf16 v[76:79], a[184:187], a[28:31], v[76:79]
    s_waitcnt lgkmcnt(5)
    v_mfma_f32_16x16x32_bf16 v[80:83], a[188:191], a[16:19], v[80:83]
    ds_read_b64_tr_b16 a[140:141], v225 offset:49160
    v_mfma_f32_16x16x32_bf16 v[84:87], a[188:191], a[20:23], v[84:87]
    buffer_load_dwordx4 a[72:75], v238, s[16:19], s56 offen offset:0
    v_mfma_f32_16x16x32_bf16 v[88:91], a[188:191], a[24:27], v[88:91]
    ds_read_b64_tr_b16 a[142:143], v225 offset:50184
    v_mfma_f32_16x16x32_bf16 v[92:95], a[188:191], a[28:31], v[92:95]
    v_mfma_f32_16x16x32_bf16 v[96:99], a[192:195], a[16:19], v[96:99]
    ds_read_b64_tr_b16 a[144:145], v226 offset:49152
    v_mfma_f32_16x16x32_bf16 v[100:103], a[192:195], a[20:23], v[100:103]
    v_mfma_f32_16x16x32_bf16 v[104:107], a[192:195], a[24:27], v[104:107]
    ds_read_b64_tr_b16 a[146:147], v226 offset:50176
    v_mfma_f32_16x16x32_bf16 v[108:111], a[192:195], a[28:31], v[108:111]
    buffer_load_dwordx4 a[76:79], v239, s[16:19], s56 offen offset:0
    v_mfma_f32_16x16x32_bf16 v[112:115], a[196:199], a[16:19], v[112:115]
    ds_read_b64_tr_b16 a[148:149], v226 offset:49160
    v_mfma_f32_16x16x32_bf16 v[116:119], a[196:199], a[20:23], v[116:119]
    v_mfma_f32_16x16x32_bf16 v[120:123], a[196:199], a[24:27], v[120:123]
    ds_read_b64_tr_b16 a[150:151], v226 offset:50184
    v_mfma_f32_16x16x32_bf16 v[124:127], a[196:199], a[28:31], v[124:127]
    v_mfma_f32_16x16x32_bf16 v[128:131], a[200:203], a[16:19], v[128:131]
    ds_read_b64_tr_b16 a[152:153], v227 offset:49152
    v_mfma_f32_16x16x32_bf16 v[132:135], a[200:203], a[20:23], v[132:135]
    buffer_load_dwordx4 a[80:83], v236, s[16:19], s56 offen offset:1024
    v_mfma_f32_16x16x32_bf16 v[136:139], a[200:203], a[24:27], v[136:139]
    ds_read_b64_tr_b16 a[154:155], v227 offset:50176
    v_mfma_f32_16x16x32_bf16 v[140:143], a[200:203], a[28:31], v[140:143]
    v_mfma_f32_16x16x32_bf16 v[144:147], a[204:207], a[16:19], v[144:147]
    ds_read_b64_tr_b16 a[156:157], v227 offset:49160
    v_mfma_f32_16x16x32_bf16 v[148:151], a[204:207], a[20:23], v[148:151]
    v_mfma_f32_16x16x32_bf16 v[152:155], a[204:207], a[24:27], v[152:155]
    ds_read_b64_tr_b16 a[158:159], v227 offset:50184
    v_mfma_f32_16x16x32_bf16 v[156:159], a[204:207], a[28:31], v[156:159]
    buffer_load_dwordx4 a[84:87], v237, s[16:19], s56 offen offset:1024
    v_mfma_f32_16x16x32_bf16 a[96:99], a[208:211], a[16:19], a[96:99]
    ds_read_b64_tr_b16 a[160:161], v228 offset:49152
    v_mfma_f32_16x16x32_bf16 a[100:103], a[208:211], a[20:23], a[100:103]
    v_mfma_f32_16x16x32_bf16 a[104:107], a[208:211], a[24:27], a[104:107]
    ds_read_b64_tr_b16 a[162:163], v228 offset:49664
    v_mfma_f32_16x16x32_bf16 a[108:111], a[208:211], a[28:31], a[108:111]
    v_mfma_f32_16x16x32_bf16 a[112:115], a[212:215], a[16:19], a[112:115]
    ds_read_b64_tr_b16 a[164:165], v229 offset:49152
    v_mfma_f32_16x16x32_bf16 a[116:119], a[212:215], a[20:23], a[116:119]
    buffer_load_dwordx4 a[88:91], v238, s[16:19], s56 offen offset:1024
    v_mfma_f32_16x16x32_bf16 a[120:123], a[212:215], a[24:27], a[120:123]
    ds_read_b64_tr_b16 a[166:167], v229 offset:49664
    v_mfma_f32_16x16x32_bf16 a[124:127], a[212:215], a[28:31], a[124:127]
    v_mfma_f32_16x16x32_bf16 a[224:227], a[216:219], a[16:19], a[224:227]
    ds_read_b64_tr_b16 a[168:169], v230 offset:49152
    v_mfma_f32_16x16x32_bf16 a[228:231], a[216:219], a[20:23], a[228:231]
    v_mfma_f32_16x16x32_bf16 a[232:235], a[216:219], a[24:27], a[232:235]
    ds_read_b64_tr_b16 a[170:171], v230 offset:49664
    v_mfma_f32_16x16x32_bf16 a[236:239], a[216:219], a[28:31], a[236:239]
    buffer_load_dwordx4 a[92:95], v239, s[16:19], s56 offen offset:1024
    v_mfma_f32_16x16x32_bf16 a[240:243], a[220:223], a[16:19], a[240:243]
    ds_read_b64_tr_b16 a[172:173], v231 offset:49152
    v_mfma_f32_16x16x32_bf16 a[244:247], a[220:223], a[20:23], a[244:247]
    v_mfma_f32_16x16x32_bf16 a[248:251], a[220:223], a[24:27], a[248:251]
    ds_read_b64_tr_b16 a[174:175], v231 offset:49664
    v_mfma_f32_16x16x32_bf16 a[252:255], a[220:223], a[28:31], a[252:255]
    s_waitcnt vmcnt(14)
    s_waitcnt lgkmcnt(5)
    v_mfma_f32_16x16x32_bf16 v[32:35], a[128:131], a[32:35], v[32:35]
    ds_read_b64_tr_b16 a[176:177], v224 offset:57344
    v_mfma_f32_16x16x32_bf16 v[36:39], a[128:131], a[36:39], v[36:39]
    s_add_u32 m0, s53, 81920
    s_mov_b32 s55, 4718592
    buffer_load_dwordx4 v232, s[20:23], s55 offen lds
    v_mfma_f32_16x16x32_bf16 v[40:43], a[128:131], a[40:43], v[40:43]
    ds_read_b64_tr_b16 a[178:179], v224 offset:58368
    v_mfma_f32_16x16x32_bf16 v[44:47], a[128:131], a[44:47], v[44:47]
    v_mfma_f32_16x16x32_bf16 v[48:51], a[132:135], a[32:35], v[48:51]
    ds_read_b64_tr_b16 a[180:181], v224 offset:57352
    v_mfma_f32_16x16x32_bf16 v[52:55], a[132:135], a[36:39], v[52:55]
    v_mfma_f32_16x16x32_bf16 v[56:59], a[132:135], a[40:43], v[56:59]
    ds_read_b64_tr_b16 a[182:183], v224 offset:58376
    v_mfma_f32_16x16x32_bf16 v[60:63], a[132:135], a[44:47], v[60:63]
    s_add_u32 m0, s53, 82944
    s_mov_b32 s55, 4751360
    buffer_load_dwordx4 v232, s[20:23], s55 offen lds
    v_mfma_f32_16x16x32_bf16 v[64:67], a[136:139], a[32:35], v[64:67]
    ds_read_b64_tr_b16 a[184:185], v225 offset:57344
    v_mfma_f32_16x16x32_bf16 v[68:71], a[136:139], a[36:39], v[68:71]
    v_mfma_f32_16x16x32_bf16 v[72:75], a[136:139], a[40:43], v[72:75]
    ds_read_b64_tr_b16 a[186:187], v225 offset:58368
    v_mfma_f32_16x16x32_bf16 v[76:79], a[136:139], a[44:47], v[76:79]
    v_mfma_f32_16x16x32_bf16 v[80:83], a[140:143], a[32:35], v[80:83]
    ds_read_b64_tr_b16 a[188:189], v225 offset:57352
    v_mfma_f32_16x16x32_bf16 v[84:87], a[140:143], a[36:39], v[84:87]
    s_add_u32 m0, s53, 83968
    s_mov_b32 s55, 4784128
    buffer_load_dwordx4 v232, s[20:23], s55 offen lds
    v_mfma_f32_16x16x32_bf16 v[88:91], a[140:143], a[40:43], v[88:91]
    ds_read_b64_tr_b16 a[190:191], v225 offset:58376
    v_mfma_f32_16x16x32_bf16 v[92:95], a[140:143], a[44:47], v[92:95]
    v_mfma_f32_16x16x32_bf16 v[96:99], a[144:147], a[32:35], v[96:99]
    ds_read_b64_tr_b16 a[192:193], v226 offset:57344
    v_mfma_f32_16x16x32_bf16 v[100:103], a[144:147], a[36:39], v[100:103]
    v_mfma_f32_16x16x32_bf16 v[104:107], a[144:147], a[40:43], v[104:107]
    ds_read_b64_tr_b16 a[194:195], v226 offset:58368
    v_mfma_f32_16x16x32_bf16 v[108:111], a[144:147], a[44:47], v[108:111]
    s_add_u32 m0, s53, 84992
    s_mov_b32 s55, 4816896
    buffer_load_dwordx4 v232, s[20:23], s55 offen lds
    v_mfma_f32_16x16x32_bf16 v[112:115], a[148:151], a[32:35], v[112:115]
    ds_read_b64_tr_b16 a[196:197], v226 offset:57352
    v_mfma_f32_16x16x32_bf16 v[116:119], a[148:151], a[36:39], v[116:119]
    v_mfma_f32_16x16x32_bf16 v[120:123], a[148:151], a[40:43], v[120:123]
    ds_read_b64_tr_b16 a[198:199], v226 offset:58376
    v_mfma_f32_16x16x32_bf16 v[124:127], a[148:151], a[44:47], v[124:127]
    v_mfma_f32_16x16x32_bf16 v[128:131], a[152:155], a[32:35], v[128:131]
    ds_read_b64_tr_b16 a[200:201], v227 offset:57344
    v_mfma_f32_16x16x32_bf16 v[132:135], a[152:155], a[36:39], v[132:135]
    s_add_u32 m0, s54, 16384
    s_mov_b32 s55, 1990656
    buffer_load_dwordx4 v233, s[24:27], s55 offen lds
    v_mfma_f32_16x16x32_bf16 v[136:139], a[152:155], a[40:43], v[136:139]
    ds_read_b64_tr_b16 a[202:203], v227 offset:58368
    v_mfma_f32_16x16x32_bf16 v[140:143], a[152:155], a[44:47], v[140:143]
    v_mfma_f32_16x16x32_bf16 v[144:147], a[156:159], a[32:35], v[144:147]
    ds_read_b64_tr_b16 a[204:205], v227 offset:57352
    v_mfma_f32_16x16x32_bf16 v[148:151], a[156:159], a[36:39], v[148:151]
    v_mfma_f32_16x16x32_bf16 v[152:155], a[156:159], a[40:43], v[152:155]
    ds_read_b64_tr_b16 a[206:207], v227 offset:58376
    v_mfma_f32_16x16x32_bf16 v[156:159], a[156:159], a[44:47], v[156:159]
    s_add_u32 m0, s54, 17408
    s_mov_b32 s55, 2018304
    buffer_load_dwordx4 v234, s[24:27], s55 offen lds
    v_mfma_f32_16x16x32_bf16 a[96:99], a[160:163], a[32:35], a[96:99]
    ds_read_b64_tr_b16 a[208:209], v228 offset:53248
    v_mfma_f32_16x16x32_bf16 a[100:103], a[160:163], a[36:39], a[100:103]
    v_mfma_f32_16x16x32_bf16 a[104:107], a[160:163], a[40:43], a[104:107]
    ds_read_b64_tr_b16 a[210:211], v228 offset:53760
    v_mfma_f32_16x16x32_bf16 a[108:111], a[160:163], a[44:47], a[108:111]
    s_waitcnt lgkmcnt(5)
    v_mfma_f32_16x16x32_bf16 a[112:115], a[164:167], a[32:35], a[112:115]
    ds_read_b64_tr_b16 a[212:213], v229 offset:53248
    v_mfma_f32_16x16x32_bf16 a[116:119], a[164:167], a[36:39], a[116:119]
    v_mfma_f32_16x16x32_bf16 a[120:123], a[164:167], a[40:43], a[120:123]
    ds_read_b64_tr_b16 a[214:215], v229 offset:53760
    v_mfma_f32_16x16x32_bf16 a[124:127], a[164:167], a[44:47], a[124:127]
    v_mfma_f32_16x16x32_bf16 a[224:227], a[168:171], a[32:35], a[224:227]
    ds_read_b64_tr_b16 a[216:217], v230 offset:53248
    v_mfma_f32_16x16x32_bf16 a[228:231], a[168:171], a[36:39], a[228:231]
    v_mfma_f32_16x16x32_bf16 a[232:235], a[168:171], a[40:43], a[232:235]
    ds_read_b64_tr_b16 a[218:219], v230 offset:53760
    v_mfma_f32_16x16x32_bf16 a[236:239], a[168:171], a[44:47], a[236:239]
    v_mfma_f32_16x16x32_bf16 a[240:243], a[172:175], a[32:35], a[240:243]
    ds_read_b64_tr_b16 a[220:221], v231 offset:53248
    v_mfma_f32_16x16x32_bf16 a[244:247], a[172:175], a[36:39], a[244:247]
    v_mfma_f32_16x16x32_bf16 a[248:251], a[172:175], a[40:43], a[248:251]
    ds_read_b64_tr_b16 a[222:223], v231 offset:53760
    v_mfma_f32_16x16x32_bf16 a[252:255], a[172:175], a[44:47], a[252:255]
    s_waitcnt vmcnt(14)
    s_barrier
    v_mfma_f32_16x16x32_bf16 v[32:35], a[176:179], a[48:51], v[32:35]
    ds_read_b64_tr_b16 a[128:129], v224 offset:0
    v_mfma_f32_16x16x32_bf16 v[36:39], a[176:179], a[52:55], v[36:39]
    s_add_u32 s56, s50, 18432
    buffer_load_dwordx4 a[0:3], v236, s[16:19], s56 offen offset:0
    v_mfma_f32_16x16x32_bf16 v[40:43], a[176:179], a[56:59], v[40:43]
    ds_read_b64_tr_b16 a[130:131], v224 offset:1024
    v_mfma_f32_16x16x32_bf16 v[44:47], a[176:179], a[60:63], v[44:47]
    v_mfma_f32_16x16x32_bf16 v[48:51], a[180:183], a[48:51], v[48:51]
    ds_read_b64_tr_b16 a[132:133], v224 offset:8
    v_mfma_f32_16x16x32_bf16 v[52:55], a[180:183], a[52:55], v[52:55]
    v_mfma_f32_16x16x32_bf16 v[56:59], a[180:183], a[56:59], v[56:59]
    ds_read_b64_tr_b16 a[134:135], v224 offset:1032
    v_mfma_f32_16x16x32_bf16 v[60:63], a[180:183], a[60:63], v[60:63]
    buffer_load_dwordx4 a[4:7], v237, s[16:19], s56 offen offset:0
    v_mfma_f32_16x16x32_bf16 v[64:67], a[184:187], a[48:51], v[64:67]
    ds_read_b64_tr_b16 a[136:137], v225 offset:0
    v_mfma_f32_16x16x32_bf16 v[68:71], a[184:187], a[52:55], v[68:71]
    v_mfma_f32_16x16x32_bf16 v[72:75], a[184:187], a[56:59], v[72:75]
    ds_read_b64_tr_b16 a[138:139], v225 offset:1024
    v_mfma_f32_16x16x32_bf16 v[76:79], a[184:187], a[60:63], v[76:79]
    v_mfma_f32_16x16x32_bf16 v[80:83], a[188:191], a[48:51], v[80:83]
    ds_read_b64_tr_b16 a[140:141], v225 offset:8
    v_mfma_f32_16x16x32_bf16 v[84:87], a[188:191], a[52:55], v[84:87]
    buffer_load_dwordx4 a[8:11], v238, s[16:19], s56 offen offset:0
    v_mfma_f32_16x16x32_bf16 v[88:91], a[188:191], a[56:59], v[88:91]
    ds_read_b64_tr_b16 a[142:143], v225 offset:1032
    v_mfma_f32_16x16x32_bf16 v[92:95], a[188:191], a[60:63], v[92:95]
    v_mfma_f32_16x16x32_bf16 v[96:99], a[192:195], a[48:51], v[96:99]
    ds_read_b64_tr_b16 a[144:145], v226 offset:0
    v_mfma_f32_16x16x32_bf16 v[100:103], a[192:195], a[52:55], v[100:103]
    v_mfma_f32_16x16x32_bf16 v[104:107], a[192:195], a[56:59], v[104:107]
    ds_read_b64_tr_b16 a[146:147], v226 offset:1024
    v_mfma_f32_16x16x32_bf16 v[108:111], a[192:195], a[60:63], v[108:111]
    buffer_load_dwordx4 a[12:15], v239, s[16:19], s56 offen offset:0
    v_mfma_f32_16x16x32_bf16 v[112:115], a[196:199], a[48:51], v[112:115]
    ds_read_b64_tr_b16 a[148:149], v226 offset:8
    v_mfma_f32_16x16x32_bf16 v[116:119], a[196:199], a[52:55], v[116:119]
    v_mfma_f32_16x16x32_bf16 v[120:123], a[196:199], a[56:59], v[120:123]
    ds_read_b64_tr_b16 a[150:151], v226 offset:1032
    v_mfma_f32_16x16x32_bf16 v[124:127], a[196:199], a[60:63], v[124:127]
    s_waitcnt lgkmcnt(6)
    v_mfma_f32_16x16x32_bf16 v[128:131], a[200:203], a[48:51], v[128:131]
    ds_read_b64_tr_b16 a[152:153], v227 offset:0
    v_mfma_f32_16x16x32_bf16 v[132:135], a[200:203], a[52:55], v[132:135]
    buffer_load_dwordx4 a[16:19], v236, s[16:19], s56 offen offset:1024
    v_mfma_f32_16x16x32_bf16 v[136:139], a[200:203], a[56:59], v[136:139]
    ds_read_b64_tr_b16 a[154:155], v227 offset:1024
    v_mfma_f32_16x16x32_bf16 v[140:143], a[200:203], a[60:63], v[140:143]
    v_mfma_f32_16x16x32_bf16 v[144:147], a[204:207], a[48:51], v[144:147]
    ds_read_b64_tr_b16 a[156:157], v227 offset:8
    v_mfma_f32_16x16x32_bf16 v[148:151], a[204:207], a[52:55], v[148:151]
    v_mfma_f32_16x16x32_bf16 v[152:155], a[204:207], a[56:59], v[152:155]
    ds_read_b64_tr_b16 a[158:159], v227 offset:1032
    v_mfma_f32_16x16x32_bf16 v[156:159], a[204:207], a[60:63], v[156:159]
    buffer_load_dwordx4 a[20:23], v237, s[16:19], s56 offen offset:1024
    v_mfma_f32_16x16x32_bf16 a[96:99], a[208:211], a[48:51], a[96:99]
    ds_read_b64_tr_b16 a[160:161], v228 offset:0
    v_mfma_f32_16x16x32_bf16 a[100:103], a[208:211], a[52:55], a[100:103]
    v_mfma_f32_16x16x32_bf16 a[104:107], a[208:211], a[56:59], a[104:107]
    ds_read_b64_tr_b16 a[162:163], v228 offset:512
    v_mfma_f32_16x16x32_bf16 a[108:111], a[208:211], a[60:63], a[108:111]
    v_mfma_f32_16x16x32_bf16 a[112:115], a[212:215], a[48:51], a[112:115]
    ds_read_b64_tr_b16 a[164:165], v229 offset:0
    v_mfma_f32_16x16x32_bf16 a[116:119], a[212:215], a[52:55], a[116:119]
    buffer_load_dwordx4 a[24:27], v238, s[16:19], s56 offen offset:1024
    v_mfma_f32_16x16x32_bf16 a[120:123], a[212:215], a[56:59], a[120:123]
    ds_read_b64_tr_b16 a[166:167], v229 offset:512
    v_mfma_f32_16x16x32_bf16 a[124:127], a[212:215], a[60:63], a[124:127]
    v_mfma_f32_16x16x32_bf16 a[224:227], a[216:219], a[48:51], a[224:227]
    ds_read_b64_tr_b16 a[168:169], v230 offset:0
    v_mfma_f32_16x16x32_bf16 a[228:231], a[216:219], a[52:55], a[228:231]
    v_mfma_f32_16x16x32_bf16 a[232:235], a[216:219], a[56:59], a[232:235]
    ds_read_b64_tr_b16 a[170:171], v230 offset:512
    v_mfma_f32_16x16x32_bf16 a[236:239], a[216:219], a[60:63], a[236:239]
    buffer_load_dwordx4 a[28:31], v239, s[16:19], s56 offen offset:1024
    v_mfma_f32_16x16x32_bf16 a[240:243], a[220:223], a[48:51], a[240:243]
    ds_read_b64_tr_b16 a[172:173], v231 offset:0
    v_mfma_f32_16x16x32_bf16 a[244:247], a[220:223], a[52:55], a[244:247]
    v_mfma_f32_16x16x32_bf16 a[248:251], a[220:223], a[56:59], a[248:251]
    ds_read_b64_tr_b16 a[174:175], v231 offset:512
    v_mfma_f32_16x16x32_bf16 a[252:255], a[220:223], a[60:63], a[252:255]
    s_waitcnt vmcnt(14)
    v_mfma_f32_16x16x32_bf16 v[32:35], a[128:131], a[64:67], v[32:35]
    ds_read_b64_tr_b16 a[176:177], v224 offset:8192
    v_mfma_f32_16x16x32_bf16 v[36:39], a[128:131], a[68:71], v[36:39]
    v_mfma_f32_16x16x32_bf16 v[40:43], a[128:131], a[72:75], v[40:43]
    ds_read_b64_tr_b16 a[178:179], v224 offset:9216
    v_mfma_f32_16x16x32_bf16 v[44:47], a[128:131], a[76:79], v[44:47]
    v_mfma_f32_16x16x32_bf16 v[48:51], a[132:135], a[64:67], v[48:51]
    ds_read_b64_tr_b16 a[180:181], v224 offset:8200
    v_mfma_f32_16x16x32_bf16 v[52:55], a[132:135], a[68:71], v[52:55]
    v_mfma_f32_16x16x32_bf16 v[56:59], a[132:135], a[72:75], v[56:59]
    ds_read_b64_tr_b16 a[182:183], v224 offset:9224
    v_mfma_f32_16x16x32_bf16 v[60:63], a[132:135], a[76:79], v[60:63]
    v_mfma_f32_16x16x32_bf16 v[64:67], a[136:139], a[64:67], v[64:67]
    ds_read_b64_tr_b16 a[184:185], v225 offset:8192
    v_mfma_f32_16x16x32_bf16 v[68:71], a[136:139], a[68:71], v[68:71]
    v_mfma_f32_16x16x32_bf16 v[72:75], a[136:139], a[72:75], v[72:75]
    ds_read_b64_tr_b16 a[186:187], v225 offset:9216
    v_mfma_f32_16x16x32_bf16 v[76:79], a[136:139], a[76:79], v[76:79]
    s_waitcnt lgkmcnt(6)
    v_mfma_f32_16x16x32_bf16 v[80:83], a[140:143], a[64:67], v[80:83]
    ds_read_b64_tr_b16 a[188:189], v225 offset:8200
    v_mfma_f32_16x16x32_bf16 v[84:87], a[140:143], a[68:71], v[84:87]
    v_mfma_f32_16x16x32_bf16 v[88:91], a[140:143], a[72:75], v[88:91]
    ds_read_b64_tr_b16 a[190:191], v225 offset:9224
    v_mfma_f32_16x16x32_bf16 v[92:95], a[140:143], a[76:79], v[92:95]
    v_mfma_f32_16x16x32_bf16 v[96:99], a[144:147], a[64:67], v[96:99]
    ds_read_b64_tr_b16 a[192:193], v226 offset:8192
    v_mfma_f32_16x16x32_bf16 v[100:103], a[144:147], a[68:71], v[100:103]
    v_mfma_f32_16x16x32_bf16 v[104:107], a[144:147], a[72:75], v[104:107]
    ds_read_b64_tr_b16 a[194:195], v226 offset:9216
    v_mfma_f32_16x16x32_bf16 v[108:111], a[144:147], a[76:79], v[108:111]
    v_mfma_f32_16x16x32_bf16 v[112:115], a[148:151], a[64:67], v[112:115]
    ds_read_b64_tr_b16 a[196:197], v226 offset:8200
    v_mfma_f32_16x16x32_bf16 v[116:119], a[148:151], a[68:71], v[116:119]
    v_mfma_f32_16x16x32_bf16 v[120:123], a[148:151], a[72:75], v[120:123]
    ds_read_b64_tr_b16 a[198:199], v226 offset:9224
    v_mfma_f32_16x16x32_bf16 v[124:127], a[148:151], a[76:79], v[124:127]
    v_mfma_f32_16x16x32_bf16 v[128:131], a[152:155], a[64:67], v[128:131]
    ds_read_b64_tr_b16 a[200:201], v227 offset:8192
    v_mfma_f32_16x16x32_bf16 v[132:135], a[152:155], a[68:71], v[132:135]
    v_mfma_f32_16x16x32_bf16 v[136:139], a[152:155], a[72:75], v[136:139]
    ds_read_b64_tr_b16 a[202:203], v227 offset:9216
    v_mfma_f32_16x16x32_bf16 v[140:143], a[152:155], a[76:79], v[140:143]
    v_mfma_f32_16x16x32_bf16 v[144:147], a[156:159], a[64:67], v[144:147]
    ds_read_b64_tr_b16 a[204:205], v227 offset:8200
    v_mfma_f32_16x16x32_bf16 v[148:151], a[156:159], a[68:71], v[148:151]
    v_mfma_f32_16x16x32_bf16 v[152:155], a[156:159], a[72:75], v[152:155]
    ds_read_b64_tr_b16 a[206:207], v227 offset:9224
    v_mfma_f32_16x16x32_bf16 v[156:159], a[156:159], a[76:79], v[156:159]
    v_mfma_f32_16x16x32_bf16 a[96:99], a[160:163], a[64:67], a[96:99]
    ds_read_b64_tr_b16 a[208:209], v228 offset:4096
    v_mfma_f32_16x16x32_bf16 a[100:103], a[160:163], a[68:71], a[100:103]
    v_mfma_f32_16x16x32_bf16 a[104:107], a[160:163], a[72:75], a[104:107]
    ds_read_b64_tr_b16 a[210:211], v228 offset:4608
    v_mfma_f32_16x16x32_bf16 a[108:111], a[160:163], a[76:79], a[108:111]
    v_mfma_f32_16x16x32_bf16 a[112:115], a[164:167], a[64:67], a[112:115]
    ds_read_b64_tr_b16 a[212:213], v229 offset:4096
    v_mfma_f32_16x16x32_bf16 a[116:119], a[164:167], a[68:71], a[116:119]
    v_mfma_f32_16x16x32_bf16 a[120:123], a[164:167], a[72:75], a[120:123]
    ds_read_b64_tr_b16 a[214:215], v229 offset:4608
    v_mfma_f32_16x16x32_bf16 a[124:127], a[164:167], a[76:79], a[124:127]
    v_mfma_f32_16x16x32_bf16 a[224:227], a[168:171], a[64:67], a[224:227]
    ds_read_b64_tr_b16 a[216:217], v230 offset:4096
    v_mfma_f32_16x16x32_bf16 a[228:231], a[168:171], a[68:71], a[228:231]
    v_mfma_f32_16x16x32_bf16 a[232:235], a[168:171], a[72:75], a[232:235]
    ds_read_b64_tr_b16 a[218:219], v230 offset:4608
    v_mfma_f32_16x16x32_bf16 a[236:239], a[168:171], a[76:79], a[236:239]
    v_mfma_f32_16x16x32_bf16 a[240:243], a[172:175], a[64:67], a[240:243]
    ds_read_b64_tr_b16 a[220:221], v231 offset:4096
    v_mfma_f32_16x16x32_bf16 a[244:247], a[172:175], a[68:71], a[244:247]
    v_mfma_f32_16x16x32_bf16 a[248:251], a[172:175], a[72:75], a[248:251]
    ds_read_b64_tr_b16 a[222:223], v231 offset:4608
    v_mfma_f32_16x16x32_bf16 a[252:255], a[172:175], a[76:79], a[252:255]
    s_waitcnt vmcnt(8)
    s_barrier
    s_waitcnt lgkmcnt(6)
    v_mfma_f32_16x16x32_bf16 v[32:35], a[176:179], a[80:83], v[32:35]
    ds_read_b64_tr_b16 a[128:129], v224 offset:16384
    v_mfma_f32_16x16x32_bf16 v[36:39], a[176:179], a[84:87], v[36:39]
    v_mfma_f32_16x16x32_bf16 v[40:43], a[176:179], a[88:91], v[40:43]
    ds_read_b64_tr_b16 a[130:131], v224 offset:17408
    v_mfma_f32_16x16x32_bf16 v[44:47], a[176:179], a[92:95], v[44:47]
    v_mfma_f32_16x16x32_bf16 v[48:51], a[180:183], a[80:83], v[48:51]
    ds_read_b64_tr_b16 a[132:133], v224 offset:16392
    v_mfma_f32_16x16x32_bf16 v[52:55], a[180:183], a[84:87], v[52:55]
    v_mfma_f32_16x16x32_bf16 v[56:59], a[180:183], a[88:91], v[56:59]
    ds_read_b64_tr_b16 a[134:135], v224 offset:17416
    v_mfma_f32_16x16x32_bf16 v[60:63], a[180:183], a[92:95], v[60:63]
    v_mfma_f32_16x16x32_bf16 v[64:67], a[184:187], a[80:83], v[64:67]
    ds_read_b64_tr_b16 a[136:137], v225 offset:16384
    v_mfma_f32_16x16x32_bf16 v[68:71], a[184:187], a[84:87], v[68:71]
    v_mfma_f32_16x16x32_bf16 v[72:75], a[184:187], a[88:91], v[72:75]
    ds_read_b64_tr_b16 a[138:139], v225 offset:17408
    v_mfma_f32_16x16x32_bf16 v[76:79], a[184:187], a[92:95], v[76:79]
    v_mfma_f32_16x16x32_bf16 v[80:83], a[188:191], a[80:83], v[80:83]
    ds_read_b64_tr_b16 a[140:141], v225 offset:16392
    v_mfma_f32_16x16x32_bf16 v[84:87], a[188:191], a[84:87], v[84:87]
    v_mfma_f32_16x16x32_bf16 v[88:91], a[188:191], a[88:91], v[88:91]
    ds_read_b64_tr_b16 a[142:143], v225 offset:17416
    v_mfma_f32_16x16x32_bf16 v[92:95], a[188:191], a[92:95], v[92:95]
    v_mfma_f32_16x16x32_bf16 v[96:99], a[192:195], a[80:83], v[96:99]
    ds_read_b64_tr_b16 a[144:145], v226 offset:16384
    v_mfma_f32_16x16x32_bf16 v[100:103], a[192:195], a[84:87], v[100:103]
    v_mfma_f32_16x16x32_bf16 v[104:107], a[192:195], a[88:91], v[104:107]
    ds_read_b64_tr_b16 a[146:147], v226 offset:17408
    v_mfma_f32_16x16x32_bf16 v[108:111], a[192:195], a[92:95], v[108:111]
    v_mfma_f32_16x16x32_bf16 v[112:115], a[196:199], a[80:83], v[112:115]
    ds_read_b64_tr_b16 a[148:149], v226 offset:16392
    v_mfma_f32_16x16x32_bf16 v[116:119], a[196:199], a[84:87], v[116:119]
    v_mfma_f32_16x16x32_bf16 v[120:123], a[196:199], a[88:91], v[120:123]
    ds_read_b64_tr_b16 a[150:151], v226 offset:17416
    v_mfma_f32_16x16x32_bf16 v[124:127], a[196:199], a[92:95], v[124:127]
    v_mfma_f32_16x16x32_bf16 v[128:131], a[200:203], a[80:83], v[128:131]
    ds_read_b64_tr_b16 a[152:153], v227 offset:16384
    v_mfma_f32_16x16x32_bf16 v[132:135], a[200:203], a[84:87], v[132:135]
    v_mfma_f32_16x16x32_bf16 v[136:139], a[200:203], a[88:91], v[136:139]
    ds_read_b64_tr_b16 a[154:155], v227 offset:17408
    v_mfma_f32_16x16x32_bf16 v[140:143], a[200:203], a[92:95], v[140:143]
    v_mfma_f32_16x16x32_bf16 v[144:147], a[204:207], a[80:83], v[144:147]
    ds_read_b64_tr_b16 a[156:157], v227 offset:16392
    v_mfma_f32_16x16x32_bf16 v[148:151], a[204:207], a[84:87], v[148:151]
    v_mfma_f32_16x16x32_bf16 v[152:155], a[204:207], a[88:91], v[152:155]
    ds_read_b64_tr_b16 a[158:159], v227 offset:17416
    v_mfma_f32_16x16x32_bf16 v[156:159], a[204:207], a[92:95], v[156:159]
    v_mfma_f32_16x16x32_bf16 a[96:99], a[208:211], a[80:83], a[96:99]
    ds_read_b64_tr_b16 a[160:161], v228 offset:16384
    v_mfma_f32_16x16x32_bf16 a[100:103], a[208:211], a[84:87], a[100:103]
    v_mfma_f32_16x16x32_bf16 a[104:107], a[208:211], a[88:91], a[104:107]
    ds_read_b64_tr_b16 a[162:163], v228 offset:16896
    v_mfma_f32_16x16x32_bf16 a[108:111], a[208:211], a[92:95], a[108:111]
    s_waitcnt lgkmcnt(6)
    v_mfma_f32_16x16x32_bf16 a[112:115], a[212:215], a[80:83], a[112:115]
    ds_read_b64_tr_b16 a[164:165], v229 offset:16384
    v_mfma_f32_16x16x32_bf16 a[116:119], a[212:215], a[84:87], a[116:119]
    v_mfma_f32_16x16x32_bf16 a[120:123], a[212:215], a[88:91], a[120:123]
    ds_read_b64_tr_b16 a[166:167], v229 offset:16896
    v_mfma_f32_16x16x32_bf16 a[124:127], a[212:215], a[92:95], a[124:127]
    v_mfma_f32_16x16x32_bf16 a[224:227], a[216:219], a[80:83], a[224:227]
    ds_read_b64_tr_b16 a[168:169], v230 offset:16384
    v_mfma_f32_16x16x32_bf16 a[228:231], a[216:219], a[84:87], a[228:231]
    v_mfma_f32_16x16x32_bf16 a[232:235], a[216:219], a[88:91], a[232:235]
    ds_read_b64_tr_b16 a[170:171], v230 offset:16896
    v_mfma_f32_16x16x32_bf16 a[236:239], a[216:219], a[92:95], a[236:239]
    v_mfma_f32_16x16x32_bf16 a[240:243], a[220:223], a[80:83], a[240:243]
    ds_read_b64_tr_b16 a[172:173], v231 offset:16384
    v_mfma_f32_16x16x32_bf16 a[244:247], a[220:223], a[84:87], a[244:247]
    v_mfma_f32_16x16x32_bf16 a[248:251], a[220:223], a[88:91], a[248:251]
    ds_read_b64_tr_b16 a[174:175], v231 offset:16896
    v_mfma_f32_16x16x32_bf16 a[252:255], a[220:223], a[92:95], a[252:255]
    s_waitcnt vmcnt(0)
    v_mfma_f32_16x16x32_bf16 v[32:35], a[128:131], a[0:3], v[32:35]
    ds_read_b64_tr_b16 a[176:177], v224 offset:24576
    v_mfma_f32_16x16x32_bf16 v[36:39], a[128:131], a[4:7], v[36:39]
    v_mfma_f32_16x16x32_bf16 v[40:43], a[128:131], a[8:11], v[40:43]
    ds_read_b64_tr_b16 a[178:179], v224 offset:25600
    v_mfma_f32_16x16x32_bf16 v[44:47], a[128:131], a[12:15], v[44:47]
    v_mfma_f32_16x16x32_bf16 v[48:51], a[132:135], a[0:3], v[48:51]
    ds_read_b64_tr_b16 a[180:181], v224 offset:24584
    v_mfma_f32_16x16x32_bf16 v[52:55], a[132:135], a[4:7], v[52:55]
    v_mfma_f32_16x16x32_bf16 v[56:59], a[132:135], a[8:11], v[56:59]
    ds_read_b64_tr_b16 a[182:183], v224 offset:25608
    v_mfma_f32_16x16x32_bf16 v[60:63], a[132:135], a[12:15], v[60:63]
    v_mfma_f32_16x16x32_bf16 v[64:67], a[136:139], a[0:3], v[64:67]
    ds_read_b64_tr_b16 a[184:185], v225 offset:24576
    v_mfma_f32_16x16x32_bf16 v[68:71], a[136:139], a[4:7], v[68:71]
    v_mfma_f32_16x16x32_bf16 v[72:75], a[136:139], a[8:11], v[72:75]
    ds_read_b64_tr_b16 a[186:187], v225 offset:25600
    v_mfma_f32_16x16x32_bf16 v[76:79], a[136:139], a[12:15], v[76:79]
    v_mfma_f32_16x16x32_bf16 v[80:83], a[140:143], a[0:3], v[80:83]
    ds_read_b64_tr_b16 a[188:189], v225 offset:24584
    v_mfma_f32_16x16x32_bf16 v[84:87], a[140:143], a[4:7], v[84:87]
    v_mfma_f32_16x16x32_bf16 v[88:91], a[140:143], a[8:11], v[88:91]
    ds_read_b64_tr_b16 a[190:191], v225 offset:25608
    v_mfma_f32_16x16x32_bf16 v[92:95], a[140:143], a[12:15], v[92:95]
    v_mfma_f32_16x16x32_bf16 v[96:99], a[144:147], a[0:3], v[96:99]
    ds_read_b64_tr_b16 a[192:193], v226 offset:24576
    v_mfma_f32_16x16x32_bf16 v[100:103], a[144:147], a[4:7], v[100:103]
    v_mfma_f32_16x16x32_bf16 v[104:107], a[144:147], a[8:11], v[104:107]
    ds_read_b64_tr_b16 a[194:195], v226 offset:25600
    v_mfma_f32_16x16x32_bf16 v[108:111], a[144:147], a[12:15], v[108:111]
    v_mfma_f32_16x16x32_bf16 v[112:115], a[148:151], a[0:3], v[112:115]
    ds_read_b64_tr_b16 a[196:197], v226 offset:24584
    v_mfma_f32_16x16x32_bf16 v[116:119], a[148:151], a[4:7], v[116:119]
    v_mfma_f32_16x16x32_bf16 v[120:123], a[148:151], a[8:11], v[120:123]
    ds_read_b64_tr_b16 a[198:199], v226 offset:25608
    v_mfma_f32_16x16x32_bf16 v[124:127], a[148:151], a[12:15], v[124:127]
    s_waitcnt lgkmcnt(6)
    v_mfma_f32_16x16x32_bf16 v[128:131], a[152:155], a[0:3], v[128:131]
    ds_read_b64_tr_b16 a[200:201], v227 offset:24576
    v_mfma_f32_16x16x32_bf16 v[132:135], a[152:155], a[4:7], v[132:135]
    v_mfma_f32_16x16x32_bf16 v[136:139], a[152:155], a[8:11], v[136:139]
    ds_read_b64_tr_b16 a[202:203], v227 offset:25600
    v_mfma_f32_16x16x32_bf16 v[140:143], a[152:155], a[12:15], v[140:143]
    v_mfma_f32_16x16x32_bf16 v[144:147], a[156:159], a[0:3], v[144:147]
    ds_read_b64_tr_b16 a[204:205], v227 offset:24584
    v_mfma_f32_16x16x32_bf16 v[148:151], a[156:159], a[4:7], v[148:151]
    v_mfma_f32_16x16x32_bf16 v[152:155], a[156:159], a[8:11], v[152:155]
    ds_read_b64_tr_b16 a[206:207], v227 offset:25608
    v_mfma_f32_16x16x32_bf16 v[156:159], a[156:159], a[12:15], v[156:159]
    v_mfma_f32_16x16x32_bf16 a[96:99], a[160:163], a[0:3], a[96:99]
    ds_read_b64_tr_b16 a[208:209], v228 offset:20480
    v_mfma_f32_16x16x32_bf16 a[100:103], a[160:163], a[4:7], a[100:103]
    v_mfma_f32_16x16x32_bf16 a[104:107], a[160:163], a[8:11], a[104:107]
    ds_read_b64_tr_b16 a[210:211], v228 offset:20992
    v_mfma_f32_16x16x32_bf16 a[108:111], a[160:163], a[12:15], a[108:111]
    v_mfma_f32_16x16x32_bf16 a[112:115], a[164:167], a[0:3], a[112:115]
    ds_read_b64_tr_b16 a[212:213], v229 offset:20480
    v_mfma_f32_16x16x32_bf16 a[116:119], a[164:167], a[4:7], a[116:119]
    v_mfma_f32_16x16x32_bf16 a[120:123], a[164:167], a[8:11], a[120:123]
    ds_read_b64_tr_b16 a[214:215], v229 offset:20992
    v_mfma_f32_16x16x32_bf16 a[124:127], a[164:167], a[12:15], a[124:127]
    v_mfma_f32_16x16x32_bf16 a[224:227], a[168:171], a[0:3], a[224:227]
    ds_read_b64_tr_b16 a[216:217], v230 offset:20480
    v_mfma_f32_16x16x32_bf16 a[228:231], a[168:171], a[4:7], a[228:231]
    v_mfma_f32_16x16x32_bf16 a[232:235], a[168:171], a[8:11], a[232:235]
    ds_read_b64_tr_b16 a[218:219], v230 offset:20992
    v_mfma_f32_16x16x32_bf16 a[236:239], a[168:171], a[12:15], a[236:239]
    v_mfma_f32_16x16x32_bf16 a[240:243], a[172:175], a[0:3], a[240:243]
    ds_read_b64_tr_b16 a[220:221], v231 offset:20480
    v_mfma_f32_16x16x32_bf16 a[244:247], a[172:175], a[4:7], a[244:247]
    v_mfma_f32_16x16x32_bf16 a[248:251], a[172:175], a[8:11], a[248:251]
    ds_read_b64_tr_b16 a[222:223], v231 offset:20992
    v_mfma_f32_16x16x32_bf16 a[252:255], a[172:175], a[12:15], a[252:255]
    s_waitcnt lgkmcnt(0)
    s_barrier
    v_mfma_f32_16x16x32_bf16 v[32:35], a[176:179], a[16:19], v[32:35]
    v_mfma_f32_16x16x32_bf16 v[36:39], a[176:179], a[20:23], v[36:39]
    s_mov_b32 s55, 0
    s_add_u32 m0, s53, 0
    s_nop 0
    buffer_load_dwordx4 v20, s[8:11], s55 offen offset:0 lds
    v_mfma_f32_16x16x32_bf16 v[40:43], a[176:179], a[24:27], v[40:43]
    v_mfma_f32_16x16x32_bf16 v[44:47], a[176:179], a[28:31], v[44:47]
    v_mfma_f32_16x16x32_bf16 v[48:51], a[180:183], a[16:19], v[48:51]
    v_mfma_f32_16x16x32_bf16 v[52:55], a[180:183], a[20:23], v[52:55]
    v_mfma_f32_16x16x32_bf16 v[56:59], a[180:183], a[24:27], v[56:59]
    v_mfma_f32_16x16x32_bf16 v[60:63], a[180:183], a[28:31], v[60:63]
    buffer_load_dwordx4 v21, s[8:11], s55 offen offset:1024 lds
    v_mfma_f32_16x16x32_bf16 v[64:67], a[184:187], a[16:19], v[64:67]
    v_mfma_f32_16x16x32_bf16 v[68:71], a[184:187], a[20:23], v[68:71]
    v_mfma_f32_16x16x32_bf16 v[72:75], a[184:187], a[24:27], v[72:75]
    v_mfma_f32_16x16x32_bf16 v[76:79], a[184:187], a[28:31], v[76:79]
    v_mfma_f32_16x16x32_bf16 v[80:83], a[188:191], a[16:19], v[80:83]
    v_mfma_f32_16x16x32_bf16 v[84:87], a[188:191], a[20:23], v[84:87]
    buffer_load_dwordx4 v22, s[8:11], s55 offen offset:2048 lds
    v_mfma_f32_16x16x32_bf16 v[88:91], a[188:191], a[24:27], v[88:91]
    v_mfma_f32_16x16x32_bf16 v[92:95], a[188:191], a[28:31], v[92:95]
    v_mfma_f32_16x16x32_bf16 v[96:99], a[192:195], a[16:19], v[96:99]
    v_mfma_f32_16x16x32_bf16 v[100:103], a[192:195], a[20:23], v[100:103]
    v_mfma_f32_16x16x32_bf16 v[104:107], a[192:195], a[24:27], v[104:107]
    v_mfma_f32_16x16x32_bf16 v[108:111], a[192:195], a[28:31], v[108:111]
    buffer_load_dwordx4 v23, s[8:11], s55 offen offset:3072 lds
    v_mfma_f32_16x16x32_bf16 v[112:115], a[196:199], a[16:19], v[112:115]
    v_mfma_f32_16x16x32_bf16 v[116:119], a[196:199], a[20:23], v[116:119]
    v_mfma_f32_16x16x32_bf16 v[120:123], a[196:199], a[24:27], v[120:123]
    v_mfma_f32_16x16x32_bf16 v[124:127], a[196:199], a[28:31], v[124:127]
    v_mfma_f32_16x16x32_bf16 v[128:131], a[200:203], a[16:19], v[128:131]
    v_mfma_f32_16x16x32_bf16 v[132:135], a[200:203], a[20:23], v[132:135]
    s_mov_b32 s55, 0
    s_add_u32 m0, s53, 65536
    s_nop 0
    buffer_load_dwordx4 v24, s[12:15], s55 offen offset:0 lds
    v_mfma_f32_16x16x32_bf16 v[136:139], a[200:203], a[24:27], v[136:139]
    v_mfma_f32_16x16x32_bf16 v[140:143], a[200:203], a[28:31], v[140:143]
    v_mfma_f32_16x16x32_bf16 v[144:147], a[204:207], a[16:19], v[144:147]
    v_mfma_f32_16x16x32_bf16 v[148:151], a[204:207], a[20:23], v[148:151]
    v_mfma_f32_16x16x32_bf16 v[152:155], a[204:207], a[24:27], v[152:155]
    v_mfma_f32_16x16x32_bf16 v[156:159], a[204:207], a[28:31], v[156:159]
    buffer_load_dwordx4 v25, s[12:15], s55 offen offset:1024 lds
    v_mfma_f32_16x16x32_bf16 a[96:99], a[208:211], a[16:19], a[96:99]
    v_mfma_f32_16x16x32_bf16 a[100:103], a[208:211], a[20:23], a[100:103]
    v_mfma_f32_16x16x32_bf16 a[104:107], a[208:211], a[24:27], a[104:107]
    v_mfma_f32_16x16x32_bf16 a[108:111], a[208:211], a[28:31], a[108:111]
    v_mfma_f32_16x16x32_bf16 a[112:115], a[212:215], a[16:19], a[112:115]
    v_mfma_f32_16x16x32_bf16 a[116:119], a[212:215], a[20:23], a[116:119]
    buffer_load_dwordx4 v24, s[12:15], s55 offen offset:2048 lds
    v_mfma_f32_16x16x32_bf16 a[120:123], a[212:215], a[24:27], a[120:123]
    v_mfma_f32_16x16x32_bf16 a[124:127], a[212:215], a[28:31], a[124:127]
    v_mfma_f32_16x16x32_bf16 a[224:227], a[216:219], a[16:19], a[224:227]
    v_mfma_f32_16x16x32_bf16 a[228:231], a[216:219], a[20:23], a[228:231]
    v_mfma_f32_16x16x32_bf16 a[232:235], a[216:219], a[24:27], a[232:235]
    v_mfma_f32_16x16x32_bf16 a[236:239], a[216:219], a[28:31], a[236:239]
    buffer_load_dwordx4 v25, s[12:15], s55 offen offset:3072 lds
    v_mfma_f32_16x16x32_bf16 a[240:243], a[220:223], a[16:19], a[240:243]
    v_mfma_f32_16x16x32_bf16 a[244:247], a[220:223], a[20:23], a[244:247]
    v_mfma_f32_16x16x32_bf16 a[248:251], a[220:223], a[24:27], a[248:251]
    v_mfma_f32_16x16x32_bf16 a[252:255], a[220:223], a[28:31], a[252:255]
    s_mov_b32 s57, 65536
    s_mov_b32 s58, 32768
    s_mov_b32 s60, 0x3e0293ee
    s_mov_b32 s61, 0x3e0293ee
    s_mov_b32 s62, 0xbfb8aa3b
    s_mov_b32 s63, 0xbfb8aa3b
    s_mov_b32 s36, s28
    s_mov_b32 s37, s29
    s_mov_b32 s39, 0x00020000
    s_cmp_ge_u32 s4, 27
    s_cselect_b32 s38, 0, s30
    s_lshl_b32 s51, s4, 11
    s_add_u32 s51, s51, 131072
    s_add_u32 s51, s51, s52
    s_nop 3
    v_pk_mul_f32 v[32:33], v[32:33], s[60:61]
    v_pk_mul_f32 v[34:35], v[34:35], s[60:61]
    v_pk_mul_f32 v[48:49], v[48:49], s[60:61]
    v_pk_mul_f32 v[50:51], v[50:51], s[60:61]
    v_cvt_pk_bf16_f32 v160, v32, v33
    v_cvt_pk_bf16_f32 v161, v34, v35
    v_cvt_pk_bf16_f32 v162, v48, v49
    v_cvt_pk_bf16_f32 v163, v50, v51
    v_pk_mul_f32 v[64:65], v[64:65], s[60:61]
    v_pk_mul_f32 v[66:67], v[66:67], s[60:61]
    v_pk_mul_f32 v[80:81], v[80:81], s[60:61]
    v_pk_mul_f32 v[82:83], v[82:83], s[60:61]
    v_cvt_pk_bf16_f32 v164, v64, v65
    v_cvt_pk_bf16_f32 v165, v66, v67
    v_cvt_pk_bf16_f32 v166, v80, v81
    v_cvt_pk_bf16_f32 v167, v82, v83
    v_pk_mul_f32 v[96:97], v[96:97], s[60:61]
    v_pk_mul_f32 v[98:99], v[98:99], s[60:61]
    v_pk_mul_f32 v[112:113], v[112:113], s[60:61]
    v_pk_mul_f32 v[114:115], v[114:115], s[60:61]
    v_cvt_pk_bf16_f32 v168, v96, v97
    v_cvt_pk_bf16_f32 v169, v98, v99
    v_cvt_pk_bf16_f32 v170, v112, v113
    v_cvt_pk_bf16_f32 v171, v114, v115
    v_pk_mul_f32 v[128:129], v[128:129], s[60:61]
    v_pk_mul_f32 v[130:131], v[130:131], s[60:61]
    v_pk_mul_f32 v[144:145], v[144:145], s[60:61]
    s_mov_b32 s55, 16384
    s_add_u32 m0, s53, 16384
    s_nop 0
    buffer_load_dwordx4 v20, s[8:11], s55 offen offset:0 lds
    v_pk_mul_f32 v[146:147], v[146:147], s[60:61]
    v_cvt_pk_bf16_f32 v172, v128, v129
    v_cvt_pk_bf16_f32 v173, v130, v131
    v_cvt_pk_bf16_f32 v174, v144, v145
    v_cvt_pk_bf16_f32 v175, v146, v147
    v_pk_mul_f32 v[36:37], v[36:37], s[60:61]
    v_pk_mul_f32 v[38:39], v[38:39], s[60:61]
    v_pk_mul_f32 v[52:53], v[52:53], s[60:61]
    v_pk_mul_f32 v[54:55], v[54:55], s[60:61]
    v_cvt_pk_bf16_f32 v176, v36, v37
    v_cvt_pk_bf16_f32 v177, v38, v39
    v_cvt_pk_bf16_f32 v178, v52, v53
    v_cvt_pk_bf16_f32 v179, v54, v55
    v_pk_mul_f32 v[68:69], v[68:69], s[60:61]
    v_pk_mul_f32 v[70:71], v[70:71], s[60:61]
    v_pk_mul_f32 v[84:85], v[84:85], s[60:61]
    v_pk_mul_f32 v[86:87], v[86:87], s[60:61]
    v_cvt_pk_bf16_f32 v180, v68, v69
    v_cvt_pk_bf16_f32 v181, v70, v71
    v_cvt_pk_bf16_f32 v182, v84, v85
    v_cvt_pk_bf16_f32 v183, v86, v87
    v_pk_mul_f32 v[100:101], v[100:101], s[60:61]
    v_pk_mul_f32 v[102:103], v[102:103], s[60:61]
    v_pk_mul_f32 v[116:117], v[116:117], s[60:61]
    v_pk_mul_f32 v[118:119], v[118:119], s[60:61]
    v_cvt_pk_bf16_f32 v184, v100, v101
    v_cvt_pk_bf16_f32 v185, v102, v103
    buffer_load_dwordx4 v21, s[8:11], s55 offen offset:1024 lds
    v_cvt_pk_bf16_f32 v186, v116, v117
    v_cvt_pk_bf16_f32 v187, v118, v119
    v_pk_mul_f32 v[132:133], v[132:133], s[60:61]
    v_pk_mul_f32 v[134:135], v[134:135], s[60:61]
    v_pk_mul_f32 v[148:149], v[148:149], s[60:61]
    v_pk_mul_f32 v[150:151], v[150:151], s[60:61]
    v_cvt_pk_bf16_f32 v188, v132, v133
    v_cvt_pk_bf16_f32 v189, v134, v135
    v_cvt_pk_bf16_f32 v190, v148, v149
    v_cvt_pk_bf16_f32 v191, v150, v151
    v_pk_mul_f32 v[40:41], v[40:41], s[60:61]
    v_pk_mul_f32 v[42:43], v[42:43], s[60:61]
    v_pk_mul_f32 v[56:57], v[56:57], s[60:61]
    v_pk_mul_f32 v[58:59], v[58:59], s[60:61]
    v_cvt_pk_bf16_f32 v192, v40, v41
    v_cvt_pk_bf16_f32 v193, v42, v43
    v_cvt_pk_bf16_f32 v194, v56, v57
    v_cvt_pk_bf16_f32 v195, v58, v59
    v_pk_mul_f32 v[72:73], v[72:73], s[60:61]
    v_pk_mul_f32 v[74:75], v[74:75], s[60:61]
    v_pk_mul_f32 v[88:89], v[88:89], s[60:61]
    v_pk_mul_f32 v[90:91], v[90:91], s[60:61]
    v_cvt_pk_bf16_f32 v196, v72, v73
    v_cvt_pk_bf16_f32 v197, v74, v75
    v_cvt_pk_bf16_f32 v198, v88, v89
    v_cvt_pk_bf16_f32 v199, v90, v91
    v_pk_mul_f32 v[104:105], v[104:105], s[60:61]
    buffer_load_dwordx4 v22, s[8:11], s55 offen offset:2048 lds
    v_pk_mul_f32 v[106:107], v[106:107], s[60:61]
    v_pk_mul_f32 v[120:121], v[120:121], s[60:61]
    v_pk_mul_f32 v[122:123], v[122:123], s[60:61]
    v_cvt_pk_bf16_f32 v200, v104, v105
    v_cvt_pk_bf16_f32 v201, v106, v107
    v_cvt_pk_bf16_f32 v202, v120, v121
    v_cvt_pk_bf16_f32 v203, v122, v123
    v_pk_mul_f32 v[136:137], v[136:137], s[60:61]
    v_pk_mul_f32 v[138:139], v[138:139], s[60:61]
    v_pk_mul_f32 v[152:153], v[152:153], s[60:61]
    v_pk_mul_f32 v[154:155], v[154:155], s[60:61]
    v_cvt_pk_bf16_f32 v204, v136, v137
    v_cvt_pk_bf16_f32 v205, v138, v139
    v_cvt_pk_bf16_f32 v206, v152, v153
    v_cvt_pk_bf16_f32 v207, v154, v155
    v_pk_mul_f32 v[44:45], v[44:45], s[60:61]
    v_pk_mul_f32 v[46:47], v[46:47], s[60:61]
    v_pk_mul_f32 v[60:61], v[60:61], s[60:61]
    v_pk_mul_f32 v[62:63], v[62:63], s[60:61]
    v_cvt_pk_bf16_f32 v208, v44, v45
    v_cvt_pk_bf16_f32 v209, v46, v47
    v_cvt_pk_bf16_f32 v210, v60, v61
    v_cvt_pk_bf16_f32 v211, v62, v63
    v_pk_mul_f32 v[76:77], v[76:77], s[60:61]
    v_pk_mul_f32 v[78:79], v[78:79], s[60:61]
    v_pk_mul_f32 v[92:93], v[92:93], s[60:61]
    v_pk_mul_f32 v[94:95], v[94:95], s[60:61]
    buffer_load_dwordx4 v23, s[8:11], s55 offen offset:3072 lds
    v_cvt_pk_bf16_f32 v212, v76, v77
    v_cvt_pk_bf16_f32 v213, v78, v79
    v_cvt_pk_bf16_f32 v214, v92, v93
    v_cvt_pk_bf16_f32 v215, v94, v95
    v_pk_mul_f32 v[108:109], v[108:109], s[60:61]
    v_pk_mul_f32 v[110:111], v[110:111], s[60:61]
    v_pk_mul_f32 v[124:125], v[124:125], s[60:61]
    v_pk_mul_f32 v[126:127], v[126:127], s[60:61]
    v_cvt_pk_bf16_f32 v216, v108, v109
    v_cvt_pk_bf16_f32 v217, v110, v111
    v_cvt_pk_bf16_f32 v218, v124, v125
    v_cvt_pk_bf16_f32 v219, v126, v127
    v_pk_mul_f32 v[140:141], v[140:141], s[60:61]
    v_pk_mul_f32 v[142:143], v[142:143], s[60:61]
    v_pk_mul_f32 v[156:157], v[156:157], s[60:61]
    v_pk_mul_f32 v[158:159], v[158:159], s[60:61]
    v_cvt_pk_bf16_f32 v220, v140, v141
    v_cvt_pk_bf16_f32 v221, v142, v143
    v_cvt_pk_bf16_f32 v222, v156, v157
    v_cvt_pk_bf16_f32 v223, v158, v159
    v_accvgpr_read_b32 v32, a96
    v_accvgpr_read_b32 v33, a97
    v_accvgpr_read_b32 v34, a98
    v_accvgpr_read_b32 v35, a99
    v_accvgpr_read_b32 v36, a112
    v_accvgpr_read_b32 v37, a113
    v_accvgpr_read_b32 v38, a114
    s_mov_b32 s55, 16384
    s_add_u32 m0, s53, 81920
    s_nop 0
    buffer_load_dwordx4 v24, s[12:15], s55 offen offset:0 lds
    v_accvgpr_read_b32 v39, a115
    v_accvgpr_read_b32 v40, a224
    v_accvgpr_read_b32 v41, a225
    v_accvgpr_read_b32 v42, a226
    v_accvgpr_read_b32 v43, a227
    v_accvgpr_read_b32 v44, a240
    v_accvgpr_read_b32 v45, a241
    v_accvgpr_read_b32 v46, a242
    v_accvgpr_read_b32 v47, a243
    v_pk_mul_f32 v[48:49], v[32:33], s[62:63]
    v_pk_mul_f32 v[50:51], v[34:35], s[62:63]
    v_pk_mul_f32 v[52:53], v[36:37], s[62:63]
    v_pk_mul_f32 v[54:55], v[38:39], s[62:63]
    v_pk_mul_f32 v[56:57], v[40:41], s[62:63]
    v_pk_mul_f32 v[58:59], v[42:43], s[62:63]
    v_pk_mul_f32 v[60:61], v[44:45], s[62:63]
    v_pk_mul_f32 v[62:63], v[46:47], s[62:63]
    v_exp_f32 v48, v48
    v_exp_f32 v49, v49
    v_exp_f32 v50, v50
    v_exp_f32 v51, v51
    v_exp_f32 v52, v52
    v_exp_f32 v53, v53
    v_exp_f32 v54, v54
    v_exp_f32 v55, v55
    v_exp_f32 v56, v56
    v_exp_f32 v57, v57
    buffer_load_dwordx4 v25, s[12:15], s55 offen offset:1024 lds
    v_exp_f32 v58, v58
    v_exp_f32 v59, v59
    v_exp_f32 v60, v60
    v_exp_f32 v61, v61
    v_exp_f32 v62, v62
    v_exp_f32 v63, v63
    v_pk_add_f32 v[48:49], v[48:49], 1.0 op_sel_hi:[1,0]
    v_pk_add_f32 v[50:51], v[50:51], 1.0 op_sel_hi:[1,0]
    v_pk_add_f32 v[52:53], v[52:53], 1.0 op_sel_hi:[1,0]
    v_pk_add_f32 v[54:55], v[54:55], 1.0 op_sel_hi:[1,0]
    v_pk_add_f32 v[56:57], v[56:57], 1.0 op_sel_hi:[1,0]
    v_pk_add_f32 v[58:59], v[58:59], 1.0 op_sel_hi:[1,0]
    v_pk_add_f32 v[60:61], v[60:61], 1.0 op_sel_hi:[1,0]
    v_pk_add_f32 v[62:63], v[62:63], 1.0 op_sel_hi:[1,0]
    v_rcp_f32 v48, v48
    v_rcp_f32 v49, v49
    v_rcp_f32 v50, v50
    v_rcp_f32 v51, v51
    v_rcp_f32 v52, v52
    v_rcp_f32 v53, v53
    v_rcp_f32 v54, v54
    v_rcp_f32 v55, v55
    v_rcp_f32 v56, v56
    v_rcp_f32 v57, v57
    v_rcp_f32 v58, v58
    v_rcp_f32 v59, v59
    v_rcp_f32 v60, v60
    buffer_load_dwordx4 v24, s[12:15], s55 offen offset:2048 lds
    v_rcp_f32 v61, v61
    v_rcp_f32 v62, v62
    v_rcp_f32 v63, v63
    v_pk_mul_f32 v[48:49], v[48:49], v[32:33]
    v_pk_mul_f32 v[50:51], v[50:51], v[34:35]
    v_pk_mul_f32 v[52:53], v[52:53], v[36:37]
    v_pk_mul_f32 v[54:55], v[54:55], v[38:39]
    v_pk_mul_f32 v[56:57], v[56:57], v[40:41]
    v_pk_mul_f32 v[58:59], v[58:59], v[42:43]
    v_pk_mul_f32 v[60:61], v[60:61], v[44:45]
    v_pk_mul_f32 v[62:63], v[62:63], v[46:47]
    v_cvt_pk_bf16_f32 v64, v48, v49
    v_cvt_pk_bf16_f32 v65, v50, v51
    v_cvt_pk_bf16_f32 v66, v52, v53
    v_cvt_pk_bf16_f32 v67, v54, v55
    v_cvt_pk_bf16_f32 v68, v56, v57
    v_cvt_pk_bf16_f32 v69, v58, v59
    v_cvt_pk_bf16_f32 v70, v60, v61
    v_cvt_pk_bf16_f32 v71, v62, v63
    buffer_store_dwordx4 v[64:67], v240, s[36:39], s51 offen offset:0 sc1
    buffer_store_dwordx4 v[68:71], v240, s[36:39], s51 offen offset:1024 sc1
    s_add_u32 s51, s51, 186368
    v_accvgpr_read_b32 v80, a100
    v_accvgpr_read_b32 v81, a101
    v_accvgpr_read_b32 v82, a102
    v_accvgpr_read_b32 v83, a103
    v_accvgpr_read_b32 v84, a116
    buffer_load_dwordx4 v25, s[12:15], s55 offen offset:3072 lds
    v_accvgpr_read_b32 v85, a117
    v_accvgpr_read_b32 v86, a118
    v_accvgpr_read_b32 v87, a119
    v_accvgpr_read_b32 v88, a228
    v_accvgpr_read_b32 v89, a229
    v_accvgpr_read_b32 v90, a230
    v_accvgpr_read_b32 v91, a231
    v_accvgpr_read_b32 v92, a244
    v_accvgpr_read_b32 v93, a245
    v_accvgpr_read_b32 v94, a246
    v_accvgpr_read_b32 v95, a247
    v_pk_mul_f32 v[96:97], v[80:81], s[62:63]
    v_pk_mul_f32 v[98:99], v[82:83], s[62:63]
    v_pk_mul_f32 v[100:101], v[84:85], s[62:63]
    v_pk_mul_f32 v[102:103], v[86:87], s[62:63]
    v_pk_mul_f32 v[104:105], v[88:89], s[62:63]
    v_pk_mul_f32 v[106:107], v[90:91], s[62:63]
    v_pk_mul_f32 v[108:109], v[92:93], s[62:63]
    v_pk_mul_f32 v[110:111], v[94:95], s[62:63]
    v_exp_f32 v96, v96
    v_exp_f32 v97, v97
    v_exp_f32 v98, v98
    v_exp_f32 v99, v99
    v_exp_f32 v100, v100
    v_exp_f32 v101, v101
    v_exp_f32 v102, v102
    v_exp_f32 v103, v103
    s_mov_b32 s55, 32768
    s_add_u32 m0, s53, 32768
    s_nop 0
    buffer_load_dwordx4 v20, s[8:11], s55 offen offset:0 lds
    v_exp_f32 v104, v104
    v_exp_f32 v105, v105
    v_exp_f32 v106, v106
    v_exp_f32 v107, v107
    v_exp_f32 v108, v108
    v_exp_f32 v109, v109
    v_exp_f32 v110, v110
    v_exp_f32 v111, v111
    v_pk_add_f32 v[96:97], v[96:97], 1.0 op_sel_hi:[1,0]
    v_pk_add_f32 v[98:99], v[98:99], 1.0 op_sel_hi:[1,0]
    v_pk_add_f32 v[100:101], v[100:101], 1.0 op_sel_hi:[1,0]
    v_pk_add_f32 v[102:103], v[102:103], 1.0 op_sel_hi:[1,0]
    v_pk_add_f32 v[104:105], v[104:105], 1.0 op_sel_hi:[1,0]
    v_pk_add_f32 v[106:107], v[106:107], 1.0 op_sel_hi:[1,0]
    v_pk_add_f32 v[108:109], v[108:109], 1.0 op_sel_hi:[1,0]
    v_pk_add_f32 v[110:111], v[110:111], 1.0 op_sel_hi:[1,0]
    v_rcp_f32 v96, v96
    v_rcp_f32 v97, v97
    v_rcp_f32 v98, v98
    v_rcp_f32 v99, v99
    v_rcp_f32 v100, v100
    v_rcp_f32 v101, v101
    v_rcp_f32 v102, v102
    v_rcp_f32 v103, v103
    v_rcp_f32 v104, v104
    v_rcp_f32 v105, v105
    v_rcp_f32 v106, v106
    buffer_load_dwordx4 v21, s[8:11], s55 offen offset:1024 lds
    v_rcp_f32 v107, v107
    v_rcp_f32 v108, v108
    v_rcp_f32 v109, v109
    v_rcp_f32 v110, v110
    v_rcp_f32 v111, v111
    v_pk_mul_f32 v[96:97], v[96:97], v[80:81]
    v_pk_mul_f32 v[98:99], v[98:99], v[82:83]
    v_pk_mul_f32 v[100:101], v[100:101], v[84:85]
    v_pk_mul_f32 v[102:103], v[102:103], v[86:87]
    v_pk_mul_f32 v[104:105], v[104:105], v[88:89]
    v_pk_mul_f32 v[106:107], v[106:107], v[90:91]
    v_pk_mul_f32 v[108:109], v[108:109], v[92:93]
    v_pk_mul_f32 v[110:111], v[110:111], v[94:95]
    v_cvt_pk_bf16_f32 v112, v96, v97
    v_cvt_pk_bf16_f32 v113, v98, v99
    v_cvt_pk_bf16_f32 v114, v100, v101
    v_cvt_pk_bf16_f32 v115, v102, v103
    v_cvt_pk_bf16_f32 v116, v104, v105
    v_cvt_pk_bf16_f32 v117, v106, v107
    v_cvt_pk_bf16_f32 v118, v108, v109
    v_cvt_pk_bf16_f32 v119, v110, v111
    buffer_store_dwordx4 v[112:115], v240, s[36:39], s51 offen offset:0 sc1
    buffer_store_dwordx4 v[116:119], v240, s[36:39], s51 offen offset:1024 sc1
    s_add_u32 s51, s51, 186368
    v_accvgpr_read_b32 v32, a104
    v_accvgpr_read_b32 v33, a105
    v_accvgpr_read_b32 v34, a106
    buffer_load_dwordx4 v22, s[8:11], s55 offen offset:2048 lds
    v_accvgpr_read_b32 v35, a107
    v_accvgpr_read_b32 v36, a120
    v_accvgpr_read_b32 v37, a121
    v_accvgpr_read_b32 v38, a122
    v_accvgpr_read_b32 v39, a123
    v_accvgpr_read_b32 v40, a232
    v_accvgpr_read_b32 v41, a233
    v_accvgpr_read_b32 v42, a234
    v_accvgpr_read_b32 v43, a235
    v_accvgpr_read_b32 v44, a248
    v_accvgpr_read_b32 v45, a249
    v_accvgpr_read_b32 v46, a250
    v_accvgpr_read_b32 v47, a251
    v_pk_mul_f32 v[48:49], v[32:33], s[62:63]
    v_pk_mul_f32 v[50:51], v[34:35], s[62:63]
    v_pk_mul_f32 v[52:53], v[36:37], s[62:63]
    v_pk_mul_f32 v[54:55], v[38:39], s[62:63]
    v_pk_mul_f32 v[56:57], v[40:41], s[62:63]
    v_pk_mul_f32 v[58:59], v[42:43], s[62:63]
    v_pk_mul_f32 v[60:61], v[44:45], s[62:63]
    v_pk_mul_f32 v[62:63], v[46:47], s[62:63]
    v_exp_f32 v48, v48
    v_exp_f32 v49, v49
    v_exp_f32 v50, v50
    v_exp_f32 v51, v51
    v_exp_f32 v52, v52
    v_exp_f32 v53, v53
    buffer_load_dwordx4 v23, s[8:11], s55 offen offset:3072 lds
    v_exp_f32 v54, v54
    v_exp_f32 v55, v55
    v_exp_f32 v56, v56
    v_exp_f32 v57, v57
    v_exp_f32 v58, v58
    v_exp_f32 v59, v59
    v_exp_f32 v60, v60
    v_exp_f32 v61, v61
    v_exp_f32 v62, v62
    v_exp_f32 v63, v63
    v_pk_add_f32 v[48:49], v[48:49], 1.0 op_sel_hi:[1,0]
    v_pk_add_f32 v[50:51], v[50:51], 1.0 op_sel_hi:[1,0]
    v_pk_add_f32 v[52:53], v[52:53], 1.0 op_sel_hi:[1,0]
    v_pk_add_f32 v[54:55], v[54:55], 1.0 op_sel_hi:[1,0]
    v_pk_add_f32 v[56:57], v[56:57], 1.0 op_sel_hi:[1,0]
    v_pk_add_f32 v[58:59], v[58:59], 1.0 op_sel_hi:[1,0]
    v_pk_add_f32 v[60:61], v[60:61], 1.0 op_sel_hi:[1,0]
    v_pk_add_f32 v[62:63], v[62:63], 1.0 op_sel_hi:[1,0]
    v_rcp_f32 v48, v48
    v_rcp_f32 v49, v49
    v_rcp_f32 v50, v50
    v_rcp_f32 v51, v51
    v_rcp_f32 v52, v52
    v_rcp_f32 v53, v53
    v_rcp_f32 v54, v54
    v_rcp_f32 v55, v55
    v_rcp_f32 v56, v56
    s_mov_b32 s55, 49152
    s_add_u32 m0, s53, 49152
    s_nop 0
    buffer_load_dwordx4 v20, s[8:11], s55 offen offset:0 lds
    v_rcp_f32 v57, v57
    v_rcp_f32 v58, v58
    v_rcp_f32 v59, v59
    v_rcp_f32 v60, v60
    v_rcp_f32 v61, v61
    v_rcp_f32 v62, v62
    v_rcp_f32 v63, v63
    v_pk_mul_f32 v[48:49], v[48:49], v[32:33]
    v_pk_mul_f32 v[50:51], v[50:51], v[34:35]
    v_pk_mul_f32 v[52:53], v[52:53], v[36:37]
    v_pk_mul_f32 v[54:55], v[54:55], v[38:39]
    v_pk_mul_f32 v[56:57], v[56:57], v[40:41]
    v_pk_mul_f32 v[58:59], v[58:59], v[42:43]
    v_pk_mul_f32 v[60:61], v[60:61], v[44:45]
    v_pk_mul_f32 v[62:63], v[62:63], v[46:47]
    v_cvt_pk_bf16_f32 v64, v48, v49
    v_cvt_pk_bf16_f32 v65, v50, v51
    v_cvt_pk_bf16_f32 v66, v52, v53
    v_cvt_pk_bf16_f32 v67, v54, v55
    v_cvt_pk_bf16_f32 v68, v56, v57
    v_cvt_pk_bf16_f32 v69, v58, v59
    v_cvt_pk_bf16_f32 v70, v60, v61
    v_cvt_pk_bf16_f32 v71, v62, v63
    buffer_store_dwordx4 v[64:67], v240, s[36:39], s51 offen offset:0 sc1
    buffer_store_dwordx4 v[68:71], v240, s[36:39], s51 offen offset:1024 sc1
    s_add_u32 s51, s51, 186368
    v_accvgpr_read_b32 v80, a108
    buffer_load_dwordx4 v21, s[8:11], s55 offen offset:1024 lds
    v_accvgpr_read_b32 v81, a109
    v_accvgpr_read_b32 v82, a110
    v_accvgpr_read_b32 v83, a111
    v_accvgpr_read_b32 v84, a124
    v_accvgpr_read_b32 v85, a125
    v_accvgpr_read_b32 v86, a126
    v_accvgpr_read_b32 v87, a127
    v_accvgpr_read_b32 v88, a236
    v_accvgpr_read_b32 v89, a237
    v_accvgpr_read_b32 v90, a238
    v_accvgpr_read_b32 v91, a239
    v_accvgpr_read_b32 v92, a252
    v_accvgpr_read_b32 v93, a253
    v_accvgpr_read_b32 v94, a254
    v_accvgpr_read_b32 v95, a255
    v_pk_mul_f32 v[96:97], v[80:81], s[62:63]
    v_pk_mul_f32 v[98:99], v[82:83], s[62:63]
    v_pk_mul_f32 v[100:101], v[84:85], s[62:63]
    v_pk_mul_f32 v[102:103], v[86:87], s[62:63]
    v_pk_mul_f32 v[104:105], v[88:89], s[62:63]
    v_pk_mul_f32 v[106:107], v[90:91], s[62:63]
    v_pk_mul_f32 v[108:109], v[92:93], s[62:63]
    v_pk_mul_f32 v[110:111], v[94:95], s[62:63]
    v_exp_f32 v96, v96
    v_exp_f32 v97, v97
    v_exp_f32 v98, v98
    v_exp_f32 v99, v99
    buffer_load_dwordx4 v22, s[8:11], s55 offen offset:2048 lds
    v_exp_f32 v100, v100
    v_exp_f32 v101, v101
    v_exp_f32 v102, v102
    v_exp_f32 v103, v103
    v_exp_f32 v104, v104
    v_exp_f32 v105, v105
    v_exp_f32 v106, v106
    v_exp_f32 v107, v107
    v_exp_f32 v108, v108
    v_exp_f32 v109, v109
    v_exp_f32 v110, v110
    v_exp_f32 v111, v111
    v_pk_add_f32 v[96:97], v[96:97], 1.0 op_sel_hi:[1,0]
    v_pk_add_f32 v[98:99], v[98:99], 1.0 op_sel_hi:[1,0]
    v_pk_add_f32 v[100:101], v[100:101], 1.0 op_sel_hi:[1,0]
    v_pk_add_f32 v[102:103], v[102:103], 1.0 op_sel_hi:[1,0]
    v_pk_add_f32 v[104:105], v[104:105], 1.0 op_sel_hi:[1,0]
    v_pk_add_f32 v[106:107], v[106:107], 1.0 op_sel_hi:[1,0]
    v_pk_add_f32 v[108:109], v[108:109], 1.0 op_sel_hi:[1,0]
    v_pk_add_f32 v[110:111], v[110:111], 1.0 op_sel_hi:[1,0]
    v_rcp_f32 v96, v96
    v_rcp_f32 v97, v97
    v_rcp_f32 v98, v98
    v_rcp_f32 v99, v99
    v_rcp_f32 v100, v100
    v_rcp_f32 v101, v101
    v_rcp_f32 v102, v102
    buffer_load_dwordx4 v23, s[8:11], s55 offen offset:3072 lds
    v_rcp_f32 v103, v103
    v_rcp_f32 v104, v104
    v_rcp_f32 v105, v105
    v_rcp_f32 v106, v106
    v_rcp_f32 v107, v107
    v_rcp_f32 v108, v108
    v_rcp_f32 v109, v109
    v_rcp_f32 v110, v110
    v_rcp_f32 v111, v111
    v_pk_mul_f32 v[96:97], v[96:97], v[80:81]
    v_pk_mul_f32 v[98:99], v[98:99], v[82:83]
    v_pk_mul_f32 v[100:101], v[100:101], v[84:85]
    v_pk_mul_f32 v[102:103], v[102:103], v[86:87]
    v_pk_mul_f32 v[104:105], v[104:105], v[88:89]
    v_pk_mul_f32 v[106:107], v[106:107], v[90:91]
    v_pk_mul_f32 v[108:109], v[108:109], v[92:93]
    v_pk_mul_f32 v[110:111], v[110:111], v[94:95]
    v_cvt_pk_bf16_f32 v112, v96, v97
    v_cvt_pk_bf16_f32 v113, v98, v99
    v_cvt_pk_bf16_f32 v114, v100, v101
    v_cvt_pk_bf16_f32 v115, v102, v103
    v_cvt_pk_bf16_f32 v116, v104, v105
    v_cvt_pk_bf16_f32 v117, v106, v107
    v_cvt_pk_bf16_f32 v118, v108, v109
    v_cvt_pk_bf16_f32 v119, v110, v111
    buffer_store_dwordx4 v[112:115], v240, s[36:39], s51 offen offset:0 sc1
    buffer_store_dwordx4 v[116:119], v240, s[36:39], s51 offen offset:1024 sc1
    s_add_u32 s51, s51, 186368
    s_waitcnt vmcnt(28)
    s_barrier
    ds_read_b128 a[144:147], v8 offset:0
    ds_read_b128 a[148:151], v9 offset:0
    ds_read_b128 a[152:155], v10 offset:0
    ds_read_b128 a[156:159], v11 offset:0
    ds_read_b128 a[160:163], v8 offset:4096
    ds_read_b128 a[164:167], v9 offset:4096
    ds_read_b128 a[168:171], v10 offset:4096
    ds_read_b128 a[172:175], v11 offset:4096
    s_waitcnt lgkmcnt(7)
    v_mfma_f32_16x16x32_bf16 v[32:35], a[144:147], v[160:163], 0
    s_add_u32 s40, s48, 0x280000
    s_addc_u32 s41, s49, 0
    s_waitcnt lgkmcnt(6)
    v_mfma_f32_16x16x32_bf16 v[32:35], a[148:151], v[164:167], v[32:35]
    s_mov_b32 s42, 0x71c000
    s_mov_b32 s43, 0x00020000
    s_waitcnt lgkmcnt(5)
    v_mfma_f32_16x16x32_bf16 v[32:35], a[152:155], v[168:171], v[32:35]
    s_movk_i32 s6, 6554
    s_movk_i32 s7, 1120
    s_waitcnt lgkmcnt(4)
    v_mfma_f32_16x16x32_bf16 v[32:35], a[156:159], v[172:175], v[32:35]
    v_add_u32 v1, 0, v0
    v_mul_lo_u32 v2, v1, s6
    v_mfma_f32_16x16x32_bf16 v[36:39], a[144:147], v[176:179], 0
    v_lshrrev_b32 v2, 16, v2
    v_mul_lo_u32 v2, v2, s7
    v_mfma_f32_16x16x32_bf16 v[36:39], a[148:151], v[180:183], v[36:39]
    v_lshl_add_u32 v248, v1, 4, v2
    v_add_u32 v1, 64, v0
    v_mfma_f32_16x16x32_bf16 v[36:39], a[152:155], v[184:187], v[36:39]
    v_mul_lo_u32 v2, v1, s6
    v_lshrrev_b32 v2, 16, v2
    v_mfma_f32_16x16x32_bf16 v[36:39], a[156:159], v[188:191], v[36:39]
    v_mul_lo_u32 v2, v2, s7
    v_lshl_add_u32 v249, v1, 4, v2
    v_mfma_f32_16x16x32_bf16 v[40:43], a[144:147], v[192:195], 0
    v_add_u32 v1, 128, v0
    v_mul_lo_u32 v2, v1, s6
    v_mfma_f32_16x16x32_bf16 v[40:43], a[148:151], v[196:199], v[40:43]
    v_lshrrev_b32 v2, 16, v2
    v_mul_lo_u32 v2, v2, s7
    v_mfma_f32_16x16x32_bf16 v[40:43], a[152:155], v[200:203], v[40:43]
    v_lshl_add_u32 v250, v1, 4, v2
    v_add_u32 v1, 192, v0
    v_mfma_f32_16x16x32_bf16 v[40:43], a[156:159], v[204:207], v[40:43]
    v_mul_lo_u32 v2, v1, s6
    v_lshrrev_b32 v2, 16, v2
    v_mfma_f32_16x16x32_bf16 v[44:47], a[144:147], v[208:211], 0
    v_mul_lo_u32 v2, v2, s7
    v_lshl_add_u32 v251, v1, 4, v2
    v_mfma_f32_16x16x32_bf16 v[44:47], a[148:151], v[212:215], v[44:47]
    v_add_u32 v1, 256, v0
    v_mul_lo_u32 v2, v1, s6
    v_mfma_f32_16x16x32_bf16 v[44:47], a[152:155], v[216:219], v[44:47]
    v_lshrrev_b32 v2, 16, v2
    v_mul_lo_u32 v2, v2, s7
    v_mfma_f32_16x16x32_bf16 v[44:47], a[156:159], v[220:223], v[44:47]
    v_lshl_add_u32 v252, v1, 4, v2
    s_mul_i32 s44, s3, 5120
    s_waitcnt lgkmcnt(0)
    v_mfma_f32_16x16x32_bf16 v[48:51], a[160:163], v[160:163], 0
    s_add_u32 s44, s44, 131328
    v_lshrrev_b32 v1, 4, v0
    v_mfma_f32_16x16x32_bf16 v[48:51], a[164:167], v[164:167], v[48:51]
    v_bfe_u32 v2, v0, 2, 2
    v_lshl_add_u32 v1, v1, 2, v2
    v_mfma_f32_16x16x32_bf16 v[48:51], a[168:171], v[168:171], v[48:51]
    s_movk_i32 s6, 160
    v_mul_lo_u32 v1, v1, s6
    v_mfma_f32_16x16x32_bf16 v[48:51], a[172:175], v[172:175], v[48:51]
    v_and_b32 v2, 3, v0
    v_lshl_add_u32 v1, v2, 3, v1
    v_mfma_f32_16x16x32_bf16 v[52:55], a[160:163], v[176:179], 0
    v_add_u32 v253, s44, v1
    v_mfma_f32_16x16x32_bf16 v[52:55], a[164:167], v[180:183], v[52:55]
    v_mfma_f32_16x16x32_bf16 v[52:55], a[168:171], v[184:187], v[52:55]
    v_mfma_f32_16x16x32_bf16 v[52:55], a[172:175], v[188:191], v[52:55]
    v_mfma_f32_16x16x32_bf16 v[56:59], a[160:163], v[192:195], 0
    v_mfma_f32_16x16x32_bf16 v[56:59], a[164:167], v[196:199], v[56:59]
    v_mfma_f32_16x16x32_bf16 v[56:59], a[168:171], v[200:203], v[56:59]
    v_mfma_f32_16x16x32_bf16 v[56:59], a[172:175], v[204:207], v[56:59]
    v_mfma_f32_16x16x32_bf16 v[60:63], a[160:163], v[208:211], 0
    v_mfma_f32_16x16x32_bf16 v[60:63], a[164:167], v[212:215], v[60:63]
    v_mfma_f32_16x16x32_bf16 v[60:63], a[168:171], v[216:219], v[60:63]
    v_mfma_f32_16x16x32_bf16 v[60:63], a[172:175], v[220:223], v[60:63]
    v_max3_f32 v1, v32, v33, v34
    v_max3_f32 v1, v1, v35, v48
    v_max3_f32 v1, v1, v49, v50
    v_max_f32 v1, v1, v51
    v_mov_b32 v5, v1
    s_nop 1
    v_permlane32_swap_b32 v1, v5
    v_max_f32 v1, v1, v5
    v_mov_b32 v5, v1
    s_nop 1
    v_permlane16_swap_b32 v1, v5
    v_max_f32 v1, v1, v5
    v_max3_f32 v2, v36, v37, v38
    v_max3_f32 v2, v2, v39, v52
    v_max3_f32 v2, v2, v53, v54
    v_max_f32 v2, v2, v55
    v_mov_b32 v5, v2
    s_nop 1
    v_permlane32_swap_b32 v2, v5
    v_max_f32 v2, v2, v5
    v_mov_b32 v5, v2
    s_nop 1
    v_permlane16_swap_b32 v2, v5
    v_max_f32 v2, v2, v5
    v_max3_f32 v3, v40, v41, v42
    v_max3_f32 v3, v3, v43, v56
    v_max3_f32 v3, v3, v57, v58
    v_max_f32 v3, v3, v59
    v_mov_b32 v5, v3
    s_nop 1
    v_permlane32_swap_b32 v3, v5
    v_max_f32 v3, v3, v5
    v_mov_b32 v5, v3
    s_nop 1
    v_permlane16_swap_b32 v3, v5
    v_max_f32 v3, v3, v5
    v_max3_f32 v4, v44, v45, v46
    v_max3_f32 v4, v4, v47, v60
    v_max3_f32 v4, v4, v61, v62
    v_max_f32 v4, v4, v63
    v_mov_b32 v5, v4
    s_nop 1
    v_permlane32_swap_b32 v4, v5
    v_max_f32 v4, v4, v5
    v_mov_b32 v5, v4
    s_nop 1
    v_permlane16_swap_b32 v4, v5
    v_max_f32 v4, v4, v5
    v_sub_f32 v96, 0, v1
    v_sub_f32 v97, 0, v1
    v_sub_f32 v98, 0, v1
    v_sub_f32 v99, 0, v1
    v_sub_f32 v32, v32, v1
    v_sub_f32 v33, v33, v1
    v_sub_f32 v34, v34, v1
    v_sub_f32 v35, v35, v1
    v_sub_f32 v48, v48, v1
    v_sub_f32 v49, v49, v1
    v_sub_f32 v50, v50, v1
    v_sub_f32 v51, v51, v1
    v_sub_f32 v100, 0, v2
    v_sub_f32 v101, 0, v2
    v_sub_f32 v102, 0, v2
    v_sub_f32 v103, 0, v2
    v_sub_f32 v36, v36, v2
    v_sub_f32 v37, v37, v2
    v_sub_f32 v38, v38, v2
    v_sub_f32 v39, v39, v2
    v_sub_f32 v52, v52, v2
    v_sub_f32 v53, v53, v2
    v_sub_f32 v54, v54, v2
    v_sub_f32 v55, v55, v2
    v_sub_f32 v104, 0, v3
    v_sub_f32 v105, 0, v3
    v_sub_f32 v106, 0, v3
    v_sub_f32 v107, 0, v3
    v_sub_f32 v40, v40, v3
    v_sub_f32 v41, v41, v3
    v_sub_f32 v42, v42, v3
    v_sub_f32 v43, v43, v3
    v_sub_f32 v56, v56, v3
    v_sub_f32 v57, v57, v3
    v_sub_f32 v58, v58, v3
    v_sub_f32 v59, v59, v3
    v_sub_f32 v108, 0, v4
    v_sub_f32 v109, 0, v4
    v_sub_f32 v110, 0, v4
    v_sub_f32 v111, 0, v4
    v_sub_f32 v44, v44, v4
    v_sub_f32 v45, v45, v4
    v_sub_f32 v46, v46, v4
    v_sub_f32 v47, v47, v4
    v_sub_f32 v60, v60, v4
    v_sub_f32 v61, v61, v4
    v_sub_f32 v62, v62, v4
    v_sub_f32 v63, v63, v4
    v_exp_f32 v32, v32
    v_exp_f32 v33, v33
    s_nop 0
    v_cvt_pk_bf16_f32 v112, v32, v33
    v_exp_f32 v34, v34
    v_exp_f32 v35, v35
    s_nop 0
    v_cvt_pk_bf16_f32 v113, v34, v35
    v_exp_f32 v36, v36
    v_exp_f32 v37, v37
    s_nop 0
    v_cvt_pk_bf16_f32 v116, v36, v37
    v_exp_f32 v38, v38
    v_exp_f32 v39, v39
    ds_read_b128 a[144:147], v8 offset:8192
    v_cvt_pk_bf16_f32 v117, v38, v39
    v_exp_f32 v40, v40
    v_exp_f32 v41, v41
    ds_read_b128 a[148:151], v9 offset:8192
    v_cvt_pk_bf16_f32 v120, v40, v41
    v_exp_f32 v42, v42
    v_exp_f32 v43, v43
    ds_read_b128 a[152:155], v10 offset:8192
    v_cvt_pk_bf16_f32 v121, v42, v43
    v_exp_f32 v44, v44
    v_exp_f32 v45, v45
    ds_read_b128 a[156:159], v11 offset:8192
    v_cvt_pk_bf16_f32 v124, v44, v45
    v_exp_f32 v46, v46
    v_exp_f32 v47, v47
    ds_read_b128 a[160:163], v8 offset:12288
    v_cvt_pk_bf16_f32 v125, v46, v47
    v_exp_f32 v48, v48
    v_exp_f32 v49, v49
    ds_read_b128 a[164:167], v9 offset:12288
    v_cvt_pk_bf16_f32 v114, v48, v49
    v_exp_f32 v50, v50
    v_exp_f32 v51, v51
    ds_read_b128 a[168:171], v10 offset:12288
    v_cvt_pk_bf16_f32 v115, v50, v51
    v_exp_f32 v52, v52
    v_exp_f32 v53, v53
    ds_read_b128 a[172:175], v11 offset:12288
    v_cvt_pk_bf16_f32 v118, v52, v53
    v_exp_f32 v54, v54
    v_exp_f32 v55, v55
    s_nop 0
    v_cvt_pk_bf16_f32 v119, v54, v55
    s_waitcnt lgkmcnt(0)
    s_waitcnt vmcnt(20) lgkmcnt(2)
    s_barrier
    v_mfma_f32_16x16x32_bf16 v[64:67], a[144:147], v[160:163], v[96:99]
    v_exp_f32 v56, v56
    v_mfma_f32_16x16x32_bf16 v[64:67], a[148:151], v[164:167], v[64:67]
    v_mfma_f32_16x16x32_bf16 v[64:67], a[152:155], v[168:171], v[64:67]
    v_exp_f32 v57, v57
    v_mfma_f32_16x16x32_bf16 v[64:67], a[156:159], v[172:175], v[64:67]
    v_cvt_pk_bf16_f32 v122, v56, v57
    v_mfma_f32_16x16x32_bf16 v[68:71], a[144:147], v[176:179], v[100:103]
    v_exp_f32 v58, v58
    v_mfma_f32_16x16x32_bf16 v[68:71], a[148:151], v[180:183], v[68:71]
    v_mfma_f32_16x16x32_bf16 v[68:71], a[152:155], v[184:187], v[68:71]
    v_exp_f32 v59, v59
    v_mfma_f32_16x16x32_bf16 v[68:71], a[156:159], v[188:191], v[68:71]
    v_cvt_pk_bf16_f32 v123, v58, v59
    v_mfma_f32_16x16x32_bf16 v[72:75], a[144:147], v[192:195], v[104:107]
    v_exp_f32 v60, v60
    v_mfma_f32_16x16x32_bf16 v[72:75], a[148:151], v[196:199], v[72:75]
    v_mfma_f32_16x16x32_bf16 v[72:75], a[152:155], v[200:203], v[72:75]
    v_exp_f32 v61, v61
    v_mfma_f32_16x16x32_bf16 v[72:75], a[156:159], v[204:207], v[72:75]
    v_cvt_pk_bf16_f32 v126, v60, v61
    v_mfma_f32_16x16x32_bf16 v[76:79], a[144:147], v[208:211], v[108:111]
    v_exp_f32 v62, v62
    v_mfma_f32_16x16x32_bf16 v[76:79], a[148:151], v[212:215], v[76:79]
    v_mfma_f32_16x16x32_bf16 v[76:79], a[152:155], v[216:219], v[76:79]
    v_exp_f32 v63, v63
    v_mfma_f32_16x16x32_bf16 v[76:79], a[156:159], v[220:223], v[76:79]
    v_cvt_pk_bf16_f32 v127, v62, v63
    v_mfma_f32_16x16x32_bf16 v[80:83], a[160:163], v[160:163], v[96:99]
    s_lshl_b32 s45, s2, 2
    s_add_u32 s45, s45, s3
    s_add_u32 s45, s45, 0
    s_lshr_b32 s46, s45, 3
    s_and_b32 s47, s45, 7
    s_cmp_lt_u32 s46, 128
    s_cselect_b32 s32, s90, s92
    s_cselect_b32 s33, s91, s93
    s_mov_b32 s34, 0x21c000
    s_cselect_b32 s34, 0x500000, s34
    s_cselect_b32 s94, 0, 128
    s_mov_b32 s35, 0x00020000
    s_sub_u32 s94, s46, s94
    s_mul_i32 s94, s94, 40960
    s_mul_i32 s95, s47, 160
    s_add_u32 s94, s94, s95
    s_mul_i32 s95, s47, 182
    s_add_u32 s95, s95, s46
    s_mul_i32 s95, s95, 5120
    s_cmp_lt_u32 s45, 1456
    s_cselect_b32 s34, s34, 0
    s_cselect_b32 s95, s95, 7454720
    s_add_u32 m0, s44, 0
    s_nop 0
    buffer_load_dwordx4 v248, s[32:35], s94 offen lds
    v_mfma_f32_16x16x32_bf16 v[80:83], a[164:167], v[164:167], v[80:83]
    v_mfma_f32_16x16x32_bf16 v[80:83], a[168:171], v[168:171], v[80:83]
    s_add_u32 m0, s44, 1024
    s_nop 0
    buffer_load_dwordx4 v249, s[32:35], s94 offen lds
    v_mfma_f32_16x16x32_bf16 v[80:83], a[172:175], v[172:175], v[80:83]
    v_mfma_f32_16x16x32_bf16 v[84:87], a[160:163], v[176:179], v[100:103]
    v_exp_f32 v64, v64
    v_mfma_f32_16x16x32_bf16 v[84:87], a[164:167], v[180:183], v[84:87]
    v_mfma_f32_16x16x32_bf16 v[84:87], a[168:171], v[184:187], v[84:87]
    v_exp_f32 v65, v65
    v_mfma_f32_16x16x32_bf16 v[84:87], a[172:175], v[188:191], v[84:87]
    v_cvt_pk_bf16_f32 v128, v64, v65
    v_mfma_f32_16x16x32_bf16 v[88:91], a[160:163], v[192:195], v[104:107]
    v_exp_f32 v66, v66
    v_mfma_f32_16x16x32_bf16 v[88:91], a[164:167], v[196:199], v[88:91]
    v_mfma_f32_16x16x32_bf16 v[88:91], a[168:171], v[200:203], v[88:91]
    v_exp_f32 v67, v67
    v_mfma_f32_16x16x32_bf16 v[88:91], a[172:175], v[204:207], v[88:91]
    v_cvt_pk_bf16_f32 v129, v66, v67
    v_mfma_f32_16x16x32_bf16 v[92:95], a[160:163], v[208:211], v[108:111]
    v_exp_f32 v68, v68
    v_mfma_f32_16x16x32_bf16 v[92:95], a[164:167], v[212:215], v[92:95]
    v_mfma_f32_16x16x32_bf16 v[92:95], a[168:171], v[216:219], v[92:95]
    v_exp_f32 v69, v69
    v_mfma_f32_16x16x32_bf16 v[92:95], a[172:175], v[220:223], v[92:95]
    v_cvt_pk_bf16_f32 v132, v68, v69
    v_exp_f32 v70, v70
    v_exp_f32 v71, v71
    ds_read_b128 a[144:147], v8 offset:16384
    v_cvt_pk_bf16_f32 v133, v70, v71
    v_exp_f32 v72, v72
    s_add_u32 m0, s53, 98304
    s_nop 0
    buffer_load_dwordx4 v24, s[12:15], s58 offen offset:0 lds
    v_exp_f32 v73, v73
    ds_read_b128 a[148:151], v9 offset:16384
    v_cvt_pk_bf16_f32 v136, v72, v73
    v_exp_f32 v74, v74
    v_exp_f32 v75, v75
    ds_read_b128 a[152:155], v10 offset:16384
    v_cvt_pk_bf16_f32 v137, v74, v75
    v_exp_f32 v76, v76
    buffer_load_dwordx4 v25, s[12:15], s58 offen offset:1024 lds
    v_exp_f32 v77, v77
    ds_read_b128 a[156:159], v11 offset:16384
    v_cvt_pk_bf16_f32 v140, v76, v77
    v_exp_f32 v78, v78
    v_exp_f32 v79, v79
    ds_read_b128 a[160:163], v8 offset:20480
    v_cvt_pk_bf16_f32 v141, v78, v79
    v_exp_f32 v80, v80
    buffer_load_dwordx4 v24, s[12:15], s58 offen offset:2048 lds
    v_exp_f32 v81, v81
    ds_read_b128 a[164:167], v9 offset:20480
    v_cvt_pk_bf16_f32 v130, v80, v81
    v_exp_f32 v82, v82
    v_exp_f32 v83, v83
    ds_read_b128 a[168:171], v10 offset:20480
    v_cvt_pk_bf16_f32 v131, v82, v83
    v_exp_f32 v84, v84
    buffer_load_dwordx4 v25, s[12:15], s58 offen offset:3072 lds
    v_exp_f32 v85, v85
    s_add_u32 s58, s58, 16384
    ds_read_b128 a[172:175], v11 offset:20480
    v_cvt_pk_bf16_f32 v134, v84, v85
    v_exp_f32 v86, v86
    v_exp_f32 v87, v87
    s_nop 0
    v_cvt_pk_bf16_f32 v135, v86, v87
    s_waitcnt lgkmcnt(3)
    v_mfma_f32_16x16x32_bf16 v[32:35], a[144:147], v[160:163], v[96:99]
    v_exp_f32 v88, v88
    v_mfma_f32_16x16x32_bf16 v[32:35], a[148:151], v[164:167], v[32:35]
    ds_read_b64_tr_b16 a[176:177], v12 offset:0
    v_mfma_f32_16x16x32_bf16 v[32:35], a[152:155], v[168:171], v[32:35]
    v_exp_f32 v89, v89
    v_mfma_f32_16x16x32_bf16 v[32:35], a[156:159], v[172:175], v[32:35]
    ds_read_b64_tr_b16 a[178:179], v12 offset:4096
    v_cvt_pk_bf16_f32 v138, v88, v89
    v_mfma_f32_16x16x32_bf16 v[36:39], a[144:147], v[176:179], v[100:103]
    v_exp_f32 v90, v90
    v_mfma_f32_16x16x32_bf16 v[36:39], a[148:151], v[180:183], v[36:39]
    ds_read_b64_tr_b16 a[180:181], v12 offset:8192
    v_mfma_f32_16x16x32_bf16 v[36:39], a[152:155], v[184:187], v[36:39]
    v_exp_f32 v91, v91
    v_mfma_f32_16x16x32_bf16 v[36:39], a[156:159], v[188:191], v[36:39]
    ds_read_b64_tr_b16 a[182:183], v12 offset:12288
    v_cvt_pk_bf16_f32 v139, v90, v91
    v_mfma_f32_16x16x32_bf16 v[40:43], a[144:147], v[192:195], v[104:107]
    v_exp_f32 v92, v92
    v_mfma_f32_16x16x32_bf16 v[40:43], a[148:151], v[196:199], v[40:43]
    ds_read_b64_tr_b16 a[184:185], v13 offset:0
    v_mfma_f32_16x16x32_bf16 v[40:43], a[152:155], v[200:203], v[40:43]
    v_exp_f32 v93, v93
    v_mfma_f32_16x16x32_bf16 v[40:43], a[156:159], v[204:207], v[40:43]
    ds_read_b64_tr_b16 a[186:187], v13 offset:4096
    v_cvt_pk_bf16_f32 v142, v92, v93
    v_mfma_f32_16x16x32_bf16 v[44:47], a[144:147], v[208:211], v[108:111]
    v_exp_f32 v94, v94
    v_mfma_f32_16x16x32_bf16 v[44:47], a[148:151], v[212:215], v[44:47]
    ds_read_b64_tr_b16 a[188:189], v13 offset:8192
    v_mfma_f32_16x16x32_bf16 v[44:47], a[152:155], v[216:219], v[44:47]
    v_exp_f32 v95, v95
    v_mfma_f32_16x16x32_bf16 v[44:47], a[156:159], v[220:223], v[44:47]
    ds_read_b64_tr_b16 a[190:191], v13 offset:12288
    v_cvt_pk_bf16_f32 v143, v94, v95
    v_mfma_f32_16x16x32_bf16 v[48:51], a[160:163], v[160:163], v[96:99]
    s_add_u32 m0, s44, 2048
    s_nop 0
    buffer_load_dwordx4 v250, s[32:35], s94 offen lds
    s_waitcnt lgkmcnt(4)
    v_mfma_f32_16x16x32_bf16 v[48:51], a[164:167], v[164:167], v[48:51]
    ds_read_b64_tr_b16 a[192:193], v14 offset:0
    v_mfma_f32_16x16x32_bf16 v[48:51], a[168:171], v[168:171], v[48:51]
    s_add_u32 m0, s44, 3072
    s_nop 0
    buffer_load_dwordx4 v251, s[32:35], s94 offen lds
    v_mfma_f32_16x16x32_bf16 v[48:51], a[172:175], v[172:175], v[48:51]
    ds_read_b64_tr_b16 a[194:195], v14 offset:4096
    v_mfma_f32_16x16x32_bf16 v[52:55], a[160:163], v[176:179], v[100:103]
    v_exp_f32 v32, v32
    v_mfma_f32_16x16x32_bf16 v[52:55], a[164:167], v[180:183], v[52:55]
    ds_read_b64_tr_b16 a[196:197], v14 offset:8192
    v_mfma_f32_16x16x32_bf16 v[52:55], a[168:171], v[184:187], v[52:55]
    v_exp_f32 v33, v33
    v_mfma_f32_16x16x32_bf16 v[52:55], a[172:175], v[188:191], v[52:55]
    ds_read_b64_tr_b16 a[198:199], v14 offset:12288
    v_cvt_pk_bf16_f32 v144, v32, v33
    v_mfma_f32_16x16x32_bf16 v[56:59], a[160:163], v[192:195], v[104:107]
    v_exp_f32 v34, v34
    v_mfma_f32_16x16x32_bf16 v[56:59], a[164:167], v[196:199], v[56:59]
    ds_read_b64_tr_b16 a[200:201], v15 offset:0
    v_mfma_f32_16x16x32_bf16 v[56:59], a[168:171], v[200:203], v[56:59]
    v_exp_f32 v35, v35
    v_mfma_f32_16x16x32_bf16 v[56:59], a[172:175], v[204:207], v[56:59]
    ds_read_b64_tr_b16 a[202:203], v15 offset:4096
    v_cvt_pk_bf16_f32 v145, v34, v35
    v_mfma_f32_16x16x32_bf16 v[60:63], a[160:163], v[208:211], v[108:111]
    v_exp_f32 v36, v36
    v_mfma_f32_16x16x32_bf16 v[60:63], a[164:167], v[212:215], v[60:63]
    ds_read_b64_tr_b16 a[204:205], v15 offset:8192
    v_mfma_f32_16x16x32_bf16 v[60:63], a[168:171], v[216:219], v[60:63]
    v_exp_f32 v37, v37
    v_mfma_f32_16x16x32_bf16 v[60:63], a[172:175], v[220:223], v[60:63]
    ds_read_b64_tr_b16 a[206:207], v15 offset:12288
    v_cvt_pk_bf16_f32 v148, v36, v37
    v_mfma_f32_16x16x32_bf16 a[0:3], a[176:179], v[112:115], 0
    v_exp_f32 v38, v38
    v_mfma_f32_16x16x32_bf16 a[0:3], a[180:183], v[128:131], a[0:3]
    v_mfma_f32_16x16x32_bf16 a[4:7], a[176:179], v[116:119], 0
    v_exp_f32 v39, v39
    v_mfma_f32_16x16x32_bf16 a[4:7], a[180:183], v[132:135], a[4:7]
    ds_read_b128 a[144:147], v8 offset:24576
    v_cvt_pk_bf16_f32 v149, v38, v39
    v_mfma_f32_16x16x32_bf16 a[8:11], a[176:179], v[120:123], 0
    v_exp_f32 v40, v40
    v_mfma_f32_16x16x32_bf16 a[8:11], a[180:183], v[136:139], a[8:11]
    s_add_u32 m0, s53, 0
    s_nop 0
    buffer_load_dwordx4 v20, s[8:11], s57 offen offset:0 lds
    v_mfma_f32_16x16x32_bf16 a[12:15], a[176:179], v[124:127], 0
    v_exp_f32 v41, v41
    v_mfma_f32_16x16x32_bf16 a[12:15], a[180:183], v[140:143], a[12:15]
    ds_read_b128 a[148:151], v9 offset:24576
    v_cvt_pk_bf16_f32 v152, v40, v41
    s_waitcnt lgkmcnt(2)
    v_mfma_f32_16x16x32_bf16 a[16:19], a[184:187], v[112:115], 0
    v_exp_f32 v42, v42
    v_mfma_f32_16x16x32_bf16 a[16:19], a[188:191], v[128:131], a[16:19]
    v_mfma_f32_16x16x32_bf16 a[20:23], a[184:187], v[116:119], 0
    v_exp_f32 v43, v43
    v_mfma_f32_16x16x32_bf16 a[20:23], a[188:191], v[132:135], a[20:23]
    ds_read_b128 a[152:155], v10 offset:24576
    v_cvt_pk_bf16_f32 v153, v42, v43
    v_mfma_f32_16x16x32_bf16 a[24:27], a[184:187], v[120:123], 0
    v_exp_f32 v44, v44
    v_mfma_f32_16x16x32_bf16 a[24:27], a[188:191], v[136:139], a[24:27]
    buffer_load_dwordx4 v21, s[8:11], s57 offen offset:1024 lds
    v_mfma_f32_16x16x32_bf16 a[28:31], a[184:187], v[124:127], 0
    v_exp_f32 v45, v45
    v_mfma_f32_16x16x32_bf16 a[28:31], a[188:191], v[140:143], a[28:31]
    ds_read_b128 a[156:159], v11 offset:24576
    v_cvt_pk_bf16_f32 v156, v44, v45
    v_mfma_f32_16x16x32_bf16 a[32:35], a[192:195], v[112:115], 0
    v_exp_f32 v46, v46
    v_mfma_f32_16x16x32_bf16 a[32:35], a[196:199], v[128:131], a[32:35]
    v_mfma_f32_16x16x32_bf16 a[36:39], a[192:195], v[116:119], 0
    v_exp_f32 v47, v47
    v_mfma_f32_16x16x32_bf16 a[36:39], a[196:199], v[132:135], a[36:39]
    ds_read_b128 a[160:163], v8 offset:28672
    v_cvt_pk_bf16_f32 v157, v46, v47
    v_mfma_f32_16x16x32_bf16 a[40:43], a[192:195], v[120:123], 0
    v_exp_f32 v48, v48
    v_mfma_f32_16x16x32_bf16 a[40:43], a[196:199], v[136:139], a[40:43]
    buffer_load_dwordx4 v22, s[8:11], s57 offen offset:2048 lds
    v_mfma_f32_16x16x32_bf16 a[44:47], a[192:195], v[124:127], 0
    v_exp_f32 v49, v49
    v_mfma_f32_16x16x32_bf16 a[44:47], a[196:199], v[140:143], a[44:47]
    ds_read_b128 a[164:167], v9 offset:28672
    v_cvt_pk_bf16_f32 v146, v48, v49
    v_mfma_f32_16x16x32_bf16 a[48:51], a[200:203], v[112:115], 0
    v_exp_f32 v50, v50
    v_mfma_f32_16x16x32_bf16 a[48:51], a[204:207], v[128:131], a[48:51]
    v_mfma_f32_16x16x32_bf16 a[52:55], a[200:203], v[116:119], 0
    v_exp_f32 v51, v51
    v_mfma_f32_16x16x32_bf16 a[52:55], a[204:207], v[132:135], a[52:55]
    ds_read_b128 a[168:171], v10 offset:28672
    v_cvt_pk_bf16_f32 v147, v50, v51
    v_mfma_f32_16x16x32_bf16 a[56:59], a[200:203], v[120:123], 0
    v_exp_f32 v52, v52
    v_mfma_f32_16x16x32_bf16 a[56:59], a[204:207], v[136:139], a[56:59]
    buffer_load_dwordx4 v23, s[8:11], s57 offen offset:3072 lds
    v_mfma_f32_16x16x32_bf16 a[60:63], a[200:203], v[124:127], 0
    v_exp_f32 v53, v53
    v_mfma_f32_16x16x32_bf16 a[60:63], a[204:207], v[140:143], a[60:63]
    s_add_u32 s57, s57, 16384
    ds_read_b128 a[172:175], v11 offset:28672
    v_cvt_pk_bf16_f32 v150, v52, v53
    v_mfma_f32_16x16x32_bf16 a[128:131], v[28:31], v[112:115], 0
    v_exp_f32 v54, v54
    v_mfma_f32_16x16x32_bf16 a[128:131], v[28:31], v[128:131], a[128:131]
    v_mfma_f32_16x16x32_bf16 a[132:135], v[28:31], v[116:119], 0
    v_exp_f32 v55, v55
    v_mfma_f32_16x16x32_bf16 a[132:135], v[28:31], v[132:135], a[132:135]
    v_cvt_pk_bf16_f32 v151, v54, v55
    s_waitcnt vmcnt(20) lgkmcnt(2)
    s_barrier
    v_mfma_f32_16x16x32_bf16 v[64:67], a[144:147], v[160:163], v[96:99]
    v_exp_f32 v56, v56
    v_mfma_f32_16x16x32_bf16 v[64:67], a[148:151], v[164:167], v[64:67]
    ds_read_b64_tr_b16 a[176:177], v16 offset:0
    v_mfma_f32_16x16x32_bf16 v[64:67], a[152:155], v[168:171], v[64:67]
    v_exp_f32 v57, v57
    v_mfma_f32_16x16x32_bf16 v[64:67], a[156:159], v[172:175], v[64:67]
    ds_read_b64_tr_b16 a[178:179], v16 offset:4096
    v_cvt_pk_bf16_f32 v154, v56, v57
    v_mfma_f32_16x16x32_bf16 v[68:71], a[144:147], v[176:179], v[100:103]
    v_exp_f32 v58, v58
    v_mfma_f32_16x16x32_bf16 v[68:71], a[148:151], v[180:183], v[68:71]
    ds_read_b64_tr_b16 a[180:181], v16 offset:8192
    v_mfma_f32_16x16x32_bf16 v[68:71], a[152:155], v[184:187], v[68:71]
    v_exp_f32 v59, v59
    v_mfma_f32_16x16x32_bf16 v[68:71], a[156:159], v[188:191], v[68:71]
    ds_read_b64_tr_b16 a[182:183], v16 offset:12288
    v_cvt_pk_bf16_f32 v155, v58, v59
    v_mfma_f32_16x16x32_bf16 v[72:75], a[144:147], v[192:195], v[104:107]
    v_exp_f32 v60, v60
    v_mfma_f32_16x16x32_bf16 v[72:75], a[148:151], v[196:199], v[72:75]
    ds_read_b64_tr_b16 a[184:185], v17 offset:0
    v_mfma_f32_16x16x32_bf16 v[72:75], a[152:155], v[200:203], v[72:75]
    v_exp_f32 v61, v61
    v_mfma_f32_16x16x32_bf16 v[72:75], a[156:159], v[204:207], v[72:75]
    ds_read_b64_tr_b16 a[186:187], v17 offset:4096
    v_cvt_pk_bf16_f32 v158, v60, v61
    v_mfma_f32_16x16x32_bf16 v[76:79], a[144:147], v[208:211], v[108:111]
    v_exp_f32 v62, v62
    v_mfma_f32_16x16x32_bf16 v[76:79], a[148:151], v[212:215], v[76:79]
    ds_read_b64_tr_b16 a[188:189], v17 offset:8192
    v_mfma_f32_16x16x32_bf16 v[76:79], a[152:155], v[216:219], v[76:79]
    v_exp_f32 v63, v63
    v_mfma_f32_16x16x32_bf16 v[76:79], a[156:159], v[220:223], v[76:79]
    ds_read_b64_tr_b16 a[190:191], v17 offset:12288
    v_cvt_pk_bf16_f32 v159, v62, v63
    v_mfma_f32_16x16x32_bf16 v[80:83], a[160:163], v[160:163], v[96:99]
    s_add_u32 m0, s44, 4096
    s_nop 0
    buffer_load_dwordx4 v252, s[32:35], s94 offen lds
    v_mfma_f32_16x16x32_bf16 v[80:83], a[164:167], v[164:167], v[80:83]
    ds_read_b64_tr_b16 a[192:193], v18 offset:0
    s_waitcnt lgkmcnt(4)
    v_mfma_f32_16x16x32_bf16 v[80:83], a[168:171], v[168:171], v[80:83]
    v_mfma_f32_16x16x32_bf16 v[80:83], a[172:175], v[172:175], v[80:83]
    ds_read_b64_tr_b16 a[194:195], v18 offset:4096
    v_mfma_f32_16x16x32_bf16 v[84:87], a[160:163], v[176:179], v[100:103]
    v_exp_f32 v64, v64
    v_mfma_f32_16x16x32_bf16 v[84:87], a[164:167], v[180:183], v[84:87]
    ds_read_b64_tr_b16 a[196:197], v18 offset:8192
    v_mfma_f32_16x16x32_bf16 v[84:87], a[168:171], v[184:187], v[84:87]
    v_exp_f32 v65, v65
    v_mfma_f32_16x16x32_bf16 v[84:87], a[172:175], v[188:191], v[84:87]
    ds_read_b64_tr_b16 a[198:199], v18 offset:12288
    v_cvt_pk_bf16_f32 v224, v64, v65
    v_mfma_f32_16x16x32_bf16 v[88:91], a[160:163], v[192:195], v[104:107]
    v_exp_f32 v66, v66
    v_mfma_f32_16x16x32_bf16 v[88:91], a[164:167], v[196:199], v[88:91]
    ds_read_b64_tr_b16 a[200:201], v19 offset:0
    v_mfma_f32_16x16x32_bf16 v[88:91], a[168:171], v[200:203], v[88:91]
    v_exp_f32 v67, v67
    v_mfma_f32_16x16x32_bf16 v[88:91], a[172:175], v[204:207], v[88:91]
    ds_read_b64_tr_b16 a[202:203], v19 offset:4096
    v_cvt_pk_bf16_f32 v225, v66, v67
    v_mfma_f32_16x16x32_bf16 v[92:95], a[160:163], v[208:211], v[108:111]
    v_exp_f32 v68, v68
    v_mfma_f32_16x16x32_bf16 v[92:95], a[164:167], v[212:215], v[92:95]
    ds_read_b64_tr_b16 a[204:205], v19 offset:8192
    v_mfma_f32_16x16x32_bf16 v[92:95], a[168:171], v[216:219], v[92:95]
    v_exp_f32 v69, v69
    v_mfma_f32_16x16x32_bf16 v[92:95], a[172:175], v[220:223], v[92:95]
    ds_read_b64_tr_b16 a[206:207], v19 offset:12288
    v_cvt_pk_bf16_f32 v228, v68, v69
    v_mfma_f32_16x16x32_bf16 a[64:67], a[176:179], v[112:115], 0
    v_exp_f32 v70, v70
    v_mfma_f32_16x16x32_bf16 a[64:67], a[180:183], v[128:131], a[64:67]
    v_mfma_f32_16x16x32_bf16 a[68:71], a[176:179], v[116:119], 0
    v_exp_f32 v71, v71
    v_mfma_f32_16x16x32_bf16 a[68:71], a[180:183], v[132:135], a[68:71]
    ds_read_b128 a[144:147], v8 offset:32768
    v_cvt_pk_bf16_f32 v229, v70, v71
    v_mfma_f32_16x16x32_bf16 a[72:75], a[176:179], v[120:123], 0
    v_exp_f32 v72, v72
    v_mfma_f32_16x16x32_bf16 a[72:75], a[180:183], v[136:139], a[72:75]
    s_add_u32 m0, s53, 114688
    s_nop 0
    buffer_load_dwordx4 v24, s[12:15], s58 offen offset:0 lds
    v_mfma_f32_16x16x32_bf16 a[76:79], a[176:179], v[124:127], 0
    v_exp_f32 v73, v73
    v_mfma_f32_16x16x32_bf16 a[76:79], a[180:183], v[140:143], a[76:79]
    ds_read_b128 a[148:151], v9 offset:32768
    v_cvt_pk_bf16_f32 v232, v72, v73
    s_waitcnt lgkmcnt(2)
    v_mfma_f32_16x16x32_bf16 a[80:83], a[184:187], v[112:115], 0
    v_exp_f32 v74, v74
    v_mfma_f32_16x16x32_bf16 a[80:83], a[188:191], v[128:131], a[80:83]
    v_mfma_f32_16x16x32_bf16 a[84:87], a[184:187], v[116:119], 0
    v_exp_f32 v75, v75
    v_mfma_f32_16x16x32_bf16 a[84:87], a[188:191], v[132:135], a[84:87]
    ds_read_b128 a[152:155], v10 offset:32768
    v_cvt_pk_bf16_f32 v233, v74, v75
    v_mfma_f32_16x16x32_bf16 a[88:91], a[184:187], v[120:123], 0
    v_exp_f32 v76, v76
    v_mfma_f32_16x16x32_bf16 a[88:91], a[188:191], v[136:139], a[88:91]
    buffer_load_dwordx4 v25, s[12:15], s58 offen offset:1024 lds
    v_mfma_f32_16x16x32_bf16 a[92:95], a[184:187], v[124:127], 0
    v_exp_f32 v77, v77
    v_mfma_f32_16x16x32_bf16 a[92:95], a[188:191], v[140:143], a[92:95]
    ds_read_b128 a[156:159], v11 offset:32768
    v_cvt_pk_bf16_f32 v236, v76, v77
    v_mfma_f32_16x16x32_bf16 a[96:99], a[192:195], v[112:115], 0
    v_exp_f32 v78, v78
    v_mfma_f32_16x16x32_bf16 a[96:99], a[196:199], v[128:131], a[96:99]
    v_mfma_f32_16x16x32_bf16 a[100:103], a[192:195], v[116:119], 0
    v_exp_f32 v79, v79
    v_mfma_f32_16x16x32_bf16 a[100:103], a[196:199], v[132:135], a[100:103]
    ds_read_b128 a[160:163], v8 offset:36864
    v_cvt_pk_bf16_f32 v237, v78, v79
    v_mfma_f32_16x16x32_bf16 a[104:107], a[192:195], v[120:123], 0
    v_exp_f32 v80, v80
    v_mfma_f32_16x16x32_bf16 a[104:107], a[196:199], v[136:139], a[104:107]
    buffer_load_dwordx4 v24, s[12:15], s58 offen offset:2048 lds
    v_mfma_f32_16x16x32_bf16 a[108:111], a[192:195], v[124:127], 0
    v_exp_f32 v81, v81
    v_mfma_f32_16x16x32_bf16 a[108:111], a[196:199], v[140:143], a[108:111]
    ds_read_b128 a[164:167], v9 offset:36864
    v_cvt_pk_bf16_f32 v226, v80, v81
    v_mfma_f32_16x16x32_bf16 a[112:115], a[200:203], v[112:115], 0
    v_exp_f32 v82, v82
    v_mfma_f32_16x16x32_bf16 a[112:115], a[204:207], v[128:131], a[112:115]
    v_mfma_f32_16x16x32_bf16 a[116:119], a[200:203], v[116:119], 0
    v_exp_f32 v83, v83
    v_mfma_f32_16x16x32_bf16 a[116:119], a[204:207], v[132:135], a[116:119]
    ds_read_b128 a[168:171], v10 offset:36864
    v_cvt_pk_bf16_f32 v227, v82, v83
    v_mfma_f32_16x16x32_bf16 a[120:123], a[200:203], v[120:123], 0
    v_exp_f32 v84, v84
    v_mfma_f32_16x16x32_bf16 a[120:123], a[204:207], v[136:139], a[120:123]
    buffer_load_dwordx4 v25, s[12:15], s58 offen offset:3072 lds
    v_mfma_f32_16x16x32_bf16 a[124:127], a[200:203], v[124:127], 0
    v_exp_f32 v85, v85
    v_mfma_f32_16x16x32_bf16 a[124:127], a[204:207], v[140:143], a[124:127]
    s_add_u32 s58, s58, 16384
    ds_read_b128 a[172:175], v11 offset:36864
    v_cvt_pk_bf16_f32 v230, v84, v85
    v_mfma_f32_16x16x32_bf16 a[136:139], v[28:31], v[120:123], 0
    v_exp_f32 v86, v86
    v_mfma_f32_16x16x32_bf16 a[136:139], v[28:31], v[136:139], a[136:139]
    v_mfma_f32_16x16x32_bf16 a[140:143], v[28:31], v[124:127], 0
    v_exp_f32 v87, v87
    v_mfma_f32_16x16x32_bf16 a[140:143], v[28:31], v[140:143], a[140:143]
    v_cvt_pk_bf16_f32 v231, v86, v87
    s_waitcnt lgkmcnt(2)
    v_mfma_f32_16x16x32_bf16 v[32:35], a[144:147], v[160:163], v[96:99]
    v_exp_f32 v88, v88
    v_mfma_f32_16x16x32_bf16 v[32:35], a[148:151], v[164:167], v[32:35]
    ds_read_b64_tr_b16 a[176:177], v12 offset:16384
    v_mfma_f32_16x16x32_bf16 v[32:35], a[152:155], v[168:171], v[32:35]
    v_exp_f32 v89, v89
    v_mfma_f32_16x16x32_bf16 v[32:35], a[156:159], v[172:175], v[32:35]
    ds_read_b64_tr_b16 a[178:179], v12 offset:20480
    v_cvt_pk_bf16_f32 v234, v88, v89
    v_mfma_f32_16x16x32_bf16 v[36:39], a[144:147], v[176:179], v[100:103]
    v_exp_f32 v90, v90
    v_mfma_f32_16x16x32_bf16 v[36:39], a[148:151], v[180:183], v[36:39]
    ds_read_b64_tr_b16 a[180:181], v12 offset:24576
    v_mfma_f32_16x16x32_bf16 v[36:39], a[152:155], v[184:187], v[36:39]
    v_exp_f32 v91, v91
    v_mfma_f32_16x16x32_bf16 v[36:39], a[156:159], v[188:191], v[36:39]
    ds_read_b64_tr_b16 a[182:183], v12 offset:28672
    v_cvt_pk_bf16_f32 v235, v90, v91
    v_mfma_f32_16x16x32_bf16 v[40:43], a[144:147], v[192:195], v[104:107]
    v_exp_f32 v92, v92
    v_mfma_f32_16x16x32_bf16 v[40:43], a[148:151], v[196:199], v[40:43]
    ds_read_b64_tr_b16 a[184:185], v13 offset:16384
    v_mfma_f32_16x16x32_bf16 v[40:43], a[152:155], v[200:203], v[40:43]
    v_exp_f32 v93, v93
    v_mfma_f32_16x16x32_bf16 v[40:43], a[156:159], v[204:207], v[40:43]
    ds_read_b64_tr_b16 a[186:187], v13 offset:20480
    v_cvt_pk_bf16_f32 v238, v92, v93
    v_mfma_f32_16x16x32_bf16 v[44:47], a[144:147], v[208:211], v[108:111]
    v_exp_f32 v94, v94
    v_mfma_f32_16x16x32_bf16 v[44:47], a[148:151], v[212:215], v[44:47]
    ds_read_b64_tr_b16 a[188:189], v13 offset:24576
    v_mfma_f32_16x16x32_bf16 v[44:47], a[152:155], v[216:219], v[44:47]
    v_exp_f32 v95, v95
    v_mfma_f32_16x16x32_bf16 v[44:47], a[156:159], v[220:223], v[44:47]
    ds_read_b64_tr_b16 a[190:191], v13 offset:28672
    v_cvt_pk_bf16_f32 v239, v94, v95
    v_mfma_f32_16x16x32_bf16 v[48:51], a[160:163], v[160:163], v[96:99]
    v_mfma_f32_16x16x32_bf16 v[48:51], a[164:167], v[164:167], v[48:51]
    ds_read_b64_tr_b16 a[192:193], v14 offset:16384
    s_waitcnt lgkmcnt(5)
    v_mfma_f32_16x16x32_bf16 v[48:51], a[168:171], v[168:171], v[48:51]
    v_mfma_f32_16x16x32_bf16 v[48:51], a[172:175], v[172:175], v[48:51]
    ds_read_b64_tr_b16 a[194:195], v14 offset:20480
    v_mfma_f32_16x16x32_bf16 v[52:55], a[160:163], v[176:179], v[100:103]
    v_exp_f32 v32, v32
    v_mfma_f32_16x16x32_bf16 v[52:55], a[164:167], v[180:183], v[52:55]
    ds_read_b64_tr_b16 a[196:197], v14 offset:24576
    v_mfma_f32_16x16x32_bf16 v[52:55], a[168:171], v[184:187], v[52:55]
    v_exp_f32 v33, v33
    v_mfma_f32_16x16x32_bf16 v[52:55], a[172:175], v[188:191], v[52:55]
    ds_read_b64_tr_b16 a[198:199], v14 offset:28672
    v_cvt_pk_bf16_f32 v112, v32, v33
    v_mfma_f32_16x16x32_bf16 v[56:59], a[160:163], v[192:195], v[104:107]
    v_exp_f32 v34, v34
    v_mfma_f32_16x16x32_bf16 v[56:59], a[164:167], v[196:199], v[56:59]
    ds_read_b64_tr_b16 a[200:201], v15 offset:16384
    v_mfma_f32_16x16x32_bf16 v[56:59], a[168:171], v[200:203], v[56:59]
    v_exp_f32 v35, v35
    v_mfma_f32_16x16x32_bf16 v[56:59], a[172:175], v[204:207], v[56:59]
    ds_read_b64_tr_b16 a[202:203], v15 offset:20480
    v_cvt_pk_bf16_f32 v113, v34, v35
    v_mfma_f32_16x16x32_bf16 v[60:63], a[160:163], v[208:211], v[108:111]
    v_exp_f32 v36, v36
    v_mfma_f32_16x16x32_bf16 v[60:63], a[164:167], v[212:215], v[60:63]
    ds_read_b64_tr_b16 a[204:205], v15 offset:24576
    v_mfma_f32_16x16x32_bf16 v[60:63], a[168:171], v[216:219], v[60:63]
    v_exp_f32 v37, v37
    v_mfma_f32_16x16x32_bf16 v[60:63], a[172:175], v[220:223], v[60:63]
    ds_read_b64_tr_b16 a[206:207], v15 offset:28672
    v_cvt_pk_bf16_f32 v116, v36, v37
    v_mfma_f32_16x16x32_bf16 a[0:3], a[176:179], v[144:147], a[0:3]
    v_exp_f32 v38, v38
    v_mfma_f32_16x16x32_bf16 a[0:3], a[180:183], v[224:227], a[0:3]
    v_mfma_f32_16x16x32_bf16 a[4:7], a[176:179], v[148:151], a[4:7]
    v_exp_f32 v39, v39
    v_mfma_f32_16x16x32_bf16 a[4:7], a[180:183], v[228:231], a[4:7]
    ds_read_b128 a[144:147], v8 offset:40960
    v_cvt_pk_bf16_f32 v117, v38, v39
    v_mfma_f32_16x16x32_bf16 a[8:11], a[176:179], v[152:155], a[8:11]
    v_exp_f32 v40, v40
    v_mfma_f32_16x16x32_bf16 a[8:11], a[180:183], v[232:235], a[8:11]
    s_add_u32 m0, s53, 16384
    s_nop 0
    buffer_load_dwordx4 v20, s[8:11], s57 offen offset:0 lds
    v_mfma_f32_16x16x32_bf16 a[12:15], a[176:179], v[156:159], a[12:15]
    v_exp_f32 v41, v41
    v_mfma_f32_16x16x32_bf16 a[12:15], a[180:183], v[236:239], a[12:15]
    ds_read_b128 a[148:151], v9 offset:40960
    v_cvt_pk_bf16_f32 v120, v40, v41
    s_waitcnt lgkmcnt(2)
    v_mfma_f32_16x16x32_bf16 a[16:19], a[184:187], v[144:147], a[16:19]
    v_exp_f32 v42, v42
    v_mfma_f32_16x16x32_bf16 a[16:19], a[188:191], v[224:227], a[16:19]
    v_mfma_f32_16x16x32_bf16 a[20:23], a[184:187], v[148:151], a[20:23]
    v_exp_f32 v43, v43
    v_mfma_f32_16x16x32_bf16 a[20:23], a[188:191], v[228:231], a[20:23]
    ds_read_b128 a[152:155], v10 offset:40960
    v_cvt_pk_bf16_f32 v121, v42, v43
    v_mfma_f32_16x16x32_bf16 a[24:27], a[184:187], v[152:155], a[24:27]
    v_exp_f32 v44, v44
    v_mfma_f32_16x16x32_bf16 a[24:27], a[188:191], v[232:235], a[24:27]
    buffer_load_dwordx4 v21, s[8:11], s57 offen offset:1024 lds
    v_mfma_f32_16x16x32_bf16 a[28:31], a[184:187], v[156:159], a[28:31]
    v_exp_f32 v45, v45
    v_mfma_f32_16x16x32_bf16 a[28:31], a[188:191], v[236:239], a[28:31]
    ds_read_b128 a[156:159], v11 offset:40960
    v_cvt_pk_bf16_f32 v124, v44, v45
    v_mfma_f32_16x16x32_bf16 a[32:35], a[192:195], v[144:147], a[32:35]
    v_exp_f32 v46, v46
    v_mfma_f32_16x16x32_bf16 a[32:35], a[196:199], v[224:227], a[32:35]
    v_mfma_f32_16x16x32_bf16 a[36:39], a[192:195], v[148:151], a[36:39]
    v_exp_f32 v47, v47
    v_mfma_f32_16x16x32_bf16 a[36:39], a[196:199], v[228:231], a[36:39]
    ds_read_b128 a[160:163], v8 offset:45056
    v_cvt_pk_bf16_f32 v125, v46, v47
    v_mfma_f32_16x16x32_bf16 a[40:43], a[192:195], v[152:155], a[40:43]
    v_exp_f32 v48, v48
    v_mfma_f32_16x16x32_bf16 a[40:43], a[196:199], v[232:235], a[40:43]
    buffer_load_dwordx4 v22, s[8:11], s57 offen offset:2048 lds
    v_mfma_f32_16x16x32_bf16 a[44:47], a[192:195], v[156:159], a[44:47]
    v_exp_f32 v49, v49
    v_mfma_f32_16x16x32_bf16 a[44:47], a[196:199], v[236:239], a[44:47]
    ds_read_b128 a[164:167], v9 offset:45056
    v_cvt_pk_bf16_f32 v114, v48, v49
    v_mfma_f32_16x16x32_bf16 a[48:51], a[200:203], v[144:147], a[48:51]
    v_exp_f32 v50, v50
    v_mfma_f32_16x16x32_bf16 a[48:51], a[204:207], v[224:227], a[48:51]
    v_mfma_f32_16x16x32_bf16 a[52:55], a[200:203], v[148:151], a[52:55]
    v_exp_f32 v51, v51
    v_mfma_f32_16x16x32_bf16 a[52:55], a[204:207], v[228:231], a[52:55]
    ds_read_b128 a[168:171], v10 offset:45056
    v_cvt_pk_bf16_f32 v115, v50, v51
    v_mfma_f32_16x16x32_bf16 a[56:59], a[200:203], v[152:155], a[56:59]
    v_exp_f32 v52, v52
    v_mfma_f32_16x16x32_bf16 a[56:59], a[204:207], v[232:235], a[56:59]
    buffer_load_dwordx4 v23, s[8:11], s57 offen offset:3072 lds
    v_mfma_f32_16x16x32_bf16 a[60:63], a[200:203], v[156:159], a[60:63]
    v_exp_f32 v53, v53
    v_mfma_f32_16x16x32_bf16 a[60:63], a[204:207], v[236:239], a[60:63]
    s_add_u32 s57, s57, 16384
    ds_read_b128 a[172:175], v11 offset:45056
    v_cvt_pk_bf16_f32 v118, v52, v53
    v_mfma_f32_16x16x32_bf16 a[128:131], v[28:31], v[144:147], a[128:131]
    v_exp_f32 v54, v54
    v_mfma_f32_16x16x32_bf16 a[128:131], v[28:31], v[224:227], a[128:131]
    v_mfma_f32_16x16x32_bf16 a[132:135], v[28:31], v[148:151], a[132:135]
    v_exp_f32 v55, v55
    v_mfma_f32_16x16x32_bf16 a[132:135], v[28:31], v[228:231], a[132:135]
    v_cvt_pk_bf16_f32 v119, v54, v55
    s_waitcnt vmcnt(15) lgkmcnt(2)
    s_barrier
    v_mfma_f32_16x16x32_bf16 v[64:67], a[144:147], v[160:163], v[96:99]
    v_exp_f32 v56, v56
    v_mfma_f32_16x16x32_bf16 v[64:67], a[148:151], v[164:167], v[64:67]
    ds_read_b64_tr_b16 a[176:177], v16 offset:16384
    v_mfma_f32_16x16x32_bf16 v[64:67], a[152:155], v[168:171], v[64:67]
    v_exp_f32 v57, v57
    v_mfma_f32_16x16x32_bf16 v[64:67], a[156:159], v[172:175], v[64:67]
    ds_read_b64_tr_b16 a[178:179], v16 offset:20480
    v_cvt_pk_bf16_f32 v122, v56, v57
    v_mfma_f32_16x16x32_bf16 v[68:71], a[144:147], v[176:179], v[100:103]
    v_exp_f32 v58, v58
    v_mfma_f32_16x16x32_bf16 v[68:71], a[148:151], v[180:183], v[68:71]
    ds_read_b64_tr_b16 a[180:181], v16 offset:24576
    v_mfma_f32_16x16x32_bf16 v[68:71], a[152:155], v[184:187], v[68:71]
    v_exp_f32 v59, v59
    v_mfma_f32_16x16x32_bf16 v[68:71], a[156:159], v[188:191], v[68:71]
    ds_read_b64_tr_b16 a[182:183], v16 offset:28672
    v_cvt_pk_bf16_f32 v123, v58, v59
    v_mfma_f32_16x16x32_bf16 v[72:75], a[144:147], v[192:195], v[104:107]
    v_exp_f32 v60, v60
    v_mfma_f32_16x16x32_bf16 v[72:75], a[148:151], v[196:199], v[72:75]
    ds_read_b64_tr_b16 a[184:185], v17 offset:16384
    v_mfma_f32_16x16x32_bf16 v[72:75], a[152:155], v[200:203], v[72:75]
    v_exp_f32 v61, v61
    v_mfma_f32_16x16x32_bf16 v[72:75], a[156:159], v[204:207], v[72:75]
    ds_read_b64_tr_b16 a[186:187], v17 offset:20480
    v_cvt_pk_bf16_f32 v126, v60, v61
    v_mfma_f32_16x16x32_bf16 v[76:79], a[144:147], v[208:211], v[108:111]
    v_exp_f32 v62, v62
    v_mfma_f32_16x16x32_bf16 v[76:79], a[148:151], v[212:215], v[76:79]
    ds_read_b64_tr_b16 a[188:189], v17 offset:24576
    v_mfma_f32_16x16x32_bf16 v[76:79], a[152:155], v[216:219], v[76:79]
    v_exp_f32 v63, v63
    v_mfma_f32_16x16x32_bf16 v[76:79], a[156:159], v[220:223], v[76:79]
    ds_read_b64_tr_b16 a[190:191], v17 offset:28672
    v_cvt_pk_bf16_f32 v127, v62, v63
    v_mfma_f32_16x16x32_bf16 v[80:83], a[160:163], v[160:163], v[96:99]
    v_mfma_f32_16x16x32_bf16 v[80:83], a[164:167], v[164:167], v[80:83]
    ds_read_b64_tr_b16 a[192:193], v18 offset:16384
    s_waitcnt lgkmcnt(5)
    v_mfma_f32_16x16x32_bf16 v[80:83], a[168:171], v[168:171], v[80:83]
    v_mfma_f32_16x16x32_bf16 v[80:83], a[172:175], v[172:175], v[80:83]
    ds_read_b64_tr_b16 a[194:195], v18 offset:20480
    v_mfma_f32_16x16x32_bf16 v[84:87], a[160:163], v[176:179], v[100:103]
    v_exp_f32 v64, v64
    v_mfma_f32_16x16x32_bf16 v[84:87], a[164:167], v[180:183], v[84:87]
    ds_read_b64_tr_b16 a[196:197], v18 offset:24576
    v_mfma_f32_16x16x32_bf16 v[84:87], a[168:171], v[184:187], v[84:87]
    v_exp_f32 v65, v65
    v_mfma_f32_16x16x32_bf16 v[84:87], a[172:175], v[188:191], v[84:87]
    ds_read_b64_tr_b16 a[198:199], v18 offset:28672
    v_cvt_pk_bf16_f32 v128, v64, v65
    v_mfma_f32_16x16x32_bf16 v[88:91], a[160:163], v[192:195], v[104:107]
    v_exp_f32 v66, v66
    v_mfma_f32_16x16x32_bf16 v[88:91], a[164:167], v[196:199], v[88:91]
    ds_read_b64_tr_b16 a[200:201], v19 offset:16384
    v_mfma_f32_16x16x32_bf16 v[88:91], a[168:171], v[200:203], v[88:91]
    v_exp_f32 v67, v67
    v_mfma_f32_16x16x32_bf16 v[88:91], a[172:175], v[204:207], v[88:91]
    ds_read_b64_tr_b16 a[202:203], v19 offset:20480
    v_cvt_pk_bf16_f32 v129, v66, v67
    v_mfma_f32_16x16x32_bf16 v[92:95], a[160:163], v[208:211], v[108:111]
    v_exp_f32 v68, v68
    v_mfma_f32_16x16x32_bf16 v[92:95], a[164:167], v[212:215], v[92:95]
    ds_read_b64_tr_b16 a[204:205], v19 offset:24576
    v_mfma_f32_16x16x32_bf16 v[92:95], a[168:171], v[216:219], v[92:95]
    v_exp_f32 v69, v69
    v_mfma_f32_16x16x32_bf16 v[92:95], a[172:175], v[220:223], v[92:95]
    ds_read_b64_tr_b16 a[206:207], v19 offset:28672
    v_cvt_pk_bf16_f32 v132, v68, v69
    v_mfma_f32_16x16x32_bf16 a[64:67], a[176:179], v[144:147], a[64:67]
    v_exp_f32 v70, v70
    v_mfma_f32_16x16x32_bf16 a[64:67], a[180:183], v[224:227], a[64:67]
    v_mfma_f32_16x16x32_bf16 a[68:71], a[176:179], v[148:151], a[68:71]
    v_exp_f32 v71, v71
    v_mfma_f32_16x16x32_bf16 a[68:71], a[180:183], v[228:231], a[68:71]
    ds_read_b128 a[144:147], v8 offset:49152
    v_cvt_pk_bf16_f32 v133, v70, v71
    v_mfma_f32_16x16x32_bf16 a[72:75], a[176:179], v[152:155], a[72:75]
    v_exp_f32 v72, v72
    v_mfma_f32_16x16x32_bf16 a[72:75], a[180:183], v[232:235], a[72:75]
    s_add_u32 m0, s53, 65536
    s_nop 0
    buffer_load_dwordx4 v24, s[12:15], s58 offen offset:0 lds
    v_mfma_f32_16x16x32_bf16 a[76:79], a[176:179], v[156:159], a[76:79]
    v_exp_f32 v73, v73
    v_mfma_f32_16x16x32_bf16 a[76:79], a[180:183], v[236:239], a[76:79]
    ds_read_b128 a[148:151], v9 offset:49152
    v_cvt_pk_bf16_f32 v136, v72, v73
    s_waitcnt lgkmcnt(2)
    v_mfma_f32_16x16x32_bf16 a[80:83], a[184:187], v[144:147], a[80:83]
    v_exp_f32 v74, v74
    v_mfma_f32_16x16x32_bf16 a[80:83], a[188:191], v[224:227], a[80:83]
    v_mfma_f32_16x16x32_bf16 a[84:87], a[184:187], v[148:151], a[84:87]
    v_exp_f32 v75, v75
    v_mfma_f32_16x16x32_bf16 a[84:87], a[188:191], v[228:231], a[84:87]
    ds_read_b128 a[152:155], v10 offset:49152
    v_cvt_pk_bf16_f32 v137, v74, v75
    v_mfma_f32_16x16x32_bf16 a[88:91], a[184:187], v[152:155], a[88:91]
    v_exp_f32 v76, v76
    v_mfma_f32_16x16x32_bf16 a[88:91], a[188:191], v[232:235], a[88:91]
    buffer_load_dwordx4 v25, s[12:15], s58 offen offset:1024 lds
    v_mfma_f32_16x16x32_bf16 a[92:95], a[184:187], v[156:159], a[92:95]
    v_exp_f32 v77, v77
    v_mfma_f32_16x16x32_bf16 a[92:95], a[188:191], v[236:239], a[92:95]
    ds_read_b128 a[156:159], v11 offset:49152
    v_cvt_pk_bf16_f32 v140, v76, v77
    v_mfma_f32_16x16x32_bf16 a[96:99], a[192:195], v[144:147], a[96:99]
    v_exp_f32 v78, v78
    v_mfma_f32_16x16x32_bf16 a[96:99], a[196:199], v[224:227], a[96:99]
    v_mfma_f32_16x16x32_bf16 a[100:103], a[192:195], v[148:151], a[100:103]
    v_exp_f32 v79, v79
    v_mfma_f32_16x16x32_bf16 a[100:103], a[196:199], v[228:231], a[100:103]
    ds_read_b128 a[160:163], v8 offset:53248
    v_cvt_pk_bf16_f32 v141, v78, v79
    v_mfma_f32_16x16x32_bf16 a[104:107], a[192:195], v[152:155], a[104:107]
    v_exp_f32 v80, v80
    v_mfma_f32_16x16x32_bf16 a[104:107], a[196:199], v[232:235], a[104:107]
    buffer_load_dwordx4 v24, s[12:15], s58 offen offset:2048 lds
    v_mfma_f32_16x16x32_bf16 a[108:111], a[192:195], v[156:159], a[108:111]
    v_exp_f32 v81, v81
    v_mfma_f32_16x16x32_bf16 a[108:111], a[196:199], v[236:239], a[108:111]
    ds_read_b128 a[164:167], v9 offset:53248
    v_cvt_pk_bf16_f32 v130, v80, v81
    v_mfma_f32_16x16x32_bf16 a[112:115], a[200:203], v[144:147], a[112:115]
    v_exp_f32 v82, v82
    v_mfma_f32_16x16x32_bf16 a[112:115], a[204:207], v[224:227], a[112:115]
    v_mfma_f32_16x16x32_bf16 a[116:119], a[200:203], v[148:151], a[116:119]
    v_exp_f32 v83, v83
    v_mfma_f32_16x16x32_bf16 a[116:119], a[204:207], v[228:231], a[116:119]
    ds_read_b128 a[168:171], v10 offset:53248
    v_cvt_pk_bf16_f32 v131, v82, v83
    v_mfma_f32_16x16x32_bf16 a[120:123], a[200:203], v[152:155], a[120:123]
    v_exp_f32 v84, v84
    v_mfma_f32_16x16x32_bf16 a[120:123], a[204:207], v[232:235], a[120:123]
    buffer_load_dwordx4 v25, s[12:15], s58 offen offset:3072 lds
    v_mfma_f32_16x16x32_bf16 a[124:127], a[200:203], v[156:159], a[124:127]
    v_exp_f32 v85, v85
    v_mfma_f32_16x16x32_bf16 a[124:127], a[204:207], v[236:239], a[124:127]
    s_add_u32 s58, s58, 16384
    ds_read_b128 a[172:175], v11 offset:53248
    v_cvt_pk_bf16_f32 v134, v84, v85
    v_mfma_f32_16x16x32_bf16 a[136:139], v[28:31], v[152:155], a[136:139]
    v_exp_f32 v86, v86
    v_mfma_f32_16x16x32_bf16 a[136:139], v[28:31], v[232:235], a[136:139]
    v_mfma_f32_16x16x32_bf16 a[140:143], v[28:31], v[156:159], a[140:143]
    v_exp_f32 v87, v87
    v_mfma_f32_16x16x32_bf16 a[140:143], v[28:31], v[236:239], a[140:143]
    v_cvt_pk_bf16_f32 v135, v86, v87
    s_waitcnt lgkmcnt(2)
    v_mfma_f32_16x16x32_bf16 v[32:35], a[144:147], v[160:163], v[96:99]
    v_exp_f32 v88, v88
    v_mfma_f32_16x16x32_bf16 v[32:35], a[148:151], v[164:167], v[32:35]
    ds_read_b64_tr_b16 a[176:177], v12 offset:32768
    v_mfma_f32_16x16x32_bf16 v[32:35], a[152:155], v[168:171], v[32:35]
    v_exp_f32 v89, v89
    v_mfma_f32_16x16x32_bf16 v[32:35], a[156:159], v[172:175], v[32:35]
    ds_read_b64_tr_b16 a[178:179], v12 offset:36864
    v_cvt_pk_bf16_f32 v138, v88, v89
    v_mfma_f32_16x16x32_bf16 v[36:39], a[144:147], v[176:179], v[100:103]
    v_exp_f32 v90, v90
    v_mfma_f32_16x16x32_bf16 v[36:39], a[148:151], v[180:183], v[36:39]
    ds_read_b64_tr_b16 a[180:181], v12 offset:40960
    v_mfma_f32_16x16x32_bf16 v[36:39], a[152:155], v[184:187], v[36:39]
    v_exp_f32 v91, v91
    v_mfma_f32_16x16x32_bf16 v[36:39], a[156:159], v[188:191], v[36:39]
    ds_read_b64_tr_b16 a[182:183], v12 offset:45056
    v_cvt_pk_bf16_f32 v139, v90, v91
    v_mfma_f32_16x16x32_bf16 v[40:43], a[144:147], v[192:195], v[104:107]
    v_exp_f32 v92, v92
    v_mfma_f32_16x16x32_bf16 v[40:43], a[148:151], v[196:199], v[40:43]
    ds_read_b64_tr_b16 a[184:185], v13 offset:32768
    v_mfma_f32_16x16x32_bf16 v[40:43], a[152:155], v[200:203], v[40:43]
    v_exp_f32 v93, v93
    v_mfma_f32_16x16x32_bf16 v[40:43], a[156:159], v[204:207], v[40:43]
    ds_read_b64_tr_b16 a[186:187], v13 offset:36864
    v_cvt_pk_bf16_f32 v142, v92, v93
    v_mfma_f32_16x16x32_bf16 v[44:47], a[144:147], v[208:211], v[108:111]
    v_exp_f32 v94, v94
    v_mfma_f32_16x16x32_bf16 v[44:47], a[148:151], v[212:215], v[44:47]
    ds_read_b64_tr_b16 a[188:189], v13 offset:40960
    v_mfma_f32_16x16x32_bf16 v[44:47], a[152:155], v[216:219], v[44:47]
    v_exp_f32 v95, v95
    v_mfma_f32_16x16x32_bf16 v[44:47], a[156:159], v[220:223], v[44:47]
    ds_read_b64_tr_b16 a[190:191], v13 offset:45056
    v_cvt_pk_bf16_f32 v143, v94, v95
    v_mfma_f32_16x16x32_bf16 v[48:51], a[160:163], v[160:163], v[96:99]
    s_waitcnt vmcnt(12)
    ds_read_b64_tr_b16 a[208:209], v253 offset:0
    v_mfma_f32_16x16x32_bf16 v[48:51], a[164:167], v[164:167], v[48:51]
    ds_read_b64_tr_b16 a[192:193], v14 offset:32768
    s_waitcnt lgkmcnt(5)
    v_mfma_f32_16x16x32_bf16 v[48:51], a[168:171], v[168:171], v[48:51]
    ds_read_b64_tr_b16 a[210:211], v253 offset:2560
    v_mfma_f32_16x16x32_bf16 v[48:51], a[172:175], v[172:175], v[48:51]
    ds_read_b64_tr_b16 a[194:195], v14 offset:36864
    v_mfma_f32_16x16x32_bf16 v[52:55], a[160:163], v[176:179], v[100:103]
    v_exp_f32 v32, v32
    v_mfma_f32_16x16x32_bf16 v[52:55], a[164:167], v[180:183], v[52:55]
    ds_read_b64_tr_b16 a[196:197], v14 offset:40960
    v_mfma_f32_16x16x32_bf16 v[52:55], a[168:171], v[184:187], v[52:55]
    v_exp_f32 v33, v33
    v_mfma_f32_16x16x32_bf16 v[52:55], a[172:175], v[188:191], v[52:55]
    ds_read_b64_tr_b16 a[198:199], v14 offset:45056
    v_cvt_pk_bf16_f32 v144, v32, v33
    v_mfma_f32_16x16x32_bf16 v[56:59], a[160:163], v[192:195], v[104:107]
    v_exp_f32 v34, v34
    v_mfma_f32_16x16x32_bf16 v[56:59], a[164:167], v[196:199], v[56:59]
    ds_read_b64_tr_b16 a[200:201], v15 offset:32768
    v_mfma_f32_16x16x32_bf16 v[56:59], a[168:171], v[200:203], v[56:59]
    v_exp_f32 v35, v35
    v_mfma_f32_16x16x32_bf16 v[56:59], a[172:175], v[204:207], v[56:59]
    ds_read_b64_tr_b16 a[202:203], v15 offset:36864
    v_cvt_pk_bf16_f32 v145, v34, v35
    v_mfma_f32_16x16x32_bf16 v[60:63], a[160:163], v[208:211], v[108:111]
    v_exp_f32 v36, v36
    v_mfma_f32_16x16x32_bf16 v[60:63], a[164:167], v[212:215], v[60:63]
    ds_read_b64_tr_b16 a[204:205], v15 offset:40960
    v_mfma_f32_16x16x32_bf16 v[60:63], a[168:171], v[216:219], v[60:63]
    v_exp_f32 v37, v37
    v_mfma_f32_16x16x32_bf16 v[60:63], a[172:175], v[220:223], v[60:63]
    ds_read_b64_tr_b16 a[206:207], v15 offset:45056
    v_cvt_pk_bf16_f32 v148, v36, v37
    v_mfma_f32_16x16x32_bf16 a[0:3], a[176:179], v[112:115], a[0:3]
    v_exp_f32 v38, v38
    v_mfma_f32_16x16x32_bf16 a[0:3], a[180:183], v[128:131], a[0:3]
    ds_read_b64_tr_b16 a[212:213], v253 offset:32
    v_mfma_f32_16x16x32_bf16 a[4:7], a[176:179], v[116:119], a[4:7]
    v_exp_f32 v39, v39
    v_mfma_f32_16x16x32_bf16 a[4:7], a[180:183], v[132:135], a[4:7]
    ds_read_b128 a[144:147], v8 offset:57344
    v_cvt_pk_bf16_f32 v149, v38, v39
    v_mfma_f32_16x16x32_bf16 a[8:11], a[176:179], v[120:123], a[8:11]
    v_exp_f32 v40, v40
    v_mfma_f32_16x16x32_bf16 a[8:11], a[180:183], v[136:139], a[8:11]
    s_add_u32 m0, s53, 32768
    s_nop 0
    buffer_load_dwordx4 v20, s[8:11], s57 offen offset:0 lds
    v_mfma_f32_16x16x32_bf16 a[12:15], a[176:179], v[124:127], a[12:15]
    v_exp_f32 v41, v41
    v_mfma_f32_16x16x32_bf16 a[12:15], a[180:183], v[140:143], a[12:15]
    ds_read_b128 a[148:151], v9 offset:57344
    v_cvt_pk_bf16_f32 v152, v40, v41
    s_waitcnt lgkmcnt(3)
    v_mfma_f32_16x16x32_bf16 a[16:19], a[184:187], v[112:115], a[16:19]
    v_exp_f32 v42, v42
    v_mfma_f32_16x16x32_bf16 a[16:19], a[188:191], v[128:131], a[16:19]
    ds_read_b64_tr_b16 a[214:215], v253 offset:2592
    v_mfma_f32_16x16x32_bf16 a[20:23], a[184:187], v[116:119], a[20:23]
    v_exp_f32 v43, v43
    v_mfma_f32_16x16x32_bf16 a[20:23], a[188:191], v[132:135], a[20:23]
    ds_read_b128 a[152:155], v10 offset:57344
    v_cvt_pk_bf16_f32 v153, v42, v43
    v_mfma_f32_16x16x32_bf16 a[24:27], a[184:187], v[120:123], a[24:27]
    v_exp_f32 v44, v44
    v_mfma_f32_16x16x32_bf16 a[24:27], a[188:191], v[136:139], a[24:27]
    buffer_load_dwordx4 v21, s[8:11], s57 offen offset:1024 lds
    v_mfma_f32_16x16x32_bf16 a[28:31], a[184:187], v[124:127], a[28:31]
    v_exp_f32 v45, v45
    v_mfma_f32_16x16x32_bf16 a[28:31], a[188:191], v[140:143], a[28:31]
    ds_read_b128 a[156:159], v11 offset:57344
    v_cvt_pk_bf16_f32 v156, v44, v45
    v_mfma_f32_16x16x32_bf16 a[32:35], a[192:195], v[112:115], a[32:35]
    v_exp_f32 v46, v46
    v_mfma_f32_16x16x32_bf16 a[32:35], a[196:199], v[128:131], a[32:35]
    ds_read_b64_tr_b16 a[216:217], v253 offset:64
    v_mfma_f32_16x16x32_bf16 a[36:39], a[192:195], v[116:119], a[36:39]
    v_exp_f32 v47, v47
    v_mfma_f32_16x16x32_bf16 a[36:39], a[196:199], v[132:135], a[36:39]
    ds_read_b128 a[160:163], v8 offset:61440
    v_cvt_pk_bf16_f32 v157, v46, v47
    v_mfma_f32_16x16x32_bf16 a[40:43], a[192:195], v[120:123], a[40:43]
    v_exp_f32 v48, v48
    v_mfma_f32_16x16x32_bf16 a[40:43], a[196:199], v[136:139], a[40:43]
    buffer_load_dwordx4 v22, s[8:11], s57 offen offset:2048 lds
    v_mfma_f32_16x16x32_bf16 a[44:47], a[192:195], v[124:127], a[44:47]
    v_exp_f32 v49, v49
    v_mfma_f32_16x16x32_bf16 a[44:47], a[196:199], v[140:143], a[44:47]
    ds_read_b128 a[164:167], v9 offset:61440
    v_cvt_pk_bf16_f32 v146, v48, v49
    v_mfma_f32_16x16x32_bf16 a[48:51], a[200:203], v[112:115], a[48:51]
    v_exp_f32 v50, v50
    v_mfma_f32_16x16x32_bf16 a[48:51], a[204:207], v[128:131], a[48:51]
    ds_read_b64_tr_b16 a[218:219], v253 offset:2624
    v_mfma_f32_16x16x32_bf16 a[52:55], a[200:203], v[116:119], a[52:55]
    v_exp_f32 v51, v51
    v_mfma_f32_16x16x32_bf16 a[52:55], a[204:207], v[132:135], a[52:55]
    ds_read_b128 a[168:171], v10 offset:61440
    v_cvt_pk_bf16_f32 v147, v50, v51
    v_mfma_f32_16x16x32_bf16 a[56:59], a[200:203], v[120:123], a[56:59]
    v_exp_f32 v52, v52
    v_mfma_f32_16x16x32_bf16 a[56:59], a[204:207], v[136:139], a[56:59]
    buffer_load_dwordx4 v23, s[8:11], s57 offen offset:3072 lds
    v_mfma_f32_16x16x32_bf16 a[60:63], a[200:203], v[124:127], a[60:63]
    v_exp_f32 v53, v53
    v_mfma_f32_16x16x32_bf16 a[60:63], a[204:207], v[140:143], a[60:63]
    s_add_u32 s57, s57, 16384
    ds_read_b128 a[172:175], v11 offset:61440
    v_cvt_pk_bf16_f32 v150, v52, v53
    v_mfma_f32_16x16x32_bf16 a[128:131], v[28:31], v[112:115], a[128:131]
    v_exp_f32 v54, v54
    v_mfma_f32_16x16x32_bf16 a[128:131], v[28:31], v[128:131], a[128:131]
    ds_read_b64_tr_b16 a[220:221], v253 offset:96
    v_mfma_f32_16x16x32_bf16 a[132:135], v[28:31], v[116:119], a[132:135]
    v_exp_f32 v55, v55
    v_mfma_f32_16x16x32_bf16 a[132:135], v[28:31], v[132:135], a[132:135]
    v_cvt_pk_bf16_f32 v151, v54, v55
    s_waitcnt vmcnt(12) lgkmcnt(2)
    s_barrier
    v_mfma_f32_16x16x32_bf16 v[64:67], a[144:147], v[160:163], v[96:99]
    v_exp_f32 v56, v56
    v_mfma_f32_16x16x32_bf16 v[64:67], a[148:151], v[164:167], v[64:67]
    ds_read_b64_tr_b16 a[176:177], v16 offset:32768
    v_mfma_f32_16x16x32_bf16 v[64:67], a[152:155], v[168:171], v[64:67]
    v_exp_f32 v57, v57
    v_mfma_f32_16x16x32_bf16 v[64:67], a[156:159], v[172:175], v[64:67]
    ds_read_b64_tr_b16 a[178:179], v16 offset:36864
    v_cvt_pk_bf16_f32 v154, v56, v57
    v_mfma_f32_16x16x32_bf16 v[68:71], a[144:147], v[176:179], v[100:103]
    v_exp_f32 v58, v58
    v_mfma_f32_16x16x32_bf16 v[68:71], a[148:151], v[180:183], v[68:71]
    ds_read_b64_tr_b16 a[180:181], v16 offset:40960
    v_mfma_f32_16x16x32_bf16 v[68:71], a[152:155], v[184:187], v[68:71]
    v_exp_f32 v59, v59
    v_mfma_f32_16x16x32_bf16 v[68:71], a[156:159], v[188:191], v[68:71]
    ds_read_b64_tr_b16 a[182:183], v16 offset:45056
    v_cvt_pk_bf16_f32 v155, v58, v59
    v_mfma_f32_16x16x32_bf16 v[72:75], a[144:147], v[192:195], v[104:107]
    v_exp_f32 v60, v60
    v_mfma_f32_16x16x32_bf16 v[72:75], a[148:151], v[196:199], v[72:75]
    ds_read_b64_tr_b16 a[184:185], v17 offset:32768
    v_mfma_f32_16x16x32_bf16 v[72:75], a[152:155], v[200:203], v[72:75]
    v_exp_f32 v61, v61
    v_mfma_f32_16x16x32_bf16 v[72:75], a[156:159], v[204:207], v[72:75]
    ds_read_b64_tr_b16 a[186:187], v17 offset:36864
    v_cvt_pk_bf16_f32 v158, v60, v61
    v_mfma_f32_16x16x32_bf16 v[76:79], a[144:147], v[208:211], v[108:111]
    v_exp_f32 v62, v62
    v_mfma_f32_16x16x32_bf16 v[76:79], a[148:151], v[212:215], v[76:79]
    ds_read_b64_tr_b16 a[188:189], v17 offset:40960
    v_mfma_f32_16x16x32_bf16 v[76:79], a[152:155], v[216:219], v[76:79]
    v_exp_f32 v63, v63
    v_mfma_f32_16x16x32_bf16 v[76:79], a[156:159], v[220:223], v[76:79]
    ds_read_b64_tr_b16 a[190:191], v17 offset:45056
    v_cvt_pk_bf16_f32 v159, v62, v63
    v_mfma_f32_16x16x32_bf16 v[80:83], a[160:163], v[160:163], v[96:99]
    ds_read_b64_tr_b16 a[222:223], v253 offset:2656
    v_mfma_f32_16x16x32_bf16 v[80:83], a[164:167], v[164:167], v[80:83]
    ds_read_b64_tr_b16 a[192:193], v18 offset:32768
    v_mfma_f32_16x16x32_bf16 v[80:83], a[168:171], v[168:171], v[80:83]
    ds_read_b64_tr_b16 a[224:225], v253 offset:128
    s_waitcnt lgkmcnt(6)
    v_mfma_f32_16x16x32_bf16 v[80:83], a[172:175], v[172:175], v[80:83]
    ds_read_b64_tr_b16 a[194:195], v18 offset:36864
    v_mfma_f32_16x16x32_bf16 v[84:87], a[160:163], v[176:179], v[100:103]
    v_exp_f32 v64, v64
    v_mfma_f32_16x16x32_bf16 v[84:87], a[164:167], v[180:183], v[84:87]
    ds_read_b64_tr_b16 a[196:197], v18 offset:40960
    v_mfma_f32_16x16x32_bf16 v[84:87], a[168:171], v[184:187], v[84:87]
    v_exp_f32 v65, v65
    v_mfma_f32_16x16x32_bf16 v[84:87], a[172:175], v[188:191], v[84:87]
    ds_read_b64_tr_b16 a[198:199], v18 offset:45056
    v_cvt_pk_bf16_f32 v224, v64, v65
    v_mfma_f32_16x16x32_bf16 v[88:91], a[160:163], v[192:195], v[104:107]
    v_exp_f32 v66, v66
    v_mfma_f32_16x16x32_bf16 v[88:91], a[164:167], v[196:199], v[88:91]
    ds_read_b64_tr_b16 a[200:201], v19 offset:32768
    v_mfma_f32_16x16x32_bf16 v[88:91], a[168:171], v[200:203], v[88:91]
    v_exp_f32 v67, v67
    v_mfma_f32_16x16x32_bf16 v[88:91], a[172:175], v[204:207], v[88:91]
    ds_read_b64_tr_b16 a[202:203], v19 offset:36864
    v_cvt_pk_bf16_f32 v225, v66, v67
    v_mfma_f32_16x16x32_bf16 v[92:95], a[160:163], v[208:211], v[108:111]
    v_exp_f32 v68, v68
    v_mfma_f32_16x16x32_bf16 v[92:95], a[164:167], v[212:215], v[92:95]
    ds_read_b64_tr_b16 a[204:205], v19 offset:40960
    v_mfma_f32_16x16x32_bf16 v[92:95], a[168:171], v[216:219], v[92:95]
    v_exp_f32 v69, v69
    v_mfma_f32_16x16x32_bf16 v[92:95], a[172:175], v[220:223], v[92:95]
    ds_read_b64_tr_b16 a[206:207], v19 offset:45056
    v_cvt_pk_bf16_f32 v228, v68, v69
    v_mfma_f32_16x16x32_bf16 a[64:67], a[176:179], v[112:115], a[64:67]
    v_exp_f32 v70, v70
    v_mfma_f32_16x16x32_bf16 a[64:67], a[180:183], v[128:131], a[64:67]
    ds_read_b64_tr_b16 a[226:227], v253 offset:2688
    v_mfma_f32_16x16x32_bf16 a[68:71], a[176:179], v[116:119], a[68:71]
    v_exp_f32 v71, v71
    v_mfma_f32_16x16x32_bf16 a[68:71], a[180:183], v[132:135], a[68:71]
    ds_read_b128 a[144:147], v8 offset:0
    v_cvt_pk_bf16_f32 v229, v70, v71
    v_mfma_f32_16x16x32_bf16 a[72:75], a[176:179], v[120:123], a[72:75]
    v_exp_f32 v72, v72
    v_mfma_f32_16x16x32_bf16 a[72:75], a[180:183], v[136:139], a[72:75]
    s_add_u32 m0, s53, 81920
    s_nop 0
    buffer_load_dwordx4 v24, s[12:15], s58 offen offset:0 lds
    v_mfma_f32_16x16x32_bf16 a[76:79], a[176:179], v[124:127], a[76:79]
    v_exp_f32 v73, v73
    v_mfma_f32_16x16x32_bf16 a[76:79], a[180:183], v[140:143], a[76:79]
    ds_read_b128 a[148:151], v9 offset:0
    v_cvt_pk_bf16_f32 v232, v72, v73
    s_waitcnt lgkmcnt(3)
    v_mfma_f32_16x16x32_bf16 a[80:83], a[184:187], v[112:115], a[80:83]
    v_exp_f32 v74, v74
    v_mfma_f32_16x16x32_bf16 a[80:83], a[188:191], v[128:131], a[80:83]
    v_mfma_f32_16x16x32_bf16 a[84:87], a[184:187], v[116:119], a[84:87]
    v_exp_f32 v75, v75
    v_mfma_f32_16x16x32_bf16 a[84:87], a[188:191], v[132:135], a[84:87]
    ds_read_b128 a[152:155], v10 offset:0
    v_cvt_pk_bf16_f32 v233, v74, v75
    v_mfma_f32_16x16x32_bf16 a[88:91], a[184:187], v[120:123], a[88:91]
    v_exp_f32 v76, v76
    v_mfma_f32_16x16x32_bf16 a[88:91], a[188:191], v[136:139], a[88:91]
    buffer_load_dwordx4 v25, s[12:15], s58 offen offset:1024 lds
    v_mfma_f32_16x16x32_bf16 a[92:95], a[184:187], v[124:127], a[92:95]
    v_exp_f32 v77, v77
    v_mfma_f32_16x16x32_bf16 a[92:95], a[188:191], v[140:143], a[92:95]
    ds_read_b128 a[156:159], v11 offset:0
    v_cvt_pk_bf16_f32 v236, v76, v77
    v_mfma_f32_16x16x32_bf16 a[96:99], a[192:195], v[112:115], a[96:99]
    v_exp_f32 v78, v78
    v_mfma_f32_16x16x32_bf16 a[96:99], a[196:199], v[128:131], a[96:99]
    v_mfma_f32_16x16x32_bf16 a[100:103], a[192:195], v[116:119], a[100:103]
    v_exp_f32 v79, v79
    v_mfma_f32_16x16x32_bf16 a[100:103], a[196:199], v[132:135], a[100:103]
    ds_read_b128 a[160:163], v8 offset:4096
    v_cvt_pk_bf16_f32 v237, v78, v79
    v_mfma_f32_16x16x32_bf16 a[104:107], a[192:195], v[120:123], a[104:107]
    v_exp_f32 v80, v80
    v_mfma_f32_16x16x32_bf16 a[104:107], a[196:199], v[136:139], a[104:107]
    buffer_load_dwordx4 v24, s[12:15], s58 offen offset:2048 lds
    v_mfma_f32_16x16x32_bf16 a[108:111], a[192:195], v[124:127], a[108:111]
    v_exp_f32 v81, v81
    v_mfma_f32_16x16x32_bf16 a[108:111], a[196:199], v[140:143], a[108:111]
    ds_read_b128 a[164:167], v9 offset:4096
    v_cvt_pk_bf16_f32 v226, v80, v81
    v_mfma_f32_16x16x32_bf16 a[112:115], a[200:203], v[112:115], a[112:115]
    v_exp_f32 v82, v82
    v_mfma_f32_16x16x32_bf16 a[112:115], a[204:207], v[128:131], a[112:115]
    v_mfma_f32_16x16x32_bf16 a[116:119], a[200:203], v[116:119], a[116:119]
    v_exp_f32 v83, v83
    v_mfma_f32_16x16x32_bf16 a[116:119], a[204:207], v[132:135], a[116:119]
    ds_read_b128 a[168:171], v10 offset:4096
    v_cvt_pk_bf16_f32 v227, v82, v83
    v_mfma_f32_16x16x32_bf16 a[120:123], a[200:203], v[120:123], a[120:123]
    v_exp_f32 v84, v84
    v_mfma_f32_16x16x32_bf16 a[120:123], a[204:207], v[136:139], a[120:123]
    buffer_load_dwordx4 v25, s[12:15], s58 offen offset:3072 lds
    v_mfma_f32_16x16x32_bf16 a[124:127], a[200:203], v[124:127], a[124:127]
    v_exp_f32 v85, v85
    v_mfma_f32_16x16x32_bf16 a[124:127], a[204:207], v[140:143], a[124:127]
    s_add_u32 s58, s58, 16384
    ds_read_b128 a[172:175], v11 offset:4096
    v_cvt_pk_bf16_f32 v230, v84, v85
    v_mfma_f32_16x16x32_bf16 a[136:139], v[28:31], v[120:123], a[136:139]
    v_exp_f32 v86, v86
    v_mfma_f32_16x16x32_bf16 a[136:139], v[28:31], v[136:139], a[136:139]
    v_mfma_f32_16x16x32_bf16 a[140:143], v[28:31], v[124:127], a[140:143]
    v_exp_f32 v87, v87
    v_mfma_f32_16x16x32_bf16 a[140:143], v[28:31], v[140:143], a[140:143]
    v_cvt_pk_bf16_f32 v231, v86, v87
    s_waitcnt lgkmcnt(2)
    v_mfma_f32_16x16x32_bf16 v[32:35], a[144:147], v[160:163], v[96:99]
    v_exp_f32 v88, v88
    v_mfma_f32_16x16x32_bf16 v[32:35], a[148:151], v[164:167], v[32:35]
    ds_read_b64_tr_b16 a[176:177], v12 offset:49152
    v_mfma_f32_16x16x32_bf16 v[32:35], a[152:155], v[168:171], v[32:35]
    v_exp_f32 v89, v89
    v_mfma_f32_16x16x32_bf16 v[32:35], a[156:159], v[172:175], v[32:35]
    ds_read_b64_tr_b16 a[178:179], v12 offset:53248
    v_cvt_pk_bf16_f32 v234, v88, v89
    v_mfma_f32_16x16x32_bf16 v[36:39], a[144:147], v[176:179], v[100:103]
    v_exp_f32 v90, v90
    v_mfma_f32_16x16x32_bf16 v[36:39], a[148:151], v[180:183], v[36:39]
    ds_read_b64_tr_b16 a[180:181], v12 offset:57344
    v_mfma_f32_16x16x32_bf16 v[36:39], a[152:155], v[184:187], v[36:39]
    v_exp_f32 v91, v91
    v_mfma_f32_16x16x32_bf16 v[36:39], a[156:159], v[188:191], v[36:39]
    ds_read_b64_tr_b16 a[182:183], v12 offset:61440
    v_cvt_pk_bf16_f32 v235, v90, v91
    v_mfma_f32_16x16x32_bf16 v[40:43], a[144:147], v[192:195], v[104:107]
    v_exp_f32 v92, v92
    v_mfma_f32_16x16x32_bf16 v[40:43], a[148:151], v[196:199], v[40:43]
    ds_read_b64_tr_b16 a[184:185], v13 offset:49152
    v_mfma_f32_16x16x32_bf16 v[40:43], a[152:155], v[200:203], v[40:43]
    v_exp_f32 v93, v93
    v_mfma_f32_16x16x32_bf16 v[40:43], a[156:159], v[204:207], v[40:43]
    ds_read_b64_tr_b16 a[186:187], v13 offset:53248
    v_cvt_pk_bf16_f32 v238, v92, v93
    v_mfma_f32_16x16x32_bf16 v[44:47], a[144:147], v[208:211], v[108:111]
    v_exp_f32 v94, v94
    v_mfma_f32_16x16x32_bf16 v[44:47], a[148:151], v[212:215], v[44:47]
    ds_read_b64_tr_b16 a[188:189], v13 offset:57344
    v_mfma_f32_16x16x32_bf16 v[44:47], a[152:155], v[216:219], v[44:47]
    v_exp_f32 v95, v95
    v_mfma_f32_16x16x32_bf16 v[44:47], a[156:159], v[220:223], v[44:47]
    ds_read_b64_tr_b16 a[190:191], v13 offset:61440
    v_cvt_pk_bf16_f32 v239, v94, v95
    v_mfma_f32_16x16x32_bf16 v[48:51], a[160:163], v[160:163], v[96:99]
    s_add_u32 s46, s95, 0
    buffer_store_dwordx4 a[208:211], v240, s[40:43], s46 offen sc1
    v_mfma_f32_16x16x32_bf16 v[48:51], a[164:167], v[164:167], v[48:51]
    ds_read_b64_tr_b16 a[192:193], v14 offset:49152
    s_waitcnt lgkmcnt(4)
    v_mfma_f32_16x16x32_bf16 v[48:51], a[168:171], v[168:171], v[48:51]
    s_add_u32 s46, s95, 1024
    buffer_store_dwordx4 a[212:215], v240, s[40:43], s46 offen sc1
    v_mfma_f32_16x16x32_bf16 v[48:51], a[172:175], v[172:175], v[48:51]
    ds_read_b64_tr_b16 a[194:195], v14 offset:53248
    v_mfma_f32_16x16x32_bf16 v[52:55], a[160:163], v[176:179], v[100:103]
    v_exp_f32 v32, v32
    v_mfma_f32_16x16x32_bf16 v[52:55], a[164:167], v[180:183], v[52:55]
    ds_read_b64_tr_b16 a[196:197], v14 offset:57344
    v_mfma_f32_16x16x32_bf16 v[52:55], a[168:171], v[184:187], v[52:55]
    v_exp_f32 v33, v33
    v_mfma_f32_16x16x32_bf16 v[52:55], a[172:175], v[188:191], v[52:55]
    ds_read_b64_tr_b16 a[198:199], v14 offset:61440
    v_cvt_pk_bf16_f32 v112, v32, v33
    v_mfma_f32_16x16x32_bf16 v[56:59], a[160:163], v[192:195], v[104:107]
    v_exp_f32 v34, v34
    v_mfma_f32_16x16x32_bf16 v[56:59], a[164:167], v[196:199], v[56:59]
    ds_read_b64_tr_b16 a[200:201], v15 offset:49152
    v_mfma_f32_16x16x32_bf16 v[56:59], a[168:171], v[200:203], v[56:59]
    v_exp_f32 v35, v35
    v_mfma_f32_16x16x32_bf16 v[56:59], a[172:175], v[204:207], v[56:59]
    ds_read_b64_tr_b16 a[202:203], v15 offset:53248
    v_cvt_pk_bf16_f32 v113, v34, v35
    v_mfma_f32_16x16x32_bf16 v[60:63], a[160:163], v[208:211], v[108:111]
    v_exp_f32 v36, v36
    v_mfma_f32_16x16x32_bf16 v[60:63], a[164:167], v[212:215], v[60:63]
    ds_read_b64_tr_b16 a[204:205], v15 offset:57344
    v_mfma_f32_16x16x32_bf16 v[60:63], a[168:171], v[216:219], v[60:63]
    v_exp_f32 v37, v37
    v_mfma_f32_16x16x32_bf16 v[60:63], a[172:175], v[220:223], v[60:63]
    ds_read_b64_tr_b16 a[206:207], v15 offset:61440
    v_cvt_pk_bf16_f32 v116, v36, v37
    v_mfma_f32_16x16x32_bf16 a[0:3], a[176:179], v[144:147], a[0:3]
    v_exp_f32 v38, v38
    v_mfma_f32_16x16x32_bf16 a[0:3], a[180:183], v[224:227], a[0:3]
    s_add_u32 s46, s95, 2048
    buffer_store_dwordx4 a[216:219], v240, s[40:43], s46 offen sc1
    v_mfma_f32_16x16x32_bf16 a[4:7], a[176:179], v[148:151], a[4:7]
    v_exp_f32 v39, v39
    v_mfma_f32_16x16x32_bf16 a[4:7], a[180:183], v[228:231], a[4:7]
    ds_read_b128 a[144:147], v8 offset:8192
    v_cvt_pk_bf16_f32 v117, v38, v39
    v_mfma_f32_16x16x32_bf16 a[8:11], a[176:179], v[152:155], a[8:11]
    v_exp_f32 v40, v40
    v_mfma_f32_16x16x32_bf16 a[8:11], a[180:183], v[232:235], a[8:11]
    s_add_u32 m0, s53, 49152
    s_nop 0
    buffer_load_dwordx4 v20, s[8:11], s57 offen offset:0 lds
    v_mfma_f32_16x16x32_bf16 a[12:15], a[176:179], v[156:159], a[12:15]
    v_exp_f32 v41, v41
    v_mfma_f32_16x16x32_bf16 a[12:15], a[180:183], v[236:239], a[12:15]
    ds_read_b128 a[148:151], v9 offset:8192
    v_cvt_pk_bf16_f32 v120, v40, v41
    s_waitcnt lgkmcnt(2)
    v_mfma_f32_16x16x32_bf16 a[16:19], a[184:187], v[144:147], a[16:19]
    v_exp_f32 v42, v42
    v_mfma_f32_16x16x32_bf16 a[16:19], a[188:191], v[224:227], a[16:19]
    s_add_u32 s46, s95, 3072
    buffer_store_dwordx4 a[220:223], v240, s[40:43], s46 offen sc1
    v_mfma_f32_16x16x32_bf16 a[20:23], a[184:187], v[148:151], a[20:23]
    v_exp_f32 v43, v43
    v_mfma_f32_16x16x32_bf16 a[20:23], a[188:191], v[228:231], a[20:23]
    ds_read_b128 a[152:155], v10 offset:8192
    v_cvt_pk_bf16_f32 v121, v42, v43
    v_mfma_f32_16x16x32_bf16 a[24:27], a[184:187], v[152:155], a[24:27]
    v_exp_f32 v44, v44
    v_mfma_f32_16x16x32_bf16 a[24:27], a[188:191], v[232:235], a[24:27]
    buffer_load_dwordx4 v21, s[8:11], s57 offen offset:1024 lds
    v_mfma_f32_16x16x32_bf16 a[28:31], a[184:187], v[156:159], a[28:31]
    v_exp_f32 v45, v45
    v_mfma_f32_16x16x32_bf16 a[28:31], a[188:191], v[236:239], a[28:31]
    ds_read_b128 a[156:159], v11 offset:8192
    v_cvt_pk_bf16_f32 v124, v44, v45
    v_mfma_f32_16x16x32_bf16 a[32:35], a[192:195], v[144:147], a[32:35]
    v_exp_f32 v46, v46
    v_mfma_f32_16x16x32_bf16 a[32:35], a[196:199], v[224:227], a[32:35]
    s_add_u32 s46, s95, 4096
    buffer_store_dwordx4 a[224:227], v240, s[40:43], s46 offen sc1
    v_mfma_f32_16x16x32_bf16 a[36:39], a[192:195], v[148:151], a[36:39]
    v_exp_f32 v47, v47
    v_mfma_f32_16x16x32_bf16 a[36:39], a[196:199], v[228:231], a[36:39]
    ds_read_b128 a[160:163], v8 offset:12288
    v_cvt_pk_bf16_f32 v125, v46, v47
    v_mfma_f32_16x16x32_bf16 a[40:43], a[192:195], v[152:155], a[40:43]
    v_exp_f32 v48, v48
    v_mfma_f32_16x16x32_bf16 a[40:43], a[196:199], v[232:235], a[40:43]
    buffer_load_dwordx4 v22, s[8:11], s57 offen offset:2048 lds
    v_mfma_f32_16x16x32_bf16 a[44:47], a[192:195], v[156:159], a[44:47]
    v_exp_f32 v49, v49
    v_mfma_f32_16x16x32_bf16 a[44:47], a[196:199], v[236:239], a[44:47]
    ds_read_b128 a[164:167], v9 offset:12288
    v_cvt_pk_bf16_f32 v114, v48, v49
    v_mfma_f32_16x16x32_bf16 a[48:51], a[200:203], v[144:147], a[48:51]
    v_exp_f32 v50, v50
    v_mfma_f32_16x16x32_bf16 a[48:51], a[204:207], v[224:227], a[48:51]
    v_mfma_f32_16x16x32_bf16 a[52:55], a[200:203], v[148:151], a[52:55]
    v_exp_f32 v51, v51
    v_mfma_f32_16x16x32_bf16 a[52:55], a[204:207], v[228:231], a[52:55]
    ds_read_b128 a[168:171], v10 offset:12288
    v_cvt_pk_bf16_f32 v115, v50, v51
    v_mfma_f32_16x16x32_bf16 a[56:59], a[200:203], v[152:155], a[56:59]
    v_exp_f32 v52, v52
    v_mfma_f32_16x16x32_bf16 a[56:59], a[204:207], v[232:235], a[56:59]
    buffer_load_dwordx4 v23, s[8:11], s57 offen offset:3072 lds
    v_mfma_f32_16x16x32_bf16 a[60:63], a[200:203], v[156:159], a[60:63]
    v_exp_f32 v53, v53
    v_mfma_f32_16x16x32_bf16 a[60:63], a[204:207], v[236:239], a[60:63]
    s_add_u32 s57, s57, 16384
    ds_read_b128 a[172:175], v11 offset:12288
    v_cvt_pk_bf16_f32 v118, v52, v53
    v_mfma_f32_16x16x32_bf16 a[128:131], v[28:31], v[144:147], a[128:131]
    v_exp_f32 v54, v54
    v_mfma_f32_16x16x32_bf16 a[128:131], v[28:31], v[224:227], a[128:131]
    v_mfma_f32_16x16x32_bf16 a[132:135], v[28:31], v[148:151], a[132:135]
    v_exp_f32 v55, v55
    v_mfma_f32_16x16x32_bf16 a[132:135], v[28:31], v[228:231], a[132:135]
    v_cvt_pk_bf16_f32 v119, v54, v55
s_mov_b32 s59, 6
KA_LOOP:
    s_waitcnt vmcnt(12) lgkmcnt(2)
    s_barrier
    v_mfma_f32_16x16x32_bf16 v[64:67], a[144:147], v[160:163], v[96:99]
    v_exp_f32 v56, v56
    v_mfma_f32_16x16x32_bf16 v[64:67], a[148:151], v[164:167], v[64:67]
    ds_read_b64_tr_b16 a[176:177], v16 offset:49152
    v_mfma_f32_16x16x32_bf16 v[64:67], a[152:155], v[168:171], v[64:67]
    v_exp_f32 v57, v57
    v_mfma_f32_16x16x32_bf16 v[64:67], a[156:159], v[172:175], v[64:67]
    ds_read_b64_tr_b16 a[178:179], v16 offset:53248
    v_cvt_pk_bf16_f32 v122, v56, v57
    v_mfma_f32_16x16x32_bf16 v[68:71], a[144:147], v[176:179], v[100:103]
    v_exp_f32 v58, v58
    v_mfma_f32_16x16x32_bf16 v[68:71], a[148:151], v[180:183], v[68:71]
    ds_read_b64_tr_b16 a[180:181], v16 offset:57344
    v_mfma_f32_16x16x32_bf16 v[68:71], a[152:155], v[184:187], v[68:71]
    v_exp_f32 v59, v59
    v_mfma_f32_16x16x32_bf16 v[68:71], a[156:159], v[188:191], v[68:71]
    ds_read_b64_tr_b16 a[182:183], v16 offset:61440
    v_cvt_pk_bf16_f32 v123, v58, v59
    v_mfma_f32_16x16x32_bf16 v[72:75], a[144:147], v[192:195], v[104:107]
    v_exp_f32 v60, v60
    v_mfma_f32_16x16x32_bf16 v[72:75], a[148:151], v[196:199], v[72:75]
    ds_read_b64_tr_b16 a[184:185], v17 offset:49152
    v_mfma_f32_16x16x32_bf16 v[72:75], a[152:155], v[200:203], v[72:75]
    v_exp_f32 v61, v61
    v_mfma_f32_16x16x32_bf16 v[72:75], a[156:159], v[204:207], v[72:75]
    ds_read_b64_tr_b16 a[186:187], v17 offset:53248
    v_cvt_pk_bf16_f32 v126, v60, v61
    v_mfma_f32_16x16x32_bf16 v[76:79], a[144:147], v[208:211], v[108:111]
    v_exp_f32 v62, v62
    v_mfma_f32_16x16x32_bf16 v[76:79], a[148:151], v[212:215], v[76:79]
    ds_read_b64_tr_b16 a[188:189], v17 offset:57344
    v_mfma_f32_16x16x32_bf16 v[76:79], a[152:155], v[216:219], v[76:79]
    v_exp_f32 v63, v63
    v_mfma_f32_16x16x32_bf16 v[76:79], a[156:159], v[220:223], v[76:79]
    ds_read_b64_tr_b16 a[190:191], v17 offset:61440
    v_cvt_pk_bf16_f32 v127, v62, v63
    v_mfma_f32_16x16x32_bf16 v[80:83], a[160:163], v[160:163], v[96:99]
    v_mfma_f32_16x16x32_bf16 v[80:83], a[164:167], v[164:167], v[80:83]
    ds_read_b64_tr_b16 a[192:193], v18 offset:49152
    s_waitcnt lgkmcnt(5)
    v_mfma_f32_16x16x32_bf16 v[80:83], a[168:171], v[168:171], v[80:83]
    v_mfma_f32_16x16x32_bf16 v[80:83], a[172:175], v[172:175], v[80:83]
    ds_read_b64_tr_b16 a[194:195], v18 offset:53248
    v_mfma_f32_16x16x32_bf16 v[84:87], a[160:163], v[176:179], v[100:103]
    v_exp_f32 v64, v64
    v_mfma_f32_16x16x32_bf16 v[84:87], a[164:167], v[180:183], v[84:87]
    ds_read_b64_tr_b16 a[196:197], v18 offset:57344
    v_mfma_f32_16x16x32_bf16 v[84:87], a[168:171], v[184:187], v[84:87]
    v_exp_f32 v65, v65
    v_mfma_f32_16x16x32_bf16 v[84:87], a[172:175], v[188:191], v[84:87]
    ds_read_b64_tr_b16 a[198:199], v18 offset:61440
    v_cvt_pk_bf16_f32 v128, v64, v65
    v_mfma_f32_16x16x32_bf16 v[88:91], a[160:163], v[192:195], v[104:107]
    v_exp_f32 v66, v66
    v_mfma_f32_16x16x32_bf16 v[88:91], a[164:167], v[196:199], v[88:91]
    ds_read_b64_tr_b16 a[200:201], v19 offset:49152
    v_mfma_f32_16x16x32_bf16 v[88:91], a[168:171], v[200:203], v[88:91]
    v_exp_f32 v67, v67
    v_mfma_f32_16x16x32_bf16 v[88:91], a[172:175], v[204:207], v[88:91]
    ds_read_b64_tr_b16 a[202:203], v19 offset:53248
    v_cvt_pk_bf16_f32 v129, v66, v67
    v_mfma_f32_16x16x32_bf16 v[92:95], a[160:163], v[208:211], v[108:111]
    v_exp_f32 v68, v68
    v_mfma_f32_16x16x32_bf16 v[92:95], a[164:167], v[212:215], v[92:95]
    ds_read_b64_tr_b16 a[204:205], v19 offset:57344
    v_mfma_f32_16x16x32_bf16 v[92:95], a[168:171], v[216:219], v[92:95]
    v_exp_f32 v69, v69
    v_mfma_f32_16x16x32_bf16 v[92:95], a[172:175], v[220:223], v[92:95]
    ds_read_b64_tr_b16 a[206:207], v19 offset:61440
    v_cvt_pk_bf16_f32 v132, v68, v69
    v_mfma_f32_16x16x32_bf16 a[64:67], a[176:179], v[144:147], a[64:67]
    v_exp_f32 v70, v70
    v_mfma_f32_16x16x32_bf16 a[64:67], a[180:183], v[224:227], a[64:67]
    v_mfma_f32_16x16x32_bf16 a[68:71], a[176:179], v[148:151], a[68:71]
    v_exp_f32 v71, v71
    v_mfma_f32_16x16x32_bf16 a[68:71], a[180:183], v[228:231], a[68:71]
    ds_read_b128 a[144:147], v8 offset:16384
    v_cvt_pk_bf16_f32 v133, v70, v71
    v_mfma_f32_16x16x32_bf16 a[72:75], a[176:179], v[152:155], a[72:75]
    v_exp_f32 v72, v72
    v_mfma_f32_16x16x32_bf16 a[72:75], a[180:183], v[232:235], a[72:75]
    s_add_u32 m0, s53, 98304
    s_nop 0
    buffer_load_dwordx4 v24, s[12:15], s58 offen offset:0 lds
    v_mfma_f32_16x16x32_bf16 a[76:79], a[176:179], v[156:159], a[76:79]
    v_exp_f32 v73, v73
    v_mfma_f32_16x16x32_bf16 a[76:79], a[180:183], v[236:239], a[76:79]
    ds_read_b128 a[148:151], v9 offset:16384
    v_cvt_pk_bf16_f32 v136, v72, v73
    s_waitcnt lgkmcnt(2)
    v_mfma_f32_16x16x32_bf16 a[80:83], a[184:187], v[144:147], a[80:83]
    v_exp_f32 v74, v74
    v_mfma_f32_16x16x32_bf16 a[80:83], a[188:191], v[224:227], a[80:83]
    v_mfma_f32_16x16x32_bf16 a[84:87], a[184:187], v[148:151], a[84:87]
    v_exp_f32 v75, v75
    v_mfma_f32_16x16x32_bf16 a[84:87], a[188:191], v[228:231], a[84:87]
    ds_read_b128 a[152:155], v10 offset:16384
    v_cvt_pk_bf16_f32 v137, v74, v75
    v_mfma_f32_16x16x32_bf16 a[88:91], a[184:187], v[152:155], a[88:91]
    v_exp_f32 v76, v76
    v_mfma_f32_16x16x32_bf16 a[88:91], a[188:191], v[232:235], a[88:91]
    buffer_load_dwordx4 v25, s[12:15], s58 offen offset:1024 lds
    v_mfma_f32_16x16x32_bf16 a[92:95], a[184:187], v[156:159], a[92:95]
    v_exp_f32 v77, v77
    v_mfma_f32_16x16x32_bf16 a[92:95], a[188:191], v[236:239], a[92:95]
    ds_read_b128 a[156:159], v11 offset:16384
    v_cvt_pk_bf16_f32 v140, v76, v77
    v_mfma_f32_16x16x32_bf16 a[96:99], a[192:195], v[144:147], a[96:99]
    v_exp_f32 v78, v78
    v_mfma_f32_16x16x32_bf16 a[96:99], a[196:199], v[224:227], a[96:99]
    v_mfma_f32_16x16x32_bf16 a[100:103], a[192:195], v[148:151], a[100:103]
    v_exp_f32 v79, v79
    v_mfma_f32_16x16x32_bf16 a[100:103], a[196:199], v[228:231], a[100:103]
    ds_read_b128 a[160:163], v8 offset:20480
    v_cvt_pk_bf16_f32 v141, v78, v79
    v_mfma_f32_16x16x32_bf16 a[104:107], a[192:195], v[152:155], a[104:107]
    v_exp_f32 v80, v80
    v_mfma_f32_16x16x32_bf16 a[104:107], a[196:199], v[232:235], a[104:107]
    buffer_load_dwordx4 v24, s[12:15], s58 offen offset:2048 lds
    v_mfma_f32_16x16x32_bf16 a[108:111], a[192:195], v[156:159], a[108:111]
    v_exp_f32 v81, v81
    v_mfma_f32_16x16x32_bf16 a[108:111], a[196:199], v[236:239], a[108:111]
    ds_read_b128 a[164:167], v9 offset:20480
    v_cvt_pk_bf16_f32 v130, v80, v81
    v_mfma_f32_16x16x32_bf16 a[112:115], a[200:203], v[144:147], a[112:115]
    v_exp_f32 v82, v82
    v_mfma_f32_16x16x32_bf16 a[112:115], a[204:207], v[224:227], a[112:115]
    v_mfma_f32_16x16x32_bf16 a[116:119], a[200:203], v[148:151], a[116:119]
    v_exp_f32 v83, v83
    v_mfma_f32_16x16x32_bf16 a[116:119], a[204:207], v[228:231], a[116:119]
    ds_read_b128 a[168:171], v10 offset:20480
    v_cvt_pk_bf16_f32 v131, v82, v83
    v_mfma_f32_16x16x32_bf16 a[120:123], a[200:203], v[152:155], a[120:123]
    v_exp_f32 v84, v84
    v_mfma_f32_16x16x32_bf16 a[120:123], a[204:207], v[232:235], a[120:123]
    buffer_load_dwordx4 v25, s[12:15], s58 offen offset:3072 lds
    v_mfma_f32_16x16x32_bf16 a[124:127], a[200:203], v[156:159], a[124:127]
    v_exp_f32 v85, v85
    v_mfma_f32_16x16x32_bf16 a[124:127], a[204:207], v[236:239], a[124:127]
    s_add_u32 s58, s58, 16384
    ds_read_b128 a[172:175], v11 offset:20480
    v_cvt_pk_bf16_f32 v134, v84, v85
    v_mfma_f32_16x16x32_bf16 a[136:139], v[28:31], v[152:155], a[136:139]
    v_exp_f32 v86, v86
    v_mfma_f32_16x16x32_bf16 a[136:139], v[28:31], v[232:235], a[136:139]
    v_mfma_f32_16x16x32_bf16 a[140:143], v[28:31], v[156:159], a[140:143]
    v_exp_f32 v87, v87
    v_mfma_f32_16x16x32_bf16 a[140:143], v[28:31], v[236:239], a[140:143]
    v_cvt_pk_bf16_f32 v135, v86, v87
    s_waitcnt lgkmcnt(2)
    v_mfma_f32_16x16x32_bf16 v[32:35], a[144:147], v[160:163], v[96:99]
    v_exp_f32 v88, v88
    v_mfma_f32_16x16x32_bf16 v[32:35], a[148:151], v[164:167], v[32:35]
    ds_read_b64_tr_b16 a[176:177], v12 offset:0
    v_mfma_f32_16x16x32_bf16 v[32:35], a[152:155], v[168:171], v[32:35]
    v_exp_f32 v89, v89
    v_mfma_f32_16x16x32_bf16 v[32:35], a[156:159], v[172:175], v[32:35]
    ds_read_b64_tr_b16 a[178:179], v12 offset:4096
    v_cvt_pk_bf16_f32 v138, v88, v89
    v_mfma_f32_16x16x32_bf16 v[36:39], a[144:147], v[176:179], v[100:103]
    v_exp_f32 v90, v90
    v_mfma_f32_16x16x32_bf16 v[36:39], a[148:151], v[180:183], v[36:39]
    ds_read_b64_tr_b16 a[180:181], v12 offset:8192
    v_mfma_f32_16x16x32_bf16 v[36:39], a[152:155], v[184:187], v[36:39]
    v_exp_f32 v91, v91
    v_mfma_f32_16x16x32_bf16 v[36:39], a[156:159], v[188:191], v[36:39]
    ds_read_b64_tr_b16 a[182:183], v12 offset:12288
    v_cvt_pk_bf16_f32 v139, v90, v91
    v_mfma_f32_16x16x32_bf16 v[40:43], a[144:147], v[192:195], v[104:107]
    v_exp_f32 v92, v92
    v_mfma_f32_16x16x32_bf16 v[40:43], a[148:151], v[196:199], v[40:43]
    ds_read_b64_tr_b16 a[184:185], v13 offset:0
    v_mfma_f32_16x16x32_bf16 v[40:43], a[152:155], v[200:203], v[40:43]
    v_exp_f32 v93, v93
    v_mfma_f32_16x16x32_bf16 v[40:43], a[156:159], v[204:207], v[40:43]
    ds_read_b64_tr_b16 a[186:187], v13 offset:4096
    v_cvt_pk_bf16_f32 v142, v92, v93
    v_mfma_f32_16x16x32_bf16 v[44:47], a[144:147], v[208:211], v[108:111]
    v_exp_f32 v94, v94
    v_mfma_f32_16x16x32_bf16 v[44:47], a[148:151], v[212:215], v[44:47]
    ds_read_b64_tr_b16 a[188:189], v13 offset:8192
    v_mfma_f32_16x16x32_bf16 v[44:47], a[152:155], v[216:219], v[44:47]
    v_exp_f32 v95, v95
    v_mfma_f32_16x16x32_bf16 v[44:47], a[156:159], v[220:223], v[44:47]
    ds_read_b64_tr_b16 a[190:191], v13 offset:12288
    v_cvt_pk_bf16_f32 v143, v94, v95
    v_mfma_f32_16x16x32_bf16 v[48:51], a[160:163], v[160:163], v[96:99]
    v_mfma_f32_16x16x32_bf16 v[48:51], a[164:167], v[164:167], v[48:51]
    ds_read_b64_tr_b16 a[192:193], v14 offset:0
    s_waitcnt lgkmcnt(5)
    v_mfma_f32_16x16x32_bf16 v[48:51], a[168:171], v[168:171], v[48:51]
    v_mfma_f32_16x16x32_bf16 v[48:51], a[172:175], v[172:175], v[48:51]
    ds_read_b64_tr_b16 a[194:195], v14 offset:4096
    v_mfma_f32_16x16x32_bf16 v[52:55], a[160:163], v[176:179], v[100:103]
    v_exp_f32 v32, v32
    v_mfma_f32_16x16x32_bf16 v[52:55], a[164:167], v[180:183], v[52:55]
    ds_read_b64_tr_b16 a[196:197], v14 offset:8192
    v_mfma_f32_16x16x32_bf16 v[52:55], a[168:171], v[184:187], v[52:55]
    v_exp_f32 v33, v33
    v_mfma_f32_16x16x32_bf16 v[52:55], a[172:175], v[188:191], v[52:55]
    ds_read_b64_tr_b16 a[198:199], v14 offset:12288
    v_cvt_pk_bf16_f32 v144, v32, v33
    v_mfma_f32_16x16x32_bf16 v[56:59], a[160:163], v[192:195], v[104:107]
    v_exp_f32 v34, v34
    v_mfma_f32_16x16x32_bf16 v[56:59], a[164:167], v[196:199], v[56:59]
    ds_read_b64_tr_b16 a[200:201], v15 offset:0
    v_mfma_f32_16x16x32_bf16 v[56:59], a[168:171], v[200:203], v[56:59]
    v_exp_f32 v35, v35
    v_mfma_f32_16x16x32_bf16 v[56:59], a[172:175], v[204:207], v[56:59]
    ds_read_b64_tr_b16 a[202:203], v15 offset:4096
    v_cvt_pk_bf16_f32 v145, v34, v35
    v_mfma_f32_16x16x32_bf16 v[60:63], a[160:163], v[208:211], v[108:111]
    v_exp_f32 v36, v36
    v_mfma_f32_16x16x32_bf16 v[60:63], a[164:167], v[212:215], v[60:63]
    ds_read_b64_tr_b16 a[204:205], v15 offset:8192
    v_mfma_f32_16x16x32_bf16 v[60:63], a[168:171], v[216:219], v[60:63]
    v_exp_f32 v37, v37
    v_mfma_f32_16x16x32_bf16 v[60:63], a[172:175], v[220:223], v[60:63]
    ds_read_b64_tr_b16 a[206:207], v15 offset:12288
    v_cvt_pk_bf16_f32 v148, v36, v37
    v_mfma_f32_16x16x32_bf16 a[0:3], a[176:179], v[112:115], a[0:3]
    v_exp_f32 v38, v38
    v_mfma_f32_16x16x32_bf16 a[0:3], a[180:183], v[128:131], a[0:3]
    v_mfma_f32_16x16x32_bf16 a[4:7], a[176:179], v[116:119], a[4:7]
    v_exp_f32 v39, v39
    v_mfma_f32_16x16x32_bf16 a[4:7], a[180:183], v[132:135], a[4:7]
    ds_read_b128 a[144:147], v8 offset:24576
    v_cvt_pk_bf16_f32 v149, v38, v39
    v_mfma_f32_16x16x32_bf16 a[8:11], a[176:179], v[120:123], a[8:11]
    v_exp_f32 v40, v40
    v_mfma_f32_16x16x32_bf16 a[8:11], a[180:183], v[136:139], a[8:11]
    s_add_u32 m0, s53, 0
    s_nop 0
    buffer_load_dwordx4 v20, s[8:11], s57 offen offset:0 lds
    v_mfma_f32_16x16x32_bf16 a[12:15], a[176:179], v[124:127], a[12:15]
    v_exp_f32 v41, v41
    v_mfma_f32_16x16x32_bf16 a[12:15], a[180:183], v[140:143], a[12:15]
    ds_read_b128 a[148:151], v9 offset:24576
    v_cvt_pk_bf16_f32 v152, v40, v41
    s_waitcnt lgkmcnt(2)
    v_mfma_f32_16x16x32_bf16 a[16:19], a[184:187], v[112:115], a[16:19]
    v_exp_f32 v42, v42
    v_mfma_f32_16x16x32_bf16 a[16:19], a[188:191], v[128:131], a[16:19]
    v_mfma_f32_16x16x32_bf16 a[20:23], a[184:187], v[116:119], a[20:23]
    v_exp_f32 v43, v43
    v_mfma_f32_16x16x32_bf16 a[20:23], a[188:191], v[132:135], a[20:23]
    ds_read_b128 a[152:155], v10 offset:24576
    v_cvt_pk_bf16_f32 v153, v42, v43
    v_mfma_f32_16x16x32_bf16 a[24:27], a[184:187], v[120:123], a[24:27]
    v_exp_f32 v44, v44
    v_mfma_f32_16x16x32_bf16 a[24:27], a[188:191], v[136:139], a[24:27]
    buffer_load_dwordx4 v21, s[8:11], s57 offen offset:1024 lds
    v_mfma_f32_16x16x32_bf16 a[28:31], a[184:187], v[124:127], a[28:31]
    v_exp_f32 v45, v45
    v_mfma_f32_16x16x32_bf16 a[28:31], a[188:191], v[140:143], a[28:31]
    ds_read_b128 a[156:159], v11 offset:24576
    v_cvt_pk_bf16_f32 v156, v44, v45
    v_mfma_f32_16x16x32_bf16 a[32:35], a[192:195], v[112:115], a[32:35]
    v_exp_f32 v46, v46
    v_mfma_f32_16x16x32_bf16 a[32:35], a[196:199], v[128:131], a[32:35]
    v_mfma_f32_16x16x32_bf16 a[36:39], a[192:195], v[116:119], a[36:39]
    v_exp_f32 v47, v47
    v_mfma_f32_16x16x32_bf16 a[36:39], a[196:199], v[132:135], a[36:39]
    ds_read_b128 a[160:163], v8 offset:28672
    v_cvt_pk_bf16_f32 v157, v46, v47
    v_mfma_f32_16x16x32_bf16 a[40:43], a[192:195], v[120:123], a[40:43]
    v_exp_f32 v48, v48
    v_mfma_f32_16x16x32_bf16 a[40:43], a[196:199], v[136:139], a[40:43]
    buffer_load_dwordx4 v22, s[8:11], s57 offen offset:2048 lds
    v_mfma_f32_16x16x32_bf16 a[44:47], a[192:195], v[124:127], a[44:47]
    v_exp_f32 v49, v49
    v_mfma_f32_16x16x32_bf16 a[44:47], a[196:199], v[140:143], a[44:47]
    ds_read_b128 a[164:167], v9 offset:28672
    v_cvt_pk_bf16_f32 v146, v48, v49
    v_mfma_f32_16x16x32_bf16 a[48:51], a[200:203], v[112:115], a[48:51]
    v_exp_f32 v50, v50
    v_mfma_f32_16x16x32_bf16 a[48:51], a[204:207], v[128:131], a[48:51]
    v_mfma_f32_16x16x32_bf16 a[52:55], a[200:203], v[116:119], a[52:55]
    v_exp_f32 v51, v51
    v_mfma_f32_16x16x32_bf16 a[52:55], a[204:207], v[132:135], a[52:55]
    ds_read_b128 a[168:171], v10 offset:28672
    v_cvt_pk_bf16_f32 v147, v50, v51
    v_mfma_f32_16x16x32_bf16 a[56:59], a[200:203], v[120:123], a[56:59]
    v_exp_f32 v52, v52
    v_mfma_f32_16x16x32_bf16 a[56:59], a[204:207], v[136:139], a[56:59]
    buffer_load_dwordx4 v23, s[8:11], s57 offen offset:3072 lds
    v_mfma_f32_16x16x32_bf16 a[60:63], a[200:203], v[124:127], a[60:63]
    v_exp_f32 v53, v53
    v_mfma_f32_16x16x32_bf16 a[60:63], a[204:207], v[140:143], a[60:63]
    s_add_u32 s57, s57, 16384
    ds_read_b128 a[172:175], v11 offset:28672
    v_cvt_pk_bf16_f32 v150, v52, v53
    v_mfma_f32_16x16x32_bf16 a[128:131], v[28:31], v[112:115], a[128:131]
    v_exp_f32 v54, v54
    v_mfma_f32_16x16x32_bf16 a[128:131], v[28:31], v[128:131], a[128:131]
    v_mfma_f32_16x16x32_bf16 a[132:135], v[28:31], v[116:119], a[132:135]
    v_exp_f32 v55, v55
    v_mfma_f32_16x16x32_bf16 a[132:135], v[28:31], v[132:135], a[132:135]
    v_cvt_pk_bf16_f32 v151, v54, v55
    s_waitcnt vmcnt(12) lgkmcnt(2)
    s_barrier
    v_mfma_f32_16x16x32_bf16 v[64:67], a[144:147], v[160:163], v[96:99]
    v_exp_f32 v56, v56
    v_mfma_f32_16x16x32_bf16 v[64:67], a[148:151], v[164:167], v[64:67]
    ds_read_b64_tr_b16 a[176:177], v16 offset:0
    v_mfma_f32_16x16x32_bf16 v[64:67], a[152:155], v[168:171], v[64:67]
    v_exp_f32 v57, v57
    v_mfma_f32_16x16x32_bf16 v[64:67], a[156:159], v[172:175], v[64:67]
    ds_read_b64_tr_b16 a[178:179], v16 offset:4096
    v_cvt_pk_bf16_f32 v154, v56, v57
    v_mfma_f32_16x16x32_bf16 v[68:71], a[144:147], v[176:179], v[100:103]
    v_exp_f32 v58, v58
    v_mfma_f32_16x16x32_bf16 v[68:71], a[148:151], v[180:183], v[68:71]
    ds_read_b64_tr_b16 a[180:181], v16 offset:8192
    v_mfma_f32_16x16x32_bf16 v[68:71], a[152:155], v[184:187], v[68:71]
    v_exp_f32 v59, v59
    v_mfma_f32_16x16x32_bf16 v[68:71], a[156:159], v[188:191], v[68:71]
    ds_read_b64_tr_b16 a[182:183], v16 offset:12288
    v_cvt_pk_bf16_f32 v155, v58, v59
    v_mfma_f32_16x16x32_bf16 v[72:75], a[144:147], v[192:195], v[104:107]
    v_exp_f32 v60, v60
    v_mfma_f32_16x16x32_bf16 v[72:75], a[148:151], v[196:199], v[72:75]
    ds_read_b64_tr_b16 a[184:185], v17 offset:0
    v_mfma_f32_16x16x32_bf16 v[72:75], a[152:155], v[200:203], v[72:75]
    v_exp_f32 v61, v61
    v_mfma_f32_16x16x32_bf16 v[72:75], a[156:159], v[204:207], v[72:75]
    ds_read_b64_tr_b16 a[186:187], v17 offset:4096
    v_cvt_pk_bf16_f32 v158, v60, v61
    v_mfma_f32_16x16x32_bf16 v[76:79], a[144:147], v[208:211], v[108:111]
    v_exp_f32 v62, v62
    v_mfma_f32_16x16x32_bf16 v[76:79], a[148:151], v[212:215], v[76:79]
    ds_read_b64_tr_b16 a[188:189], v17 offset:8192
    v_mfma_f32_16x16x32_bf16 v[76:79], a[152:155], v[216:219], v[76:79]
    v_exp_f32 v63, v63
    v_mfma_f32_16x16x32_bf16 v[76:79], a[156:159], v[220:223], v[76:79]
    ds_read_b64_tr_b16 a[190:191], v17 offset:12288
    v_cvt_pk_bf16_f32 v159, v62, v63
    v_mfma_f32_16x16x32_bf16 v[80:83], a[160:163], v[160:163], v[96:99]
    v_mfma_f32_16x16x32_bf16 v[80:83], a[164:167], v[164:167], v[80:83]
    ds_read_b64_tr_b16 a[192:193], v18 offset:0
    s_waitcnt lgkmcnt(5)
    v_mfma_f32_16x16x32_bf16 v[80:83], a[168:171], v[168:171], v[80:83]
    v_mfma_f32_16x16x32_bf16 v[80:83], a[172:175], v[172:175], v[80:83]
    ds_read_b64_tr_b16 a[194:195], v18 offset:4096
    v_mfma_f32_16x16x32_bf16 v[84:87], a[160:163], v[176:179], v[100:103]
    v_exp_f32 v64, v64
    v_mfma_f32_16x16x32_bf16 v[84:87], a[164:167], v[180:183], v[84:87]
    ds_read_b64_tr_b16 a[196:197], v18 offset:8192
    v_mfma_f32_16x16x32_bf16 v[84:87], a[168:171], v[184:187], v[84:87]
    v_exp_f32 v65, v65
    v_mfma_f32_16x16x32_bf16 v[84:87], a[172:175], v[188:191], v[84:87]
    ds_read_b64_tr_b16 a[198:199], v18 offset:12288
    v_cvt_pk_bf16_f32 v224, v64, v65
    v_mfma_f32_16x16x32_bf16 v[88:91], a[160:163], v[192:195], v[104:107]
    v_exp_f32 v66, v66
    v_mfma_f32_16x16x32_bf16 v[88:91], a[164:167], v[196:199], v[88:91]
    ds_read_b64_tr_b16 a[200:201], v19 offset:0
    v_mfma_f32_16x16x32_bf16 v[88:91], a[168:171], v[200:203], v[88:91]
    v_exp_f32 v67, v67
    v_mfma_f32_16x16x32_bf16 v[88:91], a[172:175], v[204:207], v[88:91]
    ds_read_b64_tr_b16 a[202:203], v19 offset:4096
    v_cvt_pk_bf16_f32 v225, v66, v67
    v_mfma_f32_16x16x32_bf16 v[92:95], a[160:163], v[208:211], v[108:111]
    v_exp_f32 v68, v68
    v_mfma_f32_16x16x32_bf16 v[92:95], a[164:167], v[212:215], v[92:95]
    ds_read_b64_tr_b16 a[204:205], v19 offset:8192
    v_mfma_f32_16x16x32_bf16 v[92:95], a[168:171], v[216:219], v[92:95]
    v_exp_f32 v69, v69
    v_mfma_f32_16x16x32_bf16 v[92:95], a[172:175], v[220:223], v[92:95]
    ds_read_b64_tr_b16 a[206:207], v19 offset:12288
    v_cvt_pk_bf16_f32 v228, v68, v69
    v_mfma_f32_16x16x32_bf16 a[64:67], a[176:179], v[112:115], a[64:67]
    v_exp_f32 v70, v70
    v_mfma_f32_16x16x32_bf16 a[64:67], a[180:183], v[128:131], a[64:67]
    v_mfma_f32_16x16x32_bf16 a[68:71], a[176:179], v[116:119], a[68:71]
    v_exp_f32 v71, v71
    v_mfma_f32_16x16x32_bf16 a[68:71], a[180:183], v[132:135], a[68:71]
    ds_read_b128 a[144:147], v8 offset:32768
    v_cvt_pk_bf16_f32 v229, v70, v71
    v_mfma_f32_16x16x32_bf16 a[72:75], a[176:179], v[120:123], a[72:75]
    v_exp_f32 v72, v72
    v_mfma_f32_16x16x32_bf16 a[72:75], a[180:183], v[136:139], a[72:75]
    s_add_u32 m0, s53, 114688
    s_nop 0
    buffer_load_dwordx4 v24, s[12:15], s58 offen offset:0 lds
    v_mfma_f32_16x16x32_bf16 a[76:79], a[176:179], v[124:127], a[76:79]
    v_exp_f32 v73, v73
    v_mfma_f32_16x16x32_bf16 a[76:79], a[180:183], v[140:143], a[76:79]
    ds_read_b128 a[148:151], v9 offset:32768
    v_cvt_pk_bf16_f32 v232, v72, v73
    s_waitcnt lgkmcnt(2)
    v_mfma_f32_16x16x32_bf16 a[80:83], a[184:187], v[112:115], a[80:83]
    v_exp_f32 v74, v74
    v_mfma_f32_16x16x32_bf16 a[80:83], a[188:191], v[128:131], a[80:83]
    v_mfma_f32_16x16x32_bf16 a[84:87], a[184:187], v[116:119], a[84:87]
    v_exp_f32 v75, v75
    v_mfma_f32_16x16x32_bf16 a[84:87], a[188:191], v[132:135], a[84:87]
    ds_read_b128 a[152:155], v10 offset:32768
    v_cvt_pk_bf16_f32 v233, v74, v75
    v_mfma_f32_16x16x32_bf16 a[88:91], a[184:187], v[120:123], a[88:91]
    v_exp_f32 v76, v76
    v_mfma_f32_16x16x32_bf16 a[88:91], a[188:191], v[136:139], a[88:91]
    buffer_load_dwordx4 v25, s[12:15], s58 offen offset:1024 lds
    v_mfma_f32_16x16x32_bf16 a[92:95], a[184:187], v[124:127], a[92:95]
    v_exp_f32 v77, v77
    v_mfma_f32_16x16x32_bf16 a[92:95], a[188:191], v[140:143], a[92:95]
    ds_read_b128 a[156:159], v11 offset:32768
    v_cvt_pk_bf16_f32 v236, v76, v77
    v_mfma_f32_16x16x32_bf16 a[96:99], a[192:195], v[112:115], a[96:99]
    v_exp_f32 v78, v78
    v_mfma_f32_16x16x32_bf16 a[96:99], a[196:199], v[128:131], a[96:99]
    v_mfma_f32_16x16x32_bf16 a[100:103], a[192:195], v[116:119], a[100:103]
    v_exp_f32 v79, v79
    v_mfma_f32_16x16x32_bf16 a[100:103], a[196:199], v[132:135], a[100:103]
    ds_read_b128 a[160:163], v8 offset:36864
    v_cvt_pk_bf16_f32 v237, v78, v79
    v_mfma_f32_16x16x32_bf16 a[104:107], a[192:195], v[120:123], a[104:107]
    v_exp_f32 v80, v80
    v_mfma_f32_16x16x32_bf16 a[104:107], a[196:199], v[136:139], a[104:107]
    buffer_load_dwordx4 v24, s[12:15], s58 offen offset:2048 lds
    v_mfma_f32_16x16x32_bf16 a[108:111], a[192:195], v[124:127], a[108:111]
    v_exp_f32 v81, v81
    v_mfma_f32_16x16x32_bf16 a[108:111], a[196:199], v[140:143], a[108:111]
    ds_read_b128 a[164:167], v9 offset:36864
    v_cvt_pk_bf16_f32 v226, v80, v81
    v_mfma_f32_16x16x32_bf16 a[112:115], a[200:203], v[112:115], a[112:115]
    v_exp_f32 v82, v82
    v_mfma_f32_16x16x32_bf16 a[112:115], a[204:207], v[128:131], a[112:115]
    v_mfma_f32_16x16x32_bf16 a[116:119], a[200:203], v[116:119], a[116:119]
    v_exp_f32 v83, v83
    v_mfma_f32_16x16x32_bf16 a[116:119], a[204:207], v[132:135], a[116:119]
    ds_read_b128 a[168:171], v10 offset:36864
    v_cvt_pk_bf16_f32 v227, v82, v83
    v_mfma_f32_16x16x32_bf16 a[120:123], a[200:203], v[120:123], a[120:123]
    v_exp_f32 v84, v84
    v_mfma_f32_16x16x32_bf16 a[120:123], a[204:207], v[136:139], a[120:123]
    buffer_load_dwordx4 v25, s[12:15], s58 offen offset:3072 lds
    v_mfma_f32_16x16x32_bf16 a[124:127], a[200:203], v[124:127], a[124:127]
    v_exp_f32 v85, v85
    v_mfma_f32_16x16x32_bf16 a[124:127], a[204:207], v[140:143], a[124:127]
    s_add_u32 s58, s58, 16384
    ds_read_b128 a[172:175], v11 offset:36864
    v_cvt_pk_bf16_f32 v230, v84, v85
    v_mfma_f32_16x16x32_bf16 a[136:139], v[28:31], v[120:123], a[136:139]
    v_exp_f32 v86, v86
    v_mfma_f32_16x16x32_bf16 a[136:139], v[28:31], v[136:139], a[136:139]
    v_mfma_f32_16x16x32_bf16 a[140:143], v[28:31], v[124:127], a[140:143]
    v_exp_f32 v87, v87
    v_mfma_f32_16x16x32_bf16 a[140:143], v[28:31], v[140:143], a[140:143]
    v_cvt_pk_bf16_f32 v231, v86, v87
    s_waitcnt lgkmcnt(2)
    v_mfma_f32_16x16x32_bf16 v[32:35], a[144:147], v[160:163], v[96:99]
    v_exp_f32 v88, v88
    v_mfma_f32_16x16x32_bf16 v[32:35], a[148:151], v[164:167], v[32:35]
    ds_read_b64_tr_b16 a[176:177], v12 offset:16384
    v_mfma_f32_16x16x32_bf16 v[32:35], a[152:155], v[168:171], v[32:35]
    v_exp_f32 v89, v89
    v_mfma_f32_16x16x32_bf16 v[32:35], a[156:159], v[172:175], v[32:35]
    ds_read_b64_tr_b16 a[178:179], v12 offset:20480
    v_cvt_pk_bf16_f32 v234, v88, v89
    v_mfma_f32_16x16x32_bf16 v[36:39], a[144:147], v[176:179], v[100:103]
    v_exp_f32 v90, v90
    v_mfma_f32_16x16x32_bf16 v[36:39], a[148:151], v[180:183], v[36:39]
    ds_read_b64_tr_b16 a[180:181], v12 offset:24576
    v_mfma_f32_16x16x32_bf16 v[36:39], a[152:155], v[184:187], v[36:39]
    v_exp_f32 v91, v91
    v_mfma_f32_16x16x32_bf16 v[36:39], a[156:159], v[188:191], v[36:39]
    ds_read_b64_tr_b16 a[182:183], v12 offset:28672
    v_cvt_pk_bf16_f32 v235, v90, v91
    v_mfma_f32_16x16x32_bf16 v[40:43], a[144:147], v[192:195], v[104:107]
    v_exp_f32 v92, v92
    v_mfma_f32_16x16x32_bf16 v[40:43], a[148:151], v[196:199], v[40:43]
    ds_read_b64_tr_b16 a[184:185], v13 offset:16384
    v_mfma_f32_16x16x32_bf16 v[40:43], a[152:155], v[200:203], v[40:43]
    v_exp_f32 v93, v93
    v_mfma_f32_16x16x32_bf16 v[40:43], a[156:159], v[204:207], v[40:43]
    ds_read_b64_tr_b16 a[186:187], v13 offset:20480
    v_cvt_pk_bf16_f32 v238, v92, v93
    v_mfma_f32_16x16x32_bf16 v[44:47], a[144:147], v[208:211], v[108:111]
    v_exp_f32 v94, v94
    v_mfma_f32_16x16x32_bf16 v[44:47], a[148:151], v[212:215], v[44:47]
    ds_read_b64_tr_b16 a[188:189], v13 offset:24576
    v_mfma_f32_16x16x32_bf16 v[44:47], a[152:155], v[216:219], v[44:47]
    v_exp_f32 v95, v95
    v_mfma_f32_16x16x32_bf16 v[44:47], a[156:159], v[220:223], v[44:47]
    ds_read_b64_tr_b16 a[190:191], v13 offset:28672
    v_cvt_pk_bf16_f32 v239, v94, v95
    v_mfma_f32_16x16x32_bf16 v[48:51], a[160:163], v[160:163], v[96:99]
    v_mfma_f32_16x16x32_bf16 v[48:51], a[164:167], v[164:167], v[48:51]
    ds_read_b64_tr_b16 a[192:193], v14 offset:16384
    s_waitcnt lgkmcnt(5)
    v_mfma_f32_16x16x32_bf16 v[48:51], a[168:171], v[168:171], v[48:51]
    v_mfma_f32_16x16x32_bf16 v[48:51], a[172:175], v[172:175], v[48:51]
    ds_read_b64_tr_b16 a[194:195], v14 offset:20480
    v_mfma_f32_16x16x32_bf16 v[52:55], a[160:163], v[176:179], v[100:103]
    v_exp_f32 v32, v32
    v_mfma_f32_16x16x32_bf16 v[52:55], a[164:167], v[180:183], v[52:55]
    ds_read_b64_tr_b16 a[196:197], v14 offset:24576
    v_mfma_f32_16x16x32_bf16 v[52:55], a[168:171], v[184:187], v[52:55]
    v_exp_f32 v33, v33
    v_mfma_f32_16x16x32_bf16 v[52:55], a[172:175], v[188:191], v[52:55]
    ds_read_b64_tr_b16 a[198:199], v14 offset:28672
    v_cvt_pk_bf16_f32 v112, v32, v33
    v_mfma_f32_16x16x32_bf16 v[56:59], a[160:163], v[192:195], v[104:107]
    v_exp_f32 v34, v34
    v_mfma_f32_16x16x32_bf16 v[56:59], a[164:167], v[196:199], v[56:59]
    ds_read_b64_tr_b16 a[200:201], v15 offset:16384
    v_mfma_f32_16x16x32_bf16 v[56:59], a[168:171], v[200:203], v[56:59]
    v_exp_f32 v35, v35
    v_mfma_f32_16x16x32_bf16 v[56:59], a[172:175], v[204:207], v[56:59]
    ds_read_b64_tr_b16 a[202:203], v15 offset:20480
    v_cvt_pk_bf16_f32 v113, v34, v35
    v_mfma_f32_16x16x32_bf16 v[60:63], a[160:163], v[208:211], v[108:111]
    v_exp_f32 v36, v36
    v_mfma_f32_16x16x32_bf16 v[60:63], a[164:167], v[212:215], v[60:63]
    ds_read_b64_tr_b16 a[204:205], v15 offset:24576
    v_mfma_f32_16x16x32_bf16 v[60:63], a[168:171], v[216:219], v[60:63]
    v_exp_f32 v37, v37
    v_mfma_f32_16x16x32_bf16 v[60:63], a[172:175], v[220:223], v[60:63]
    ds_read_b64_tr_b16 a[206:207], v15 offset:28672
    v_cvt_pk_bf16_f32 v116, v36, v37
    v_mfma_f32_16x16x32_bf16 a[0:3], a[176:179], v[144:147], a[0:3]
    v_exp_f32 v38, v38
    v_mfma_f32_16x16x32_bf16 a[0:3], a[180:183], v[224:227], a[0:3]
    v_mfma_f32_16x16x32_bf16 a[4:7], a[176:179], v[148:151], a[4:7]
    v_exp_f32 v39, v39
    v_mfma_f32_16x16x32_bf16 a[4:7], a[180:183], v[228:231], a[4:7]
    ds_read_b128 a[144:147], v8 offset:40960
    v_cvt_pk_bf16_f32 v117, v38, v39
    v_mfma_f32_16x16x32_bf16 a[8:11], a[176:179], v[152:155], a[8:11]
    v_exp_f32 v40, v40
    v_mfma_f32_16x16x32_bf16 a[8:11], a[180:183], v[232:235], a[8:11]
    s_add_u32 m0, s53, 16384
    s_nop 0
    buffer_load_dwordx4 v20, s[8:11], s57 offen offset:0 lds
    v_mfma_f32_16x16x32_bf16 a[12:15], a[176:179], v[156:159], a[12:15]
    v_exp_f32 v41, v41
    v_mfma_f32_16x16x32_bf16 a[12:15], a[180:183], v[236:239], a[12:15]
    ds_read_b128 a[148:151], v9 offset:40960
    v_cvt_pk_bf16_f32 v120, v40, v41
    s_waitcnt lgkmcnt(2)
    v_mfma_f32_16x16x32_bf16 a[16:19], a[184:187], v[144:147], a[16:19]
    v_exp_f32 v42, v42
    v_mfma_f32_16x16x32_bf16 a[16:19], a[188:191], v[224:227], a[16:19]
    v_mfma_f32_16x16x32_bf16 a[20:23], a[184:187], v[148:151], a[20:23]
    v_exp_f32 v43, v43
    v_mfma_f32_16x16x32_bf16 a[20:23], a[188:191], v[228:231], a[20:23]
    ds_read_b128 a[152:155], v10 offset:40960
    v_cvt_pk_bf16_f32 v121, v42, v43
    v_mfma_f32_16x16x32_bf16 a[24:27], a[184:187], v[152:155], a[24:27]
    v_exp_f32 v44, v44
    v_mfma_f32_16x16x32_bf16 a[24:27], a[188:191], v[232:235], a[24:27]
    buffer_load_dwordx4 v21, s[8:11], s57 offen offset:1024 lds
    v_mfma_f32_16x16x32_bf16 a[28:31], a[184:187], v[156:159], a[28:31]
    v_exp_f32 v45, v45
    v_mfma_f32_16x16x32_bf16 a[28:31], a[188:191], v[236:239], a[28:31]
    ds_read_b128 a[156:159], v11 offset:40960
    v_cvt_pk_bf16_f32 v124, v44, v45
    v_mfma_f32_16x16x32_bf16 a[32:35], a[192:195], v[144:147], a[32:35]
    v_exp_f32 v46, v46
    v_mfma_f32_16x16x32_bf16 a[32:35], a[196:199], v[224:227], a[32:35]
    v_mfma_f32_16x16x32_bf16 a[36:39], a[192:195], v[148:151], a[36:39]
    v_exp_f32 v47, v47
    v_mfma_f32_16x16x32_bf16 a[36:39], a[196:199], v[228:231], a[36:39]
    ds_read_b128 a[160:163], v8 offset:45056
    v_cvt_pk_bf16_f32 v125, v46, v47
    v_mfma_f32_16x16x32_bf16 a[40:43], a[192:195], v[152:155], a[40:43]
    v_exp_f32 v48, v48
    v_mfma_f32_16x16x32_bf16 a[40:43], a[196:199], v[232:235], a[40:43]
    buffer_load_dwordx4 v22, s[8:11], s57 offen offset:2048 lds
    v_mfma_f32_16x16x32_bf16 a[44:47], a[192:195], v[156:159], a[44:47]
    v_exp_f32 v49, v49
    v_mfma_f32_16x16x32_bf16 a[44:47], a[196:199], v[236:239], a[44:47]
    ds_read_b128 a[164:167], v9 offset:45056
    v_cvt_pk_bf16_f32 v114, v48, v49
    v_mfma_f32_16x16x32_bf16 a[48:51], a[200:203], v[144:147], a[48:51]
    v_exp_f32 v50, v50
    v_mfma_f32_16x16x32_bf16 a[48:51], a[204:207], v[224:227], a[48:51]
    v_mfma_f32_16x16x32_bf16 a[52:55], a[200:203], v[148:151], a[52:55]
    v_exp_f32 v51, v51
    v_mfma_f32_16x16x32_bf16 a[52:55], a[204:207], v[228:231], a[52:55]
    ds_read_b128 a[168:171], v10 offset:45056
    v_cvt_pk_bf16_f32 v115, v50, v51
    v_mfma_f32_16x16x32_bf16 a[56:59], a[200:203], v[152:155], a[56:59]
    v_exp_f32 v52, v52
    v_mfma_f32_16x16x32_bf16 a[56:59], a[204:207], v[232:235], a[56:59]
    buffer_load_dwordx4 v23, s[8:11], s57 offen offset:3072 lds
    v_mfma_f32_16x16x32_bf16 a[60:63], a[200:203], v[156:159], a[60:63]
    v_exp_f32 v53, v53
    v_mfma_f32_16x16x32_bf16 a[60:63], a[204:207], v[236:239], a[60:63]
    s_add_u32 s57, s57, 16384
    ds_read_b128 a[172:175], v11 offset:45056
    v_cvt_pk_bf16_f32 v118, v52, v53
    v_mfma_f32_16x16x32_bf16 a[128:131], v[28:31], v[144:147], a[128:131]
    v_exp_f32 v54, v54
    v_mfma_f32_16x16x32_bf16 a[128:131], v[28:31], v[224:227], a[128:131]
    v_mfma_f32_16x16x32_bf16 a[132:135], v[28:31], v[148:151], a[132:135]
    v_exp_f32 v55, v55
    v_mfma_f32_16x16x32_bf16 a[132:135], v[28:31], v[228:231], a[132:135]
    v_cvt_pk_bf16_f32 v119, v54, v55
    s_waitcnt vmcnt(12) lgkmcnt(2)
    s_barrier
    v_mfma_f32_16x16x32_bf16 v[64:67], a[144:147], v[160:163], v[96:99]
    v_exp_f32 v56, v56
    v_mfma_f32_16x16x32_bf16 v[64:67], a[148:151], v[164:167], v[64:67]
    ds_read_b64_tr_b16 a[176:177], v16 offset:16384
    v_mfma_f32_16x16x32_bf16 v[64:67], a[152:155], v[168:171], v[64:67]
    v_exp_f32 v57, v57
    v_mfma_f32_16x16x32_bf16 v[64:67], a[156:159], v[172:175], v[64:67]
    ds_read_b64_tr_b16 a[178:179], v16 offset:20480
    v_cvt_pk_bf16_f32 v122, v56, v57
    v_mfma_f32_16x16x32_bf16 v[68:71], a[144:147], v[176:179], v[100:103]
    v_exp_f32 v58, v58
    v_mfma_f32_16x16x32_bf16 v[68:71], a[148:151], v[180:183], v[68:71]
    ds_read_b64_tr_b16 a[180:181], v16 offset:24576
    v_mfma_f32_16x16x32_bf16 v[68:71], a[152:155], v[184:187], v[68:71]
    v_exp_f32 v59, v59
    v_mfma_f32_16x16x32_bf16 v[68:71], a[156:159], v[188:191], v[68:71]
    ds_read_b64_tr_b16 a[182:183], v16 offset:28672
    v_cvt_pk_bf16_f32 v123, v58, v59
    v_mfma_f32_16x16x32_bf16 v[72:75], a[144:147], v[192:195], v[104:107]
    v_exp_f32 v60, v60
    v_mfma_f32_16x16x32_bf16 v[72:75], a[148:151], v[196:199], v[72:75]
    ds_read_b64_tr_b16 a[184:185], v17 offset:16384
    v_mfma_f32_16x16x32_bf16 v[72:75], a[152:155], v[200:203], v[72:75]
    v_exp_f32 v61, v61
    v_mfma_f32_16x16x32_bf16 v[72:75], a[156:159], v[204:207], v[72:75]
    ds_read_b64_tr_b16 a[186:187], v17 offset:20480
    v_cvt_pk_bf16_f32 v126, v60, v61
    v_mfma_f32_16x16x32_bf16 v[76:79], a[144:147], v[208:211], v[108:111]
    v_exp_f32 v62, v62
    v_mfma_f32_16x16x32_bf16 v[76:79], a[148:151], v[212:215], v[76:79]
    ds_read_b64_tr_b16 a[188:189], v17 offset:24576
    v_mfma_f32_16x16x32_bf16 v[76:79], a[152:155], v[216:219], v[76:79]
    v_exp_f32 v63, v63
    v_mfma_f32_16x16x32_bf16 v[76:79], a[156:159], v[220:223], v[76:79]
    ds_read_b64_tr_b16 a[190:191], v17 offset:28672
    v_cvt_pk_bf16_f32 v127, v62, v63
    v_mfma_f32_16x16x32_bf16 v[80:83], a[160:163], v[160:163], v[96:99]
    v_mfma_f32_16x16x32_bf16 v[80:83], a[164:167], v[164:167], v[80:83]
    ds_read_b64_tr_b16 a[192:193], v18 offset:16384
    s_waitcnt lgkmcnt(5)
    v_mfma_f32_16x16x32_bf16 v[80:83], a[168:171], v[168:171], v[80:83]
    v_mfma_f32_16x16x32_bf16 v[80:83], a[172:175], v[172:175], v[80:83]
    ds_read_b64_tr_b16 a[194:195], v18 offset:20480
    v_mfma_f32_16x16x32_bf16 v[84:87], a[160:163], v[176:179], v[100:103]
    v_exp_f32 v64, v64
    v_mfma_f32_16x16x32_bf16 v[84:87], a[164:167], v[180:183], v[84:87]
    ds_read_b64_tr_b16 a[196:197], v18 offset:24576
    v_mfma_f32_16x16x32_bf16 v[84:87], a[168:171], v[184:187], v[84:87]
    v_exp_f32 v65, v65
    v_mfma_f32_16x16x32_bf16 v[84:87], a[172:175], v[188:191], v[84:87]
    ds_read_b64_tr_b16 a[198:199], v18 offset:28672
    v_cvt_pk_bf16_f32 v128, v64, v65
    v_mfma_f32_16x16x32_bf16 v[88:91], a[160:163], v[192:195], v[104:107]
    v_exp_f32 v66, v66
    v_mfma_f32_16x16x32_bf16 v[88:91], a[164:167], v[196:199], v[88:91]
    ds_read_b64_tr_b16 a[200:201], v19 offset:16384
    v_mfma_f32_16x16x32_bf16 v[88:91], a[168:171], v[200:203], v[88:91]
    v_exp_f32 v67, v67
    v_mfma_f32_16x16x32_bf16 v[88:91], a[172:175], v[204:207], v[88:91]
    ds_read_b64_tr_b16 a[202:203], v19 offset:20480
    v_cvt_pk_bf16_f32 v129, v66, v67
    v_mfma_f32_16x16x32_bf16 v[92:95], a[160:163], v[208:211], v[108:111]
    v_exp_f32 v68, v68
    v_mfma_f32_16x16x32_bf16 v[92:95], a[164:167], v[212:215], v[92:95]
    ds_read_b64_tr_b16 a[204:205], v19 offset:24576
    v_mfma_f32_16x16x32_bf16 v[92:95], a[168:171], v[216:219], v[92:95]
    v_exp_f32 v69, v69
    v_mfma_f32_16x16x32_bf16 v[92:95], a[172:175], v[220:223], v[92:95]
    ds_read_b64_tr_b16 a[206:207], v19 offset:28672
    v_cvt_pk_bf16_f32 v132, v68, v69
    v_mfma_f32_16x16x32_bf16 a[64:67], a[176:179], v[144:147], a[64:67]
    v_exp_f32 v70, v70
    v_mfma_f32_16x16x32_bf16 a[64:67], a[180:183], v[224:227], a[64:67]
    v_mfma_f32_16x16x32_bf16 a[68:71], a[176:179], v[148:151], a[68:71]
    v_exp_f32 v71, v71
    v_mfma_f32_16x16x32_bf16 a[68:71], a[180:183], v[228:231], a[68:71]
    ds_read_b128 a[144:147], v8 offset:49152
    v_cvt_pk_bf16_f32 v133, v70, v71
    v_mfma_f32_16x16x32_bf16 a[72:75], a[176:179], v[152:155], a[72:75]
    v_exp_f32 v72, v72
    v_mfma_f32_16x16x32_bf16 a[72:75], a[180:183], v[232:235], a[72:75]
    s_add_u32 m0, s53, 65536
    s_nop 0
    buffer_load_dwordx4 v24, s[12:15], s58 offen offset:0 lds
    v_mfma_f32_16x16x32_bf16 a[76:79], a[176:179], v[156:159], a[76:79]
    v_exp_f32 v73, v73
    v_mfma_f32_16x16x32_bf16 a[76:79], a[180:183], v[236:239], a[76:79]
    ds_read_b128 a[148:151], v9 offset:49152
    v_cvt_pk_bf16_f32 v136, v72, v73
    s_waitcnt lgkmcnt(2)
    v_mfma_f32_16x16x32_bf16 a[80:83], a[184:187], v[144:147], a[80:83]
    v_exp_f32 v74, v74
    v_mfma_f32_16x16x32_bf16 a[80:83], a[188:191], v[224:227], a[80:83]
    v_mfma_f32_16x16x32_bf16 a[84:87], a[184:187], v[148:151], a[84:87]
    v_exp_f32 v75, v75
    v_mfma_f32_16x16x32_bf16 a[84:87], a[188:191], v[228:231], a[84:87]
    ds_read_b128 a[152:155], v10 offset:49152
    v_cvt_pk_bf16_f32 v137, v74, v75
    v_mfma_f32_16x16x32_bf16 a[88:91], a[184:187], v[152:155], a[88:91]
    v_exp_f32 v76, v76
    v_mfma_f32_16x16x32_bf16 a[88:91], a[188:191], v[232:235], a[88:91]
    buffer_load_dwordx4 v25, s[12:15], s58 offen offset:1024 lds
    v_mfma_f32_16x16x32_bf16 a[92:95], a[184:187], v[156:159], a[92:95]
    v_exp_f32 v77, v77
    v_mfma_f32_16x16x32_bf16 a[92:95], a[188:191], v[236:239], a[92:95]
    ds_read_b128 a[156:159], v11 offset:49152
    v_cvt_pk_bf16_f32 v140, v76, v77
    v_mfma_f32_16x16x32_bf16 a[96:99], a[192:195], v[144:147], a[96:99]
    v_exp_f32 v78, v78
    v_mfma_f32_16x16x32_bf16 a[96:99], a[196:199], v[224:227], a[96:99]
    v_mfma_f32_16x16x32_bf16 a[100:103], a[192:195], v[148:151], a[100:103]
    v_exp_f32 v79, v79
    v_mfma_f32_16x16x32_bf16 a[100:103], a[196:199], v[228:231], a[100:103]
    ds_read_b128 a[160:163], v8 offset:53248
    v_cvt_pk_bf16_f32 v141, v78, v79
    v_mfma_f32_16x16x32_bf16 a[104:107], a[192:195], v[152:155], a[104:107]
    v_exp_f32 v80, v80
    v_mfma_f32_16x16x32_bf16 a[104:107], a[196:199], v[232:235], a[104:107]
    buffer_load_dwordx4 v24, s[12:15], s58 offen offset:2048 lds
    v_mfma_f32_16x16x32_bf16 a[108:111], a[192:195], v[156:159], a[108:111]
    v_exp_f32 v81, v81
    v_mfma_f32_16x16x32_bf16 a[108:111], a[196:199], v[236:239], a[108:111]
    ds_read_b128 a[164:167], v9 offset:53248
    v_cvt_pk_bf16_f32 v130, v80, v81
    v_mfma_f32_16x16x32_bf16 a[112:115], a[200:203], v[144:147], a[112:115]
    v_exp_f32 v82, v82
    v_mfma_f32_16x16x32_bf16 a[112:115], a[204:207], v[224:227], a[112:115]
    v_mfma_f32_16x16x32_bf16 a[116:119], a[200:203], v[148:151], a[116:119]
    v_exp_f32 v83, v83
    v_mfma_f32_16x16x32_bf16 a[116:119], a[204:207], v[228:231], a[116:119]
    ds_read_b128 a[168:171], v10 offset:53248
    v_cvt_pk_bf16_f32 v131, v82, v83
    v_mfma_f32_16x16x32_bf16 a[120:123], a[200:203], v[152:155], a[120:123]
    v_exp_f32 v84, v84
    v_mfma_f32_16x16x32_bf16 a[120:123], a[204:207], v[232:235], a[120:123]
    buffer_load_dwordx4 v25, s[12:15], s58 offen offset:3072 lds
    v_mfma_f32_16x16x32_bf16 a[124:127], a[200:203], v[156:159], a[124:127]
    v_exp_f32 v85, v85
    v_mfma_f32_16x16x32_bf16 a[124:127], a[204:207], v[236:239], a[124:127]
    s_add_u32 s58, s58, 16384
    ds_read_b128 a[172:175], v11 offset:53248
    v_cvt_pk_bf16_f32 v134, v84, v85
    v_mfma_f32_16x16x32_bf16 a[136:139], v[28:31], v[152:155], a[136:139]
    v_exp_f32 v86, v86
    v_mfma_f32_16x16x32_bf16 a[136:139], v[28:31], v[232:235], a[136:139]
    v_mfma_f32_16x16x32_bf16 a[140:143], v[28:31], v[156:159], a[140:143]
    v_exp_f32 v87, v87
    v_mfma_f32_16x16x32_bf16 a[140:143], v[28:31], v[236:239], a[140:143]
    v_cvt_pk_bf16_f32 v135, v86, v87
    s_waitcnt lgkmcnt(2)
    v_mfma_f32_16x16x32_bf16 v[32:35], a[144:147], v[160:163], v[96:99]
    v_exp_f32 v88, v88
    v_mfma_f32_16x16x32_bf16 v[32:35], a[148:151], v[164:167], v[32:35]
    ds_read_b64_tr_b16 a[176:177], v12 offset:32768
    v_mfma_f32_16x16x32_bf16 v[32:35], a[152:155], v[168:171], v[32:35]
    v_exp_f32 v89, v89
    v_mfma_f32_16x16x32_bf16 v[32:35], a[156:159], v[172:175], v[32:35]
    ds_read_b64_tr_b16 a[178:179], v12 offset:36864
    v_cvt_pk_bf16_f32 v138, v88, v89
    v_mfma_f32_16x16x32_bf16 v[36:39], a[144:147], v[176:179], v[100:103]
    v_exp_f32 v90, v90
    v_mfma_f32_16x16x32_bf16 v[36:39], a[148:151], v[180:183], v[36:39]
    ds_read_b64_tr_b16 a[180:181], v12 offset:40960
    v_mfma_f32_16x16x32_bf16 v[36:39], a[152:155], v[184:187], v[36:39]
    v_exp_f32 v91, v91
    v_mfma_f32_16x16x32_bf16 v[36:39], a[156:159], v[188:191], v[36:39]
    ds_read_b64_tr_b16 a[182:183], v12 offset:45056
    v_cvt_pk_bf16_f32 v139, v90, v91
    v_mfma_f32_16x16x32_bf16 v[40:43], a[144:147], v[192:195], v[104:107]
    v_exp_f32 v92, v92
    v_mfma_f32_16x16x32_bf16 v[40:43], a[148:151], v[196:199], v[40:43]
    ds_read_b64_tr_b16 a[184:185], v13 offset:32768
    v_mfma_f32_16x16x32_bf16 v[40:43], a[152:155], v[200:203], v[40:43]
    v_exp_f32 v93, v93
    v_mfma_f32_16x16x32_bf16 v[40:43], a[156:159], v[204:207], v[40:43]
    ds_read_b64_tr_b16 a[186:187], v13 offset:36864
    v_cvt_pk_bf16_f32 v142, v92, v93
    v_mfma_f32_16x16x32_bf16 v[44:47], a[144:147], v[208:211], v[108:111]
    v_exp_f32 v94, v94
    v_mfma_f32_16x16x32_bf16 v[44:47], a[148:151], v[212:215], v[44:47]
    ds_read_b64_tr_b16 a[188:189], v13 offset:40960
    v_mfma_f32_16x16x32_bf16 v[44:47], a[152:155], v[216:219], v[44:47]
    v_exp_f32 v95, v95
    v_mfma_f32_16x16x32_bf16 v[44:47], a[156:159], v[220:223], v[44:47]
    ds_read_b64_tr_b16 a[190:191], v13 offset:45056
    v_cvt_pk_bf16_f32 v143, v94, v95
    v_mfma_f32_16x16x32_bf16 v[48:51], a[160:163], v[160:163], v[96:99]
    v_mfma_f32_16x16x32_bf16 v[48:51], a[164:167], v[164:167], v[48:51]
    ds_read_b64_tr_b16 a[192:193], v14 offset:32768
    s_waitcnt lgkmcnt(5)
    v_mfma_f32_16x16x32_bf16 v[48:51], a[168:171], v[168:171], v[48:51]
    v_mfma_f32_16x16x32_bf16 v[48:51], a[172:175], v[172:175], v[48:51]
    ds_read_b64_tr_b16 a[194:195], v14 offset:36864
    v_mfma_f32_16x16x32_bf16 v[52:55], a[160:163], v[176:179], v[100:103]
    v_exp_f32 v32, v32
    v_mfma_f32_16x16x32_bf16 v[52:55], a[164:167], v[180:183], v[52:55]
    ds_read_b64_tr_b16 a[196:197], v14 offset:40960
    v_mfma_f32_16x16x32_bf16 v[52:55], a[168:171], v[184:187], v[52:55]
    v_exp_f32 v33, v33
    v_mfma_f32_16x16x32_bf16 v[52:55], a[172:175], v[188:191], v[52:55]
    ds_read_b64_tr_b16 a[198:199], v14 offset:45056
    v_cvt_pk_bf16_f32 v144, v32, v33
    v_mfma_f32_16x16x32_bf16 v[56:59], a[160:163], v[192:195], v[104:107]
    v_exp_f32 v34, v34
    v_mfma_f32_16x16x32_bf16 v[56:59], a[164:167], v[196:199], v[56:59]
    ds_read_b64_tr_b16 a[200:201], v15 offset:32768
    v_mfma_f32_16x16x32_bf16 v[56:59], a[168:171], v[200:203], v[56:59]
    v_exp_f32 v35, v35
    v_mfma_f32_16x16x32_bf16 v[56:59], a[172:175], v[204:207], v[56:59]
    ds_read_b64_tr_b16 a[202:203], v15 offset:36864
    v_cvt_pk_bf16_f32 v145, v34, v35
    v_mfma_f32_16x16x32_bf16 v[60:63], a[160:163], v[208:211], v[108:111]
    v_exp_f32 v36, v36
    v_mfma_f32_16x16x32_bf16 v[60:63], a[164:167], v[212:215], v[60:63]
    ds_read_b64_tr_b16 a[204:205], v15 offset:40960
    v_mfma_f32_16x16x32_bf16 v[60:63], a[168:171], v[216:219], v[60:63]
    v_exp_f32 v37, v37
    v_mfma_f32_16x16x32_bf16 v[60:63], a[172:175], v[220:223], v[60:63]
    ds_read_b64_tr_b16 a[206:207], v15 offset:45056
    v_cvt_pk_bf16_f32 v148, v36, v37
    v_mfma_f32_16x16x32_bf16 a[0:3], a[176:179], v[112:115], a[0:3]
    v_exp_f32 v38, v38
    v_mfma_f32_16x16x32_bf16 a[0:3], a[180:183], v[128:131], a[0:3]
    v_mfma_f32_16x16x32_bf16 a[4:7], a[176:179], v[116:119], a[4:7]
    v_exp_f32 v39, v39
    v_mfma_f32_16x16x32_bf16 a[4:7], a[180:183], v[132:135], a[4:7]
    ds_read_b128 a[144:147], v8 offset:57344
    v_cvt_pk_bf16_f32 v149, v38, v39
    v_mfma_f32_16x16x32_bf16 a[8:11], a[176:179], v[120:123], a[8:11]
    v_exp_f32 v40, v40
    v_mfma_f32_16x16x32_bf16 a[8:11], a[180:183], v[136:139], a[8:11]
    s_add_u32 m0, s53, 32768
    s_nop 0
    buffer_load_dwordx4 v20, s[8:11], s57 offen offset:0 lds
    v_mfma_f32_16x16x32_bf16 a[12:15], a[176:179], v[124:127], a[12:15]
    v_exp_f32 v41, v41
    v_mfma_f32_16x16x32_bf16 a[12:15], a[180:183], v[140:143], a[12:15]
    ds_read_b128 a[148:151], v9 offset:57344
    v_cvt_pk_bf16_f32 v152, v40, v41
    s_waitcnt lgkmcnt(2)
    v_mfma_f32_16x16x32_bf16 a[16:19], a[184:187], v[112:115], a[16:19]
    v_exp_f32 v42, v42
    v_mfma_f32_16x16x32_bf16 a[16:19], a[188:191], v[128:131], a[16:19]
    v_mfma_f32_16x16x32_bf16 a[20:23], a[184:187], v[116:119], a[20:23]
    v_exp_f32 v43, v43
    v_mfma_f32_16x16x32_bf16 a[20:23], a[188:191], v[132:135], a[20:23]
    ds_read_b128 a[152:155], v10 offset:57344
    v_cvt_pk_bf16_f32 v153, v42, v43
    v_mfma_f32_16x16x32_bf16 a[24:27], a[184:187], v[120:123], a[24:27]
    v_exp_f32 v44, v44
    v_mfma_f32_16x16x32_bf16 a[24:27], a[188:191], v[136:139], a[24:27]
    buffer_load_dwordx4 v21, s[8:11], s57 offen offset:1024 lds
    v_mfma_f32_16x16x32_bf16 a[28:31], a[184:187], v[124:127], a[28:31]
    v_exp_f32 v45, v45
    v_mfma_f32_16x16x32_bf16 a[28:31], a[188:191], v[140:143], a[28:31]
    ds_read_b128 a[156:159], v11 offset:57344
    v_cvt_pk_bf16_f32 v156, v44, v45
    v_mfma_f32_16x16x32_bf16 a[32:35], a[192:195], v[112:115], a[32:35]
    v_exp_f32 v46, v46
    v_mfma_f32_16x16x32_bf16 a[32:35], a[196:199], v[128:131], a[32:35]
    v_mfma_f32_16x16x32_bf16 a[36:39], a[192:195], v[116:119], a[36:39]
    v_exp_f32 v47, v47
    v_mfma_f32_16x16x32_bf16 a[36:39], a[196:199], v[132:135], a[36:39]
    ds_read_b128 a[160:163], v8 offset:61440
    v_cvt_pk_bf16_f32 v157, v46, v47
    v_mfma_f32_16x16x32_bf16 a[40:43], a[192:195], v[120:123], a[40:43]
    v_exp_f32 v48, v48
    v_mfma_f32_16x16x32_bf16 a[40:43], a[196:199], v[136:139], a[40:43]
    buffer_load_dwordx4 v22, s[8:11], s57 offen offset:2048 lds
    v_mfma_f32_16x16x32_bf16 a[44:47], a[192:195], v[124:127], a[44:47]
    v_exp_f32 v49, v49
    v_mfma_f32_16x16x32_bf16 a[44:47], a[196:199], v[140:143], a[44:47]
    ds_read_b128 a[164:167], v9 offset:61440
    v_cvt_pk_bf16_f32 v146, v48, v49
    v_mfma_f32_16x16x32_bf16 a[48:51], a[200:203], v[112:115], a[48:51]
    v_exp_f32 v50, v50
    v_mfma_f32_16x16x32_bf16 a[48:51], a[204:207], v[128:131], a[48:51]
    v_mfma_f32_16x16x32_bf16 a[52:55], a[200:203], v[116:119], a[52:55]
    v_exp_f32 v51, v51
    v_mfma_f32_16x16x32_bf16 a[52:55], a[204:207], v[132:135], a[52:55]
    ds_read_b128 a[168:171], v10 offset:61440
    v_cvt_pk_bf16_f32 v147, v50, v51
    v_mfma_f32_16x16x32_bf16 a[56:59], a[200:203], v[120:123], a[56:59]
    v_exp_f32 v52, v52
    v_mfma_f32_16x16x32_bf16 a[56:59], a[204:207], v[136:139], a[56:59]
    buffer_load_dwordx4 v23, s[8:11], s57 offen offset:3072 lds
    v_mfma_f32_16x16x32_bf16 a[60:63], a[200:203], v[124:127], a[60:63]
    v_exp_f32 v53, v53
    v_mfma_f32_16x16x32_bf16 a[60:63], a[204:207], v[140:143], a[60:63]
    s_add_u32 s57, s57, 16384
    ds_read_b128 a[172:175], v11 offset:61440
    v_cvt_pk_bf16_f32 v150, v52, v53
    v_mfma_f32_16x16x32_bf16 a[128:131], v[28:31], v[112:115], a[128:131]
    v_exp_f32 v54, v54
    v_mfma_f32_16x16x32_bf16 a[128:131], v[28:31], v[128:131], a[128:131]
    v_mfma_f32_16x16x32_bf16 a[132:135], v[28:31], v[116:119], a[132:135]
    v_exp_f32 v55, v55
    v_mfma_f32_16x16x32_bf16 a[132:135], v[28:31], v[132:135], a[132:135]
    v_cvt_pk_bf16_f32 v151, v54, v55
    s_waitcnt vmcnt(12) lgkmcnt(2)
    s_barrier
    v_mfma_f32_16x16x32_bf16 v[64:67], a[144:147], v[160:163], v[96:99]
    v_exp_f32 v56, v56
    v_mfma_f32_16x16x32_bf16 v[64:67], a[148:151], v[164:167], v[64:67]
    ds_read_b64_tr_b16 a[176:177], v16 offset:32768
    v_mfma_f32_16x16x32_bf16 v[64:67], a[152:155], v[168:171], v[64:67]
    v_exp_f32 v57, v57
    v_mfma_f32_16x16x32_bf16 v[64:67], a[156:159], v[172:175], v[64:67]
    ds_read_b64_tr_b16 a[178:179], v16 offset:36864
    v_cvt_pk_bf16_f32 v154, v56, v57
    v_mfma_f32_16x16x32_bf16 v[68:71], a[144:147], v[176:179], v[100:103]
    v_exp_f32 v58, v58
    v_mfma_f32_16x16x32_bf16 v[68:71], a[148:151], v[180:183], v[68:71]
    ds_read_b64_tr_b16 a[180:181], v16 offset:40960
    v_mfma_f32_16x16x32_bf16 v[68:71], a[152:155], v[184:187], v[68:71]
    v_exp_f32 v59, v59
    v_mfma_f32_16x16x32_bf16 v[68:71], a[156:159], v[188:191], v[68:71]
    ds_read_b64_tr_b16 a[182:183], v16 offset:45056
    v_cvt_pk_bf16_f32 v155, v58, v59
    v_mfma_f32_16x16x32_bf16 v[72:75], a[144:147], v[192:195], v[104:107]
    v_exp_f32 v60, v60
    v_mfma_f32_16x16x32_bf16 v[72:75], a[148:151], v[196:199], v[72:75]
    ds_read_b64_tr_b16 a[184:185], v17 offset:32768
    v_mfma_f32_16x16x32_bf16 v[72:75], a[152:155], v[200:203], v[72:75]
    v_exp_f32 v61, v61
    v_mfma_f32_16x16x32_bf16 v[72:75], a[156:159], v[204:207], v[72:75]
    ds_read_b64_tr_b16 a[186:187], v17 offset:36864
    v_cvt_pk_bf16_f32 v158, v60, v61
    v_mfma_f32_16x16x32_bf16 v[76:79], a[144:147], v[208:211], v[108:111]
    v_exp_f32 v62, v62
    v_mfma_f32_16x16x32_bf16 v[76:79], a[148:151], v[212:215], v[76:79]
    ds_read_b64_tr_b16 a[188:189], v17 offset:40960
    v_mfma_f32_16x16x32_bf16 v[76:79], a[152:155], v[216:219], v[76:79]
    v_exp_f32 v63, v63
    v_mfma_f32_16x16x32_bf16 v[76:79], a[156:159], v[220:223], v[76:79]
    ds_read_b64_tr_b16 a[190:191], v17 offset:45056
    v_cvt_pk_bf16_f32 v159, v62, v63
    v_mfma_f32_16x16x32_bf16 v[80:83], a[160:163], v[160:163], v[96:99]
    v_mfma_f32_16x16x32_bf16 v[80:83], a[164:167], v[164:167], v[80:83]
    ds_read_b64_tr_b16 a[192:193], v18 offset:32768
    s_waitcnt lgkmcnt(5)
    v_mfma_f32_16x16x32_bf16 v[80:83], a[168:171], v[168:171], v[80:83]
    v_mfma_f32_16x16x32_bf16 v[80:83], a[172:175], v[172:175], v[80:83]
    ds_read_b64_tr_b16 a[194:195], v18 offset:36864
    v_mfma_f32_16x16x32_bf16 v[84:87], a[160:163], v[176:179], v[100:103]
    v_exp_f32 v64, v64
    v_mfma_f32_16x16x32_bf16 v[84:87], a[164:167], v[180:183], v[84:87]
    ds_read_b64_tr_b16 a[196:197], v18 offset:40960
    v_mfma_f32_16x16x32_bf16 v[84:87], a[168:171], v[184:187], v[84:87]
    v_exp_f32 v65, v65
    v_mfma_f32_16x16x32_bf16 v[84:87], a[172:175], v[188:191], v[84:87]
    ds_read_b64_tr_b16 a[198:199], v18 offset:45056
    v_cvt_pk_bf16_f32 v224, v64, v65
    v_mfma_f32_16x16x32_bf16 v[88:91], a[160:163], v[192:195], v[104:107]
    v_exp_f32 v66, v66
    v_mfma_f32_16x16x32_bf16 v[88:91], a[164:167], v[196:199], v[88:91]
    ds_read_b64_tr_b16 a[200:201], v19 offset:32768
    v_mfma_f32_16x16x32_bf16 v[88:91], a[168:171], v[200:203], v[88:91]
    v_exp_f32 v67, v67
    v_mfma_f32_16x16x32_bf16 v[88:91], a[172:175], v[204:207], v[88:91]
    ds_read_b64_tr_b16 a[202:203], v19 offset:36864
    v_cvt_pk_bf16_f32 v225, v66, v67
    v_mfma_f32_16x16x32_bf16 v[92:95], a[160:163], v[208:211], v[108:111]
    v_exp_f32 v68, v68
    v_mfma_f32_16x16x32_bf16 v[92:95], a[164:167], v[212:215], v[92:95]
    ds_read_b64_tr_b16 a[204:205], v19 offset:40960
    v_mfma_f32_16x16x32_bf16 v[92:95], a[168:171], v[216:219], v[92:95]
    v_exp_f32 v69, v69
    v_mfma_f32_16x16x32_bf16 v[92:95], a[172:175], v[220:223], v[92:95]
    ds_read_b64_tr_b16 a[206:207], v19 offset:45056
    v_cvt_pk_bf16_f32 v228, v68, v69
    v_mfma_f32_16x16x32_bf16 a[64:67], a[176:179], v[112:115], a[64:67]
    v_exp_f32 v70, v70
    v_mfma_f32_16x16x32_bf16 a[64:67], a[180:183], v[128:131], a[64:67]
    v_mfma_f32_16x16x32_bf16 a[68:71], a[176:179], v[116:119], a[68:71]
    v_exp_f32 v71, v71
    v_mfma_f32_16x16x32_bf16 a[68:71], a[180:183], v[132:135], a[68:71]
    ds_read_b128 a[144:147], v8 offset:0
    v_cvt_pk_bf16_f32 v229, v70, v71
    v_mfma_f32_16x16x32_bf16 a[72:75], a[176:179], v[120:123], a[72:75]
    v_exp_f32 v72, v72
    v_mfma_f32_16x16x32_bf16 a[72:75], a[180:183], v[136:139], a[72:75]
    s_add_u32 m0, s53, 81920
    s_nop 0
    buffer_load_dwordx4 v24, s[12:15], s58 offen offset:0 lds
    v_mfma_f32_16x16x32_bf16 a[76:79], a[176:179], v[124:127], a[76:79]
    v_exp_f32 v73, v73
    v_mfma_f32_16x16x32_bf16 a[76:79], a[180:183], v[140:143], a[76:79]
    ds_read_b128 a[148:151], v9 offset:0
    v_cvt_pk_bf16_f32 v232, v72, v73
    s_waitcnt lgkmcnt(2)
    v_mfma_f32_16x16x32_bf16 a[80:83], a[184:187], v[112:115], a[80:83]
    v_exp_f32 v74, v74
    v_mfma_f32_16x16x32_bf16 a[80:83], a[188:191], v[128:131], a[80:83]
    v_mfma_f32_16x16x32_bf16 a[84:87], a[184:187], v[116:119], a[84:87]
    v_exp_f32 v75, v75
    v_mfma_f32_16x16x32_bf16 a[84:87], a[188:191], v[132:135], a[84:87]
    ds_read_b128 a[152:155], v10 offset:0
    v_cvt_pk_bf16_f32 v233, v74, v75
    v_mfma_f32_16x16x32_bf16 a[88:91], a[184:187], v[120:123], a[88:91]
    v_exp_f32 v76, v76
    v_mfma_f32_16x16x32_bf16 a[88:91], a[188:191], v[136:139], a[88:91]
    buffer_load_dwordx4 v25, s[12:15], s58 offen offset:1024 lds
    v_mfma_f32_16x16x32_bf16 a[92:95], a[184:187], v[124:127], a[92:95]
    v_exp_f32 v77, v77
    v_mfma_f32_16x16x32_bf16 a[92:95], a[188:191], v[140:143], a[92:95]
    ds_read_b128 a[156:159], v11 offset:0
    v_cvt_pk_bf16_f32 v236, v76, v77
    v_mfma_f32_16x16x32_bf16 a[96:99], a[192:195], v[112:115], a[96:99]
    v_exp_f32 v78, v78
    v_mfma_f32_16x16x32_bf16 a[96:99], a[196:199], v[128:131], a[96:99]
    v_mfma_f32_16x16x32_bf16 a[100:103], a[192:195], v[116:119], a[100:103]
    v_exp_f32 v79, v79
    v_mfma_f32_16x16x32_bf16 a[100:103], a[196:199], v[132:135], a[100:103]
    ds_read_b128 a[160:163], v8 offset:4096
    v_cvt_pk_bf16_f32 v237, v78, v79
    v_mfma_f32_16x16x32_bf16 a[104:107], a[192:195], v[120:123], a[104:107]
    v_exp_f32 v80, v80
    v_mfma_f32_16x16x32_bf16 a[104:107], a[196:199], v[136:139], a[104:107]
    buffer_load_dwordx4 v24, s[12:15], s58 offen offset:2048 lds
    v_mfma_f32_16x16x32_bf16 a[108:111], a[192:195], v[124:127], a[108:111]
    v_exp_f32 v81, v81
    v_mfma_f32_16x16x32_bf16 a[108:111], a[196:199], v[140:143], a[108:111]
    ds_read_b128 a[164:167], v9 offset:4096
    v_cvt_pk_bf16_f32 v226, v80, v81
    v_mfma_f32_16x16x32_bf16 a[112:115], a[200:203], v[112:115], a[112:115]
    v_exp_f32 v82, v82
    v_mfma_f32_16x16x32_bf16 a[112:115], a[204:207], v[128:131], a[112:115]
    v_mfma_f32_16x16x32_bf16 a[116:119], a[200:203], v[116:119], a[116:119]
    v_exp_f32 v83, v83
    v_mfma_f32_16x16x32_bf16 a[116:119], a[204:207], v[132:135], a[116:119]
    ds_read_b128 a[168:171], v10 offset:4096
    v_cvt_pk_bf16_f32 v227, v82, v83
    v_mfma_f32_16x16x32_bf16 a[120:123], a[200:203], v[120:123], a[120:123]
    v_exp_f32 v84, v84
    v_mfma_f32_16x16x32_bf16 a[120:123], a[204:207], v[136:139], a[120:123]
    buffer_load_dwordx4 v25, s[12:15], s58 offen offset:3072 lds
    v_mfma_f32_16x16x32_bf16 a[124:127], a[200:203], v[124:127], a[124:127]
    v_exp_f32 v85, v85
    v_mfma_f32_16x16x32_bf16 a[124:127], a[204:207], v[140:143], a[124:127]
    s_add_u32 s58, s58, 16384
    ds_read_b128 a[172:175], v11 offset:4096
    v_cvt_pk_bf16_f32 v230, v84, v85
    v_mfma_f32_16x16x32_bf16 a[136:139], v[28:31], v[120:123], a[136:139]
    v_exp_f32 v86, v86
    v_mfma_f32_16x16x32_bf16 a[136:139], v[28:31], v[136:139], a[136:139]
    v_mfma_f32_16x16x32_bf16 a[140:143], v[28:31], v[124:127], a[140:143]
    v_exp_f32 v87, v87
    v_mfma_f32_16x16x32_bf16 a[140:143], v[28:31], v[140:143], a[140:143]
    v_cvt_pk_bf16_f32 v231, v86, v87
    s_waitcnt lgkmcnt(2)
    v_mfma_f32_16x16x32_bf16 v[32:35], a[144:147], v[160:163], v[96:99]
    v_exp_f32 v88, v88
    v_mfma_f32_16x16x32_bf16 v[32:35], a[148:151], v[164:167], v[32:35]
    ds_read_b64_tr_b16 a[176:177], v12 offset:49152
    v_mfma_f32_16x16x32_bf16 v[32:35], a[152:155], v[168:171], v[32:35]
    v_exp_f32 v89, v89
    v_mfma_f32_16x16x32_bf16 v[32:35], a[156:159], v[172:175], v[32:35]
    ds_read_b64_tr_b16 a[178:179], v12 offset:53248
    v_cvt_pk_bf16_f32 v234, v88, v89
    v_mfma_f32_16x16x32_bf16 v[36:39], a[144:147], v[176:179], v[100:103]
    v_exp_f32 v90, v90
    v_mfma_f32_16x16x32_bf16 v[36:39], a[148:151], v[180:183], v[36:39]
    ds_read_b64_tr_b16 a[180:181], v12 offset:57344
    v_mfma_f32_16x16x32_bf16 v[36:39], a[152:155], v[184:187], v[36:39]
    v_exp_f32 v91, v91
    v_mfma_f32_16x16x32_bf16 v[36:39], a[156:159], v[188:191], v[36:39]
    ds_read_b64_tr_b16 a[182:183], v12 offset:61440
    v_cvt_pk_bf16_f32 v235, v90, v91
    v_mfma_f32_16x16x32_bf16 v[40:43], a[144:147], v[192:195], v[104:107]
    v_exp_f32 v92, v92
    v_mfma_f32_16x16x32_bf16 v[40:43], a[148:151], v[196:199], v[40:43]
    ds_read_b64_tr_b16 a[184:185], v13 offset:49152
    v_mfma_f32_16x16x32_bf16 v[40:43], a[152:155], v[200:203], v[40:43]
    v_exp_f32 v93, v93
    v_mfma_f32_16x16x32_bf16 v[40:43], a[156:159], v[204:207], v[40:43]
    ds_read_b64_tr_b16 a[186:187], v13 offset:53248
    v_cvt_pk_bf16_f32 v238, v92, v93
    v_mfma_f32_16x16x32_bf16 v[44:47], a[144:147], v[208:211], v[108:111]
    v_exp_f32 v94, v94
    v_mfma_f32_16x16x32_bf16 v[44:47], a[148:151], v[212:215], v[44:47]
    ds_read_b64_tr_b16 a[188:189], v13 offset:57344
    v_mfma_f32_16x16x32_bf16 v[44:47], a[152:155], v[216:219], v[44:47]
    v_exp_f32 v95, v95
    v_mfma_f32_16x16x32_bf16 v[44:47], a[156:159], v[220:223], v[44:47]
    ds_read_b64_tr_b16 a[190:191], v13 offset:61440
    v_cvt_pk_bf16_f32 v239, v94, v95
    v_mfma_f32_16x16x32_bf16 v[48:51], a[160:163], v[160:163], v[96:99]
    v_mfma_f32_16x16x32_bf16 v[48:51], a[164:167], v[164:167], v[48:51]
    ds_read_b64_tr_b16 a[192:193], v14 offset:49152
    s_waitcnt lgkmcnt(5)
    v_mfma_f32_16x16x32_bf16 v[48:51], a[168:171], v[168:171], v[48:51]
    v_mfma_f32_16x16x32_bf16 v[48:51], a[172:175], v[172:175], v[48:51]
    ds_read_b64_tr_b16 a[194:195], v14 offset:53248
    v_mfma_f32_16x16x32_bf16 v[52:55], a[160:163], v[176:179], v[100:103]
    v_exp_f32 v32, v32
    v_mfma_f32_16x16x32_bf16 v[52:55], a[164:167], v[180:183], v[52:55]
    ds_read_b64_tr_b16 a[196:197], v14 offset:57344
    v_mfma_f32_16x16x32_bf16 v[52:55], a[168:171], v[184:187], v[52:55]
    v_exp_f32 v33, v33
    v_mfma_f32_16x16x32_bf16 v[52:55], a[172:175], v[188:191], v[52:55]
    ds_read_b64_tr_b16 a[198:199], v14 offset:61440
    v_cvt_pk_bf16_f32 v112, v32, v33
    v_mfma_f32_16x16x32_bf16 v[56:59], a[160:163], v[192:195], v[104:107]
    v_exp_f32 v34, v34
    v_mfma_f32_16x16x32_bf16 v[56:59], a[164:167], v[196:199], v[56:59]
    ds_read_b64_tr_b16 a[200:201], v15 offset:49152
    v_mfma_f32_16x16x32_bf16 v[56:59], a[168:171], v[200:203], v[56:59]
    v_exp_f32 v35, v35
    v_mfma_f32_16x16x32_bf16 v[56:59], a[172:175], v[204:207], v[56:59]
    ds_read_b64_tr_b16 a[202:203], v15 offset:53248
    v_cvt_pk_bf16_f32 v113, v34, v35
    v_mfma_f32_16x16x32_bf16 v[60:63], a[160:163], v[208:211], v[108:111]
    v_exp_f32 v36, v36
    v_mfma_f32_16x16x32_bf16 v[60:63], a[164:167], v[212:215], v[60:63]
    ds_read_b64_tr_b16 a[204:205], v15 offset:57344
    v_mfma_f32_16x16x32_bf16 v[60:63], a[168:171], v[216:219], v[60:63]
    v_exp_f32 v37, v37
    v_mfma_f32_16x16x32_bf16 v[60:63], a[172:175], v[220:223], v[60:63]
    ds_read_b64_tr_b16 a[206:207], v15 offset:61440
    v_cvt_pk_bf16_f32 v116, v36, v37
    v_mfma_f32_16x16x32_bf16 a[0:3], a[176:179], v[144:147], a[0:3]
    v_exp_f32 v38, v38
    v_mfma_f32_16x16x32_bf16 a[0:3], a[180:183], v[224:227], a[0:3]
    v_mfma_f32_16x16x32_bf16 a[4:7], a[176:179], v[148:151], a[4:7]
    v_exp_f32 v39, v39
    v_mfma_f32_16x16x32_bf16 a[4:7], a[180:183], v[228:231], a[4:7]
    ds_read_b128 a[144:147], v8 offset:8192
    v_cvt_pk_bf16_f32 v117, v38, v39
    v_mfma_f32_16x16x32_bf16 a[8:11], a[176:179], v[152:155], a[8:11]
    v_exp_f32 v40, v40
    v_mfma_f32_16x16x32_bf16 a[8:11], a[180:183], v[232:235], a[8:11]
    s_add_u32 m0, s53, 49152
    s_nop 0
    buffer_load_dwordx4 v20, s[8:11], s57 offen offset:0 lds
    v_mfma_f32_16x16x32_bf16 a[12:15], a[176:179], v[156:159], a[12:15]
    v_exp_f32 v41, v41
    v_mfma_f32_16x16x32_bf16 a[12:15], a[180:183], v[236:239], a[12:15]
    ds_read_b128 a[148:151], v9 offset:8192
    v_cvt_pk_bf16_f32 v120, v40, v41
    s_waitcnt lgkmcnt(2)
    v_mfma_f32_16x16x32_bf16 a[16:19], a[184:187], v[144:147], a[16:19]
    v_exp_f32 v42, v42
    v_mfma_f32_16x16x32_bf16 a[16:19], a[188:191], v[224:227], a[16:19]
    v_mfma_f32_16x16x32_bf16 a[20:23], a[184:187], v[148:151], a[20:23]
    v_exp_f32 v43, v43
    v_mfma_f32_16x16x32_bf16 a[20:23], a[188:191], v[228:231], a[20:23]
    ds_read_b128 a[152:155], v10 offset:8192
    v_cvt_pk_bf16_f32 v121, v42, v43
    v_mfma_f32_16x16x32_bf16 a[24:27], a[184:187], v[152:155], a[24:27]
    v_exp_f32 v44, v44
    v_mfma_f32_16x16x32_bf16 a[24:27], a[188:191], v[232:235], a[24:27]
    buffer_load_dwordx4 v21, s[8:11], s57 offen offset:1024 lds
    v_mfma_f32_16x16x32_bf16 a[28:31], a[184:187], v[156:159], a[28:31]
    v_exp_f32 v45, v45
    v_mfma_f32_16x16x32_bf16 a[28:31], a[188:191], v[236:239], a[28:31]
    ds_read_b128 a[156:159], v11 offset:8192
    v_cvt_pk_bf16_f32 v124, v44, v45
    v_mfma_f32_16x16x32_bf16 a[32:35], a[192:195], v[144:147], a[32:35]
    v_exp_f32 v46, v46
    v_mfma_f32_16x16x32_bf16 a[32:35], a[196:199], v[224:227], a[32:35]
    v_mfma_f32_16x16x32_bf16 a[36:39], a[192:195], v[148:151], a[36:39]
    v_exp_f32 v47, v47
    v_mfma_f32_16x16x32_bf16 a[36:39], a[196:199], v[228:231], a[36:39]
    ds_read_b128 a[160:163], v8 offset:12288
    v_cvt_pk_bf16_f32 v125, v46, v47
    v_mfma_f32_16x16x32_bf16 a[40:43], a[192:195], v[152:155], a[40:43]
    v_exp_f32 v48, v48
    v_mfma_f32_16x16x32_bf16 a[40:43], a[196:199], v[232:235], a[40:43]
    buffer_load_dwordx4 v22, s[8:11], s57 offen offset:2048 lds
    v_mfma_f32_16x16x32_bf16 a[44:47], a[192:195], v[156:159], a[44:47]
    v_exp_f32 v49, v49
    v_mfma_f32_16x16x32_bf16 a[44:47], a[196:199], v[236:239], a[44:47]
    ds_read_b128 a[164:167], v9 offset:12288
    v_cvt_pk_bf16_f32 v114, v48, v49
    v_mfma_f32_16x16x32_bf16 a[48:51], a[200:203], v[144:147], a[48:51]
    v_exp_f32 v50, v50
    v_mfma_f32_16x16x32_bf16 a[48:51], a[204:207], v[224:227], a[48:51]
    v_mfma_f32_16x16x32_bf16 a[52:55], a[200:203], v[148:151], a[52:55]
    v_exp_f32 v51, v51
    v_mfma_f32_16x16x32_bf16 a[52:55], a[204:207], v[228:231], a[52:55]
    ds_read_b128 a[168:171], v10 offset:12288
    v_cvt_pk_bf16_f32 v115, v50, v51
    v_mfma_f32_16x16x32_bf16 a[56:59], a[200:203], v[152:155], a[56:59]
    v_exp_f32 v52, v52
    v_mfma_f32_16x16x32_bf16 a[56:59], a[204:207], v[232:235], a[56:59]
    buffer_load_dwordx4 v23, s[8:11], s57 offen offset:3072 lds
    v_mfma_f32_16x16x32_bf16 a[60:63], a[200:203], v[156:159], a[60:63]
    v_exp_f32 v53, v53
    v_mfma_f32_16x16x32_bf16 a[60:63], a[204:207], v[236:239], a[60:63]
    s_add_u32 s57, s57, 16384
    ds_read_b128 a[172:175], v11 offset:12288
    v_cvt_pk_bf16_f32 v118, v52, v53
    v_mfma_f32_16x16x32_bf16 a[128:131], v[28:31], v[144:147], a[128:131]
    v_exp_f32 v54, v54
    v_mfma_f32_16x16x32_bf16 a[128:131], v[28:31], v[224:227], a[128:131]
    v_mfma_f32_16x16x32_bf16 a[132:135], v[28:31], v[148:151], a[132:135]
    v_exp_f32 v55, v55
    v_mfma_f32_16x16x32_bf16 a[132:135], v[28:31], v[228:231], a[132:135]
    v_cvt_pk_bf16_f32 v119, v54, v55
s_sub_u32 s59, s59, 1
s_cmp_lg_u32 s59, 0
s_cbranch_scc1 KA_LOOP
    s_waitcnt vmcnt(12) lgkmcnt(2)
    s_barrier
    v_mfma_f32_16x16x32_bf16 v[64:67], a[144:147], v[160:163], v[96:99]
    v_exp_f32 v56, v56
    v_mfma_f32_16x16x32_bf16 v[64:67], a[148:151], v[164:167], v[64:67]
    ds_read_b64_tr_b16 a[176:177], v16 offset:49152
    v_mfma_f32_16x16x32_bf16 v[64:67], a[152:155], v[168:171], v[64:67]
    v_exp_f32 v57, v57
    v_mfma_f32_16x16x32_bf16 v[64:67], a[156:159], v[172:175], v[64:67]
    ds_read_b64_tr_b16 a[178:179], v16 offset:53248
    v_cvt_pk_bf16_f32 v122, v56, v57
    v_mfma_f32_16x16x32_bf16 v[68:71], a[144:147], v[176:179], v[100:103]
    v_exp_f32 v58, v58
    v_mfma_f32_16x16x32_bf16 v[68:71], a[148:151], v[180:183], v[68:71]
    ds_read_b64_tr_b16 a[180:181], v16 offset:57344
    v_mfma_f32_16x16x32_bf16 v[68:71], a[152:155], v[184:187], v[68:71]
    v_exp_f32 v59, v59
    v_mfma_f32_16x16x32_bf16 v[68:71], a[156:159], v[188:191], v[68:71]
    ds_read_b64_tr_b16 a[182:183], v16 offset:61440
    v_cvt_pk_bf16_f32 v123, v58, v59
    v_mfma_f32_16x16x32_bf16 v[72:75], a[144:147], v[192:195], v[104:107]
    v_exp_f32 v60, v60
    v_mfma_f32_16x16x32_bf16 v[72:75], a[148:151], v[196:199], v[72:75]
    ds_read_b64_tr_b16 a[184:185], v17 offset:49152
    v_mfma_f32_16x16x32_bf16 v[72:75], a[152:155], v[200:203], v[72:75]
    v_exp_f32 v61, v61
    v_mfma_f32_16x16x32_bf16 v[72:75], a[156:159], v[204:207], v[72:75]
    ds_read_b64_tr_b16 a[186:187], v17 offset:53248
    v_cvt_pk_bf16_f32 v126, v60, v61
    v_mfma_f32_16x16x32_bf16 v[76:79], a[144:147], v[208:211], v[108:111]
    v_exp_f32 v62, v62
    v_mfma_f32_16x16x32_bf16 v[76:79], a[148:151], v[212:215], v[76:79]
    ds_read_b64_tr_b16 a[188:189], v17 offset:57344
    v_mfma_f32_16x16x32_bf16 v[76:79], a[152:155], v[216:219], v[76:79]
    v_exp_f32 v63, v63
    v_mfma_f32_16x16x32_bf16 v[76:79], a[156:159], v[220:223], v[76:79]
    ds_read_b64_tr_b16 a[190:191], v17 offset:61440
    v_cvt_pk_bf16_f32 v127, v62, v63
    v_mfma_f32_16x16x32_bf16 v[80:83], a[160:163], v[160:163], v[96:99]
    s_lshl_b32 s45, s2, 2
    s_add_u32 s45, s45, s3
    s_add_u32 s45, s45, 1024
    s_lshr_b32 s46, s45, 3
    s_and_b32 s47, s45, 7
    s_cmp_lt_u32 s46, 128
    s_cselect_b32 s32, s90, s92
    s_cselect_b32 s33, s91, s93
    s_mov_b32 s34, 0x21c000
    s_cselect_b32 s34, 0x500000, s34
    s_cselect_b32 s94, 0, 128
    s_mov_b32 s35, 0x00020000
    s_sub_u32 s94, s46, s94
    s_mul_i32 s94, s94, 40960
    s_mul_i32 s95, s47, 160
    s_add_u32 s94, s94, s95
    s_mul_i32 s95, s47, 182
    s_add_u32 s95, s95, s46
    s_mul_i32 s95, s95, 5120
    s_cmp_lt_u32 s45, 1456
    s_cselect_b32 s34, s34, 0
    s_cselect_b32 s95, s95, 7454720
    s_add_u32 m0, s44, 0
    s_nop 0
    buffer_load_dwordx4 v248, s[32:35], s94 offen lds
    v_mfma_f32_16x16x32_bf16 v[80:83], a[164:167], v[164:167], v[80:83]
    ds_read_b64_tr_b16 a[192:193], v18 offset:49152
    s_waitcnt lgkmcnt(1)
    v_mfma_f32_16x16x32_bf16 v[80:83], a[168:171], v[168:171], v[80:83]
    s_add_u32 m0, s44, 1024
    s_nop 0
    buffer_load_dwordx4 v249, s[32:35], s94 offen lds
    v_mfma_f32_16x16x32_bf16 v[80:83], a[172:175], v[172:175], v[80:83]
    ds_read_b64_tr_b16 a[194:195], v18 offset:53248
    v_mfma_f32_16x16x32_bf16 v[84:87], a[160:163], v[176:179], v[100:103]
    v_exp_f32 v64, v64
    v_mfma_f32_16x16x32_bf16 v[84:87], a[164:167], v[180:183], v[84:87]
    ds_read_b64_tr_b16 a[196:197], v18 offset:57344
    v_mfma_f32_16x16x32_bf16 v[84:87], a[168:171], v[184:187], v[84:87]
    v_exp_f32 v65, v65
    v_mfma_f32_16x16x32_bf16 v[84:87], a[172:175], v[188:191], v[84:87]
    ds_read_b64_tr_b16 a[198:199], v18 offset:61440
    v_cvt_pk_bf16_f32 v128, v64, v65
    v_mfma_f32_16x16x32_bf16 v[88:91], a[160:163], v[192:195], v[104:107]
    v_exp_f32 v66, v66
    v_mfma_f32_16x16x32_bf16 v[88:91], a[164:167], v[196:199], v[88:91]
    ds_read_b64_tr_b16 a[200:201], v19 offset:49152
    v_mfma_f32_16x16x32_bf16 v[88:91], a[168:171], v[200:203], v[88:91]
    v_exp_f32 v67, v67
    v_mfma_f32_16x16x32_bf16 v[88:91], a[172:175], v[204:207], v[88:91]
    ds_read_b64_tr_b16 a[202:203], v19 offset:53248
    v_cvt_pk_bf16_f32 v129, v66, v67
    v_mfma_f32_16x16x32_bf16 v[92:95], a[160:163], v[208:211], v[108:111]
    v_exp_f32 v68, v68
    v_mfma_f32_16x16x32_bf16 v[92:95], a[164:167], v[212:215], v[92:95]
    ds_read_b64_tr_b16 a[204:205], v19 offset:57344
    v_mfma_f32_16x16x32_bf16 v[92:95], a[168:171], v[216:219], v[92:95]
    v_exp_f32 v69, v69
    v_mfma_f32_16x16x32_bf16 v[92:95], a[172:175], v[220:223], v[92:95]
    ds_read_b64_tr_b16 a[206:207], v19 offset:61440
    v_cvt_pk_bf16_f32 v132, v68, v69
    v_mfma_f32_16x16x32_bf16 a[64:67], a[176:179], v[144:147], a[64:67]
    v_exp_f32 v70, v70
    v_mfma_f32_16x16x32_bf16 a[64:67], a[180:183], v[224:227], a[64:67]
    v_mfma_f32_16x16x32_bf16 a[68:71], a[176:179], v[148:151], a[68:71]
    v_exp_f32 v71, v71
    v_mfma_f32_16x16x32_bf16 a[68:71], a[180:183], v[228:231], a[68:71]
    ds_read_b128 a[144:147], v8 offset:16384
    v_cvt_pk_bf16_f32 v133, v70, v71
    v_mfma_f32_16x16x32_bf16 a[72:75], a[176:179], v[152:155], a[72:75]
    v_exp_f32 v72, v72
    v_mfma_f32_16x16x32_bf16 a[72:75], a[180:183], v[232:235], a[72:75]
    s_add_u32 m0, s53, 98304
    s_nop 0
    buffer_load_dwordx4 v24, s[12:15], s58 offen offset:0 lds
    v_mfma_f32_16x16x32_bf16 a[76:79], a[176:179], v[156:159], a[76:79]
    v_exp_f32 v73, v73
    v_mfma_f32_16x16x32_bf16 a[76:79], a[180:183], v[236:239], a[76:79]
    ds_read_b128 a[148:151], v9 offset:16384
    v_cvt_pk_bf16_f32 v136, v72, v73
    v_mfma_f32_16x16x32_bf16 a[80:83], a[184:187], v[144:147], a[80:83]
    v_exp_f32 v74, v74
    v_mfma_f32_16x16x32_bf16 a[80:83], a[188:191], v[224:227], a[80:83]
    v_mfma_f32_16x16x32_bf16 a[84:87], a[184:187], v[148:151], a[84:87]
    v_exp_f32 v75, v75
    v_mfma_f32_16x16x32_bf16 a[84:87], a[188:191], v[228:231], a[84:87]
    ds_read_b128 a[152:155], v10 offset:16384
    v_cvt_pk_bf16_f32 v137, v74, v75
    v_mfma_f32_16x16x32_bf16 a[88:91], a[184:187], v[152:155], a[88:91]
    v_exp_f32 v76, v76
    v_mfma_f32_16x16x32_bf16 a[88:91], a[188:191], v[232:235], a[88:91]
    buffer_load_dwordx4 v25, s[12:15], s58 offen offset:1024 lds
    v_mfma_f32_16x16x32_bf16 a[92:95], a[184:187], v[156:159], a[92:95]
    v_exp_f32 v77, v77
    v_mfma_f32_16x16x32_bf16 a[92:95], a[188:191], v[236:239], a[92:95]
    ds_read_b128 a[156:159], v11 offset:16384
    v_cvt_pk_bf16_f32 v140, v76, v77
    s_waitcnt lgkmcnt(3)
    v_mfma_f32_16x16x32_bf16 a[96:99], a[192:195], v[144:147], a[96:99]
    v_exp_f32 v78, v78
    v_mfma_f32_16x16x32_bf16 a[96:99], a[196:199], v[224:227], a[96:99]
    v_mfma_f32_16x16x32_bf16 a[100:103], a[192:195], v[148:151], a[100:103]
    v_exp_f32 v79, v79
    v_mfma_f32_16x16x32_bf16 a[100:103], a[196:199], v[228:231], a[100:103]
    ds_read_b128 a[160:163], v8 offset:20480
    v_cvt_pk_bf16_f32 v141, v78, v79
    v_mfma_f32_16x16x32_bf16 a[104:107], a[192:195], v[152:155], a[104:107]
    v_exp_f32 v80, v80
    v_mfma_f32_16x16x32_bf16 a[104:107], a[196:199], v[232:235], a[104:107]
    buffer_load_dwordx4 v24, s[12:15], s58 offen offset:2048 lds
    v_mfma_f32_16x16x32_bf16 a[108:111], a[192:195], v[156:159], a[108:111]
    v_exp_f32 v81, v81
    v_mfma_f32_16x16x32_bf16 a[108:111], a[196:199], v[236:239], a[108:111]
    ds_read_b128 a[164:167], v9 offset:20480
    v_cvt_pk_bf16_f32 v130, v80, v81
    v_mfma_f32_16x16x32_bf16 a[112:115], a[200:203], v[144:147], a[112:115]
    v_exp_f32 v82, v82
    v_mfma_f32_16x16x32_bf16 a[112:115], a[204:207], v[224:227], a[112:115]
    v_mfma_f32_16x16x32_bf16 a[116:119], a[200:203], v[148:151], a[116:119]
    v_exp_f32 v83, v83
    v_mfma_f32_16x16x32_bf16 a[116:119], a[204:207], v[228:231], a[116:119]
    ds_read_b128 a[168:171], v10 offset:20480
    v_cvt_pk_bf16_f32 v131, v82, v83
    v_mfma_f32_16x16x32_bf16 a[120:123], a[200:203], v[152:155], a[120:123]
    v_exp_f32 v84, v84
    v_mfma_f32_16x16x32_bf16 a[120:123], a[204:207], v[232:235], a[120:123]
    buffer_load_dwordx4 v25, s[12:15], s58 offen offset:3072 lds
    v_mfma_f32_16x16x32_bf16 a[124:127], a[200:203], v[156:159], a[124:127]
    v_exp_f32 v85, v85
    v_mfma_f32_16x16x32_bf16 a[124:127], a[204:207], v[236:239], a[124:127]
    s_add_u32 s58, s58, 16384
    ds_read_b128 a[172:175], v11 offset:20480
    v_cvt_pk_bf16_f32 v134, v84, v85
    v_mfma_f32_16x16x32_bf16 a[136:139], v[28:31], v[152:155], a[136:139]
    v_exp_f32 v86, v86
    v_mfma_f32_16x16x32_bf16 a[136:139], v[28:31], v[232:235], a[136:139]
    v_mfma_f32_16x16x32_bf16 a[140:143], v[28:31], v[156:159], a[140:143]
    v_exp_f32 v87, v87
    v_mfma_f32_16x16x32_bf16 a[140:143], v[28:31], v[236:239], a[140:143]
    v_cvt_pk_bf16_f32 v135, v86, v87
    v_mfma_f32_16x16x32_bf16 v[32:35], a[144:147], v[160:163], v[96:99]
    v_exp_f32 v88, v88
    s_waitcnt lgkmcnt(1)
    v_mfma_f32_16x16x32_bf16 v[32:35], a[148:151], v[164:167], v[32:35]
    ds_read_b64_tr_b16 a[176:177], v12 offset:0
    v_mfma_f32_16x16x32_bf16 v[32:35], a[152:155], v[168:171], v[32:35]
    v_exp_f32 v89, v89
    v_mfma_f32_16x16x32_bf16 v[32:35], a[156:159], v[172:175], v[32:35]
    ds_read_b64_tr_b16 a[178:179], v12 offset:4096
    v_cvt_pk_bf16_f32 v138, v88, v89
    v_mfma_f32_16x16x32_bf16 v[36:39], a[144:147], v[176:179], v[100:103]
    v_exp_f32 v90, v90
    v_mfma_f32_16x16x32_bf16 v[36:39], a[148:151], v[180:183], v[36:39]
    ds_read_b64_tr_b16 a[180:181], v12 offset:8192
    v_mfma_f32_16x16x32_bf16 v[36:39], a[152:155], v[184:187], v[36:39]
    v_exp_f32 v91, v91
    v_mfma_f32_16x16x32_bf16 v[36:39], a[156:159], v[188:191], v[36:39]
    ds_read_b64_tr_b16 a[182:183], v12 offset:12288
    v_cvt_pk_bf16_f32 v139, v90, v91
    v_mfma_f32_16x16x32_bf16 v[40:43], a[144:147], v[192:195], v[104:107]
    v_exp_f32 v92, v92
    v_mfma_f32_16x16x32_bf16 v[40:43], a[148:151], v[196:199], v[40:43]
    ds_read_b64_tr_b16 a[184:185], v13 offset:0
    v_mfma_f32_16x16x32_bf16 v[40:43], a[152:155], v[200:203], v[40:43]
    v_exp_f32 v93, v93
    v_mfma_f32_16x16x32_bf16 v[40:43], a[156:159], v[204:207], v[40:43]
    ds_read_b64_tr_b16 a[186:187], v13 offset:4096
    v_cvt_pk_bf16_f32 v142, v92, v93
    v_mfma_f32_16x16x32_bf16 v[44:47], a[144:147], v[208:211], v[108:111]
    v_exp_f32 v94, v94
    v_mfma_f32_16x16x32_bf16 v[44:47], a[148:151], v[212:215], v[44:47]
    ds_read_b64_tr_b16 a[188:189], v13 offset:8192
    v_mfma_f32_16x16x32_bf16 v[44:47], a[152:155], v[216:219], v[44:47]
    v_exp_f32 v95, v95
    v_mfma_f32_16x16x32_bf16 v[44:47], a[156:159], v[220:223], v[44:47]
    ds_read_b64_tr_b16 a[190:191], v13 offset:12288
    v_cvt_pk_bf16_f32 v143, v94, v95
    v_mfma_f32_16x16x32_bf16 v[48:51], a[160:163], v[160:163], v[96:99]
    s_add_u32 m0, s44, 2048
    s_nop 0
    buffer_load_dwordx4 v250, s[32:35], s94 offen lds
    v_mfma_f32_16x16x32_bf16 v[48:51], a[164:167], v[164:167], v[48:51]
    ds_read_b64_tr_b16 a[192:193], v14 offset:0
    v_mfma_f32_16x16x32_bf16 v[48:51], a[168:171], v[168:171], v[48:51]
    s_add_u32 m0, s44, 3072
    s_nop 0
    buffer_load_dwordx4 v251, s[32:35], s94 offen lds
    s_waitcnt lgkmcnt(3)
    v_mfma_f32_16x16x32_bf16 v[48:51], a[172:175], v[172:175], v[48:51]
    ds_read_b64_tr_b16 a[194:195], v14 offset:4096
    v_mfma_f32_16x16x32_bf16 v[52:55], a[160:163], v[176:179], v[100:103]
    v_exp_f32 v32, v32
    v_mfma_f32_16x16x32_bf16 v[52:55], a[164:167], v[180:183], v[52:55]
    ds_read_b64_tr_b16 a[196:197], v14 offset:8192
    v_mfma_f32_16x16x32_bf16 v[52:55], a[168:171], v[184:187], v[52:55]
    v_exp_f32 v33, v33
    v_mfma_f32_16x16x32_bf16 v[52:55], a[172:175], v[188:191], v[52:55]
    ds_read_b64_tr_b16 a[198:199], v14 offset:12288
    v_cvt_pk_bf16_f32 v144, v32, v33
    v_mfma_f32_16x16x32_bf16 v[56:59], a[160:163], v[192:195], v[104:107]
    v_exp_f32 v34, v34
    v_mfma_f32_16x16x32_bf16 v[56:59], a[164:167], v[196:199], v[56:59]
    ds_read_b64_tr_b16 a[200:201], v15 offset:0
    v_mfma_f32_16x16x32_bf16 v[56:59], a[168:171], v[200:203], v[56:59]
    v_exp_f32 v35, v35
    v_mfma_f32_16x16x32_bf16 v[56:59], a[172:175], v[204:207], v[56:59]
    ds_read_b64_tr_b16 a[202:203], v15 offset:4096
    v_cvt_pk_bf16_f32 v145, v34, v35
    v_mfma_f32_16x16x32_bf16 v[60:63], a[160:163], v[208:211], v[108:111]
    v_exp_f32 v36, v36
    v_mfma_f32_16x16x32_bf16 v[60:63], a[164:167], v[212:215], v[60:63]
    ds_read_b64_tr_b16 a[204:205], v15 offset:8192
    v_mfma_f32_16x16x32_bf16 v[60:63], a[168:171], v[216:219], v[60:63]
    v_exp_f32 v37, v37
    v_mfma_f32_16x16x32_bf16 v[60:63], a[172:175], v[220:223], v[60:63]
    ds_read_b64_tr_b16 a[206:207], v15 offset:12288
    v_cvt_pk_bf16_f32 v148, v36, v37
    v_mfma_f32_16x16x32_bf16 a[0:3], a[176:179], v[112:115], a[0:3]
    v_exp_f32 v38, v38
    v_mfma_f32_16x16x32_bf16 a[0:3], a[180:183], v[128:131], a[0:3]
    v_mfma_f32_16x16x32_bf16 a[4:7], a[176:179], v[116:119], a[4:7]
    v_exp_f32 v39, v39
    v_mfma_f32_16x16x32_bf16 a[4:7], a[180:183], v[132:135], a[4:7]
    ds_read_b128 a[144:147], v8 offset:24576
    v_cvt_pk_bf16_f32 v149, v38, v39
    v_mfma_f32_16x16x32_bf16 a[8:11], a[176:179], v[120:123], a[8:11]
    v_exp_f32 v40, v40
    v_mfma_f32_16x16x32_bf16 a[8:11], a[180:183], v[136:139], a[8:11]
    v_mfma_f32_16x16x32_bf16 a[12:15], a[176:179], v[124:127], a[12:15]
    v_exp_f32 v41, v41
    v_mfma_f32_16x16x32_bf16 a[12:15], a[180:183], v[140:143], a[12:15]
    ds_read_b128 a[148:151], v9 offset:24576
    v_cvt_pk_bf16_f32 v152, v40, v41
    v_mfma_f32_16x16x32_bf16 a[16:19], a[184:187], v[112:115], a[16:19]
    v_exp_f32 v42, v42
    s_waitcnt lgkmcnt(2)
    v_mfma_f32_16x16x32_bf16 a[16:19], a[188:191], v[128:131], a[16:19]
    v_mfma_f32_16x16x32_bf16 a[20:23], a[184:187], v[116:119], a[20:23]
    v_exp_f32 v43, v43
    v_mfma_f32_16x16x32_bf16 a[20:23], a[188:191], v[132:135], a[20:23]
    ds_read_b128 a[152:155], v10 offset:24576
    v_cvt_pk_bf16_f32 v153, v42, v43
    v_mfma_f32_16x16x32_bf16 a[24:27], a[184:187], v[120:123], a[24:27]
    v_exp_f32 v44, v44
    v_mfma_f32_16x16x32_bf16 a[24:27], a[188:191], v[136:139], a[24:27]
    v_mfma_f32_16x16x32_bf16 a[28:31], a[184:187], v[124:127], a[28:31]
    v_exp_f32 v45, v45
    v_mfma_f32_16x16x32_bf16 a[28:31], a[188:191], v[140:143], a[28:31]
    ds_read_b128 a[156:159], v11 offset:24576
    v_cvt_pk_bf16_f32 v156, v44, v45
    v_mfma_f32_16x16x32_bf16 a[32:35], a[192:195], v[112:115], a[32:35]
    v_exp_f32 v46, v46
    v_mfma_f32_16x16x32_bf16 a[32:35], a[196:199], v[128:131], a[32:35]
    v_mfma_f32_16x16x32_bf16 a[36:39], a[192:195], v[116:119], a[36:39]
    v_exp_f32 v47, v47
    v_mfma_f32_16x16x32_bf16 a[36:39], a[196:199], v[132:135], a[36:39]
    ds_read_b128 a[160:163], v8 offset:28672
    v_cvt_pk_bf16_f32 v157, v46, v47
    v_mfma_f32_16x16x32_bf16 a[40:43], a[192:195], v[120:123], a[40:43]
    v_exp_f32 v48, v48
    v_mfma_f32_16x16x32_bf16 a[40:43], a[196:199], v[136:139], a[40:43]
    v_mfma_f32_16x16x32_bf16 a[44:47], a[192:195], v[124:127], a[44:47]
    v_exp_f32 v49, v49
    v_mfma_f32_16x16x32_bf16 a[44:47], a[196:199], v[140:143], a[44:47]
    ds_read_b128 a[164:167], v9 offset:28672
    v_cvt_pk_bf16_f32 v146, v48, v49
    v_mfma_f32_16x16x32_bf16 a[48:51], a[200:203], v[112:115], a[48:51]
    v_exp_f32 v50, v50
    v_mfma_f32_16x16x32_bf16 a[48:51], a[204:207], v[128:131], a[48:51]
    v_mfma_f32_16x16x32_bf16 a[52:55], a[200:203], v[116:119], a[52:55]
    v_exp_f32 v51, v51
    v_mfma_f32_16x16x32_bf16 a[52:55], a[204:207], v[132:135], a[52:55]
    ds_read_b128 a[168:171], v10 offset:28672
    v_cvt_pk_bf16_f32 v147, v50, v51
    v_mfma_f32_16x16x32_bf16 a[56:59], a[200:203], v[120:123], a[56:59]
    v_exp_f32 v52, v52
    v_mfma_f32_16x16x32_bf16 a[56:59], a[204:207], v[136:139], a[56:59]
    v_mfma_f32_16x16x32_bf16 a[60:63], a[200:203], v[124:127], a[60:63]
    v_exp_f32 v53, v53
    v_mfma_f32_16x16x32_bf16 a[60:63], a[204:207], v[140:143], a[60:63]
    ds_read_b128 a[172:175], v11 offset:28672
    v_cvt_pk_bf16_f32 v150, v52, v53
    v_mfma_f32_16x16x32_bf16 a[128:131], v[28:31], v[112:115], a[128:131]
    v_exp_f32 v54, v54
    v_mfma_f32_16x16x32_bf16 a[128:131], v[28:31], v[128:131], a[128:131]
    v_mfma_f32_16x16x32_bf16 a[132:135], v[28:31], v[116:119], a[132:135]
    v_exp_f32 v55, v55
    v_mfma_f32_16x16x32_bf16 a[132:135], v[28:31], v[132:135], a[132:135]
    v_cvt_pk_bf16_f32 v151, v54, v55
    s_waitcnt vmcnt(12) lgkmcnt(2)
    s_barrier
    v_mfma_f32_16x16x32_bf16 v[64:67], a[144:147], v[160:163], v[96:99]
    v_exp_f32 v56, v56
    v_mfma_f32_16x16x32_bf16 v[64:67], a[148:151], v[164:167], v[64:67]
    ds_read_b64_tr_b16 a[176:177], v16 offset:0
    v_mfma_f32_16x16x32_bf16 v[64:67], a[152:155], v[168:171], v[64:67]
    v_exp_f32 v57, v57
    v_mfma_f32_16x16x32_bf16 v[64:67], a[156:159], v[172:175], v[64:67]
    ds_read_b64_tr_b16 a[178:179], v16 offset:4096
    v_cvt_pk_bf16_f32 v154, v56, v57
    v_mfma_f32_16x16x32_bf16 v[68:71], a[144:147], v[176:179], v[100:103]
    v_exp_f32 v58, v58
    v_mfma_f32_16x16x32_bf16 v[68:71], a[148:151], v[180:183], v[68:71]
    ds_read_b64_tr_b16 a[180:181], v16 offset:8192
    v_mfma_f32_16x16x32_bf16 v[68:71], a[152:155], v[184:187], v[68:71]
    v_exp_f32 v59, v59
    v_mfma_f32_16x16x32_bf16 v[68:71], a[156:159], v[188:191], v[68:71]
    ds_read_b64_tr_b16 a[182:183], v16 offset:12288
    v_cvt_pk_bf16_f32 v155, v58, v59
    v_mfma_f32_16x16x32_bf16 v[72:75], a[144:147], v[192:195], v[104:107]
    v_exp_f32 v60, v60
    v_mfma_f32_16x16x32_bf16 v[72:75], a[148:151], v[196:199], v[72:75]
    ds_read_b64_tr_b16 a[184:185], v17 offset:0
    v_mfma_f32_16x16x32_bf16 v[72:75], a[152:155], v[200:203], v[72:75]
    v_exp_f32 v61, v61
    v_mfma_f32_16x16x32_bf16 v[72:75], a[156:159], v[204:207], v[72:75]
    ds_read_b64_tr_b16 a[186:187], v17 offset:4096
    v_cvt_pk_bf16_f32 v158, v60, v61
    v_mfma_f32_16x16x32_bf16 v[76:79], a[144:147], v[208:211], v[108:111]
    v_exp_f32 v62, v62
    v_mfma_f32_16x16x32_bf16 v[76:79], a[148:151], v[212:215], v[76:79]
    ds_read_b64_tr_b16 a[188:189], v17 offset:8192
    v_mfma_f32_16x16x32_bf16 v[76:79], a[152:155], v[216:219], v[76:79]
    v_exp_f32 v63, v63
    v_mfma_f32_16x16x32_bf16 v[76:79], a[156:159], v[220:223], v[76:79]
    ds_read_b64_tr_b16 a[190:191], v17 offset:12288
    v_cvt_pk_bf16_f32 v159, v62, v63
    v_mfma_f32_16x16x32_bf16 v[80:83], a[160:163], v[160:163], v[96:99]
    s_add_u32 m0, s44, 4096
    s_nop 0
    buffer_load_dwordx4 v252, s[32:35], s94 offen lds
    v_mfma_f32_16x16x32_bf16 v[80:83], a[164:167], v[164:167], v[80:83]
    ds_read_b64_tr_b16 a[192:193], v18 offset:0
    s_waitcnt lgkmcnt(4)
    v_mfma_f32_16x16x32_bf16 v[80:83], a[168:171], v[168:171], v[80:83]
    v_mfma_f32_16x16x32_bf16 v[80:83], a[172:175], v[172:175], v[80:83]
    ds_read_b64_tr_b16 a[194:195], v18 offset:4096
    v_mfma_f32_16x16x32_bf16 v[84:87], a[160:163], v[176:179], v[100:103]
    v_exp_f32 v64, v64
    v_mfma_f32_16x16x32_bf16 v[84:87], a[164:167], v[180:183], v[84:87]
    ds_read_b64_tr_b16 a[196:197], v18 offset:8192
    v_mfma_f32_16x16x32_bf16 v[84:87], a[168:171], v[184:187], v[84:87]
    v_exp_f32 v65, v65
    v_mfma_f32_16x16x32_bf16 v[84:87], a[172:175], v[188:191], v[84:87]
    ds_read_b64_tr_b16 a[198:199], v18 offset:12288
    v_cvt_pk_bf16_f32 v224, v64, v65
    v_mfma_f32_16x16x32_bf16 v[88:91], a[160:163], v[192:195], v[104:107]
    v_exp_f32 v66, v66
    v_mfma_f32_16x16x32_bf16 v[88:91], a[164:167], v[196:199], v[88:91]
    ds_read_b64_tr_b16 a[200:201], v19 offset:0
    v_mfma_f32_16x16x32_bf16 v[88:91], a[168:171], v[200:203], v[88:91]
    v_exp_f32 v67, v67
    v_mfma_f32_16x16x32_bf16 v[88:91], a[172:175], v[204:207], v[88:91]
    ds_read_b64_tr_b16 a[202:203], v19 offset:4096
    v_cvt_pk_bf16_f32 v225, v66, v67
    v_mfma_f32_16x16x32_bf16 v[92:95], a[160:163], v[208:211], v[108:111]
    v_exp_f32 v68, v68
    v_mfma_f32_16x16x32_bf16 v[92:95], a[164:167], v[212:215], v[92:95]
    ds_read_b64_tr_b16 a[204:205], v19 offset:8192
    v_mfma_f32_16x16x32_bf16 v[92:95], a[168:171], v[216:219], v[92:95]
    v_exp_f32 v69, v69
    v_mfma_f32_16x16x32_bf16 v[92:95], a[172:175], v[220:223], v[92:95]
    ds_read_b64_tr_b16 a[206:207], v19 offset:12288
    v_cvt_pk_bf16_f32 v228, v68, v69
    v_mfma_f32_16x16x32_bf16 a[64:67], a[176:179], v[112:115], a[64:67]
    v_exp_f32 v70, v70
    v_mfma_f32_16x16x32_bf16 a[64:67], a[180:183], v[128:131], a[64:67]
    v_mfma_f32_16x16x32_bf16 a[68:71], a[176:179], v[116:119], a[68:71]
    v_exp_f32 v71, v71
    v_mfma_f32_16x16x32_bf16 a[68:71], a[180:183], v[132:135], a[68:71]
    ds_read_b128 a[144:147], v8 offset:32768
    v_cvt_pk_bf16_f32 v229, v70, v71
    v_mfma_f32_16x16x32_bf16 a[72:75], a[176:179], v[120:123], a[72:75]
    v_exp_f32 v72, v72
    v_mfma_f32_16x16x32_bf16 a[72:75], a[180:183], v[136:139], a[72:75]
    s_add_u32 m0, s53, 114688
    s_nop 0
    buffer_load_dwordx4 v24, s[12:15], s58 offen offset:0 lds
    v_mfma_f32_16x16x32_bf16 a[76:79], a[176:179], v[124:127], a[76:79]
    v_exp_f32 v73, v73
    v_mfma_f32_16x16x32_bf16 a[76:79], a[180:183], v[140:143], a[76:79]
    ds_read_b128 a[148:151], v9 offset:32768
    v_cvt_pk_bf16_f32 v232, v72, v73
    s_waitcnt lgkmcnt(2)
    v_mfma_f32_16x16x32_bf16 a[80:83], a[184:187], v[112:115], a[80:83]
    v_exp_f32 v74, v74
    v_mfma_f32_16x16x32_bf16 a[80:83], a[188:191], v[128:131], a[80:83]
    v_mfma_f32_16x16x32_bf16 a[84:87], a[184:187], v[116:119], a[84:87]
    v_exp_f32 v75, v75
    v_mfma_f32_16x16x32_bf16 a[84:87], a[188:191], v[132:135], a[84:87]
    ds_read_b128 a[152:155], v10 offset:32768
    v_cvt_pk_bf16_f32 v233, v74, v75
    v_mfma_f32_16x16x32_bf16 a[88:91], a[184:187], v[120:123], a[88:91]
    v_exp_f32 v76, v76
    v_mfma_f32_16x16x32_bf16 a[88:91], a[188:191], v[136:139], a[88:91]
    buffer_load_dwordx4 v25, s[12:15], s58 offen offset:1024 lds
    v_mfma_f32_16x16x32_bf16 a[92:95], a[184:187], v[124:127], a[92:95]
    v_exp_f32 v77, v77
    v_mfma_f32_16x16x32_bf16 a[92:95], a[188:191], v[140:143], a[92:95]
    ds_read_b128 a[156:159], v11 offset:32768
    v_cvt_pk_bf16_f32 v236, v76, v77
    v_mfma_f32_16x16x32_bf16 a[96:99], a[192:195], v[112:115], a[96:99]
    v_exp_f32 v78, v78
    v_mfma_f32_16x16x32_bf16 a[96:99], a[196:199], v[128:131], a[96:99]
    v_mfma_f32_16x16x32_bf16 a[100:103], a[192:195], v[116:119], a[100:103]
    v_exp_f32 v79, v79
    v_mfma_f32_16x16x32_bf16 a[100:103], a[196:199], v[132:135], a[100:103]
    ds_read_b128 a[160:163], v8 offset:36864
    v_cvt_pk_bf16_f32 v237, v78, v79
    v_mfma_f32_16x16x32_bf16 a[104:107], a[192:195], v[120:123], a[104:107]
    v_exp_f32 v80, v80
    v_mfma_f32_16x16x32_bf16 a[104:107], a[196:199], v[136:139], a[104:107]
    buffer_load_dwordx4 v24, s[12:15], s58 offen offset:2048 lds
    v_mfma_f32_16x16x32_bf16 a[108:111], a[192:195], v[124:127], a[108:111]
    v_exp_f32 v81, v81
    v_mfma_f32_16x16x32_bf16 a[108:111], a[196:199], v[140:143], a[108:111]
    ds_read_b128 a[164:167], v9 offset:36864
    v_cvt_pk_bf16_f32 v226, v80, v81
    v_mfma_f32_16x16x32_bf16 a[112:115], a[200:203], v[112:115], a[112:115]
    v_exp_f32 v82, v82
    v_mfma_f32_16x16x32_bf16 a[112:115], a[204:207], v[128:131], a[112:115]
    v_mfma_f32_16x16x32_bf16 a[116:119], a[200:203], v[116:119], a[116:119]
    v_exp_f32 v83, v83
    v_mfma_f32_16x16x32_bf16 a[116:119], a[204:207], v[132:135], a[116:119]
    ds_read_b128 a[168:171], v10 offset:36864
    v_cvt_pk_bf16_f32 v227, v82, v83
    v_mfma_f32_16x16x32_bf16 a[120:123], a[200:203], v[120:123], a[120:123]
    v_exp_f32 v84, v84
    v_mfma_f32_16x16x32_bf16 a[120:123], a[204:207], v[136:139], a[120:123]
    buffer_load_dwordx4 v25, s[12:15], s58 offen offset:3072 lds
    v_mfma_f32_16x16x32_bf16 a[124:127], a[200:203], v[124:127], a[124:127]
    v_exp_f32 v85, v85
    v_mfma_f32_16x16x32_bf16 a[124:127], a[204:207], v[140:143], a[124:127]
    s_add_u32 s58, s58, 16384
    ds_read_b128 a[172:175], v11 offset:36864
    v_cvt_pk_bf16_f32 v230, v84, v85
    v_mfma_f32_16x16x32_bf16 a[136:139], v[28:31], v[120:123], a[136:139]
    v_exp_f32 v86, v86
    v_mfma_f32_16x16x32_bf16 a[136:139], v[28:31], v[136:139], a[136:139]
    v_mfma_f32_16x16x32_bf16 a[140:143], v[28:31], v[124:127], a[140:143]
    v_exp_f32 v87, v87
    v_mfma_f32_16x16x32_bf16 a[140:143], v[28:31], v[140:143], a[140:143]
    v_cvt_pk_bf16_f32 v231, v86, v87
    s_waitcnt lgkmcnt(2)
    v_mfma_f32_16x16x32_bf16 v[32:35], a[144:147], v[160:163], v[96:99]
    v_exp_f32 v88, v88
    v_mfma_f32_16x16x32_bf16 v[32:35], a[148:151], v[164:167], v[32:35]
    ds_read_b64_tr_b16 a[176:177], v12 offset:16384
    v_mfma_f32_16x16x32_bf16 v[32:35], a[152:155], v[168:171], v[32:35]
    v_exp_f32 v89, v89
    v_mfma_f32_16x16x32_bf16 v[32:35], a[156:159], v[172:175], v[32:35]
    ds_read_b64_tr_b16 a[178:179], v12 offset:20480
    v_cvt_pk_bf16_f32 v234, v88, v89
    v_mfma_f32_16x16x32_bf16 v[36:39], a[144:147], v[176:179], v[100:103]
    v_exp_f32 v90, v90
    v_mfma_f32_16x16x32_bf16 v[36:39], a[148:151], v[180:183], v[36:39]
    ds_read_b64_tr_b16 a[180:181], v12 offset:24576
    v_mfma_f32_16x16x32_bf16 v[36:39], a[152:155], v[184:187], v[36:39]
    v_exp_f32 v91, v91
    v_mfma_f32_16x16x32_bf16 v[36:39], a[156:159], v[188:191], v[36:39]
    ds_read_b64_tr_b16 a[182:183], v12 offset:28672
    v_cvt_pk_bf16_f32 v235, v90, v91
    v_mfma_f32_16x16x32_bf16 v[40:43], a[144:147], v[192:195], v[104:107]
    v_exp_f32 v92, v92
    v_mfma_f32_16x16x32_bf16 v[40:43], a[148:151], v[196:199], v[40:43]
    ds_read_b64_tr_b16 a[184:185], v13 offset:16384
    v_mfma_f32_16x16x32_bf16 v[40:43], a[152:155], v[200:203], v[40:43]
    v_exp_f32 v93, v93
    v_mfma_f32_16x16x32_bf16 v[40:43], a[156:159], v[204:207], v[40:43]
    ds_read_b64_tr_b16 a[186:187], v13 offset:20480
    v_cvt_pk_bf16_f32 v238, v92, v93
    v_mfma_f32_16x16x32_bf16 v[44:47], a[144:147], v[208:211], v[108:111]
    v_exp_f32 v94, v94
    v_mfma_f32_16x16x32_bf16 v[44:47], a[148:151], v[212:215], v[44:47]
    ds_read_b64_tr_b16 a[188:189], v13 offset:24576
    v_mfma_f32_16x16x32_bf16 v[44:47], a[152:155], v[216:219], v[44:47]
    v_exp_f32 v95, v95
    v_mfma_f32_16x16x32_bf16 v[44:47], a[156:159], v[220:223], v[44:47]
    ds_read_b64_tr_b16 a[190:191], v13 offset:28672
    v_cvt_pk_bf16_f32 v239, v94, v95
    v_mfma_f32_16x16x32_bf16 v[48:51], a[160:163], v[160:163], v[96:99]
    v_mfma_f32_16x16x32_bf16 v[48:51], a[164:167], v[164:167], v[48:51]
    ds_read_b64_tr_b16 a[192:193], v14 offset:16384
    s_waitcnt lgkmcnt(5)
    v_mfma_f32_16x16x32_bf16 v[48:51], a[168:171], v[168:171], v[48:51]
    v_mfma_f32_16x16x32_bf16 v[48:51], a[172:175], v[172:175], v[48:51]
    ds_read_b64_tr_b16 a[194:195], v14 offset:20480
    v_mfma_f32_16x16x32_bf16 v[52:55], a[160:163], v[176:179], v[100:103]
    v_exp_f32 v32, v32
    v_mfma_f32_16x16x32_bf16 v[52:55], a[164:167], v[180:183], v[52:55]
    ds_read_b64_tr_b16 a[196:197], v14 offset:24576
    v_mfma_f32_16x16x32_bf16 v[52:55], a[168:171], v[184:187], v[52:55]
    v_exp_f32 v33, v33
    v_mfma_f32_16x16x32_bf16 v[52:55], a[172:175], v[188:191], v[52:55]
    ds_read_b64_tr_b16 a[198:199], v14 offset:28672
    v_cvt_pk_bf16_f32 v112, v32, v33
    v_mfma_f32_16x16x32_bf16 v[56:59], a[160:163], v[192:195], v[104:107]
    v_exp_f32 v34, v34
    v_mfma_f32_16x16x32_bf16 v[56:59], a[164:167], v[196:199], v[56:59]
    ds_read_b64_tr_b16 a[200:201], v15 offset:16384
    v_mfma_f32_16x16x32_bf16 v[56:59], a[168:171], v[200:203], v[56:59]
    v_exp_f32 v35, v35
    v_mfma_f32_16x16x32_bf16 v[56:59], a[172:175], v[204:207], v[56:59]
    ds_read_b64_tr_b16 a[202:203], v15 offset:20480
    v_cvt_pk_bf16_f32 v113, v34, v35
    v_mfma_f32_16x16x32_bf16 v[60:63], a[160:163], v[208:211], v[108:111]
    v_exp_f32 v36, v36
    v_mfma_f32_16x16x32_bf16 v[60:63], a[164:167], v[212:215], v[60:63]
    ds_read_b64_tr_b16 a[204:205], v15 offset:24576
    v_mfma_f32_16x16x32_bf16 v[60:63], a[168:171], v[216:219], v[60:63]
    v_exp_f32 v37, v37
    v_mfma_f32_16x16x32_bf16 v[60:63], a[172:175], v[220:223], v[60:63]
    ds_read_b64_tr_b16 a[206:207], v15 offset:28672
    v_cvt_pk_bf16_f32 v116, v36, v37
    v_mfma_f32_16x16x32_bf16 a[0:3], a[176:179], v[144:147], a[0:3]
    v_exp_f32 v38, v38
    v_mfma_f32_16x16x32_bf16 a[0:3], a[180:183], v[224:227], a[0:3]
    v_mfma_f32_16x16x32_bf16 a[4:7], a[176:179], v[148:151], a[4:7]
    v_exp_f32 v39, v39
    v_mfma_f32_16x16x32_bf16 a[4:7], a[180:183], v[228:231], a[4:7]
    ds_read_b128 a[144:147], v8 offset:40960
    v_cvt_pk_bf16_f32 v117, v38, v39
    v_mfma_f32_16x16x32_bf16 a[8:11], a[176:179], v[152:155], a[8:11]
    v_exp_f32 v40, v40
    v_mfma_f32_16x16x32_bf16 a[8:11], a[180:183], v[232:235], a[8:11]
    v_mfma_f32_16x16x32_bf16 a[12:15], a[176:179], v[156:159], a[12:15]
    v_exp_f32 v41, v41
    v_mfma_f32_16x16x32_bf16 a[12:15], a[180:183], v[236:239], a[12:15]
    ds_read_b128 a[148:151], v9 offset:40960
    v_cvt_pk_bf16_f32 v120, v40, v41
    s_waitcnt lgkmcnt(3)
    v_mfma_f32_16x16x32_bf16 a[16:19], a[184:187], v[144:147], a[16:19]
    v_exp_f32 v42, v42
    v_mfma_f32_16x16x32_bf16 a[16:19], a[188:191], v[224:227], a[16:19]
    v_mfma_f32_16x16x32_bf16 a[20:23], a[184:187], v[148:151], a[20:23]
    v_exp_f32 v43, v43
    v_mfma_f32_16x16x32_bf16 a[20:23], a[188:191], v[228:231], a[20:23]
    ds_read_b128 a[152:155], v10 offset:40960
    v_cvt_pk_bf16_f32 v121, v42, v43
    v_mfma_f32_16x16x32_bf16 a[24:27], a[184:187], v[152:155], a[24:27]
    v_exp_f32 v44, v44
    v_mfma_f32_16x16x32_bf16 a[24:27], a[188:191], v[232:235], a[24:27]
    v_mfma_f32_16x16x32_bf16 a[28:31], a[184:187], v[156:159], a[28:31]
    v_exp_f32 v45, v45
    v_mfma_f32_16x16x32_bf16 a[28:31], a[188:191], v[236:239], a[28:31]
    ds_read_b128 a[156:159], v11 offset:40960
    v_cvt_pk_bf16_f32 v124, v44, v45
    v_mfma_f32_16x16x32_bf16 a[32:35], a[192:195], v[144:147], a[32:35]
    v_exp_f32 v46, v46
    v_mfma_f32_16x16x32_bf16 a[32:35], a[196:199], v[224:227], a[32:35]
    v_mfma_f32_16x16x32_bf16 a[36:39], a[192:195], v[148:151], a[36:39]
    v_exp_f32 v47, v47
    v_mfma_f32_16x16x32_bf16 a[36:39], a[196:199], v[228:231], a[36:39]
    ds_read_b128 a[160:163], v8 offset:45056
    v_cvt_pk_bf16_f32 v125, v46, v47
    v_mfma_f32_16x16x32_bf16 a[40:43], a[192:195], v[152:155], a[40:43]
    v_exp_f32 v48, v48
    v_mfma_f32_16x16x32_bf16 a[40:43], a[196:199], v[232:235], a[40:43]
    v_mfma_f32_16x16x32_bf16 a[44:47], a[192:195], v[156:159], a[44:47]
    v_exp_f32 v49, v49
    v_mfma_f32_16x16x32_bf16 a[44:47], a[196:199], v[236:239], a[44:47]
    ds_read_b128 a[164:167], v9 offset:45056
    v_cvt_pk_bf16_f32 v114, v48, v49
    v_mfma_f32_16x16x32_bf16 a[48:51], a[200:203], v[144:147], a[48:51]
    v_exp_f32 v50, v50
    s_waitcnt lgkmcnt(2)
    v_mfma_f32_16x16x32_bf16 a[48:51], a[204:207], v[224:227], a[48:51]
    v_mfma_f32_16x16x32_bf16 a[52:55], a[200:203], v[148:151], a[52:55]
    v_exp_f32 v51, v51
    v_mfma_f32_16x16x32_bf16 a[52:55], a[204:207], v[228:231], a[52:55]
    ds_read_b128 a[168:171], v10 offset:45056
    v_cvt_pk_bf16_f32 v115, v50, v51
    v_mfma_f32_16x16x32_bf16 a[56:59], a[200:203], v[152:155], a[56:59]
    v_exp_f32 v52, v52
    v_mfma_f32_16x16x32_bf16 a[56:59], a[204:207], v[232:235], a[56:59]
    v_mfma_f32_16x16x32_bf16 a[60:63], a[200:203], v[156:159], a[60:63]
    v_exp_f32 v53, v53
    v_mfma_f32_16x16x32_bf16 a[60:63], a[204:207], v[236:239], a[60:63]
    ds_read_b128 a[172:175], v11 offset:45056
    v_cvt_pk_bf16_f32 v118, v52, v53
    v_mfma_f32_16x16x32_bf16 a[128:131], v[28:31], v[144:147], a[128:131]
    v_exp_f32 v54, v54
    v_mfma_f32_16x16x32_bf16 a[128:131], v[28:31], v[224:227], a[128:131]
    v_mfma_f32_16x16x32_bf16 a[132:135], v[28:31], v[148:151], a[132:135]
    v_exp_f32 v55, v55
    v_mfma_f32_16x16x32_bf16 a[132:135], v[28:31], v[228:231], a[132:135]
    v_cvt_pk_bf16_f32 v119, v54, v55
    s_waitcnt vmcnt(7) lgkmcnt(2)
    s_barrier
    v_mfma_f32_16x16x32_bf16 v[64:67], a[144:147], v[160:163], v[96:99]
    v_exp_f32 v56, v56
    v_mfma_f32_16x16x32_bf16 v[64:67], a[148:151], v[164:167], v[64:67]
    ds_read_b64_tr_b16 a[176:177], v16 offset:16384
    v_mfma_f32_16x16x32_bf16 v[64:67], a[152:155], v[168:171], v[64:67]
    v_exp_f32 v57, v57
    v_mfma_f32_16x16x32_bf16 v[64:67], a[156:159], v[172:175], v[64:67]
    ds_read_b64_tr_b16 a[178:179], v16 offset:20480
    v_cvt_pk_bf16_f32 v122, v56, v57
    v_mfma_f32_16x16x32_bf16 v[68:71], a[144:147], v[176:179], v[100:103]
    v_exp_f32 v58, v58
    v_mfma_f32_16x16x32_bf16 v[68:71], a[148:151], v[180:183], v[68:71]
    ds_read_b64_tr_b16 a[180:181], v16 offset:24576
    v_mfma_f32_16x16x32_bf16 v[68:71], a[152:155], v[184:187], v[68:71]
    v_exp_f32 v59, v59
    v_mfma_f32_16x16x32_bf16 v[68:71], a[156:159], v[188:191], v[68:71]
    ds_read_b64_tr_b16 a[182:183], v16 offset:28672
    v_cvt_pk_bf16_f32 v123, v58, v59
    v_mfma_f32_16x16x32_bf16 v[72:75], a[144:147], v[192:195], v[104:107]
    v_exp_f32 v60, v60
    v_mfma_f32_16x16x32_bf16 v[72:75], a[148:151], v[196:199], v[72:75]
    ds_read_b64_tr_b16 a[184:185], v17 offset:16384
    v_mfma_f32_16x16x32_bf16 v[72:75], a[152:155], v[200:203], v[72:75]
    v_exp_f32 v61, v61
    v_mfma_f32_16x16x32_bf16 v[72:75], a[156:159], v[204:207], v[72:75]
    ds_read_b64_tr_b16 a[186:187], v17 offset:20480
    v_cvt_pk_bf16_f32 v126, v60, v61
    v_mfma_f32_16x16x32_bf16 v[76:79], a[144:147], v[208:211], v[108:111]
    v_exp_f32 v62, v62
    v_mfma_f32_16x16x32_bf16 v[76:79], a[148:151], v[212:215], v[76:79]
    ds_read_b64_tr_b16 a[188:189], v17 offset:24576
    v_mfma_f32_16x16x32_bf16 v[76:79], a[152:155], v[216:219], v[76:79]
    v_exp_f32 v63, v63
    v_mfma_f32_16x16x32_bf16 v[76:79], a[156:159], v[220:223], v[76:79]
    ds_read_b64_tr_b16 a[190:191], v17 offset:28672
    v_cvt_pk_bf16_f32 v127, v62, v63
    v_mfma_f32_16x16x32_bf16 v[80:83], a[160:163], v[160:163], v[96:99]
    v_mfma_f32_16x16x32_bf16 v[80:83], a[164:167], v[164:167], v[80:83]
    ds_read_b64_tr_b16 a[192:193], v18 offset:16384
    s_waitcnt lgkmcnt(5)
    v_mfma_f32_16x16x32_bf16 v[80:83], a[168:171], v[168:171], v[80:83]
    v_mfma_f32_16x16x32_bf16 v[80:83], a[172:175], v[172:175], v[80:83]
    ds_read_b64_tr_b16 a[194:195], v18 offset:20480
    v_mfma_f32_16x16x32_bf16 v[84:87], a[160:163], v[176:179], v[100:103]
    v_exp_f32 v64, v64
    v_mfma_f32_16x16x32_bf16 v[84:87], a[164:167], v[180:183], v[84:87]
    ds_read_b64_tr_b16 a[196:197], v18 offset:24576
    v_mfma_f32_16x16x32_bf16 v[84:87], a[168:171], v[184:187], v[84:87]
    v_exp_f32 v65, v65
    v_mfma_f32_16x16x32_bf16 v[84:87], a[172:175], v[188:191], v[84:87]
    ds_read_b64_tr_b16 a[198:199], v18 offset:28672
    v_cvt_pk_bf16_f32 v128, v64, v65
    v_mfma_f32_16x16x32_bf16 v[88:91], a[160:163], v[192:195], v[104:107]
    v_exp_f32 v66, v66
    v_mfma_f32_16x16x32_bf16 v[88:91], a[164:167], v[196:199], v[88:91]
    ds_read_b64_tr_b16 a[200:201], v19 offset:16384
    v_mfma_f32_16x16x32_bf16 v[88:91], a[168:171], v[200:203], v[88:91]
    v_exp_f32 v67, v67
    v_mfma_f32_16x16x32_bf16 v[88:91], a[172:175], v[204:207], v[88:91]
    ds_read_b64_tr_b16 a[202:203], v19 offset:20480
    v_cvt_pk_bf16_f32 v129, v66, v67
    v_mfma_f32_16x16x32_bf16 v[92:95], a[160:163], v[208:211], v[108:111]
    v_exp_f32 v68, v68
    v_mfma_f32_16x16x32_bf16 v[92:95], a[164:167], v[212:215], v[92:95]
    ds_read_b64_tr_b16 a[204:205], v19 offset:24576
    v_mfma_f32_16x16x32_bf16 v[92:95], a[168:171], v[216:219], v[92:95]
    v_exp_f32 v69, v69
    v_mfma_f32_16x16x32_bf16 v[92:95], a[172:175], v[220:223], v[92:95]
    ds_read_b64_tr_b16 a[206:207], v19 offset:28672
    v_cvt_pk_bf16_f32 v132, v68, v69
    v_mfma_f32_16x16x32_bf16 a[64:67], a[176:179], v[144:147], a[64:67]
    v_exp_f32 v70, v70
    v_mfma_f32_16x16x32_bf16 a[64:67], a[180:183], v[224:227], a[64:67]
    v_mfma_f32_16x16x32_bf16 a[68:71], a[176:179], v[148:151], a[68:71]
    v_exp_f32 v71, v71
    v_mfma_f32_16x16x32_bf16 a[68:71], a[180:183], v[228:231], a[68:71]
    ds_read_b128 a[144:147], v8 offset:49152
    v_cvt_pk_bf16_f32 v133, v70, v71
    v_mfma_f32_16x16x32_bf16 a[72:75], a[176:179], v[152:155], a[72:75]
    v_exp_f32 v72, v72
    v_mfma_f32_16x16x32_bf16 a[72:75], a[180:183], v[232:235], a[72:75]
    v_mfma_f32_16x16x32_bf16 a[76:79], a[176:179], v[156:159], a[76:79]
    v_exp_f32 v73, v73
    v_mfma_f32_16x16x32_bf16 a[76:79], a[180:183], v[236:239], a[76:79]
    ds_read_b128 a[148:151], v9 offset:49152
    v_cvt_pk_bf16_f32 v136, v72, v73
    s_waitcnt lgkmcnt(3)
    v_mfma_f32_16x16x32_bf16 a[80:83], a[184:187], v[144:147], a[80:83]
    v_exp_f32 v74, v74
    v_mfma_f32_16x16x32_bf16 a[80:83], a[188:191], v[224:227], a[80:83]
    v_mfma_f32_16x16x32_bf16 a[84:87], a[184:187], v[148:151], a[84:87]
    v_exp_f32 v75, v75
    v_mfma_f32_16x16x32_bf16 a[84:87], a[188:191], v[228:231], a[84:87]
    ds_read_b128 a[152:155], v10 offset:49152
    v_cvt_pk_bf16_f32 v137, v74, v75
    v_mfma_f32_16x16x32_bf16 a[88:91], a[184:187], v[152:155], a[88:91]
    v_exp_f32 v76, v76
    v_mfma_f32_16x16x32_bf16 a[88:91], a[188:191], v[232:235], a[88:91]
    v_mfma_f32_16x16x32_bf16 a[92:95], a[184:187], v[156:159], a[92:95]
    v_exp_f32 v77, v77
    v_mfma_f32_16x16x32_bf16 a[92:95], a[188:191], v[236:239], a[92:95]
    ds_read_b128 a[156:159], v11 offset:49152
    v_cvt_pk_bf16_f32 v140, v76, v77
    v_mfma_f32_16x16x32_bf16 a[96:99], a[192:195], v[144:147], a[96:99]
    v_exp_f32 v78, v78
    v_mfma_f32_16x16x32_bf16 a[96:99], a[196:199], v[224:227], a[96:99]
    v_mfma_f32_16x16x32_bf16 a[100:103], a[192:195], v[148:151], a[100:103]
    v_exp_f32 v79, v79
    v_mfma_f32_16x16x32_bf16 a[100:103], a[196:199], v[228:231], a[100:103]
    ds_read_b128 a[160:163], v8 offset:53248
    v_cvt_pk_bf16_f32 v141, v78, v79
    v_mfma_f32_16x16x32_bf16 a[104:107], a[192:195], v[152:155], a[104:107]
    v_exp_f32 v80, v80
    v_mfma_f32_16x16x32_bf16 a[104:107], a[196:199], v[232:235], a[104:107]
    v_mfma_f32_16x16x32_bf16 a[108:111], a[192:195], v[156:159], a[108:111]
    v_exp_f32 v81, v81
    v_mfma_f32_16x16x32_bf16 a[108:111], a[196:199], v[236:239], a[108:111]
    ds_read_b128 a[164:167], v9 offset:53248
    v_cvt_pk_bf16_f32 v130, v80, v81
    v_mfma_f32_16x16x32_bf16 a[112:115], a[200:203], v[144:147], a[112:115]
    v_exp_f32 v82, v82
    s_waitcnt lgkmcnt(2)
    v_mfma_f32_16x16x32_bf16 a[112:115], a[204:207], v[224:227], a[112:115]
    v_mfma_f32_16x16x32_bf16 a[116:119], a[200:203], v[148:151], a[116:119]
    v_exp_f32 v83, v83
    v_mfma_f32_16x16x32_bf16 a[116:119], a[204:207], v[228:231], a[116:119]
    ds_read_b128 a[168:171], v10 offset:53248
    v_cvt_pk_bf16_f32 v131, v82, v83
    v_mfma_f32_16x16x32_bf16 a[120:123], a[200:203], v[152:155], a[120:123]
    v_exp_f32 v84, v84
    v_mfma_f32_16x16x32_bf16 a[120:123], a[204:207], v[232:235], a[120:123]
    v_mfma_f32_16x16x32_bf16 a[124:127], a[200:203], v[156:159], a[124:127]
    v_exp_f32 v85, v85
    v_mfma_f32_16x16x32_bf16 a[124:127], a[204:207], v[236:239], a[124:127]
    ds_read_b128 a[172:175], v11 offset:53248
    v_cvt_pk_bf16_f32 v134, v84, v85
    v_mfma_f32_16x16x32_bf16 a[136:139], v[28:31], v[152:155], a[136:139]
    v_exp_f32 v86, v86
    v_mfma_f32_16x16x32_bf16 a[136:139], v[28:31], v[232:235], a[136:139]
    v_mfma_f32_16x16x32_bf16 a[140:143], v[28:31], v[156:159], a[140:143]
    v_exp_f32 v87, v87
    v_mfma_f32_16x16x32_bf16 a[140:143], v[28:31], v[236:239], a[140:143]
    v_cvt_pk_bf16_f32 v135, v86, v87
    v_mfma_f32_16x16x32_bf16 v[32:35], a[144:147], v[160:163], v[96:99]
    v_exp_f32 v88, v88
    v_mfma_f32_16x16x32_bf16 v[32:35], a[148:151], v[164:167], v[32:35]
    ds_read_b64_tr_b16 a[176:177], v12 offset:32768
    v_mfma_f32_16x16x32_bf16 v[32:35], a[152:155], v[168:171], v[32:35]
    v_exp_f32 v89, v89
    v_mfma_f32_16x16x32_bf16 v[32:35], a[156:159], v[172:175], v[32:35]
    ds_read_b64_tr_b16 a[178:179], v12 offset:36864
    v_cvt_pk_bf16_f32 v138, v88, v89
    v_mfma_f32_16x16x32_bf16 v[36:39], a[144:147], v[176:179], v[100:103]
    v_exp_f32 v90, v90
    v_mfma_f32_16x16x32_bf16 v[36:39], a[148:151], v[180:183], v[36:39]
    ds_read_b64_tr_b16 a[180:181], v12 offset:40960
    v_mfma_f32_16x16x32_bf16 v[36:39], a[152:155], v[184:187], v[36:39]
    v_exp_f32 v91, v91
    v_mfma_f32_16x16x32_bf16 v[36:39], a[156:159], v[188:191], v[36:39]
    ds_read_b64_tr_b16 a[182:183], v12 offset:45056
    v_cvt_pk_bf16_f32 v139, v90, v91
    v_mfma_f32_16x16x32_bf16 v[40:43], a[144:147], v[192:195], v[104:107]
    v_exp_f32 v92, v92
    v_mfma_f32_16x16x32_bf16 v[40:43], a[148:151], v[196:199], v[40:43]
    ds_read_b64_tr_b16 a[184:185], v13 offset:32768
    v_mfma_f32_16x16x32_bf16 v[40:43], a[152:155], v[200:203], v[40:43]
    v_exp_f32 v93, v93
    v_mfma_f32_16x16x32_bf16 v[40:43], a[156:159], v[204:207], v[40:43]
    ds_read_b64_tr_b16 a[186:187], v13 offset:36864
    v_cvt_pk_bf16_f32 v142, v92, v93
    v_mfma_f32_16x16x32_bf16 v[44:47], a[144:147], v[208:211], v[108:111]
    v_exp_f32 v94, v94
    v_mfma_f32_16x16x32_bf16 v[44:47], a[148:151], v[212:215], v[44:47]
    ds_read_b64_tr_b16 a[188:189], v13 offset:40960
    v_mfma_f32_16x16x32_bf16 v[44:47], a[152:155], v[216:219], v[44:47]
    v_exp_f32 v95, v95
    v_mfma_f32_16x16x32_bf16 v[44:47], a[156:159], v[220:223], v[44:47]
    ds_read_b64_tr_b16 a[190:191], v13 offset:45056
    v_cvt_pk_bf16_f32 v143, v94, v95
    s_waitcnt lgkmcnt(4)
    v_mfma_f32_16x16x32_bf16 v[48:51], a[160:163], v[160:163], v[96:99]
    s_waitcnt vmcnt(4)
    ds_read_b64_tr_b16 a[208:209], v253 offset:0
    v_mfma_f32_16x16x32_bf16 v[48:51], a[164:167], v[164:167], v[48:51]
    ds_read_b64_tr_b16 a[192:193], v14 offset:32768
    v_mfma_f32_16x16x32_bf16 v[48:51], a[168:171], v[168:171], v[48:51]
    ds_read_b64_tr_b16 a[210:211], v253 offset:2560
    v_mfma_f32_16x16x32_bf16 v[48:51], a[172:175], v[172:175], v[48:51]
    ds_read_b64_tr_b16 a[194:195], v14 offset:36864
    v_mfma_f32_16x16x32_bf16 v[52:55], a[160:163], v[176:179], v[100:103]
    v_exp_f32 v32, v32
    v_mfma_f32_16x16x32_bf16 v[52:55], a[164:167], v[180:183], v[52:55]
    ds_read_b64_tr_b16 a[196:197], v14 offset:40960
    v_mfma_f32_16x16x32_bf16 v[52:55], a[168:171], v[184:187], v[52:55]
    v_exp_f32 v33, v33
    v_mfma_f32_16x16x32_bf16 v[52:55], a[172:175], v[188:191], v[52:55]
    ds_read_b64_tr_b16 a[198:199], v14 offset:45056
    v_cvt_pk_bf16_f32 v144, v32, v33
    v_mfma_f32_16x16x32_bf16 v[56:59], a[160:163], v[192:195], v[104:107]
    v_exp_f32 v34, v34
    v_mfma_f32_16x16x32_bf16 v[56:59], a[164:167], v[196:199], v[56:59]
    ds_read_b64_tr_b16 a[200:201], v15 offset:32768
    v_mfma_f32_16x16x32_bf16 v[56:59], a[168:171], v[200:203], v[56:59]
    v_exp_f32 v35, v35
    v_mfma_f32_16x16x32_bf16 v[56:59], a[172:175], v[204:207], v[56:59]
    ds_read_b64_tr_b16 a[202:203], v15 offset:36864
    v_cvt_pk_bf16_f32 v145, v34, v35
    v_mfma_f32_16x16x32_bf16 v[60:63], a[160:163], v[208:211], v[108:111]
    v_exp_f32 v36, v36
    v_mfma_f32_16x16x32_bf16 v[60:63], a[164:167], v[212:215], v[60:63]
    ds_read_b64_tr_b16 a[204:205], v15 offset:40960
    v_mfma_f32_16x16x32_bf16 v[60:63], a[168:171], v[216:219], v[60:63]
    v_exp_f32 v37, v37
    v_mfma_f32_16x16x32_bf16 v[60:63], a[172:175], v[220:223], v[60:63]
    ds_read_b64_tr_b16 a[206:207], v15 offset:45056
    v_cvt_pk_bf16_f32 v148, v36, v37
    v_mfma_f32_16x16x32_bf16 a[0:3], a[176:179], v[112:115], a[0:3]
    v_exp_f32 v38, v38
    v_mfma_f32_16x16x32_bf16 a[0:3], a[180:183], v[128:131], a[0:3]
    ds_read_b64_tr_b16 a[212:213], v253 offset:32
    v_mfma_f32_16x16x32_bf16 a[4:7], a[176:179], v[116:119], a[4:7]
    v_exp_f32 v39, v39
    v_mfma_f32_16x16x32_bf16 a[4:7], a[180:183], v[132:135], a[4:7]
    ds_read_b128 a[144:147], v8 offset:57344
    v_cvt_pk_bf16_f32 v149, v38, v39
    v_mfma_f32_16x16x32_bf16 a[8:11], a[176:179], v[120:123], a[8:11]
    v_exp_f32 v40, v40
    v_mfma_f32_16x16x32_bf16 a[8:11], a[180:183], v[136:139], a[8:11]
    v_mfma_f32_16x16x32_bf16 a[12:15], a[176:179], v[124:127], a[12:15]
    v_exp_f32 v41, v41
    v_mfma_f32_16x16x32_bf16 a[12:15], a[180:183], v[140:143], a[12:15]
    ds_read_b128 a[148:151], v9 offset:57344
    v_cvt_pk_bf16_f32 v152, v40, v41
    s_waitcnt lgkmcnt(4)
    v_mfma_f32_16x16x32_bf16 a[16:19], a[184:187], v[112:115], a[16:19]
    v_exp_f32 v42, v42
    v_mfma_f32_16x16x32_bf16 a[16:19], a[188:191], v[128:131], a[16:19]
    ds_read_b64_tr_b16 a[214:215], v253 offset:2592
    v_mfma_f32_16x16x32_bf16 a[20:23], a[184:187], v[116:119], a[20:23]
    v_exp_f32 v43, v43
    v_mfma_f32_16x16x32_bf16 a[20:23], a[188:191], v[132:135], a[20:23]
    ds_read_b128 a[152:155], v10 offset:57344
    v_cvt_pk_bf16_f32 v153, v42, v43
    v_mfma_f32_16x16x32_bf16 a[24:27], a[184:187], v[120:123], a[24:27]
    v_exp_f32 v44, v44
    v_mfma_f32_16x16x32_bf16 a[24:27], a[188:191], v[136:139], a[24:27]
    v_mfma_f32_16x16x32_bf16 a[28:31], a[184:187], v[124:127], a[28:31]
    v_exp_f32 v45, v45
    v_mfma_f32_16x16x32_bf16 a[28:31], a[188:191], v[140:143], a[28:31]
    ds_read_b128 a[156:159], v11 offset:57344
    v_cvt_pk_bf16_f32 v156, v44, v45
    v_mfma_f32_16x16x32_bf16 a[32:35], a[192:195], v[112:115], a[32:35]
    v_exp_f32 v46, v46
    v_mfma_f32_16x16x32_bf16 a[32:35], a[196:199], v[128:131], a[32:35]
    ds_read_b64_tr_b16 a[216:217], v253 offset:64
    v_mfma_f32_16x16x32_bf16 a[36:39], a[192:195], v[116:119], a[36:39]
    v_exp_f32 v47, v47
    v_mfma_f32_16x16x32_bf16 a[36:39], a[196:199], v[132:135], a[36:39]
    ds_read_b128 a[160:163], v8 offset:61440
    v_cvt_pk_bf16_f32 v157, v46, v47
    v_mfma_f32_16x16x32_bf16 a[40:43], a[192:195], v[120:123], a[40:43]
    v_exp_f32 v48, v48
    v_mfma_f32_16x16x32_bf16 a[40:43], a[196:199], v[136:139], a[40:43]
    v_mfma_f32_16x16x32_bf16 a[44:47], a[192:195], v[124:127], a[44:47]
    v_exp_f32 v49, v49
    v_mfma_f32_16x16x32_bf16 a[44:47], a[196:199], v[140:143], a[44:47]
    ds_read_b128 a[164:167], v9 offset:61440
    v_cvt_pk_bf16_f32 v146, v48, v49
    v_mfma_f32_16x16x32_bf16 a[48:51], a[200:203], v[112:115], a[48:51]
    v_exp_f32 v50, v50
    s_waitcnt lgkmcnt(3)
    v_mfma_f32_16x16x32_bf16 a[48:51], a[204:207], v[128:131], a[48:51]
    ds_read_b64_tr_b16 a[218:219], v253 offset:2624
    v_mfma_f32_16x16x32_bf16 a[52:55], a[200:203], v[116:119], a[52:55]
    v_exp_f32 v51, v51
    v_mfma_f32_16x16x32_bf16 a[52:55], a[204:207], v[132:135], a[52:55]
    ds_read_b128 a[168:171], v10 offset:61440
    v_cvt_pk_bf16_f32 v147, v50, v51
    v_mfma_f32_16x16x32_bf16 a[56:59], a[200:203], v[120:123], a[56:59]
    v_exp_f32 v52, v52
    v_mfma_f32_16x16x32_bf16 a[56:59], a[204:207], v[136:139], a[56:59]
    v_mfma_f32_16x16x32_bf16 a[60:63], a[200:203], v[124:127], a[60:63]
    v_exp_f32 v53, v53
    v_mfma_f32_16x16x32_bf16 a[60:63], a[204:207], v[140:143], a[60:63]
    ds_read_b128 a[172:175], v11 offset:61440
    v_cvt_pk_bf16_f32 v150, v52, v53
    v_mfma_f32_16x16x32_bf16 a[128:131], v[28:31], v[112:115], a[128:131]
    v_exp_f32 v54, v54
    v_mfma_f32_16x16x32_bf16 a[128:131], v[28:31], v[128:131], a[128:131]
    ds_read_b64_tr_b16 a[220:221], v253 offset:96
    v_mfma_f32_16x16x32_bf16 a[132:135], v[28:31], v[116:119], a[132:135]
    v_exp_f32 v55, v55
    v_mfma_f32_16x16x32_bf16 a[132:135], v[28:31], v[132:135], a[132:135]
    v_cvt_pk_bf16_f32 v151, v54, v55
    s_waitcnt vmcnt(0) lgkmcnt(2)
    s_barrier
    v_mfma_f32_16x16x32_bf16 v[64:67], a[144:147], v[160:163], v[96:99]
    v_exp_f32 v56, v56
    v_mfma_f32_16x16x32_bf16 v[64:67], a[148:151], v[164:167], v[64:67]
    ds_read_b64_tr_b16 a[176:177], v16 offset:32768
    v_mfma_f32_16x16x32_bf16 v[64:67], a[152:155], v[168:171], v[64:67]
    v_exp_f32 v57, v57
    v_mfma_f32_16x16x32_bf16 v[64:67], a[156:159], v[172:175], v[64:67]
    ds_read_b64_tr_b16 a[178:179], v16 offset:36864
    v_cvt_pk_bf16_f32 v154, v56, v57
    v_mfma_f32_16x16x32_bf16 v[68:71], a[144:147], v[176:179], v[100:103]
    v_exp_f32 v58, v58
    v_mfma_f32_16x16x32_bf16 v[68:71], a[148:151], v[180:183], v[68:71]
    ds_read_b64_tr_b16 a[180:181], v16 offset:40960
    v_mfma_f32_16x16x32_bf16 v[68:71], a[152:155], v[184:187], v[68:71]
    v_exp_f32 v59, v59
    v_mfma_f32_16x16x32_bf16 v[68:71], a[156:159], v[188:191], v[68:71]
    ds_read_b64_tr_b16 a[182:183], v16 offset:45056
    v_cvt_pk_bf16_f32 v155, v58, v59
    v_mfma_f32_16x16x32_bf16 v[72:75], a[144:147], v[192:195], v[104:107]
    v_exp_f32 v60, v60
    v_mfma_f32_16x16x32_bf16 v[72:75], a[148:151], v[196:199], v[72:75]
    ds_read_b64_tr_b16 a[184:185], v17 offset:32768
    v_mfma_f32_16x16x32_bf16 v[72:75], a[152:155], v[200:203], v[72:75]
    v_exp_f32 v61, v61
    v_mfma_f32_16x16x32_bf16 v[72:75], a[156:159], v[204:207], v[72:75]
    ds_read_b64_tr_b16 a[186:187], v17 offset:36864
    v_cvt_pk_bf16_f32 v158, v60, v61
    v_mfma_f32_16x16x32_bf16 v[76:79], a[144:147], v[208:211], v[108:111]
    v_exp_f32 v62, v62
    v_mfma_f32_16x16x32_bf16 v[76:79], a[148:151], v[212:215], v[76:79]
    ds_read_b64_tr_b16 a[188:189], v17 offset:40960
    v_mfma_f32_16x16x32_bf16 v[76:79], a[152:155], v[216:219], v[76:79]
    v_exp_f32 v63, v63
    v_mfma_f32_16x16x32_bf16 v[76:79], a[156:159], v[220:223], v[76:79]
    ds_read_b64_tr_b16 a[190:191], v17 offset:45056
    v_cvt_pk_bf16_f32 v159, v62, v63
    v_mfma_f32_16x16x32_bf16 v[80:83], a[160:163], v[160:163], v[96:99]
    ds_read_b64_tr_b16 a[222:223], v253 offset:2656
    v_mfma_f32_16x16x32_bf16 v[80:83], a[164:167], v[164:167], v[80:83]
    ds_read_b64_tr_b16 a[192:193], v18 offset:32768
    v_mfma_f32_16x16x32_bf16 v[80:83], a[168:171], v[168:171], v[80:83]
    ds_read_b64_tr_b16 a[224:225], v253 offset:128
    s_waitcnt lgkmcnt(6)
    v_mfma_f32_16x16x32_bf16 v[80:83], a[172:175], v[172:175], v[80:83]
    ds_read_b64_tr_b16 a[194:195], v18 offset:36864
    v_mfma_f32_16x16x32_bf16 v[84:87], a[160:163], v[176:179], v[100:103]
    v_exp_f32 v64, v64
    v_mfma_f32_16x16x32_bf16 v[84:87], a[164:167], v[180:183], v[84:87]
    ds_read_b64_tr_b16 a[196:197], v18 offset:40960
    v_mfma_f32_16x16x32_bf16 v[84:87], a[168:171], v[184:187], v[84:87]
    v_exp_f32 v65, v65
    v_mfma_f32_16x16x32_bf16 v[84:87], a[172:175], v[188:191], v[84:87]
    ds_read_b64_tr_b16 a[198:199], v18 offset:45056
    v_cvt_pk_bf16_f32 v224, v64, v65
    v_mfma_f32_16x16x32_bf16 v[88:91], a[160:163], v[192:195], v[104:107]
    v_exp_f32 v66, v66
    v_mfma_f32_16x16x32_bf16 v[88:91], a[164:167], v[196:199], v[88:91]
    ds_read_b64_tr_b16 a[200:201], v19 offset:32768
    v_mfma_f32_16x16x32_bf16 v[88:91], a[168:171], v[200:203], v[88:91]
    v_exp_f32 v67, v67
    v_mfma_f32_16x16x32_bf16 v[88:91], a[172:175], v[204:207], v[88:91]
    ds_read_b64_tr_b16 a[202:203], v19 offset:36864
    v_cvt_pk_bf16_f32 v225, v66, v67
    v_mfma_f32_16x16x32_bf16 v[92:95], a[160:163], v[208:211], v[108:111]
    v_exp_f32 v68, v68
    v_mfma_f32_16x16x32_bf16 v[92:95], a[164:167], v[212:215], v[92:95]
    ds_read_b64_tr_b16 a[204:205], v19 offset:40960
    v_mfma_f32_16x16x32_bf16 v[92:95], a[168:171], v[216:219], v[92:95]
    v_exp_f32 v69, v69
    v_mfma_f32_16x16x32_bf16 v[92:95], a[172:175], v[220:223], v[92:95]
    ds_read_b64_tr_b16 a[206:207], v19 offset:45056
    v_cvt_pk_bf16_f32 v228, v68, v69
    v_mfma_f32_16x16x32_bf16 a[64:67], a[176:179], v[112:115], a[64:67]
    v_exp_f32 v70, v70
    v_mfma_f32_16x16x32_bf16 a[64:67], a[180:183], v[128:131], a[64:67]
    ds_read_b64_tr_b16 a[226:227], v253 offset:2688
    v_mfma_f32_16x16x32_bf16 a[68:71], a[176:179], v[116:119], a[68:71]
    v_exp_f32 v71, v71
    v_mfma_f32_16x16x32_bf16 a[68:71], a[180:183], v[132:135], a[68:71]
    v_cvt_pk_bf16_f32 v229, v70, v71
    v_mfma_f32_16x16x32_bf16 a[72:75], a[176:179], v[120:123], a[72:75]
    v_exp_f32 v72, v72
    v_mfma_f32_16x16x32_bf16 a[72:75], a[180:183], v[136:139], a[72:75]
    v_mfma_f32_16x16x32_bf16 a[76:79], a[176:179], v[124:127], a[76:79]
    v_exp_f32 v73, v73
    v_mfma_f32_16x16x32_bf16 a[76:79], a[180:183], v[140:143], a[76:79]
    v_cvt_pk_bf16_f32 v232, v72, v73
    s_waitcnt lgkmcnt(2)
    v_mfma_f32_16x16x32_bf16 a[80:83], a[184:187], v[112:115], a[80:83]
    v_exp_f32 v74, v74
    v_mfma_f32_16x16x32_bf16 a[80:83], a[188:191], v[128:131], a[80:83]
    v_mfma_f32_16x16x32_bf16 a[84:87], a[184:187], v[116:119], a[84:87]
    v_exp_f32 v75, v75
    v_mfma_f32_16x16x32_bf16 a[84:87], a[188:191], v[132:135], a[84:87]
    v_cvt_pk_bf16_f32 v233, v74, v75
    v_mfma_f32_16x16x32_bf16 a[88:91], a[184:187], v[120:123], a[88:91]
    v_exp_f32 v76, v76
    v_mfma_f32_16x16x32_bf16 a[88:91], a[188:191], v[136:139], a[88:91]
    v_mfma_f32_16x16x32_bf16 a[92:95], a[184:187], v[124:127], a[92:95]
    v_exp_f32 v77, v77
    v_mfma_f32_16x16x32_bf16 a[92:95], a[188:191], v[140:143], a[92:95]
    v_cvt_pk_bf16_f32 v236, v76, v77
    v_mfma_f32_16x16x32_bf16 a[96:99], a[192:195], v[112:115], a[96:99]
    v_exp_f32 v78, v78
    v_mfma_f32_16x16x32_bf16 a[96:99], a[196:199], v[128:131], a[96:99]
    v_mfma_f32_16x16x32_bf16 a[100:103], a[192:195], v[116:119], a[100:103]
    v_exp_f32 v79, v79
    v_mfma_f32_16x16x32_bf16 a[100:103], a[196:199], v[132:135], a[100:103]
    v_cvt_pk_bf16_f32 v237, v78, v79
    v_mfma_f32_16x16x32_bf16 a[104:107], a[192:195], v[120:123], a[104:107]
    v_exp_f32 v80, v80
    v_mfma_f32_16x16x32_bf16 a[104:107], a[196:199], v[136:139], a[104:107]
    v_mfma_f32_16x16x32_bf16 a[108:111], a[192:195], v[124:127], a[108:111]
    v_exp_f32 v81, v81
    v_mfma_f32_16x16x32_bf16 a[108:111], a[196:199], v[140:143], a[108:111]
    v_cvt_pk_bf16_f32 v226, v80, v81
    v_mfma_f32_16x16x32_bf16 a[112:115], a[200:203], v[112:115], a[112:115]
    v_exp_f32 v82, v82
    s_waitcnt lgkmcnt(0)
    v_mfma_f32_16x16x32_bf16 a[112:115], a[204:207], v[128:131], a[112:115]
    v_mfma_f32_16x16x32_bf16 a[116:119], a[200:203], v[116:119], a[116:119]
    v_exp_f32 v83, v83
    v_mfma_f32_16x16x32_bf16 a[116:119], a[204:207], v[132:135], a[116:119]
    v_cvt_pk_bf16_f32 v227, v82, v83
    v_mfma_f32_16x16x32_bf16 a[120:123], a[200:203], v[120:123], a[120:123]
    v_exp_f32 v84, v84
    v_mfma_f32_16x16x32_bf16 a[120:123], a[204:207], v[136:139], a[120:123]
    v_mfma_f32_16x16x32_bf16 a[124:127], a[200:203], v[124:127], a[124:127]
    v_exp_f32 v85, v85
    v_mfma_f32_16x16x32_bf16 a[124:127], a[204:207], v[140:143], a[124:127]
    v_cvt_pk_bf16_f32 v230, v84, v85
    v_mfma_f32_16x16x32_bf16 a[136:139], v[28:31], v[120:123], a[136:139]
    v_exp_f32 v86, v86
    v_mfma_f32_16x16x32_bf16 a[136:139], v[28:31], v[136:139], a[136:139]
    v_mfma_f32_16x16x32_bf16 a[140:143], v[28:31], v[124:127], a[140:143]
    v_exp_f32 v87, v87
    v_mfma_f32_16x16x32_bf16 a[140:143], v[28:31], v[140:143], a[140:143]
    v_cvt_pk_bf16_f32 v231, v86, v87
    v_exp_f32 v88, v88
    ds_read_b64_tr_b16 a[176:177], v12 offset:49152
    v_exp_f32 v89, v89
    ds_read_b64_tr_b16 a[178:179], v12 offset:53248
    v_cvt_pk_bf16_f32 v234, v88, v89
    v_exp_f32 v90, v90
    ds_read_b64_tr_b16 a[180:181], v12 offset:57344
    v_exp_f32 v91, v91
    ds_read_b64_tr_b16 a[182:183], v12 offset:61440
    v_cvt_pk_bf16_f32 v235, v90, v91
    v_exp_f32 v92, v92
    ds_read_b64_tr_b16 a[184:185], v13 offset:49152
    v_exp_f32 v93, v93
    ds_read_b64_tr_b16 a[186:187], v13 offset:53248
    v_cvt_pk_bf16_f32 v238, v92, v93
    v_exp_f32 v94, v94
    ds_read_b64_tr_b16 a[188:189], v13 offset:57344
    v_exp_f32 v95, v95
    ds_read_b64_tr_b16 a[190:191], v13 offset:61440
    v_cvt_pk_bf16_f32 v239, v94, v95
    s_add_u32 s46, s95, 0
    buffer_store_dwordx4 a[208:211], v240, s[40:43], s46 offen sc1
    ds_read_b64_tr_b16 a[192:193], v14 offset:49152
    s_add_u32 s46, s95, 1024
    buffer_store_dwordx4 a[212:215], v240, s[40:43], s46 offen sc1
    ds_read_b64_tr_b16 a[194:195], v14 offset:53248
    ds_read_b64_tr_b16 a[196:197], v14 offset:57344
    ds_read_b64_tr_b16 a[198:199], v14 offset:61440
    ds_read_b64_tr_b16 a[200:201], v15 offset:49152
    ds_read_b64_tr_b16 a[202:203], v15 offset:53248
    ds_read_b64_tr_b16 a[204:205], v15 offset:57344
    ds_read_b64_tr_b16 a[206:207], v15 offset:61440
    s_waitcnt lgkmcnt(11)
    v_mfma_f32_16x16x32_bf16 a[0:3], a[176:179], v[144:147], a[0:3]
    v_mfma_f32_16x16x32_bf16 a[0:3], a[180:183], v[224:227], a[0:3]
    s_add_u32 s46, s95, 2048
    buffer_store_dwordx4 a[216:219], v240, s[40:43], s46 offen sc1
    v_mfma_f32_16x16x32_bf16 a[4:7], a[176:179], v[148:151], a[4:7]
    v_mfma_f32_16x16x32_bf16 a[4:7], a[180:183], v[228:231], a[4:7]
    v_mfma_f32_16x16x32_bf16 a[8:11], a[176:179], v[152:155], a[8:11]
    v_mfma_f32_16x16x32_bf16 a[8:11], a[180:183], v[232:235], a[8:11]
    v_mfma_f32_16x16x32_bf16 a[12:15], a[176:179], v[156:159], a[12:15]
    v_mfma_f32_16x16x32_bf16 a[12:15], a[180:183], v[236:239], a[12:15]
    s_waitcnt lgkmcnt(7)
    v_mfma_f32_16x16x32_bf16 a[16:19], a[184:187], v[144:147], a[16:19]
    v_mfma_f32_16x16x32_bf16 a[16:19], a[188:191], v[224:227], a[16:19]
    s_add_u32 s46, s95, 3072
    buffer_store_dwordx4 a[220:223], v240, s[40:43], s46 offen sc1
    v_mfma_f32_16x16x32_bf16 a[20:23], a[184:187], v[148:151], a[20:23]
    v_mfma_f32_16x16x32_bf16 a[20:23], a[188:191], v[228:231], a[20:23]
    v_mfma_f32_16x16x32_bf16 a[24:27], a[184:187], v[152:155], a[24:27]
    v_mfma_f32_16x16x32_bf16 a[24:27], a[188:191], v[232:235], a[24:27]
    v_mfma_f32_16x16x32_bf16 a[28:31], a[184:187], v[156:159], a[28:31]
    v_mfma_f32_16x16x32_bf16 a[28:31], a[188:191], v[236:239], a[28:31]
    s_waitcnt lgkmcnt(0)
    v_mfma_f32_16x16x32_bf16 a[32:35], a[192:195], v[144:147], a[32:35]
    v_mfma_f32_16x16x32_bf16 a[32:35], a[196:199], v[224:227], a[32:35]
    s_add_u32 s46, s95, 4096
    buffer_store_dwordx4 a[224:227], v240, s[40:43], s46 offen sc1
    v_mfma_f32_16x16x32_bf16 a[36:39], a[192:195], v[148:151], a[36:39]
    v_mfma_f32_16x16x32_bf16 a[36:39], a[196:199], v[228:231], a[36:39]
    v_mfma_f32_16x16x32_bf16 a[40:43], a[192:195], v[152:155], a[40:43]
    v_mfma_f32_16x16x32_bf16 a[40:43], a[196:199], v[232:235], a[40:43]
    v_mfma_f32_16x16x32_bf16 a[44:47], a[192:195], v[156:159], a[44:47]
    v_mfma_f32_16x16x32_bf16 a[44:47], a[196:199], v[236:239], a[44:47]
    v_mfma_f32_16x16x32_bf16 a[48:51], a[200:203], v[144:147], a[48:51]
    v_mfma_f32_16x16x32_bf16 a[48:51], a[204:207], v[224:227], a[48:51]
    v_mfma_f32_16x16x32_bf16 a[52:55], a[200:203], v[148:151], a[52:55]
    v_mfma_f32_16x16x32_bf16 a[52:55], a[204:207], v[228:231], a[52:55]
    v_mfma_f32_16x16x32_bf16 a[56:59], a[200:203], v[152:155], a[56:59]
    v_mfma_f32_16x16x32_bf16 a[56:59], a[204:207], v[232:235], a[56:59]
    v_mfma_f32_16x16x32_bf16 a[60:63], a[200:203], v[156:159], a[60:63]
    v_mfma_f32_16x16x32_bf16 a[60:63], a[204:207], v[236:239], a[60:63]
    v_mfma_f32_16x16x32_bf16 a[128:131], v[28:31], v[144:147], a[128:131]
    v_mfma_f32_16x16x32_bf16 a[128:131], v[28:31], v[224:227], a[128:131]
    v_mfma_f32_16x16x32_bf16 a[132:135], v[28:31], v[148:151], a[132:135]
    v_mfma_f32_16x16x32_bf16 a[132:135], v[28:31], v[228:231], a[132:135]
    ds_read_b64_tr_b16 a[176:177], v16 offset:49152
    ds_read_b64_tr_b16 a[178:179], v16 offset:53248
    ds_read_b64_tr_b16 a[180:181], v16 offset:57344
    ds_read_b64_tr_b16 a[182:183], v16 offset:61440
    ds_read_b64_tr_b16 a[184:185], v17 offset:49152
    ds_read_b64_tr_b16 a[186:187], v17 offset:53248
    ds_read_b64_tr_b16 a[188:189], v17 offset:57344
    ds_read_b64_tr_b16 a[190:191], v17 offset:61440
    ds_read_b64_tr_b16 a[192:193], v18 offset:49152
    ds_read_b64_tr_b16 a[194:195], v18 offset:53248
    ds_read_b64_tr_b16 a[196:197], v18 offset:57344
    ds_read_b64_tr_b16 a[198:199], v18 offset:61440
    ds_read_b64_tr_b16 a[200:201], v19 offset:49152
    ds_read_b64_tr_b16 a[202:203], v19 offset:53248
    ds_read_b64_tr_b16 a[204:205], v19 offset:57344
    ds_read_b64_tr_b16 a[206:207], v19 offset:61440
    s_waitcnt lgkmcnt(14)
    v_mfma_f32_16x16x32_bf16 a[64:67], a[176:179], v[144:147], a[64:67]
    s_waitcnt lgkmcnt(12)
    v_mfma_f32_16x16x32_bf16 a[64:67], a[180:183], v[224:227], a[64:67]
    v_mfma_f32_16x16x32_bf16 a[68:71], a[176:179], v[148:151], a[68:71]
    v_mfma_f32_16x16x32_bf16 a[68:71], a[180:183], v[228:231], a[68:71]
    v_mfma_f32_16x16x32_bf16 a[72:75], a[176:179], v[152:155], a[72:75]
    v_mfma_f32_16x16x32_bf16 a[72:75], a[180:183], v[232:235], a[72:75]
    v_mfma_f32_16x16x32_bf16 a[76:79], a[176:179], v[156:159], a[76:79]
    v_mfma_f32_16x16x32_bf16 a[76:79], a[180:183], v[236:239], a[76:79]
    s_waitcnt lgkmcnt(10)
    v_mfma_f32_16x16x32_bf16 a[80:83], a[184:187], v[144:147], a[80:83]
    s_waitcnt lgkmcnt(8)
    v_mfma_f32_16x16x32_bf16 a[80:83], a[188:191], v[224:227], a[80:83]
    v_mfma_f32_16x16x32_bf16 a[84:87], a[184:187], v[148:151], a[84:87]
    v_mfma_f32_16x16x32_bf16 a[84:87], a[188:191], v[228:231], a[84:87]
    v_mfma_f32_16x16x32_bf16 a[88:91], a[184:187], v[152:155], a[88:91]
    v_mfma_f32_16x16x32_bf16 a[88:91], a[188:191], v[232:235], a[88:91]
    v_mfma_f32_16x16x32_bf16 a[92:95], a[184:187], v[156:159], a[92:95]
    v_mfma_f32_16x16x32_bf16 a[92:95], a[188:191], v[236:239], a[92:95]
    s_waitcnt lgkmcnt(3)
    v_mfma_f32_16x16x32_bf16 a[96:99], a[192:195], v[144:147], a[96:99]
    v_mfma_f32_16x16x32_bf16 a[96:99], a[196:199], v[224:227], a[96:99]
    v_mfma_f32_16x16x32_bf16 a[100:103], a[192:195], v[148:151], a[100:103]
    v_mfma_f32_16x16x32_bf16 a[100:103], a[196:199], v[228:231], a[100:103]
    v_mfma_f32_16x16x32_bf16 a[104:107], a[192:195], v[152:155], a[104:107]
    v_mfma_f32_16x16x32_bf16 a[104:107], a[196:199], v[232:235], a[104:107]
    v_mfma_f32_16x16x32_bf16 a[108:111], a[192:195], v[156:159], a[108:111]
    v_mfma_f32_16x16x32_bf16 a[108:111], a[196:199], v[236:239], a[108:111]
    s_waitcnt lgkmcnt(0)
    v_mfma_f32_16x16x32_bf16 a[112:115], a[200:203], v[144:147], a[112:115]
    v_mfma_f32_16x16x32_bf16 a[112:115], a[204:207], v[224:227], a[112:115]
    v_mfma_f32_16x16x32_bf16 a[116:119], a[200:203], v[148:151], a[116:119]
    v_mfma_f32_16x16x32_bf16 a[116:119], a[204:207], v[228:231], a[116:119]
    v_mfma_f32_16x16x32_bf16 a[120:123], a[200:203], v[152:155], a[120:123]
    v_mfma_f32_16x16x32_bf16 a[120:123], a[204:207], v[232:235], a[120:123]
    v_mfma_f32_16x16x32_bf16 a[124:127], a[200:203], v[156:159], a[124:127]
    v_mfma_f32_16x16x32_bf16 a[124:127], a[204:207], v[236:239], a[124:127]
    v_mfma_f32_16x16x32_bf16 a[136:139], v[28:31], v[152:155], a[136:139]
    v_mfma_f32_16x16x32_bf16 a[136:139], v[28:31], v[232:235], a[136:139]
    v_mfma_f32_16x16x32_bf16 a[140:143], v[28:31], v[156:159], a[140:143]
    v_mfma_f32_16x16x32_bf16 a[140:143], v[28:31], v[236:239], a[140:143]
    s_waitcnt lgkmcnt(0)
    s_nop 7
    v_accvgpr_read_b32 v4, a128
    v_accvgpr_read_b32 v5, a132
    v_accvgpr_read_b32 v6, a136
    v_accvgpr_read_b32 v7, a140
    v_max3_f32 v2, v4, v5, v6
    v_max_f32 v2, v2, v7
    v_add_f32 v3, v4, v5
    v_add_f32 v3, v3, v6
    v_add_f32 v3, v3, v7
    v_fmac_f32 v2, 0, v3
    v_mov_b32 v3, 0
    v_rcp_f32 v4, v4
    v_rcp_f32 v5, v5
    v_rcp_f32 v6, v6
    v_rcp_f32 v7, v7
    s_lshl_b32 s55, s4, 12
    s_add_u32 s55, s55, s52
    v_accvgpr_read_b32 v32, a0
    v_accvgpr_read_b32 v33, a1
    v_accvgpr_read_b32 v34, a2
    v_accvgpr_read_b32 v35, a3
    v_accvgpr_read_b32 v36, a16
    v_accvgpr_read_b32 v37, a17
    v_accvgpr_read_b32 v38, a18
    v_accvgpr_read_b32 v39, a19
    v_pk_fma_f32 v[2:3], v[32:33], 0, v[2:3] op_sel_hi:[1,0,1]
    v_pk_fma_f32 v[2:3], v[34:35], 0, v[2:3] op_sel_hi:[1,0,1]
    v_pk_fma_f32 v[2:3], v[36:37], 0, v[2:3] op_sel_hi:[1,0,1]
    v_pk_fma_f32 v[2:3], v[38:39], 0, v[2:3] op_sel_hi:[1,0,1]
    v_pk_mul_f32 v[32:33], v[32:33], v[4:5] op_sel:[0,0] op_sel_hi:[1,0]
    v_pk_mul_f32 v[34:35], v[34:35], v[4:5] op_sel:[0,0] op_sel_hi:[1,0]
    v_pk_mul_f32 v[36:37], v[36:37], v[4:5] op_sel:[0,0] op_sel_hi:[1,0]
    v_pk_mul_f32 v[38:39], v[38:39], v[4:5] op_sel:[0,0] op_sel_hi:[1,0]
    v_cvt_pk_bf16_f32 v8, v32, v33
    v_cvt_pk_bf16_f32 v9, v34, v35
    v_cvt_pk_bf16_f32 v10, v36, v37
    v_cvt_pk_bf16_f32 v11, v38, v39
    buffer_store_dwordx4 v[8:11], v240, s[28:31], s55 offen offset:0 sc1
    v_accvgpr_read_b32 v40, a32
    v_accvgpr_read_b32 v41, a33
    v_accvgpr_read_b32 v42, a34
    v_accvgpr_read_b32 v43, a35
    v_accvgpr_read_b32 v44, a48
    v_accvgpr_read_b32 v45, a49
    v_accvgpr_read_b32 v46, a50
    v_accvgpr_read_b32 v47, a51
    v_pk_fma_f32 v[2:3], v[40:41], 0, v[2:3] op_sel_hi:[1,0,1]
    v_pk_fma_f32 v[2:3], v[42:43], 0, v[2:3] op_sel_hi:[1,0,1]
    v_pk_fma_f32 v[2:3], v[44:45], 0, v[2:3] op_sel_hi:[1,0,1]
    v_pk_fma_f32 v[2:3], v[46:47], 0, v[2:3] op_sel_hi:[1,0,1]
    v_pk_mul_f32 v[40:41], v[40:41], v[4:5] op_sel:[0,0] op_sel_hi:[1,0]
    v_pk_mul_f32 v[42:43], v[42:43], v[4:5] op_sel:[0,0] op_sel_hi:[1,0]
    v_pk_mul_f32 v[44:45], v[44:45], v[4:5] op_sel:[0,0] op_sel_hi:[1,0]
    v_pk_mul_f32 v[46:47], v[46:47], v[4:5] op_sel:[0,0] op_sel_hi:[1,0]
    v_cvt_pk_bf16_f32 v12, v40, v41
    v_cvt_pk_bf16_f32 v13, v42, v43
    v_cvt_pk_bf16_f32 v14, v44, v45
    v_cvt_pk_bf16_f32 v15, v46, v47
    buffer_store_dwordx4 v[12:15], v240, s[28:31], s55 offen offset:1024 sc1
    v_accvgpr_read_b32 v48, a64
    v_accvgpr_read_b32 v49, a65
    v_accvgpr_read_b32 v50, a66
    v_accvgpr_read_b32 v51, a67
    v_accvgpr_read_b32 v52, a80
    v_accvgpr_read_b32 v53, a81
    v_accvgpr_read_b32 v54, a82
    v_accvgpr_read_b32 v55, a83
    v_pk_fma_f32 v[2:3], v[48:49], 0, v[2:3] op_sel_hi:[1,0,1]
    v_pk_fma_f32 v[2:3], v[50:51], 0, v[2:3] op_sel_hi:[1,0,1]
    v_pk_fma_f32 v[2:3], v[52:53], 0, v[2:3] op_sel_hi:[1,0,1]
    v_pk_fma_f32 v[2:3], v[54:55], 0, v[2:3] op_sel_hi:[1,0,1]
    v_pk_mul_f32 v[48:49], v[48:49], v[4:5] op_sel:[0,0] op_sel_hi:[1,0]
    v_pk_mul_f32 v[50:51], v[50:51], v[4:5] op_sel:[0,0] op_sel_hi:[1,0]
    v_pk_mul_f32 v[52:53], v[52:53], v[4:5] op_sel:[0,0] op_sel_hi:[1,0]
    v_pk_mul_f32 v[54:55], v[54:55], v[4:5] op_sel:[0,0] op_sel_hi:[1,0]
    v_cvt_pk_bf16_f32 v16, v48, v49
    v_cvt_pk_bf16_f32 v17, v50, v51
    v_cvt_pk_bf16_f32 v18, v52, v53
    v_cvt_pk_bf16_f32 v19, v54, v55
    buffer_store_dwordx4 v[16:19], v240, s[28:31], s55 offen offset:2048 sc1
    v_accvgpr_read_b32 v56, a96
    v_accvgpr_read_b32 v57, a97
    v_accvgpr_read_b32 v58, a98
    v_accvgpr_read_b32 v59, a99
    v_accvgpr_read_b32 v60, a112
    v_accvgpr_read_b32 v61, a113
    v_accvgpr_read_b32 v62, a114
    v_accvgpr_read_b32 v63, a115
    v_pk_fma_f32 v[2:3], v[56:57], 0, v[2:3] op_sel_hi:[1,0,1]
    v_pk_fma_f32 v[2:3], v[58:59], 0, v[2:3] op_sel_hi:[1,0,1]
    v_pk_fma_f32 v[2:3], v[60:61], 0, v[2:3] op_sel_hi:[1,0,1]
    v_pk_fma_f32 v[2:3], v[62:63], 0, v[2:3] op_sel_hi:[1,0,1]
    v_pk_mul_f32 v[56:57], v[56:57], v[4:5] op_sel:[0,0] op_sel_hi:[1,0]
    v_pk_mul_f32 v[58:59], v[58:59], v[4:5] op_sel:[0,0] op_sel_hi:[1,0]
    v_pk_mul_f32 v[60:61], v[60:61], v[4:5] op_sel:[0,0] op_sel_hi:[1,0]
    v_pk_mul_f32 v[62:63], v[62:63], v[4:5] op_sel:[0,0] op_sel_hi:[1,0]
    v_cvt_pk_bf16_f32 v20, v56, v57
    v_cvt_pk_bf16_f32 v21, v58, v59
    v_cvt_pk_bf16_f32 v22, v60, v61
    v_cvt_pk_bf16_f32 v23, v62, v63
    buffer_store_dwordx4 v[20:23], v240, s[28:31], s55 offen offset:3072 sc1
    s_add_u32 s55, s55, 186368
    v_accvgpr_read_b32 v32, a4
    v_accvgpr_read_b32 v33, a5
    v_accvgpr_read_b32 v34, a6
    v_accvgpr_read_b32 v35, a7
    v_accvgpr_read_b32 v36, a20
    v_accvgpr_read_b32 v37, a21
    v_accvgpr_read_b32 v38, a22
    v_accvgpr_read_b32 v39, a23
    v_pk_fma_f32 v[2:3], v[32:33], 0, v[2:3] op_sel_hi:[1,0,1]
    v_pk_fma_f32 v[2:3], v[34:35], 0, v[2:3] op_sel_hi:[1,0,1]
    v_pk_fma_f32 v[2:3], v[36:37], 0, v[2:3] op_sel_hi:[1,0,1]
    v_pk_fma_f32 v[2:3], v[38:39], 0, v[2:3] op_sel_hi:[1,0,1]
    v_pk_mul_f32 v[32:33], v[32:33], v[4:5] op_sel:[0,1] op_sel_hi:[1,1]
    v_pk_mul_f32 v[34:35], v[34:35], v[4:5] op_sel:[0,1] op_sel_hi:[1,1]
    v_pk_mul_f32 v[36:37], v[36:37], v[4:5] op_sel:[0,1] op_sel_hi:[1,1]
    v_pk_mul_f32 v[38:39], v[38:39], v[4:5] op_sel:[0,1] op_sel_hi:[1,1]
    v_cvt_pk_bf16_f32 v8, v32, v33
    v_cvt_pk_bf16_f32 v9, v34, v35
    v_cvt_pk_bf16_f32 v10, v36, v37
    v_cvt_pk_bf16_f32 v11, v38, v39
    buffer_store_dwordx4 v[8:11], v240, s[28:31], s55 offen offset:0 sc1
    v_accvgpr_read_b32 v40, a36
    v_accvgpr_read_b32 v41, a37
    v_accvgpr_read_b32 v42, a38
    v_accvgpr_read_b32 v43, a39
    v_accvgpr_read_b32 v44, a52
    v_accvgpr_read_b32 v45, a53
    v_accvgpr_read_b32 v46, a54
    v_accvgpr_read_b32 v47, a55
    v_pk_fma_f32 v[2:3], v[40:41], 0, v[2:3] op_sel_hi:[1,0,1]
    v_pk_fma_f32 v[2:3], v[42:43], 0, v[2:3] op_sel_hi:[1,0,1]
    v_pk_fma_f32 v[2:3], v[44:45], 0, v[2:3] op_sel_hi:[1,0,1]
    v_pk_fma_f32 v[2:3], v[46:47], 0, v[2:3] op_sel_hi:[1,0,1]
    v_pk_mul_f32 v[40:41], v[40:41], v[4:5] op_sel:[0,1] op_sel_hi:[1,1]
    v_pk_mul_f32 v[42:43], v[42:43], v[4:5] op_sel:[0,1] op_sel_hi:[1,1]
    v_pk_mul_f32 v[44:45], v[44:45], v[4:5] op_sel:[0,1] op_sel_hi:[1,1]
    v_pk_mul_f32 v[46:47], v[46:47], v[4:5] op_sel:[0,1] op_sel_hi:[1,1]
    v_cvt_pk_bf16_f32 v12, v40, v41
    v_cvt_pk_bf16_f32 v13, v42, v43
    v_cvt_pk_bf16_f32 v14, v44, v45
    v_cvt_pk_bf16_f32 v15, v46, v47
    buffer_store_dwordx4 v[12:15], v240, s[28:31], s55 offen offset:1024 sc1
    v_accvgpr_read_b32 v48, a68
    v_accvgpr_read_b32 v49, a69
    v_accvgpr_read_b32 v50, a70
    v_accvgpr_read_b32 v51, a71
    v_accvgpr_read_b32 v52, a84
    v_accvgpr_read_b32 v53, a85
    v_accvgpr_read_b32 v54, a86
    v_accvgpr_read_b32 v55, a87
    v_pk_fma_f32 v[2:3], v[48:49], 0, v[2:3] op_sel_hi:[1,0,1]
    v_pk_fma_f32 v[2:3], v[50:51], 0, v[2:3] op_sel_hi:[1,0,1]
    v_pk_fma_f32 v[2:3], v[52:53], 0, v[2:3] op_sel_hi:[1,0,1]
    v_pk_fma_f32 v[2:3], v[54:55], 0, v[2:3] op_sel_hi:[1,0,1]
    v_pk_mul_f32 v[48:49], v[48:49], v[4:5] op_sel:[0,1] op_sel_hi:[1,1]
    v_pk_mul_f32 v[50:51], v[50:51], v[4:5] op_sel:[0,1] op_sel_hi:[1,1]
    v_pk_mul_f32 v[52:53], v[52:53], v[4:5] op_sel:[0,1] op_sel_hi:[1,1]
    v_pk_mul_f32 v[54:55], v[54:55], v[4:5] op_sel:[0,1] op_sel_hi:[1,1]
    v_cvt_pk_bf16_f32 v16, v48, v49
    v_cvt_pk_bf16_f32 v17, v50, v51
    v_cvt_pk_bf16_f32 v18, v52, v53
    v_cvt_pk_bf16_f32 v19, v54, v55
    buffer_store_dwordx4 v[16:19], v240, s[28:31], s55 offen offset:2048 sc1
    v_accvgpr_read_b32 v56, a100
    v_accvgpr_read_b32 v57, a101
    v_accvgpr_read_b32 v58, a102
    v_accvgpr_read_b32 v59, a103
    v_accvgpr_read_b32 v60, a116
    v_accvgpr_read_b32 v61, a117
    v_accvgpr_read_b32 v62, a118
    v_accvgpr_read_b32 v63, a119
    v_pk_fma_f32 v[2:3], v[56:57], 0, v[2:3] op_sel_hi:[1,0,1]
    v_pk_fma_f32 v[2:3], v[58:59], 0, v[2:3] op_sel_hi:[1,0,1]
    v_pk_fma_f32 v[2:3], v[60:61], 0, v[2:3] op_sel_hi:[1,0,1]
    v_pk_fma_f32 v[2:3], v[62:63], 0, v[2:3] op_sel_hi:[1,0,1]
    v_pk_mul_f32 v[56:57], v[56:57], v[4:5] op_sel:[0,1] op_sel_hi:[1,1]
    v_pk_mul_f32 v[58:59], v[58:59], v[4:5] op_sel:[0,1] op_sel_hi:[1,1]
    v_pk_mul_f32 v[60:61], v[60:61], v[4:5] op_sel:[0,1] op_sel_hi:[1,1]
    v_pk_mul_f32 v[62:63], v[62:63], v[4:5] op_sel:[0,1] op_sel_hi:[1,1]
    v_cvt_pk_bf16_f32 v20, v56, v57
    v_cvt_pk_bf16_f32 v21, v58, v59
    v_cvt_pk_bf16_f32 v22, v60, v61
    v_cvt_pk_bf16_f32 v23, v62, v63
    buffer_store_dwordx4 v[20:23], v240, s[28:31], s55 offen offset:3072 sc1
    s_add_u32 s55, s55, 186368
    v_accvgpr_read_b32 v32, a8
    v_accvgpr_read_b32 v33, a9
    v_accvgpr_read_b32 v34, a10
    v_accvgpr_read_b32 v35, a11
    v_accvgpr_read_b32 v36, a24
    v_accvgpr_read_b32 v37, a25
    v_accvgpr_read_b32 v38, a26
    v_accvgpr_read_b32 v39, a27
    v_pk_fma_f32 v[2:3], v[32:33], 0, v[2:3] op_sel_hi:[1,0,1]
    v_pk_fma_f32 v[2:3], v[34:35], 0, v[2:3] op_sel_hi:[1,0,1]
    v_pk_fma_f32 v[2:3], v[36:37], 0, v[2:3] op_sel_hi:[1,0,1]
    v_pk_fma_f32 v[2:3], v[38:39], 0, v[2:3] op_sel_hi:[1,0,1]
    v_pk_mul_f32 v[32:33], v[32:33], v[6:7] op_sel:[0,0] op_sel_hi:[1,0]
    v_pk_mul_f32 v[34:35], v[34:35], v[6:7] op_sel:[0,0] op_sel_hi:[1,0]
    v_pk_mul_f32 v[36:37], v[36:37], v[6:7] op_sel:[0,0] op_sel_hi:[1,0]
    v_pk_mul_f32 v[38:39], v[38:39], v[6:7] op_sel:[0,0] op_sel_hi:[1,0]
    v_cvt_pk_bf16_f32 v8, v32, v33
    v_cvt_pk_bf16_f32 v9, v34, v35
    v_cvt_pk_bf16_f32 v10, v36, v37
    v_cvt_pk_bf16_f32 v11, v38, v39
    buffer_store_dwordx4 v[8:11], v240, s[28:31], s55 offen offset:0 sc1
    v_accvgpr_read_b32 v40, a40
    v_accvgpr_read_b32 v41, a41
    v_accvgpr_read_b32 v42, a42
    v_accvgpr_read_b32 v43, a43
    v_accvgpr_read_b32 v44, a56
    v_accvgpr_read_b32 v45, a57
    v_accvgpr_read_b32 v46, a58
    v_accvgpr_read_b32 v47, a59
    v_pk_fma_f32 v[2:3], v[40:41], 0, v[2:3] op_sel_hi:[1,0,1]
    v_pk_fma_f32 v[2:3], v[42:43], 0, v[2:3] op_sel_hi:[1,0,1]
    v_pk_fma_f32 v[2:3], v[44:45], 0, v[2:3] op_sel_hi:[1,0,1]
    v_pk_fma_f32 v[2:3], v[46:47], 0, v[2:3] op_sel_hi:[1,0,1]
    v_pk_mul_f32 v[40:41], v[40:41], v[6:7] op_sel:[0,0] op_sel_hi:[1,0]
    v_pk_mul_f32 v[42:43], v[42:43], v[6:7] op_sel:[0,0] op_sel_hi:[1,0]
    v_pk_mul_f32 v[44:45], v[44:45], v[6:7] op_sel:[0,0] op_sel_hi:[1,0]
    v_pk_mul_f32 v[46:47], v[46:47], v[6:7] op_sel:[0,0] op_sel_hi:[1,0]
    v_cvt_pk_bf16_f32 v12, v40, v41
    v_cvt_pk_bf16_f32 v13, v42, v43
    v_cvt_pk_bf16_f32 v14, v44, v45
    v_cvt_pk_bf16_f32 v15, v46, v47
    buffer_store_dwordx4 v[12:15], v240, s[28:31], s55 offen offset:1024 sc1
    v_accvgpr_read_b32 v48, a72
    v_accvgpr_read_b32 v49, a73
    v_accvgpr_read_b32 v50, a74
    v_accvgpr_read_b32 v51, a75
    v_accvgpr_read_b32 v52, a88
    v_accvgpr_read_b32 v53, a89
    v_accvgpr_read_b32 v54, a90
    v_accvgpr_read_b32 v55, a91
    v_pk_fma_f32 v[2:3], v[48:49], 0, v[2:3] op_sel_hi:[1,0,1]
    v_pk_fma_f32 v[2:3], v[50:51], 0, v[2:3] op_sel_hi:[1,0,1]
    v_pk_fma_f32 v[2:3], v[52:53], 0, v[2:3] op_sel_hi:[1,0,1]
    v_pk_fma_f32 v[2:3], v[54:55], 0, v[2:3] op_sel_hi:[1,0,1]
    v_pk_mul_f32 v[48:49], v[48:49], v[6:7] op_sel:[0,0] op_sel_hi:[1,0]
    v_pk_mul_f32 v[50:51], v[50:51], v[6:7] op_sel:[0,0] op_sel_hi:[1,0]
    v_pk_mul_f32 v[52:53], v[52:53], v[6:7] op_sel:[0,0] op_sel_hi:[1,0]
    v_pk_mul_f32 v[54:55], v[54:55], v[6:7] op_sel:[0,0] op_sel_hi:[1,0]
    v_cvt_pk_bf16_f32 v16, v48, v49
    v_cvt_pk_bf16_f32 v17, v50, v51
    v_cvt_pk_bf16_f32 v18, v52, v53
    v_cvt_pk_bf16_f32 v19, v54, v55
    buffer_store_dwordx4 v[16:19], v240, s[28:31], s55 offen offset:2048 sc1
    v_accvgpr_read_b32 v56, a104
    v_accvgpr_read_b32 v57, a105
    v_accvgpr_read_b32 v58, a106
    v_accvgpr_read_b32 v59, a107
    v_accvgpr_read_b32 v60, a120
    v_accvgpr_read_b32 v61, a121
    v_accvgpr_read_b32 v62, a122
    v_accvgpr_read_b32 v63, a123
    v_pk_fma_f32 v[2:3], v[56:57], 0, v[2:3] op_sel_hi:[1,0,1]
    v_pk_fma_f32 v[2:3], v[58:59], 0, v[2:3] op_sel_hi:[1,0,1]
    v_pk_fma_f32 v[2:3], v[60:61], 0, v[2:3] op_sel_hi:[1,0,1]
    v_pk_fma_f32 v[2:3], v[62:63], 0, v[2:3] op_sel_hi:[1,0,1]
    v_pk_mul_f32 v[56:57], v[56:57], v[6:7] op_sel:[0,0] op_sel_hi:[1,0]
    v_pk_mul_f32 v[58:59], v[58:59], v[6:7] op_sel:[0,0] op_sel_hi:[1,0]
    v_pk_mul_f32 v[60:61], v[60:61], v[6:7] op_sel:[0,0] op_sel_hi:[1,0]
    v_pk_mul_f32 v[62:63], v[62:63], v[6:7] op_sel:[0,0] op_sel_hi:[1,0]
    v_cvt_pk_bf16_f32 v20, v56, v57
    v_cvt_pk_bf16_f32 v21, v58, v59
    v_cvt_pk_bf16_f32 v22, v60, v61
    v_cvt_pk_bf16_f32 v23, v62, v63
    buffer_store_dwordx4 v[20:23], v240, s[28:31], s55 offen offset:3072 sc1
    s_add_u32 s55, s55, 186368
    v_accvgpr_read_b32 v32, a12
    v_accvgpr_read_b32 v33, a13
    v_accvgpr_read_b32 v34, a14
    v_accvgpr_read_b32 v35, a15
    v_accvgpr_read_b32 v36, a28
    v_accvgpr_read_b32 v37, a29
    v_accvgpr_read_b32 v38, a30
    v_accvgpr_read_b32 v39, a31
    v_pk_fma_f32 v[2:3], v[32:33], 0, v[2:3] op_sel_hi:[1,0,1]
    v_pk_fma_f32 v[2:3], v[34:35], 0, v[2:3] op_sel_hi:[1,0,1]
    v_pk_fma_f32 v[2:3], v[36:37], 0, v[2:3] op_sel_hi:[1,0,1]
    v_pk_fma_f32 v[2:3], v[38:39], 0, v[2:3] op_sel_hi:[1,0,1]
    v_pk_mul_f32 v[32:33], v[32:33], v[6:7] op_sel:[0,1] op_sel_hi:[1,1]
    v_pk_mul_f32 v[34:35], v[34:35], v[6:7] op_sel:[0,1] op_sel_hi:[1,1]
    v_pk_mul_f32 v[36:37], v[36:37], v[6:7] op_sel:[0,1] op_sel_hi:[1,1]
    v_pk_mul_f32 v[38:39], v[38:39], v[6:7] op_sel:[0,1] op_sel_hi:[1,1]
    v_cvt_pk_bf16_f32 v8, v32, v33
    v_cvt_pk_bf16_f32 v9, v34, v35
    v_cvt_pk_bf16_f32 v10, v36, v37
    v_cvt_pk_bf16_f32 v11, v38, v39
    buffer_store_dwordx4 v[8:11], v240, s[28:31], s55 offen offset:0 sc1
    v_accvgpr_read_b32 v40, a44
    v_accvgpr_read_b32 v41, a45
    v_accvgpr_read_b32 v42, a46
    v_accvgpr_read_b32 v43, a47
    v_accvgpr_read_b32 v44, a60
    v_accvgpr_read_b32 v45, a61
    v_accvgpr_read_b32 v46, a62
    v_accvgpr_read_b32 v47, a63
    v_pk_fma_f32 v[2:3], v[40:41], 0, v[2:3] op_sel_hi:[1,0,1]
    v_pk_fma_f32 v[2:3], v[42:43], 0, v[2:3] op_sel_hi:[1,0,1]
    v_pk_fma_f32 v[2:3], v[44:45], 0, v[2:3] op_sel_hi:[1,0,1]
    v_pk_fma_f32 v[2:3], v[46:47], 0, v[2:3] op_sel_hi:[1,0,1]
    v_pk_mul_f32 v[40:41], v[40:41], v[6:7] op_sel:[0,1] op_sel_hi:[1,1]
    v_pk_mul_f32 v[42:43], v[42:43], v[6:7] op_sel:[0,1] op_sel_hi:[1,1]
    v_pk_mul_f32 v[44:45], v[44:45], v[6:7] op_sel:[0,1] op_sel_hi:[1,1]
    v_pk_mul_f32 v[46:47], v[46:47], v[6:7] op_sel:[0,1] op_sel_hi:[1,1]
    v_cvt_pk_bf16_f32 v12, v40, v41
    v_cvt_pk_bf16_f32 v13, v42, v43
    v_cvt_pk_bf16_f32 v14, v44, v45
    v_cvt_pk_bf16_f32 v15, v46, v47
    buffer_store_dwordx4 v[12:15], v240, s[28:31], s55 offen offset:1024 sc1
    v_accvgpr_read_b32 v48, a76
    v_accvgpr_read_b32 v49, a77
    v_accvgpr_read_b32 v50, a78
    v_accvgpr_read_b32 v51, a79
    v_accvgpr_read_b32 v52, a92
    v_accvgpr_read_b32 v53, a93
    v_accvgpr_read_b32 v54, a94
    v_accvgpr_read_b32 v55, a95
    v_pk_fma_f32 v[2:3], v[48:49], 0, v[2:3] op_sel_hi:[1,0,1]
    v_pk_fma_f32 v[2:3], v[50:51], 0, v[2:3] op_sel_hi:[1,0,1]
    v_pk_fma_f32 v[2:3], v[52:53], 0, v[2:3] op_sel_hi:[1,0,1]
    v_pk_fma_f32 v[2:3], v[54:55], 0, v[2:3] op_sel_hi:[1,0,1]
    v_pk_mul_f32 v[48:49], v[48:49], v[6:7] op_sel:[0,1] op_sel_hi:[1,1]
    v_pk_mul_f32 v[50:51], v[50:51], v[6:7] op_sel:[0,1] op_sel_hi:[1,1]
    v_pk_mul_f32 v[52:53], v[52:53], v[6:7] op_sel:[0,1] op_sel_hi:[1,1]
    v_pk_mul_f32 v[54:55], v[54:55], v[6:7] op_sel:[0,1] op_sel_hi:[1,1]
    v_cvt_pk_bf16_f32 v16, v48, v49
    v_cvt_pk_bf16_f32 v17, v50, v51
    v_cvt_pk_bf16_f32 v18, v52, v53
    v_cvt_pk_bf16_f32 v19, v54, v55
    buffer_store_dwordx4 v[16:19], v240, s[28:31], s55 offen offset:2048 sc1
    v_accvgpr_read_b32 v56, a108
    v_accvgpr_read_b32 v57, a109
    v_accvgpr_read_b32 v58, a110
    v_accvgpr_read_b32 v59, a111
    v_accvgpr_read_b32 v60, a124
    v_accvgpr_read_b32 v61, a125
    v_accvgpr_read_b32 v62, a126
    v_accvgpr_read_b32 v63, a127
    v_pk_fma_f32 v[2:3], v[56:57], 0, v[2:3] op_sel_hi:[1,0,1]
    v_pk_fma_f32 v[2:3], v[58:59], 0, v[2:3] op_sel_hi:[1,0,1]
    v_pk_fma_f32 v[2:3], v[60:61], 0, v[2:3] op_sel_hi:[1,0,1]
    v_pk_fma_f32 v[2:3], v[62:63], 0, v[2:3] op_sel_hi:[1,0,1]
    v_pk_mul_f32 v[56:57], v[56:57], v[6:7] op_sel:[0,1] op_sel_hi:[1,1]
    v_pk_mul_f32 v[58:59], v[58:59], v[6:7] op_sel:[0,1] op_sel_hi:[1,1]
    v_pk_mul_f32 v[60:61], v[60:61], v[6:7] op_sel:[0,1] op_sel_hi:[1,1]
    v_pk_mul_f32 v[62:63], v[62:63], v[6:7] op_sel:[0,1] op_sel_hi:[1,1]
    v_cvt_pk_bf16_f32 v20, v56, v57
    v_cvt_pk_bf16_f32 v21, v58, v59
    v_cvt_pk_bf16_f32 v22, v60, v61
    v_cvt_pk_bf16_f32 v23, v62, v63
    buffer_store_dwordx4 v[20:23], v240, s[28:31], s55 offen offset:3072 sc1
    s_add_u32 s55, s55, 186368
    v_add_f32 v2, v2, v3
    s_mov_b32 s55, 0x71800000
    v_cmp_ngt_f32 vcc, s55, v2
    s_nop 3
    s_cmp_lg_u64 vcc, 0
    s_cselect_b32 s55, 1, 0
    s_lshl_b32 s56, s3, 2
    s_add_u32 s56, s56, 131072
    v_mov_b32 v2, s55
    v_mov_b32 v3, s56
    ds_write_b32 v3, v2
    s_waitcnt lgkmcnt(0)
    s_barrier
    v_mov_b32 v3, 131072
    ds_read_b128 v[4:7], v3
    s_waitcnt lgkmcnt(0)
    v_or_b32 v4, v4, v5
    v_or3_b32 v4, v4, v6, v7
    s_nop 0
    v_readfirstlane_b32 s55, v4
    s_nop 3
    s_cmp_lg_u32 s55, 0
    s_cbranch_scc1 KA_FALL
KA_END:
    s_endpgm
KA_FALL:
    s_waitcnt vmcnt(0)
    v_and_b32 v1, 15, v0
    v_lshrrev_b32 v2, 4, v0
    v_lshrrev_b32 v4, 2, v1
    v_and_b32 v5, 3, v0
    s_lshl_b32 s6, s3, 4
    v_add_u32 v27, s6, v2
    v_or_b32 v7, 0, v2
    v_xor_b32 v7, v7, v1
    v_lshlrev_b32 v7, 4, v7
    v_lshl_add_u32 v20, v27, 8, v7
    v_or_b32 v7, 4, v2
    v_xor_b32 v7, v7, v1
    v_lshlrev_b32 v7, 4, v7
    v_lshl_add_u32 v21, v27, 8, v7
    v_or_b32 v7, 8, v2
    v_xor_b32 v7, v7, v1
    v_lshlrev_b32 v7, 4, v7
    v_lshl_add_u32 v22, v27, 8, v7
    v_or_b32 v7, 12, v2
    v_xor_b32 v7, v7, v1
    v_lshlrev_b32 v7, 4, v7
    v_lshl_add_u32 v23, v27, 8, v7
    v_or_b32 v7, 0, v2
    v_lshlrev_b32 v7, 1, v7
    v_xor_b32 v7, v7, v1
    v_lshlrev_b32 v7, 4, v7
    v_lshl_add_u32 v24, v27, 8, v7
    v_or_b32 v7, 4, v2
    v_lshlrev_b32 v7, 1, v7
    v_xor_b32 v7, v7, v1
    v_lshlrev_b32 v7, 4, v7
    v_lshl_add_u32 v25, v27, 8, v7
    v_or_b32 v7, 0, v2
    v_xor_b32 v7, v7, v1
    v_lshlrev_b32 v7, 4, v7
    v_lshl_add_u32 v8, v1, 8, v7
    v_or_b32 v7, 4, v2
    v_xor_b32 v7, v7, v1
    v_lshlrev_b32 v7, 4, v7
    v_lshl_add_u32 v9, v1, 8, v7
    v_or_b32 v7, 8, v2
    v_xor_b32 v7, v7, v1
    v_lshlrev_b32 v7, 4, v7
    v_lshl_add_u32 v10, v1, 8, v7
    v_or_b32 v7, 12, v2
    v_xor_b32 v7, v7, v1
    v_lshlrev_b32 v7, 4, v7
    v_lshl_add_u32 v11, v1, 8, v7
    v_lshl_add_u32 v3, v2, 2, v4
    v_and_b32 v6, 7, v3
    v_lshlrev_b32 v3, 8, v3
    v_lshl_add_u32 v3, v5, 3, v3
    v_add_u32 v3, 0x10000, v3
    v_xor_b32 v7, 0, v6
    v_lshl_add_u32 v12, v7, 5, v3
    v_xor_b32 v7, 1, v6
    v_lshl_add_u32 v13, v7, 5, v3
    v_xor_b32 v7, 2, v6
    v_lshl_add_u32 v14, v7, 5, v3
    v_xor_b32 v7, 3, v6
    v_lshl_add_u32 v15, v7, 5, v3
    v_xor_b32 v7, 4, v6
    v_lshl_add_u32 v16, v7, 5, v3
    v_xor_b32 v7, 5, v6
    v_lshl_add_u32 v17, v7, 5, v3
    v_xor_b32 v7, 6, v6
    v_lshl_add_u32 v18, v7, 5, v3
    v_xor_b32 v7, 7, v6
    v_lshl_add_u32 v19, v7, 5, v3
    v_lshl_add_u32 v3, v2, 3, v4
    v_lshlrev_b32 v6, 8, v3
    v_lshl_add_u32 v6, v5, 4, v6
    v_add_u32 v6, 0x10000, v6
    v_xor_b32 v7, 0, v4
    v_lshl_add_u32 v224, v7, 6, v6
    v_xor_b32 v7, 1, v4
    v_lshl_add_u32 v225, v7, 6, v6
    v_xor_b32 v7, 2, v4
    v_lshl_add_u32 v226, v7, 6, v6
    v_xor_b32 v7, 3, v4
    v_lshl_add_u32 v227, v7, 6, v6
    v_bfe_u32 v6, v3, 1, 1
    v_bfe_u32 v7, v3, 3, 1
    v_lshl_or_b32 v6, v7, 1, v6
    v_lshlrev_b32 v3, 7, v3
    v_lshl_add_u32 v3, v5, 3, v3
    v_xor_b32 v7, 0, v6
    v_lshl_add_u32 v228, v7, 5, v3
    v_xor_b32 v7, 1, v6
    v_lshl_add_u32 v229, v7, 5, v3
    v_xor_b32 v7, 2, v6
    v_lshl_add_u32 v230, v7, 5, v3
    v_xor_b32 v7, 3, v6
    v_lshl_add_u32 v231, v7, 5, v3
    v_mov_b32 v28, 0x3f803f80
    v_mov_b32 v29, 0x3f803f80
    v_mov_b32 v30, 0x3f803f80
    v_mov_b32 v31, 0x3f803f80
    v_lshlrev_b32 v26, 8, v0
    v_accvgpr_write_b32 a0, 0
    v_accvgpr_write_b32 a1, 0
    v_accvgpr_write_b32 a2, 0
    v_accvgpr_write_b32 a3, 0
    v_accvgpr_write_b32 a4, 0
    v_accvgpr_write_b32 a5, 0
    v_accvgpr_write_b32 a6, 0
    v_accvgpr_write_b32 a7, 0
    v_accvgpr_write_b32 a8, 0
    v_accvgpr_write_b32 a9, 0
    v_accvgpr_write_b32 a10, 0
    v_accvgpr_write_b32 a11, 0
    v_accvgpr_write_b32 a12, 0
    v_accvgpr_write_b32 a13, 0
    v_accvgpr_write_b32 a14, 0
    v_accvgpr_write_b32 a15, 0
    v_accvgpr_write_b32 a16, 0
    v_accvgpr_write_b32 a17, 0
    v_accvgpr_write_b32 a18, 0
    v_accvgpr_write_b32 a19, 0
    v_accvgpr_write_b32 a20, 0
    v_accvgpr_write_b32 a21, 0
    v_accvgpr_write_b32 a22, 0
    v_accvgpr_write_b32 a23, 0
    v_accvgpr_write_b32 a24, 0
    v_accvgpr_write_b32 a25, 0
    v_accvgpr_write_b32 a26, 0
    v_accvgpr_write_b32 a27, 0
    v_accvgpr_write_b32 a28, 0
    v_accvgpr_write_b32 a29, 0
    v_accvgpr_write_b32 a30, 0
    v_accvgpr_write_b32 a31, 0
    v_accvgpr_write_b32 a32, 0
    v_accvgpr_write_b32 a33, 0
    v_accvgpr_write_b32 a34, 0
    v_accvgpr_write_b32 a35, 0
    v_accvgpr_write_b32 a36, 0
    v_accvgpr_write_b32 a37, 0
    v_accvgpr_write_b32 a38, 0
    v_accvgpr_write_b32 a39, 0
    v_accvgpr_write_b32 a40, 0
    v_accvgpr_write_b32 a41, 0
    v_accvgpr_write_b32 a42, 0
    v_accvgpr_write_b32 a43, 0
    v_accvgpr_write_b32 a44, 0
    v_accvgpr_write_b32 a45, 0
    v_accvgpr_write_b32 a46, 0
    v_accvgpr_write_b32 a47, 0
    v_accvgpr_write_b32 a48, 0
    v_accvgpr_write_b32 a49, 0
    v_accvgpr_write_b32 a50, 0
    v_accvgpr_write_b32 a51, 0
    v_accvgpr_write_b32 a52, 0
    v_accvgpr_write_b32 a53, 0
    v_accvgpr_write_b32 a54, 0
    v_accvgpr_write_b32 a55, 0
    v_accvgpr_write_b32 a56, 0
    v_accvgpr_write_b32 a57, 0
    v_accvgpr_write_b32 a58, 0
    v_accvgpr_write_b32 a59, 0
    v_accvgpr_write_b32 a60, 0
    v_accvgpr_write_b32 a61, 0
    v_accvgpr_write_b32 a62, 0
    v_accvgpr_write_b32 a63, 0
    v_accvgpr_write_b32 a64, 0
    v_accvgpr_write_b32 a65, 0
    v_accvgpr_write_b32 a66, 0
    v_accvgpr_write_b32 a67, 0
    v_accvgpr_write_b32 a68, 0
    v_accvgpr_write_b32 a69, 0
    v_accvgpr_write_b32 a70, 0
    v_accvgpr_write_b32 a71, 0
    v_accvgpr_write_b32 a72, 0
    v_accvgpr_write_b32 a73, 0
    v_accvgpr_write_b32 a74, 0
    v_accvgpr_write_b32 a75, 0
    v_accvgpr_write_b32 a76, 0
    v_accvgpr_write_b32 a77, 0
    v_accvgpr_write_b32 a78, 0
    v_accvgpr_write_b32 a79, 0
    v_accvgpr_write_b32 a80, 0
    v_accvgpr_write_b32 a81, 0
    v_accvgpr_write_b32 a82, 0
    v_accvgpr_write_b32 a83, 0
    v_accvgpr_write_b32 a84, 0
    v_accvgpr_write_b32 a85, 0
    v_accvgpr_write_b32 a86, 0
    v_accvgpr_write_b32 a87, 0
    v_accvgpr_write_b32 a88, 0
    v_accvgpr_write_b32 a89, 0
    v_accvgpr_write_b32 a90, 0
    v_accvgpr_write_b32 a91, 0
    v_accvgpr_write_b32 a92, 0
    v_accvgpr_write_b32 a93, 0
    v_accvgpr_write_b32 a94, 0
    v_accvgpr_write_b32 a95, 0
    v_accvgpr_write_b32 a96, 0
    v_accvgpr_write_b32 a97, 0
    v_accvgpr_write_b32 a98, 0
    v_accvgpr_write_b32 a99, 0
    v_accvgpr_write_b32 a100, 0
    v_accvgpr_write_b32 a101, 0
    v_accvgpr_write_b32 a102, 0
    v_accvgpr_write_b32 a103, 0
    v_accvgpr_write_b32 a104, 0
    v_accvgpr_write_b32 a105, 0
    v_accvgpr_write_b32 a106, 0
    v_accvgpr_write_b32 a107, 0
    v_accvgpr_write_b32 a108, 0
    v_accvgpr_write_b32 a109, 0
    v_accvgpr_write_b32 a110, 0
    v_accvgpr_write_b32 a111, 0
    v_accvgpr_write_b32 a112, 0
    v_accvgpr_write_b32 a113, 0
    v_accvgpr_write_b32 a114, 0
    v_accvgpr_write_b32 a115, 0
    v_accvgpr_write_b32 a116, 0
    v_accvgpr_write_b32 a117, 0
    v_accvgpr_write_b32 a118, 0
    v_accvgpr_write_b32 a119, 0
    v_accvgpr_write_b32 a120, 0
    v_accvgpr_write_b32 a121, 0
    v_accvgpr_write_b32 a122, 0
    v_accvgpr_write_b32 a123, 0
    v_accvgpr_write_b32 a124, 0
    v_accvgpr_write_b32 a125, 0
    v_accvgpr_write_b32 a126, 0
    v_accvgpr_write_b32 a127, 0
    v_accvgpr_write_b32 a128, 0
    v_accvgpr_write_b32 a129, 0
    v_accvgpr_write_b32 a130, 0
    v_accvgpr_write_b32 a131, 0
    v_accvgpr_write_b32 a132, 0
    v_accvgpr_write_b32 a133, 0
    v_accvgpr_write_b32 a134, 0
    v_accvgpr_write_b32 a135, 0
    v_accvgpr_write_b32 a136, 0
    v_accvgpr_write_b32 a137, 0
    v_accvgpr_write_b32 a138, 0
    v_accvgpr_write_b32 a139, 0
    v_accvgpr_write_b32 a140, 0
    v_accvgpr_write_b32 a141, 0
    v_accvgpr_write_b32 a142, 0
    v_accvgpr_write_b32 a143, 0
    v_mov_b32 v244, 0xff7fffff
    v_mov_b32 v245, 0xff7fffff
    v_mov_b32 v246, 0xff7fffff
    v_mov_b32 v247, 0xff7fffff
    s_mov_b32 s57, 0
    s_mov_b32 s59, 32
KA_FLOOP:
    s_barrier
    s_add_u32 m0, s53, 0
    s_nop 0
    buffer_load_dwordx4 v20, s[8:11], s57 offen offset:0 lds
    buffer_load_dwordx4 v21, s[8:11], s57 offen offset:1024 lds
    buffer_load_dwordx4 v22, s[8:11], s57 offen offset:2048 lds
    buffer_load_dwordx4 v23, s[8:11], s57 offen offset:3072 lds
    s_add_u32 m0, s53, 65536
    s_nop 0
    buffer_load_dwordx4 v24, s[12:15], s57 offen offset:0 lds
    buffer_load_dwordx4 v25, s[12:15], s57 offen offset:1024 lds
    buffer_load_dwordx4 v24, s[12:15], s57 offen offset:2048 lds
    buffer_load_dwordx4 v25, s[12:15], s57 offen offset:3072 lds
    s_waitcnt vmcnt(0)
    s_barrier
    ds_read_b128 a[144:147], v8 offset:0
    ds_read_b128 a[148:151], v9 offset:0
    ds_read_b128 a[152:155], v10 offset:0
    ds_read_b128 a[156:159], v11 offset:0
    ds_read_b128 a[160:163], v8 offset:4096
    ds_read_b128 a[164:167], v9 offset:4096
    ds_read_b128 a[168:171], v10 offset:4096
    ds_read_b128 a[172:175], v11 offset:4096
    s_waitcnt lgkmcnt(7)
    v_mfma_f32_16x16x32_bf16 v[32:35], a[144:147], v[160:163], 0
    s_waitcnt lgkmcnt(6)
    v_mfma_f32_16x16x32_bf16 v[32:35], a[148:151], v[164:167], v[32:35]
    s_waitcnt lgkmcnt(5)
    v_mfma_f32_16x16x32_bf16 v[32:35], a[152:155], v[168:171], v[32:35]
    s_waitcnt lgkmcnt(4)
    v_mfma_f32_16x16x32_bf16 v[32:35], a[156:159], v[172:175], v[32:35]
    v_mfma_f32_16x16x32_bf16 v[36:39], a[144:147], v[176:179], 0
    v_mfma_f32_16x16x32_bf16 v[36:39], a[148:151], v[180:183], v[36:39]
    v_mfma_f32_16x16x32_bf16 v[36:39], a[152:155], v[184:187], v[36:39]
    v_mfma_f32_16x16x32_bf16 v[36:39], a[156:159], v[188:191], v[36:39]
    v_mfma_f32_16x16x32_bf16 v[40:43], a[144:147], v[192:195], 0
    v_mfma_f32_16x16x32_bf16 v[40:43], a[148:151], v[196:199], v[40:43]
    v_mfma_f32_16x16x32_bf16 v[40:43], a[152:155], v[200:203], v[40:43]
    v_mfma_f32_16x16x32_bf16 v[40:43], a[156:159], v[204:207], v[40:43]
    v_mfma_f32_16x16x32_bf16 v[44:47], a[144:147], v[208:211], 0
    v_mfma_f32_16x16x32_bf16 v[44:47], a[148:151], v[212:215], v[44:47]
    v_mfma_f32_16x16x32_bf16 v[44:47], a[152:155], v[216:219], v[44:47]
    v_mfma_f32_16x16x32_bf16 v[44:47], a[156:159], v[220:223], v[44:47]
    s_waitcnt lgkmcnt(3)
    v_mfma_f32_16x16x32_bf16 v[48:51], a[160:163], v[160:163], 0
    s_waitcnt lgkmcnt(2)
    v_mfma_f32_16x16x32_bf16 v[48:51], a[164:167], v[164:167], v[48:51]
    s_waitcnt lgkmcnt(1)
    v_mfma_f32_16x16x32_bf16 v[48:51], a[168:171], v[168:171], v[48:51]
    s_waitcnt lgkmcnt(0)
    v_mfma_f32_16x16x32_bf16 v[48:51], a[172:175], v[172:175], v[48:51]
    v_mfma_f32_16x16x32_bf16 v[52:55], a[160:163], v[176:179], 0
    v_mfma_f32_16x16x32_bf16 v[52:55], a[164:167], v[180:183], v[52:55]
    v_mfma_f32_16x16x32_bf16 v[52:55], a[168:171], v[184:187], v[52:55]
    v_mfma_f32_16x16x32_bf16 v[52:55], a[172:175], v[188:191], v[52:55]
    v_mfma_f32_16x16x32_bf16 v[56:59], a[160:163], v[192:195], 0
    v_mfma_f32_16x16x32_bf16 v[56:59], a[164:167], v[196:199], v[56:59]
    v_mfma_f32_16x16x32_bf16 v[56:59], a[168:171], v[200:203], v[56:59]
    v_mfma_f32_16x16x32_bf16 v[56:59], a[172:175], v[204:207], v[56:59]
    v_mfma_f32_16x16x32_bf16 v[60:63], a[160:163], v[208:211], 0
    v_mfma_f32_16x16x32_bf16 v[60:63], a[164:167], v[212:215], v[60:63]
    v_mfma_f32_16x16x32_bf16 v[60:63], a[168:171], v[216:219], v[60:63]
    v_mfma_f32_16x16x32_bf16 v[60:63], a[172:175], v[220:223], v[60:63]
    v_max3_f32 v1, v32, v33, v34
    v_max3_f32 v1, v1, v35, v48
    v_max3_f32 v1, v1, v49, v50
    v_max_f32 v1, v1, v51
    v_mov_b32 v5, v1
    s_nop 1
    v_permlane32_swap_b32 v1, v5
    v_max_f32 v1, v1, v5
    v_mov_b32 v5, v1
    s_nop 1
    v_permlane16_swap_b32 v1, v5
    v_max_f32 v1, v1, v5
    v_max3_f32 v2, v36, v37, v38
    v_max3_f32 v2, v2, v39, v52
    v_max3_f32 v2, v2, v53, v54
    v_max_f32 v2, v2, v55
    v_mov_b32 v5, v2
    s_nop 1
    v_permlane32_swap_b32 v2, v5
    v_max_f32 v2, v2, v5
    v_mov_b32 v5, v2
    s_nop 1
    v_permlane16_swap_b32 v2, v5
    v_max_f32 v2, v2, v5
    v_max3_f32 v3, v40, v41, v42
    v_max3_f32 v3, v3, v43, v56
    v_max3_f32 v3, v3, v57, v58
    v_max_f32 v3, v3, v59
    v_mov_b32 v5, v3
    s_nop 1
    v_permlane32_swap_b32 v3, v5
    v_max_f32 v3, v3, v5
    v_mov_b32 v5, v3
    s_nop 1
    v_permlane16_swap_b32 v3, v5
    v_max_f32 v3, v3, v5
    v_max3_f32 v4, v44, v45, v46
    v_max3_f32 v4, v4, v47, v60
    v_max3_f32 v4, v4, v61, v62
    v_max_f32 v4, v4, v63
    v_mov_b32 v5, v4
    s_nop 1
    v_permlane32_swap_b32 v4, v5
    v_max_f32 v4, v4, v5
    v_mov_b32 v5, v4
    s_nop 1
    v_permlane16_swap_b32 v4, v5
    v_max_f32 v4, v4, v5
    v_max_f32 v1, v1, v244
    v_sub_f32 v6, v244, v1
    v_exp_f32 v6, v6
    v_mov_b32 v244, v1
    v_accvgpr_read_b32 v64, a0
    v_accvgpr_read_b32 v65, a1
    v_accvgpr_read_b32 v66, a2
    v_accvgpr_read_b32 v67, a3
    v_mul_f32 v64, v6, v64
    v_mul_f32 v65, v6, v65
    v_mul_f32 v66, v6, v66
    v_mul_f32 v67, v6, v67
    v_accvgpr_write_b32 a0, v64
    v_accvgpr_write_b32 a1, v65
    v_accvgpr_write_b32 a2, v66
    v_accvgpr_write_b32 a3, v67
    v_accvgpr_read_b32 v64, a16
    v_accvgpr_read_b32 v65, a17
    v_accvgpr_read_b32 v66, a18
    v_accvgpr_read_b32 v67, a19
    v_mul_f32 v64, v6, v64
    v_mul_f32 v65, v6, v65
    v_mul_f32 v66, v6, v66
    v_mul_f32 v67, v6, v67
    v_accvgpr_write_b32 a16, v64
    v_accvgpr_write_b32 a17, v65
    v_accvgpr_write_b32 a18, v66
    v_accvgpr_write_b32 a19, v67
    v_accvgpr_read_b32 v64, a32
    v_accvgpr_read_b32 v65, a33
    v_accvgpr_read_b32 v66, a34
    v_accvgpr_read_b32 v67, a35
    v_mul_f32 v64, v6, v64
    v_mul_f32 v65, v6, v65
    v_mul_f32 v66, v6, v66
    v_mul_f32 v67, v6, v67
    v_accvgpr_write_b32 a32, v64
    v_accvgpr_write_b32 a33, v65
    v_accvgpr_write_b32 a34, v66
    v_accvgpr_write_b32 a35, v67
    v_accvgpr_read_b32 v64, a48
    v_accvgpr_read_b32 v65, a49
    v_accvgpr_read_b32 v66, a50
    v_accvgpr_read_b32 v67, a51
    v_mul_f32 v64, v6, v64
    v_mul_f32 v65, v6, v65
    v_mul_f32 v66, v6, v66
    v_mul_f32 v67, v6, v67
    v_accvgpr_write_b32 a48, v64
    v_accvgpr_write_b32 a49, v65
    v_accvgpr_write_b32 a50, v66
    v_accvgpr_write_b32 a51, v67
    v_accvgpr_read_b32 v64, a64
    v_accvgpr_read_b32 v65, a65
    v_accvgpr_read_b32 v66, a66
    v_accvgpr_read_b32 v67, a67
    v_mul_f32 v64, v6, v64
    v_mul_f32 v65, v6, v65
    v_mul_f32 v66, v6, v66
    v_mul_f32 v67, v6, v67
    v_accvgpr_write_b32 a64, v64
    v_accvgpr_write_b32 a65, v65
    v_accvgpr_write_b32 a66, v66
    v_accvgpr_write_b32 a67, v67
    v_accvgpr_read_b32 v64, a80
    v_accvgpr_read_b32 v65, a81
    v_accvgpr_read_b32 v66, a82
    v_accvgpr_read_b32 v67, a83
    v_mul_f32 v64, v6, v64
    v_mul_f32 v65, v6, v65
    v_mul_f32 v66, v6, v66
    v_mul_f32 v67, v6, v67
    v_accvgpr_write_b32 a80, v64
    v_accvgpr_write_b32 a81, v65
    v_accvgpr_write_b32 a82, v66
    v_accvgpr_write_b32 a83, v67
    v_accvgpr_read_b32 v64, a96
    v_accvgpr_read_b32 v65, a97
    v_accvgpr_read_b32 v66, a98
    v_accvgpr_read_b32 v67, a99
    v_mul_f32 v64, v6, v64
    v_mul_f32 v65, v6, v65
    v_mul_f32 v66, v6, v66
    v_mul_f32 v67, v6, v67
    v_accvgpr_write_b32 a96, v64
    v_accvgpr_write_b32 a97, v65
    v_accvgpr_write_b32 a98, v66
    v_accvgpr_write_b32 a99, v67
    v_accvgpr_read_b32 v64, a112
    v_accvgpr_read_b32 v65, a113
    v_accvgpr_read_b32 v66, a114
    v_accvgpr_read_b32 v67, a115
    v_mul_f32 v64, v6, v64
    v_mul_f32 v65, v6, v65
    v_mul_f32 v66, v6, v66
    v_mul_f32 v67, v6, v67
    v_accvgpr_write_b32 a112, v64
    v_accvgpr_write_b32 a113, v65
    v_accvgpr_write_b32 a114, v66
    v_accvgpr_write_b32 a115, v67
    v_accvgpr_read_b32 v64, a128
    v_accvgpr_read_b32 v65, a129
    v_accvgpr_read_b32 v66, a130
    v_accvgpr_read_b32 v67, a131
    v_mul_f32 v64, v6, v64
    v_mul_f32 v65, v6, v65
    v_mul_f32 v66, v6, v66
    v_mul_f32 v67, v6, v67
    v_accvgpr_write_b32 a128, v64
    v_accvgpr_write_b32 a129, v65
    v_accvgpr_write_b32 a130, v66
    v_accvgpr_write_b32 a131, v67
    v_sub_f32 v32, v32, v1
    v_sub_f32 v33, v33, v1
    v_sub_f32 v34, v34, v1
    v_sub_f32 v35, v35, v1
    v_sub_f32 v48, v48, v1
    v_sub_f32 v49, v49, v1
    v_sub_f32 v50, v50, v1
    v_sub_f32 v51, v51, v1
    v_max_f32 v2, v2, v245
    v_sub_f32 v6, v245, v2
    v_exp_f32 v6, v6
    v_mov_b32 v245, v2
    v_accvgpr_read_b32 v64, a4
    v_accvgpr_read_b32 v65, a5
    v_accvgpr_read_b32 v66, a6
    v_accvgpr_read_b32 v67, a7
    v_mul_f32 v64, v6, v64
    v_mul_f32 v65, v6, v65
    v_mul_f32 v66, v6, v66
    v_mul_f32 v67, v6, v67
    v_accvgpr_write_b32 a4, v64
    v_accvgpr_write_b32 a5, v65
    v_accvgpr_write_b32 a6, v66
    v_accvgpr_write_b32 a7, v67
    v_accvgpr_read_b32 v64, a20
    v_accvgpr_read_b32 v65, a21
    v_accvgpr_read_b32 v66, a22
    v_accvgpr_read_b32 v67, a23
    v_mul_f32 v64, v6, v64
    v_mul_f32 v65, v6, v65
    v_mul_f32 v66, v6, v66
    v_mul_f32 v67, v6, v67
    v_accvgpr_write_b32 a20, v64
    v_accvgpr_write_b32 a21, v65
    v_accvgpr_write_b32 a22, v66
    v_accvgpr_write_b32 a23, v67
    v_accvgpr_read_b32 v64, a36
    v_accvgpr_read_b32 v65, a37
    v_accvgpr_read_b32 v66, a38
    v_accvgpr_read_b32 v67, a39
    v_mul_f32 v64, v6, v64
    v_mul_f32 v65, v6, v65
    v_mul_f32 v66, v6, v66
    v_mul_f32 v67, v6, v67
    v_accvgpr_write_b32 a36, v64
    v_accvgpr_write_b32 a37, v65
    v_accvgpr_write_b32 a38, v66
    v_accvgpr_write_b32 a39, v67
    v_accvgpr_read_b32 v64, a52
    v_accvgpr_read_b32 v65, a53
    v_accvgpr_read_b32 v66, a54
    v_accvgpr_read_b32 v67, a55
    v_mul_f32 v64, v6, v64
    v_mul_f32 v65, v6, v65
    v_mul_f32 v66, v6, v66
    v_mul_f32 v67, v6, v67
    v_accvgpr_write_b32 a52, v64
    v_accvgpr_write_b32 a53, v65
    v_accvgpr_write_b32 a54, v66
    v_accvgpr_write_b32 a55, v67
    v_accvgpr_read_b32 v64, a68
    v_accvgpr_read_b32 v65, a69
    v_accvgpr_read_b32 v66, a70
    v_accvgpr_read_b32 v67, a71
    v_mul_f32 v64, v6, v64
    v_mul_f32 v65, v6, v65
    v_mul_f32 v66, v6, v66
    v_mul_f32 v67, v6, v67
    v_accvgpr_write_b32 a68, v64
    v_accvgpr_write_b32 a69, v65
    v_accvgpr_write_b32 a70, v66
    v_accvgpr_write_b32 a71, v67
    v_accvgpr_read_b32 v64, a84
    v_accvgpr_read_b32 v65, a85
    v_accvgpr_read_b32 v66, a86
    v_accvgpr_read_b32 v67, a87
    v_mul_f32 v64, v6, v64
    v_mul_f32 v65, v6, v65
    v_mul_f32 v66, v6, v66
    v_mul_f32 v67, v6, v67
    v_accvgpr_write_b32 a84, v64
    v_accvgpr_write_b32 a85, v65
    v_accvgpr_write_b32 a86, v66
    v_accvgpr_write_b32 a87, v67
    v_accvgpr_read_b32 v64, a100
    v_accvgpr_read_b32 v65, a101
    v_accvgpr_read_b32 v66, a102
    v_accvgpr_read_b32 v67, a103
    v_mul_f32 v64, v6, v64
    v_mul_f32 v65, v6, v65
    v_mul_f32 v66, v6, v66
    v_mul_f32 v67, v6, v67
    v_accvgpr_write_b32 a100, v64
    v_accvgpr_write_b32 a101, v65
    v_accvgpr_write_b32 a102, v66
    v_accvgpr_write_b32 a103, v67
    v_accvgpr_read_b32 v64, a116
    v_accvgpr_read_b32 v65, a117
    v_accvgpr_read_b32 v66, a118
    v_accvgpr_read_b32 v67, a119
    v_mul_f32 v64, v6, v64
    v_mul_f32 v65, v6, v65
    v_mul_f32 v66, v6, v66
    v_mul_f32 v67, v6, v67
    v_accvgpr_write_b32 a116, v64
    v_accvgpr_write_b32 a117, v65
    v_accvgpr_write_b32 a118, v66
    v_accvgpr_write_b32 a119, v67
    v_accvgpr_read_b32 v64, a132
    v_accvgpr_read_b32 v65, a133
    v_accvgpr_read_b32 v66, a134
    v_accvgpr_read_b32 v67, a135
    v_mul_f32 v64, v6, v64
    v_mul_f32 v65, v6, v65
    v_mul_f32 v66, v6, v66
    v_mul_f32 v67, v6, v67
    v_accvgpr_write_b32 a132, v64
    v_accvgpr_write_b32 a133, v65
    v_accvgpr_write_b32 a134, v66
    v_accvgpr_write_b32 a135, v67
    v_sub_f32 v36, v36, v2
    v_sub_f32 v37, v37, v2
    v_sub_f32 v38, v38, v2
    v_sub_f32 v39, v39, v2
    v_sub_f32 v52, v52, v2
    v_sub_f32 v53, v53, v2
    v_sub_f32 v54, v54, v2
    v_sub_f32 v55, v55, v2
    v_max_f32 v3, v3, v246
    v_sub_f32 v6, v246, v3
    v_exp_f32 v6, v6
    v_mov_b32 v246, v3
    v_accvgpr_read_b32 v64, a8
    v_accvgpr_read_b32 v65, a9
    v_accvgpr_read_b32 v66, a10
    v_accvgpr_read_b32 v67, a11
    v_mul_f32 v64, v6, v64
    v_mul_f32 v65, v6, v65
    v_mul_f32 v66, v6, v66
    v_mul_f32 v67, v6, v67
    v_accvgpr_write_b32 a8, v64
    v_accvgpr_write_b32 a9, v65
    v_accvgpr_write_b32 a10, v66
    v_accvgpr_write_b32 a11, v67
    v_accvgpr_read_b32 v64, a24
    v_accvgpr_read_b32 v65, a25
    v_accvgpr_read_b32 v66, a26
    v_accvgpr_read_b32 v67, a27
    v_mul_f32 v64, v6, v64
    v_mul_f32 v65, v6, v65
    v_mul_f32 v66, v6, v66
    v_mul_f32 v67, v6, v67
    v_accvgpr_write_b32 a24, v64
    v_accvgpr_write_b32 a25, v65
    v_accvgpr_write_b32 a26, v66
    v_accvgpr_write_b32 a27, v67
    v_accvgpr_read_b32 v64, a40
    v_accvgpr_read_b32 v65, a41
    v_accvgpr_read_b32 v66, a42
    v_accvgpr_read_b32 v67, a43
    v_mul_f32 v64, v6, v64
    v_mul_f32 v65, v6, v65
    v_mul_f32 v66, v6, v66
    v_mul_f32 v67, v6, v67
    v_accvgpr_write_b32 a40, v64
    v_accvgpr_write_b32 a41, v65
    v_accvgpr_write_b32 a42, v66
    v_accvgpr_write_b32 a43, v67
    v_accvgpr_read_b32 v64, a56
    v_accvgpr_read_b32 v65, a57
    v_accvgpr_read_b32 v66, a58
    v_accvgpr_read_b32 v67, a59
    v_mul_f32 v64, v6, v64
    v_mul_f32 v65, v6, v65
    v_mul_f32 v66, v6, v66
    v_mul_f32 v67, v6, v67
    v_accvgpr_write_b32 a56, v64
    v_accvgpr_write_b32 a57, v65
    v_accvgpr_write_b32 a58, v66
    v_accvgpr_write_b32 a59, v67
    v_accvgpr_read_b32 v64, a72
    v_accvgpr_read_b32 v65, a73
    v_accvgpr_read_b32 v66, a74
    v_accvgpr_read_b32 v67, a75
    v_mul_f32 v64, v6, v64
    v_mul_f32 v65, v6, v65
    v_mul_f32 v66, v6, v66
    v_mul_f32 v67, v6, v67
    v_accvgpr_write_b32 a72, v64
    v_accvgpr_write_b32 a73, v65
    v_accvgpr_write_b32 a74, v66
    v_accvgpr_write_b32 a75, v67
    v_accvgpr_read_b32 v64, a88
    v_accvgpr_read_b32 v65, a89
    v_accvgpr_read_b32 v66, a90
    v_accvgpr_read_b32 v67, a91
    v_mul_f32 v64, v6, v64
    v_mul_f32 v65, v6, v65
    v_mul_f32 v66, v6, v66
    v_mul_f32 v67, v6, v67
    v_accvgpr_write_b32 a88, v64
    v_accvgpr_write_b32 a89, v65
    v_accvgpr_write_b32 a90, v66
    v_accvgpr_write_b32 a91, v67
    v_accvgpr_read_b32 v64, a104
    v_accvgpr_read_b32 v65, a105
    v_accvgpr_read_b32 v66, a106
    v_accvgpr_read_b32 v67, a107
    v_mul_f32 v64, v6, v64
    v_mul_f32 v65, v6, v65
    v_mul_f32 v66, v6, v66
    v_mul_f32 v67, v6, v67
    v_accvgpr_write_b32 a104, v64
    v_accvgpr_write_b32 a105, v65
    v_accvgpr_write_b32 a106, v66
    v_accvgpr_write_b32 a107, v67
    v_accvgpr_read_b32 v64, a120
    v_accvgpr_read_b32 v65, a121
    v_accvgpr_read_b32 v66, a122
    v_accvgpr_read_b32 v67, a123
    v_mul_f32 v64, v6, v64
    v_mul_f32 v65, v6, v65
    v_mul_f32 v66, v6, v66
    v_mul_f32 v67, v6, v67
    v_accvgpr_write_b32 a120, v64
    v_accvgpr_write_b32 a121, v65
    v_accvgpr_write_b32 a122, v66
    v_accvgpr_write_b32 a123, v67
    v_accvgpr_read_b32 v64, a136
    v_accvgpr_read_b32 v65, a137
    v_accvgpr_read_b32 v66, a138
    v_accvgpr_read_b32 v67, a139
    v_mul_f32 v64, v6, v64
    v_mul_f32 v65, v6, v65
    v_mul_f32 v66, v6, v66
    v_mul_f32 v67, v6, v67
    v_accvgpr_write_b32 a136, v64
    v_accvgpr_write_b32 a137, v65
    v_accvgpr_write_b32 a138, v66
    v_accvgpr_write_b32 a139, v67
    v_sub_f32 v40, v40, v3
    v_sub_f32 v41, v41, v3
    v_sub_f32 v42, v42, v3
    v_sub_f32 v43, v43, v3
    v_sub_f32 v56, v56, v3
    v_sub_f32 v57, v57, v3
    v_sub_f32 v58, v58, v3
    v_sub_f32 v59, v59, v3
    v_max_f32 v4, v4, v247
    v_sub_f32 v6, v247, v4
    v_exp_f32 v6, v6
    v_mov_b32 v247, v4
    v_accvgpr_read_b32 v64, a12
    v_accvgpr_read_b32 v65, a13
    v_accvgpr_read_b32 v66, a14
    v_accvgpr_read_b32 v67, a15
    v_mul_f32 v64, v6, v64
    v_mul_f32 v65, v6, v65
    v_mul_f32 v66, v6, v66
    v_mul_f32 v67, v6, v67
    v_accvgpr_write_b32 a12, v64
    v_accvgpr_write_b32 a13, v65
    v_accvgpr_write_b32 a14, v66
    v_accvgpr_write_b32 a15, v67
    v_accvgpr_read_b32 v64, a28
    v_accvgpr_read_b32 v65, a29
    v_accvgpr_read_b32 v66, a30
    v_accvgpr_read_b32 v67, a31
    v_mul_f32 v64, v6, v64
    v_mul_f32 v65, v6, v65
    v_mul_f32 v66, v6, v66
    v_mul_f32 v67, v6, v67
    v_accvgpr_write_b32 a28, v64
    v_accvgpr_write_b32 a29, v65
    v_accvgpr_write_b32 a30, v66
    v_accvgpr_write_b32 a31, v67
    v_accvgpr_read_b32 v64, a44
    v_accvgpr_read_b32 v65, a45
    v_accvgpr_read_b32 v66, a46
    v_accvgpr_read_b32 v67, a47
    v_mul_f32 v64, v6, v64
    v_mul_f32 v65, v6, v65
    v_mul_f32 v66, v6, v66
    v_mul_f32 v67, v6, v67
    v_accvgpr_write_b32 a44, v64
    v_accvgpr_write_b32 a45, v65
    v_accvgpr_write_b32 a46, v66
    v_accvgpr_write_b32 a47, v67
    v_accvgpr_read_b32 v64, a60
    v_accvgpr_read_b32 v65, a61
    v_accvgpr_read_b32 v66, a62
    v_accvgpr_read_b32 v67, a63
    v_mul_f32 v64, v6, v64
    v_mul_f32 v65, v6, v65
    v_mul_f32 v66, v6, v66
    v_mul_f32 v67, v6, v67
    v_accvgpr_write_b32 a60, v64
    v_accvgpr_write_b32 a61, v65
    v_accvgpr_write_b32 a62, v66
    v_accvgpr_write_b32 a63, v67
    v_accvgpr_read_b32 v64, a76
    v_accvgpr_read_b32 v65, a77
    v_accvgpr_read_b32 v66, a78
    v_accvgpr_read_b32 v67, a79
    v_mul_f32 v64, v6, v64
    v_mul_f32 v65, v6, v65
    v_mul_f32 v66, v6, v66
    v_mul_f32 v67, v6, v67
    v_accvgpr_write_b32 a76, v64
    v_accvgpr_write_b32 a77, v65
    v_accvgpr_write_b32 a78, v66
    v_accvgpr_write_b32 a79, v67
    v_accvgpr_read_b32 v64, a92
    v_accvgpr_read_b32 v65, a93
    v_accvgpr_read_b32 v66, a94
    v_accvgpr_read_b32 v67, a95
    v_mul_f32 v64, v6, v64
    v_mul_f32 v65, v6, v65
    v_mul_f32 v66, v6, v66
    v_mul_f32 v67, v6, v67
    v_accvgpr_write_b32 a92, v64
    v_accvgpr_write_b32 a93, v65
    v_accvgpr_write_b32 a94, v66
    v_accvgpr_write_b32 a95, v67
    v_accvgpr_read_b32 v64, a108
    v_accvgpr_read_b32 v65, a109
    v_accvgpr_read_b32 v66, a110
    v_accvgpr_read_b32 v67, a111
    v_mul_f32 v64, v6, v64
    v_mul_f32 v65, v6, v65
    v_mul_f32 v66, v6, v66
    v_mul_f32 v67, v6, v67
    v_accvgpr_write_b32 a108, v64
    v_accvgpr_write_b32 a109, v65
    v_accvgpr_write_b32 a110, v66
    v_accvgpr_write_b32 a111, v67
    v_accvgpr_read_b32 v64, a124
    v_accvgpr_read_b32 v65, a125
    v_accvgpr_read_b32 v66, a126
    v_accvgpr_read_b32 v67, a127
    v_mul_f32 v64, v6, v64
    v_mul_f32 v65, v6, v65
    v_mul_f32 v66, v6, v66
    v_mul_f32 v67, v6, v67
    v_accvgpr_write_b32 a124, v64
    v_accvgpr_write_b32 a125, v65
    v_accvgpr_write_b32 a126, v66
    v_accvgpr_write_b32 a127, v67
    v_accvgpr_read_b32 v64, a140
    v_accvgpr_read_b32 v65, a141
    v_accvgpr_read_b32 v66, a142
    v_accvgpr_read_b32 v67, a143
    v_mul_f32 v64, v6, v64
    v_mul_f32 v65, v6, v65
    v_mul_f32 v66, v6, v66
    v_mul_f32 v67, v6, v67
    v_accvgpr_write_b32 a140, v64
    v_accvgpr_write_b32 a141, v65
    v_accvgpr_write_b32 a142, v66
    v_accvgpr_write_b32 a143, v67
    v_sub_f32 v44, v44, v4
    v_sub_f32 v45, v45, v4
    v_sub_f32 v46, v46, v4
    v_sub_f32 v47, v47, v4
    v_sub_f32 v60, v60, v4
    v_sub_f32 v61, v61, v4
    v_sub_f32 v62, v62, v4
    v_sub_f32 v63, v63, v4
    v_exp_f32 v32, v32
    v_exp_f32 v33, v33
    s_nop 0
    v_cvt_pk_bf16_f32 v112, v32, v33
    v_exp_f32 v34, v34
    v_exp_f32 v35, v35
    s_nop 0
    v_cvt_pk_bf16_f32 v113, v34, v35
    v_exp_f32 v36, v36
    v_exp_f32 v37, v37
    s_nop 0
    v_cvt_pk_bf16_f32 v116, v36, v37
    v_exp_f32 v38, v38
    v_exp_f32 v39, v39
    s_nop 0
    v_cvt_pk_bf16_f32 v117, v38, v39
    v_exp_f32 v40, v40
    v_exp_f32 v41, v41
    s_nop 0
    v_cvt_pk_bf16_f32 v120, v40, v41
    v_exp_f32 v42, v42
    v_exp_f32 v43, v43
    s_nop 0
    v_cvt_pk_bf16_f32 v121, v42, v43
    v_exp_f32 v44, v44
    v_exp_f32 v45, v45
    s_nop 0
    v_cvt_pk_bf16_f32 v124, v44, v45
    v_exp_f32 v46, v46
    v_exp_f32 v47, v47
    s_nop 0
    v_cvt_pk_bf16_f32 v125, v46, v47
    v_exp_f32 v48, v48
    v_exp_f32 v49, v49
    s_nop 0
    v_cvt_pk_bf16_f32 v114, v48, v49
    v_exp_f32 v50, v50
    v_exp_f32 v51, v51
    s_nop 0
    v_cvt_pk_bf16_f32 v115, v50, v51
    v_exp_f32 v52, v52
    v_exp_f32 v53, v53
    s_nop 0
    v_cvt_pk_bf16_f32 v118, v52, v53
    v_exp_f32 v54, v54
    v_exp_f32 v55, v55
    s_nop 0
    v_cvt_pk_bf16_f32 v119, v54, v55
    v_exp_f32 v56, v56
    v_exp_f32 v57, v57
    s_nop 0
    v_cvt_pk_bf16_f32 v122, v56, v57
    v_exp_f32 v58, v58
    v_exp_f32 v59, v59
    s_nop 0
    v_cvt_pk_bf16_f32 v123, v58, v59
    v_exp_f32 v60, v60
    v_exp_f32 v61, v61
    s_nop 0
    v_cvt_pk_bf16_f32 v126, v60, v61
    v_exp_f32 v62, v62
    v_exp_f32 v63, v63
    s_nop 0
    v_cvt_pk_bf16_f32 v127, v62, v63
    ds_read_b64_tr_b16 a[176:177], v12 offset:0
    ds_read_b64_tr_b16 a[178:179], v12 offset:4096
    ds_read_b64_tr_b16 a[180:181], v13 offset:0
    ds_read_b64_tr_b16 a[182:183], v13 offset:4096
    ds_read_b64_tr_b16 a[184:185], v14 offset:0
    ds_read_b64_tr_b16 a[186:187], v14 offset:4096
    ds_read_b64_tr_b16 a[188:189], v15 offset:0
    ds_read_b64_tr_b16 a[190:191], v15 offset:4096
    ds_read_b64_tr_b16 a[192:193], v16 offset:0
    ds_read_b64_tr_b16 a[194:195], v16 offset:4096
    ds_read_b64_tr_b16 a[196:197], v17 offset:0
    ds_read_b64_tr_b16 a[198:199], v17 offset:4096
    ds_read_b64_tr_b16 a[200:201], v18 offset:0
    ds_read_b64_tr_b16 a[202:203], v18 offset:4096
    ds_read_b64_tr_b16 a[204:205], v19 offset:0
    ds_read_b64_tr_b16 a[206:207], v19 offset:4096
    s_waitcnt lgkmcnt(14)
    v_mfma_f32_16x16x32_bf16 a[0:3], a[176:179], v[112:115], a[0:3]
    v_mfma_f32_16x16x32_bf16 a[4:7], a[176:179], v[116:119], a[4:7]
    v_mfma_f32_16x16x32_bf16 a[8:11], a[176:179], v[120:123], a[8:11]
    v_mfma_f32_16x16x32_bf16 a[12:15], a[176:179], v[124:127], a[12:15]
    s_waitcnt lgkmcnt(12)
    v_mfma_f32_16x16x32_bf16 a[16:19], a[180:183], v[112:115], a[16:19]
    v_mfma_f32_16x16x32_bf16 a[20:23], a[180:183], v[116:119], a[20:23]
    v_mfma_f32_16x16x32_bf16 a[24:27], a[180:183], v[120:123], a[24:27]
    v_mfma_f32_16x16x32_bf16 a[28:31], a[180:183], v[124:127], a[28:31]
    s_waitcnt lgkmcnt(10)
    v_mfma_f32_16x16x32_bf16 a[32:35], a[184:187], v[112:115], a[32:35]
    v_mfma_f32_16x16x32_bf16 a[36:39], a[184:187], v[116:119], a[36:39]
    v_mfma_f32_16x16x32_bf16 a[40:43], a[184:187], v[120:123], a[40:43]
    v_mfma_f32_16x16x32_bf16 a[44:47], a[184:187], v[124:127], a[44:47]
    s_waitcnt lgkmcnt(7)
    v_mfma_f32_16x16x32_bf16 a[48:51], a[188:191], v[112:115], a[48:51]
    v_mfma_f32_16x16x32_bf16 a[52:55], a[188:191], v[116:119], a[52:55]
    v_mfma_f32_16x16x32_bf16 a[56:59], a[188:191], v[120:123], a[56:59]
    v_mfma_f32_16x16x32_bf16 a[60:63], a[188:191], v[124:127], a[60:63]
    s_waitcnt lgkmcnt(3)
    v_mfma_f32_16x16x32_bf16 a[64:67], a[192:195], v[112:115], a[64:67]
    v_mfma_f32_16x16x32_bf16 a[68:71], a[192:195], v[116:119], a[68:71]
    v_mfma_f32_16x16x32_bf16 a[72:75], a[192:195], v[120:123], a[72:75]
    v_mfma_f32_16x16x32_bf16 a[76:79], a[192:195], v[124:127], a[76:79]
    v_mfma_f32_16x16x32_bf16 a[80:83], a[196:199], v[112:115], a[80:83]
    v_mfma_f32_16x16x32_bf16 a[84:87], a[196:199], v[116:119], a[84:87]
    v_mfma_f32_16x16x32_bf16 a[88:91], a[196:199], v[120:123], a[88:91]
    v_mfma_f32_16x16x32_bf16 a[92:95], a[196:199], v[124:127], a[92:95]
    s_waitcnt lgkmcnt(0)
    v_mfma_f32_16x16x32_bf16 a[96:99], a[200:203], v[112:115], a[96:99]
    v_mfma_f32_16x16x32_bf16 a[100:103], a[200:203], v[116:119], a[100:103]
    v_mfma_f32_16x16x32_bf16 a[104:107], a[200:203], v[120:123], a[104:107]
    v_mfma_f32_16x16x32_bf16 a[108:111], a[200:203], v[124:127], a[108:111]
    v_mfma_f32_16x16x32_bf16 a[112:115], a[204:207], v[112:115], a[112:115]
    v_mfma_f32_16x16x32_bf16 a[116:119], a[204:207], v[116:119], a[116:119]
    v_mfma_f32_16x16x32_bf16 a[120:123], a[204:207], v[120:123], a[120:123]
    v_mfma_f32_16x16x32_bf16 a[124:127], a[204:207], v[124:127], a[124:127]
    v_mfma_f32_16x16x32_bf16 a[128:131], v[28:31], v[112:115], a[128:131]
    v_mfma_f32_16x16x32_bf16 a[132:135], v[28:31], v[116:119], a[132:135]
    v_mfma_f32_16x16x32_bf16 a[136:139], v[28:31], v[120:123], a[136:139]
    v_mfma_f32_16x16x32_bf16 a[140:143], v[28:31], v[124:127], a[140:143]
    ds_read_b128 a[144:147], v8 offset:8192
    ds_read_b128 a[148:151], v9 offset:8192
    ds_read_b128 a[152:155], v10 offset:8192
    ds_read_b128 a[156:159], v11 offset:8192
    ds_read_b128 a[160:163], v8 offset:12288
    ds_read_b128 a[164:167], v9 offset:12288
    ds_read_b128 a[168:171], v10 offset:12288
    ds_read_b128 a[172:175], v11 offset:12288
    s_waitcnt lgkmcnt(7)
    v_mfma_f32_16x16x32_bf16 v[32:35], a[144:147], v[160:163], 0
    s_waitcnt lgkmcnt(6)
    v_mfma_f32_16x16x32_bf16 v[32:35], a[148:151], v[164:167], v[32:35]
    s_waitcnt lgkmcnt(5)
    v_mfma_f32_16x16x32_bf16 v[32:35], a[152:155], v[168:171], v[32:35]
    s_waitcnt lgkmcnt(4)
    v_mfma_f32_16x16x32_bf16 v[32:35], a[156:159], v[172:175], v[32:35]
    v_mfma_f32_16x16x32_bf16 v[36:39], a[144:147], v[176:179], 0
    v_mfma_f32_16x16x32_bf16 v[36:39], a[148:151], v[180:183], v[36:39]
    v_mfma_f32_16x16x32_bf16 v[36:39], a[152:155], v[184:187], v[36:39]
    v_mfma_f32_16x16x32_bf16 v[36:39], a[156:159], v[188:191], v[36:39]
    v_mfma_f32_16x16x32_bf16 v[40:43], a[144:147], v[192:195], 0
    v_mfma_f32_16x16x32_bf16 v[40:43], a[148:151], v[196:199], v[40:43]
    v_mfma_f32_16x16x32_bf16 v[40:43], a[152:155], v[200:203], v[40:43]
    v_mfma_f32_16x16x32_bf16 v[40:43], a[156:159], v[204:207], v[40:43]
    v_mfma_f32_16x16x32_bf16 v[44:47], a[144:147], v[208:211], 0
    v_mfma_f32_16x16x32_bf16 v[44:47], a[148:151], v[212:215], v[44:47]
    v_mfma_f32_16x16x32_bf16 v[44:47], a[152:155], v[216:219], v[44:47]
    v_mfma_f32_16x16x32_bf16 v[44:47], a[156:159], v[220:223], v[44:47]
    s_waitcnt lgkmcnt(3)
    v_mfma_f32_16x16x32_bf16 v[48:51], a[160:163], v[160:163], 0
    s_waitcnt lgkmcnt(2)
    v_mfma_f32_16x16x32_bf16 v[48:51], a[164:167], v[164:167], v[48:51]
    s_waitcnt lgkmcnt(1)
    v_mfma_f32_16x16x32_bf16 v[48:51], a[168:171], v[168:171], v[48:51]
    s_waitcnt lgkmcnt(0)
    v_mfma_f32_16x16x32_bf16 v[48:51], a[172:175], v[172:175], v[48:51]
    v_mfma_f32_16x16x32_bf16 v[52:55], a[160:163], v[176:179], 0
    v_mfma_f32_16x16x32_bf16 v[52:55], a[164:167], v[180:183], v[52:55]
    v_mfma_f32_16x16x32_bf16 v[52:55], a[168:171], v[184:187], v[52:55]
    v_mfma_f32_16x16x32_bf16 v[52:55], a[172:175], v[188:191], v[52:55]
    v_mfma_f32_16x16x32_bf16 v[56:59], a[160:163], v[192:195], 0
    v_mfma_f32_16x16x32_bf16 v[56:59], a[164:167], v[196:199], v[56:59]
    v_mfma_f32_16x16x32_bf16 v[56:59], a[168:171], v[200:203], v[56:59]
    v_mfma_f32_16x16x32_bf16 v[56:59], a[172:175], v[204:207], v[56:59]
    v_mfma_f32_16x16x32_bf16 v[60:63], a[160:163], v[208:211], 0
    v_mfma_f32_16x16x32_bf16 v[60:63], a[164:167], v[212:215], v[60:63]
    v_mfma_f32_16x16x32_bf16 v[60:63], a[168:171], v[216:219], v[60:63]
    v_mfma_f32_16x16x32_bf16 v[60:63], a[172:175], v[220:223], v[60:63]
    v_max3_f32 v1, v32, v33, v34
    v_max3_f32 v1, v1, v35, v48
    v_max3_f32 v1, v1, v49, v50
    v_max_f32 v1, v1, v51
    v_mov_b32 v5, v1
    s_nop 1
    v_permlane32_swap_b32 v1, v5
    v_max_f32 v1, v1, v5
    v_mov_b32 v5, v1
    s_nop 1
    v_permlane16_swap_b32 v1, v5
    v_max_f32 v1, v1, v5
    v_max3_f32 v2, v36, v37, v38
    v_max3_f32 v2, v2, v39, v52
    v_max3_f32 v2, v2, v53, v54
    v_max_f32 v2, v2, v55
    v_mov_b32 v5, v2
    s_nop 1
    v_permlane32_swap_b32 v2, v5
    v_max_f32 v2, v2, v5
    v_mov_b32 v5, v2
    s_nop 1
    v_permlane16_swap_b32 v2, v5
    v_max_f32 v2, v2, v5
    v_max3_f32 v3, v40, v41, v42
    v_max3_f32 v3, v3, v43, v56
    v_max3_f32 v3, v3, v57, v58
    v_max_f32 v3, v3, v59
    v_mov_b32 v5, v3
    s_nop 1
    v_permlane32_swap_b32 v3, v5
    v_max_f32 v3, v3, v5
    v_mov_b32 v5, v3
    s_nop 1
    v_permlane16_swap_b32 v3, v5
    v_max_f32 v3, v3, v5
    v_max3_f32 v4, v44, v45, v46
    v_max3_f32 v4, v4, v47, v60
    v_max3_f32 v4, v4, v61, v62
    v_max_f32 v4, v4, v63
    v_mov_b32 v5, v4
    s_nop 1
    v_permlane32_swap_b32 v4, v5
    v_max_f32 v4, v4, v5
    v_mov_b32 v5, v4
    s_nop 1
    v_permlane16_swap_b32 v4, v5
    v_max_f32 v4, v4, v5
    v_max_f32 v1, v1, v244
    v_sub_f32 v6, v244, v1
    v_exp_f32 v6, v6
    v_mov_b32 v244, v1
    v_accvgpr_read_b32 v64, a0
    v_accvgpr_read_b32 v65, a1
    v_accvgpr_read_b32 v66, a2
    v_accvgpr_read_b32 v67, a3
    v_mul_f32 v64, v6, v64
    v_mul_f32 v65, v6, v65
    v_mul_f32 v66, v6, v66
    v_mul_f32 v67, v6, v67
    v_accvgpr_write_b32 a0, v64
    v_accvgpr_write_b32 a1, v65
    v_accvgpr_write_b32 a2, v66
    v_accvgpr_write_b32 a3, v67
    v_accvgpr_read_b32 v64, a16
    v_accvgpr_read_b32 v65, a17
    v_accvgpr_read_b32 v66, a18
    v_accvgpr_read_b32 v67, a19
    v_mul_f32 v64, v6, v64
    v_mul_f32 v65, v6, v65
    v_mul_f32 v66, v6, v66
    v_mul_f32 v67, v6, v67
    v_accvgpr_write_b32 a16, v64
    v_accvgpr_write_b32 a17, v65
    v_accvgpr_write_b32 a18, v66
    v_accvgpr_write_b32 a19, v67
    v_accvgpr_read_b32 v64, a32
    v_accvgpr_read_b32 v65, a33
    v_accvgpr_read_b32 v66, a34
    v_accvgpr_read_b32 v67, a35
    v_mul_f32 v64, v6, v64
    v_mul_f32 v65, v6, v65
    v_mul_f32 v66, v6, v66
    v_mul_f32 v67, v6, v67
    v_accvgpr_write_b32 a32, v64
    v_accvgpr_write_b32 a33, v65
    v_accvgpr_write_b32 a34, v66
    v_accvgpr_write_b32 a35, v67
    v_accvgpr_read_b32 v64, a48
    v_accvgpr_read_b32 v65, a49
    v_accvgpr_read_b32 v66, a50
    v_accvgpr_read_b32 v67, a51
    v_mul_f32 v64, v6, v64
    v_mul_f32 v65, v6, v65
    v_mul_f32 v66, v6, v66
    v_mul_f32 v67, v6, v67
    v_accvgpr_write_b32 a48, v64
    v_accvgpr_write_b32 a49, v65
    v_accvgpr_write_b32 a50, v66
    v_accvgpr_write_b32 a51, v67
    v_accvgpr_read_b32 v64, a64
    v_accvgpr_read_b32 v65, a65
    v_accvgpr_read_b32 v66, a66
    v_accvgpr_read_b32 v67, a67
    v_mul_f32 v64, v6, v64
    v_mul_f32 v65, v6, v65
    v_mul_f32 v66, v6, v66
    v_mul_f32 v67, v6, v67
    v_accvgpr_write_b32 a64, v64
    v_accvgpr_write_b32 a65, v65
    v_accvgpr_write_b32 a66, v66
    v_accvgpr_write_b32 a67, v67
    v_accvgpr_read_b32 v64, a80
    v_accvgpr_read_b32 v65, a81
    v_accvgpr_read_b32 v66, a82
    v_accvgpr_read_b32 v67, a83
    v_mul_f32 v64, v6, v64
    v_mul_f32 v65, v6, v65
    v_mul_f32 v66, v6, v66
    v_mul_f32 v67, v6, v67
    v_accvgpr_write_b32 a80, v64
    v_accvgpr_write_b32 a81, v65
    v_accvgpr_write_b32 a82, v66
    v_accvgpr_write_b32 a83, v67
    v_accvgpr_read_b32 v64, a96
    v_accvgpr_read_b32 v65, a97
    v_accvgpr_read_b32 v66, a98
    v_accvgpr_read_b32 v67, a99
    v_mul_f32 v64, v6, v64
    v_mul_f32 v65, v6, v65
    v_mul_f32 v66, v6, v66
    v_mul_f32 v67, v6, v67
    v_accvgpr_write_b32 a96, v64
    v_accvgpr_write_b32 a97, v65
    v_accvgpr_write_b32 a98, v66
    v_accvgpr_write_b32 a99, v67
    v_accvgpr_read_b32 v64, a112
    v_accvgpr_read_b32 v65, a113
    v_accvgpr_read_b32 v66, a114
    v_accvgpr_read_b32 v67, a115
    v_mul_f32 v64, v6, v64
    v_mul_f32 v65, v6, v65
    v_mul_f32 v66, v6, v66
    v_mul_f32 v67, v6, v67
    v_accvgpr_write_b32 a112, v64
    v_accvgpr_write_b32 a113, v65
    v_accvgpr_write_b32 a114, v66
    v_accvgpr_write_b32 a115, v67
    v_accvgpr_read_b32 v64, a128
    v_accvgpr_read_b32 v65, a129
    v_accvgpr_read_b32 v66, a130
    v_accvgpr_read_b32 v67, a131
    v_mul_f32 v64, v6, v64
    v_mul_f32 v65, v6, v65
    v_mul_f32 v66, v6, v66
    v_mul_f32 v67, v6, v67
    v_accvgpr_write_b32 a128, v64
    v_accvgpr_write_b32 a129, v65
    v_accvgpr_write_b32 a130, v66
    v_accvgpr_write_b32 a131, v67
    v_sub_f32 v32, v32, v1
    v_sub_f32 v33, v33, v1
    v_sub_f32 v34, v34, v1
    v_sub_f32 v35, v35, v1
    v_sub_f32 v48, v48, v1
    v_sub_f32 v49, v49, v1
    v_sub_f32 v50, v50, v1
    v_sub_f32 v51, v51, v1
    v_max_f32 v2, v2, v245
    v_sub_f32 v6, v245, v2
    v_exp_f32 v6, v6
    v_mov_b32 v245, v2
    v_accvgpr_read_b32 v64, a4
    v_accvgpr_read_b32 v65, a5
    v_accvgpr_read_b32 v66, a6
    v_accvgpr_read_b32 v67, a7
    v_mul_f32 v64, v6, v64
    v_mul_f32 v65, v6, v65
    v_mul_f32 v66, v6, v66
    v_mul_f32 v67, v6, v67
    v_accvgpr_write_b32 a4, v64
    v_accvgpr_write_b32 a5, v65
    v_accvgpr_write_b32 a6, v66
    v_accvgpr_write_b32 a7, v67
    v_accvgpr_read_b32 v64, a20
    v_accvgpr_read_b32 v65, a21
    v_accvgpr_read_b32 v66, a22
    v_accvgpr_read_b32 v67, a23
    v_mul_f32 v64, v6, v64
    v_mul_f32 v65, v6, v65
    v_mul_f32 v66, v6, v66
    v_mul_f32 v67, v6, v67
    v_accvgpr_write_b32 a20, v64
    v_accvgpr_write_b32 a21, v65
    v_accvgpr_write_b32 a22, v66
    v_accvgpr_write_b32 a23, v67
    v_accvgpr_read_b32 v64, a36
    v_accvgpr_read_b32 v65, a37
    v_accvgpr_read_b32 v66, a38
    v_accvgpr_read_b32 v67, a39
    v_mul_f32 v64, v6, v64
    v_mul_f32 v65, v6, v65
    v_mul_f32 v66, v6, v66
    v_mul_f32 v67, v6, v67
    v_accvgpr_write_b32 a36, v64
    v_accvgpr_write_b32 a37, v65
    v_accvgpr_write_b32 a38, v66
    v_accvgpr_write_b32 a39, v67
    v_accvgpr_read_b32 v64, a52
    v_accvgpr_read_b32 v65, a53
    v_accvgpr_read_b32 v66, a54
    v_accvgpr_read_b32 v67, a55
    v_mul_f32 v64, v6, v64
    v_mul_f32 v65, v6, v65
    v_mul_f32 v66, v6, v66
    v_mul_f32 v67, v6, v67
    v_accvgpr_write_b32 a52, v64
    v_accvgpr_write_b32 a53, v65
    v_accvgpr_write_b32 a54, v66
    v_accvgpr_write_b32 a55, v67
    v_accvgpr_read_b32 v64, a68
    v_accvgpr_read_b32 v65, a69
    v_accvgpr_read_b32 v66, a70
    v_accvgpr_read_b32 v67, a71
    v_mul_f32 v64, v6, v64
    v_mul_f32 v65, v6, v65
    v_mul_f32 v66, v6, v66
    v_mul_f32 v67, v6, v67
    v_accvgpr_write_b32 a68, v64
    v_accvgpr_write_b32 a69, v65
    v_accvgpr_write_b32 a70, v66
    v_accvgpr_write_b32 a71, v67
    v_accvgpr_read_b32 v64, a84
    v_accvgpr_read_b32 v65, a85
    v_accvgpr_read_b32 v66, a86
    v_accvgpr_read_b32 v67, a87
    v_mul_f32 v64, v6, v64
    v_mul_f32 v65, v6, v65
    v_mul_f32 v66, v6, v66
    v_mul_f32 v67, v6, v67
    v_accvgpr_write_b32 a84, v64
    v_accvgpr_write_b32 a85, v65
    v_accvgpr_write_b32 a86, v66
    v_accvgpr_write_b32 a87, v67
    v_accvgpr_read_b32 v64, a100
    v_accvgpr_read_b32 v65, a101
    v_accvgpr_read_b32 v66, a102
    v_accvgpr_read_b32 v67, a103
    v_mul_f32 v64, v6, v64
    v_mul_f32 v65, v6, v65
    v_mul_f32 v66, v6, v66
    v_mul_f32 v67, v6, v67
    v_accvgpr_write_b32 a100, v64
    v_accvgpr_write_b32 a101, v65
    v_accvgpr_write_b32 a102, v66
    v_accvgpr_write_b32 a103, v67
    v_accvgpr_read_b32 v64, a116
    v_accvgpr_read_b32 v65, a117
    v_accvgpr_read_b32 v66, a118
    v_accvgpr_read_b32 v67, a119
    v_mul_f32 v64, v6, v64
    v_mul_f32 v65, v6, v65
    v_mul_f32 v66, v6, v66
    v_mul_f32 v67, v6, v67
    v_accvgpr_write_b32 a116, v64
    v_accvgpr_write_b32 a117, v65
    v_accvgpr_write_b32 a118, v66
    v_accvgpr_write_b32 a119, v67
    v_accvgpr_read_b32 v64, a132
    v_accvgpr_read_b32 v65, a133
    v_accvgpr_read_b32 v66, a134
    v_accvgpr_read_b32 v67, a135
    v_mul_f32 v64, v6, v64
    v_mul_f32 v65, v6, v65
    v_mul_f32 v66, v6, v66
    v_mul_f32 v67, v6, v67
    v_accvgpr_write_b32 a132, v64
    v_accvgpr_write_b32 a133, v65
    v_accvgpr_write_b32 a134, v66
    v_accvgpr_write_b32 a135, v67
    v_sub_f32 v36, v36, v2
    v_sub_f32 v37, v37, v2
    v_sub_f32 v38, v38, v2
    v_sub_f32 v39, v39, v2
    v_sub_f32 v52, v52, v2
    v_sub_f32 v53, v53, v2
    v_sub_f32 v54, v54, v2
    v_sub_f32 v55, v55, v2
    v_max_f32 v3, v3, v246
    v_sub_f32 v6, v246, v3
    v_exp_f32 v6, v6
    v_mov_b32 v246, v3
    v_accvgpr_read_b32 v64, a8
    v_accvgpr_read_b32 v65, a9
    v_accvgpr_read_b32 v66, a10
    v_accvgpr_read_b32 v67, a11
    v_mul_f32 v64, v6, v64
    v_mul_f32 v65, v6, v65
    v_mul_f32 v66, v6, v66
    v_mul_f32 v67, v6, v67
    v_accvgpr_write_b32 a8, v64
    v_accvgpr_write_b32 a9, v65
    v_accvgpr_write_b32 a10, v66
    v_accvgpr_write_b32 a11, v67
    v_accvgpr_read_b32 v64, a24
    v_accvgpr_read_b32 v65, a25
    v_accvgpr_read_b32 v66, a26
    v_accvgpr_read_b32 v67, a27
    v_mul_f32 v64, v6, v64
    v_mul_f32 v65, v6, v65
    v_mul_f32 v66, v6, v66
    v_mul_f32 v67, v6, v67
    v_accvgpr_write_b32 a24, v64
    v_accvgpr_write_b32 a25, v65
    v_accvgpr_write_b32 a26, v66
    v_accvgpr_write_b32 a27, v67
    v_accvgpr_read_b32 v64, a40
    v_accvgpr_read_b32 v65, a41
    v_accvgpr_read_b32 v66, a42
    v_accvgpr_read_b32 v67, a43
    v_mul_f32 v64, v6, v64
    v_mul_f32 v65, v6, v65
    v_mul_f32 v66, v6, v66
    v_mul_f32 v67, v6, v67
    v_accvgpr_write_b32 a40, v64
    v_accvgpr_write_b32 a41, v65
    v_accvgpr_write_b32 a42, v66
    v_accvgpr_write_b32 a43, v67
    v_accvgpr_read_b32 v64, a56
    v_accvgpr_read_b32 v65, a57
    v_accvgpr_read_b32 v66, a58
    v_accvgpr_read_b32 v67, a59
    v_mul_f32 v64, v6, v64
    v_mul_f32 v65, v6, v65
    v_mul_f32 v66, v6, v66
    v_mul_f32 v67, v6, v67
    v_accvgpr_write_b32 a56, v64
    v_accvgpr_write_b32 a57, v65
    v_accvgpr_write_b32 a58, v66
    v_accvgpr_write_b32 a59, v67
    v_accvgpr_read_b32 v64, a72
    v_accvgpr_read_b32 v65, a73
    v_accvgpr_read_b32 v66, a74
    v_accvgpr_read_b32 v67, a75
    v_mul_f32 v64, v6, v64
    v_mul_f32 v65, v6, v65
    v_mul_f32 v66, v6, v66
    v_mul_f32 v67, v6, v67
    v_accvgpr_write_b32 a72, v64
    v_accvgpr_write_b32 a73, v65
    v_accvgpr_write_b32 a74, v66
    v_accvgpr_write_b32 a75, v67
    v_accvgpr_read_b32 v64, a88
    v_accvgpr_read_b32 v65, a89
    v_accvgpr_read_b32 v66, a90
    v_accvgpr_read_b32 v67, a91
    v_mul_f32 v64, v6, v64
    v_mul_f32 v65, v6, v65
    v_mul_f32 v66, v6, v66
    v_mul_f32 v67, v6, v67
    v_accvgpr_write_b32 a88, v64
    v_accvgpr_write_b32 a89, v65
    v_accvgpr_write_b32 a90, v66
    v_accvgpr_write_b32 a91, v67
    v_accvgpr_read_b32 v64, a104
    v_accvgpr_read_b32 v65, a105
    v_accvgpr_read_b32 v66, a106
    v_accvgpr_read_b32 v67, a107
    v_mul_f32 v64, v6, v64
    v_mul_f32 v65, v6, v65
    v_mul_f32 v66, v6, v66
    v_mul_f32 v67, v6, v67
    v_accvgpr_write_b32 a104, v64
    v_accvgpr_write_b32 a105, v65
    v_accvgpr_write_b32 a106, v66
    v_accvgpr_write_b32 a107, v67
    v_accvgpr_read_b32 v64, a120
    v_accvgpr_read_b32 v65, a121
    v_accvgpr_read_b32 v66, a122
    v_accvgpr_read_b32 v67, a123
    v_mul_f32 v64, v6, v64
    v_mul_f32 v65, v6, v65
    v_mul_f32 v66, v6, v66
    v_mul_f32 v67, v6, v67
    v_accvgpr_write_b32 a120, v64
    v_accvgpr_write_b32 a121, v65
    v_accvgpr_write_b32 a122, v66
    v_accvgpr_write_b32 a123, v67
    v_accvgpr_read_b32 v64, a136
    v_accvgpr_read_b32 v65, a137
    v_accvgpr_read_b32 v66, a138
    v_accvgpr_read_b32 v67, a139
    v_mul_f32 v64, v6, v64
    v_mul_f32 v65, v6, v65
    v_mul_f32 v66, v6, v66
    v_mul_f32 v67, v6, v67
    v_accvgpr_write_b32 a136, v64
    v_accvgpr_write_b32 a137, v65
    v_accvgpr_write_b32 a138, v66
    v_accvgpr_write_b32 a139, v67
    v_sub_f32 v40, v40, v3
    v_sub_f32 v41, v41, v3
    v_sub_f32 v42, v42, v3
    v_sub_f32 v43, v43, v3
    v_sub_f32 v56, v56, v3
    v_sub_f32 v57, v57, v3
    v_sub_f32 v58, v58, v3
    v_sub_f32 v59, v59, v3
    v_max_f32 v4, v4, v247
    v_sub_f32 v6, v247, v4
    v_exp_f32 v6, v6
    v_mov_b32 v247, v4
    v_accvgpr_read_b32 v64, a12
    v_accvgpr_read_b32 v65, a13
    v_accvgpr_read_b32 v66, a14
    v_accvgpr_read_b32 v67, a15
    v_mul_f32 v64, v6, v64
    v_mul_f32 v65, v6, v65
    v_mul_f32 v66, v6, v66
    v_mul_f32 v67, v6, v67
    v_accvgpr_write_b32 a12, v64
    v_accvgpr_write_b32 a13, v65
    v_accvgpr_write_b32 a14, v66
    v_accvgpr_write_b32 a15, v67
    v_accvgpr_read_b32 v64, a28
    v_accvgpr_read_b32 v65, a29
    v_accvgpr_read_b32 v66, a30
    v_accvgpr_read_b32 v67, a31
    v_mul_f32 v64, v6, v64
    v_mul_f32 v65, v6, v65
    v_mul_f32 v66, v6, v66
    v_mul_f32 v67, v6, v67
    v_accvgpr_write_b32 a28, v64
    v_accvgpr_write_b32 a29, v65
    v_accvgpr_write_b32 a30, v66
    v_accvgpr_write_b32 a31, v67
    v_accvgpr_read_b32 v64, a44
    v_accvgpr_read_b32 v65, a45
    v_accvgpr_read_b32 v66, a46
    v_accvgpr_read_b32 v67, a47
    v_mul_f32 v64, v6, v64
    v_mul_f32 v65, v6, v65
    v_mul_f32 v66, v6, v66
    v_mul_f32 v67, v6, v67
    v_accvgpr_write_b32 a44, v64
    v_accvgpr_write_b32 a45, v65
    v_accvgpr_write_b32 a46, v66
    v_accvgpr_write_b32 a47, v67
    v_accvgpr_read_b32 v64, a60
    v_accvgpr_read_b32 v65, a61
    v_accvgpr_read_b32 v66, a62
    v_accvgpr_read_b32 v67, a63
    v_mul_f32 v64, v6, v64
    v_mul_f32 v65, v6, v65
    v_mul_f32 v66, v6, v66
    v_mul_f32 v67, v6, v67
    v_accvgpr_write_b32 a60, v64
    v_accvgpr_write_b32 a61, v65
    v_accvgpr_write_b32 a62, v66
    v_accvgpr_write_b32 a63, v67
    v_accvgpr_read_b32 v64, a76
    v_accvgpr_read_b32 v65, a77
    v_accvgpr_read_b32 v66, a78
    v_accvgpr_read_b32 v67, a79
    v_mul_f32 v64, v6, v64
    v_mul_f32 v65, v6, v65
    v_mul_f32 v66, v6, v66
    v_mul_f32 v67, v6, v67
    v_accvgpr_write_b32 a76, v64
    v_accvgpr_write_b32 a77, v65
    v_accvgpr_write_b32 a78, v66
    v_accvgpr_write_b32 a79, v67
    v_accvgpr_read_b32 v64, a92
    v_accvgpr_read_b32 v65, a93
    v_accvgpr_read_b32 v66, a94
    v_accvgpr_read_b32 v67, a95
    v_mul_f32 v64, v6, v64
    v_mul_f32 v65, v6, v65
    v_mul_f32 v66, v6, v66
    v_mul_f32 v67, v6, v67
    v_accvgpr_write_b32 a92, v64
    v_accvgpr_write_b32 a93, v65
    v_accvgpr_write_b32 a94, v66
    v_accvgpr_write_b32 a95, v67
    v_accvgpr_read_b32 v64, a108
    v_accvgpr_read_b32 v65, a109
    v_accvgpr_read_b32 v66, a110
    v_accvgpr_read_b32 v67, a111
    v_mul_f32 v64, v6, v64
    v_mul_f32 v65, v6, v65
    v_mul_f32 v66, v6, v66
    v_mul_f32 v67, v6, v67
    v_accvgpr_write_b32 a108, v64
    v_accvgpr_write_b32 a109, v65
    v_accvgpr_write_b32 a110, v66
    v_accvgpr_write_b32 a111, v67
    v_accvgpr_read_b32 v64, a124
    v_accvgpr_read_b32 v65, a125
    v_accvgpr_read_b32 v66, a126
    v_accvgpr_read_b32 v67, a127
    v_mul_f32 v64, v6, v64
    v_mul_f32 v65, v6, v65
    v_mul_f32 v66, v6, v66
    v_mul_f32 v67, v6, v67
    v_accvgpr_write_b32 a124, v64
    v_accvgpr_write_b32 a125, v65
    v_accvgpr_write_b32 a126, v66
    v_accvgpr_write_b32 a127, v67
    v_accvgpr_read_b32 v64, a140
    v_accvgpr_read_b32 v65, a141
    v_accvgpr_read_b32 v66, a142
    v_accvgpr_read_b32 v67, a143
    v_mul_f32 v64, v6, v64
    v_mul_f32 v65, v6, v65
    v_mul_f32 v66, v6, v66
    v_mul_f32 v67, v6, v67
    v_accvgpr_write_b32 a140, v64
    v_accvgpr_write_b32 a141, v65
    v_accvgpr_write_b32 a142, v66
    v_accvgpr_write_b32 a143, v67
    v_sub_f32 v44, v44, v4
    v_sub_f32 v45, v45, v4
    v_sub_f32 v46, v46, v4
    v_sub_f32 v47, v47, v4
    v_sub_f32 v60, v60, v4
    v_sub_f32 v61, v61, v4
    v_sub_f32 v62, v62, v4
    v_sub_f32 v63, v63, v4
    v_exp_f32 v32, v32
    v_exp_f32 v33, v33
    s_nop 0
    v_cvt_pk_bf16_f32 v112, v32, v33
    v_exp_f32 v34, v34
    v_exp_f32 v35, v35
    s_nop 0
    v_cvt_pk_bf16_f32 v113, v34, v35
    v_exp_f32 v36, v36
    v_exp_f32 v37, v37
    s_nop 0
    v_cvt_pk_bf16_f32 v116, v36, v37
    v_exp_f32 v38, v38
    v_exp_f32 v39, v39
    s_nop 0
    v_cvt_pk_bf16_f32 v117, v38, v39
    v_exp_f32 v40, v40
    v_exp_f32 v41, v41
    s_nop 0
    v_cvt_pk_bf16_f32 v120, v40, v41
    v_exp_f32 v42, v42
    v_exp_f32 v43, v43
    s_nop 0
    v_cvt_pk_bf16_f32 v121, v42, v43
    v_exp_f32 v44, v44
    v_exp_f32 v45, v45
    s_nop 0
    v_cvt_pk_bf16_f32 v124, v44, v45
    v_exp_f32 v46, v46
    v_exp_f32 v47, v47
    s_nop 0
    v_cvt_pk_bf16_f32 v125, v46, v47
    v_exp_f32 v48, v48
    v_exp_f32 v49, v49
    s_nop 0
    v_cvt_pk_bf16_f32 v114, v48, v49
    v_exp_f32 v50, v50
    v_exp_f32 v51, v51
    s_nop 0
    v_cvt_pk_bf16_f32 v115, v50, v51
    v_exp_f32 v52, v52
    v_exp_f32 v53, v53
    s_nop 0
    v_cvt_pk_bf16_f32 v118, v52, v53
    v_exp_f32 v54, v54
    v_exp_f32 v55, v55
    s_nop 0
    v_cvt_pk_bf16_f32 v119, v54, v55
    v_exp_f32 v56, v56
    v_exp_f32 v57, v57
    s_nop 0
    v_cvt_pk_bf16_f32 v122, v56, v57
    v_exp_f32 v58, v58
    v_exp_f32 v59, v59
    s_nop 0
    v_cvt_pk_bf16_f32 v123, v58, v59
    v_exp_f32 v60, v60
    v_exp_f32 v61, v61
    s_nop 0
    v_cvt_pk_bf16_f32 v126, v60, v61
    v_exp_f32 v62, v62
    v_exp_f32 v63, v63
    s_nop 0
    v_cvt_pk_bf16_f32 v127, v62, v63
    ds_read_b64_tr_b16 a[176:177], v12 offset:8192
    ds_read_b64_tr_b16 a[178:179], v12 offset:12288
    ds_read_b64_tr_b16 a[180:181], v13 offset:8192
    ds_read_b64_tr_b16 a[182:183], v13 offset:12288
    ds_read_b64_tr_b16 a[184:185], v14 offset:8192
    ds_read_b64_tr_b16 a[186:187], v14 offset:12288
    ds_read_b64_tr_b16 a[188:189], v15 offset:8192
    ds_read_b64_tr_b16 a[190:191], v15 offset:12288
    ds_read_b64_tr_b16 a[192:193], v16 offset:8192
    ds_read_b64_tr_b16 a[194:195], v16 offset:12288
    ds_read_b64_tr_b16 a[196:197], v17 offset:8192
    ds_read_b64_tr_b16 a[198:199], v17 offset:12288
    ds_read_b64_tr_b16 a[200:201], v18 offset:8192
    ds_read_b64_tr_b16 a[202:203], v18 offset:12288
    ds_read_b64_tr_b16 a[204:205], v19 offset:8192
    ds_read_b64_tr_b16 a[206:207], v19 offset:12288
    s_waitcnt lgkmcnt(14)
    v_mfma_f32_16x16x32_bf16 a[0:3], a[176:179], v[112:115], a[0:3]
    v_mfma_f32_16x16x32_bf16 a[4:7], a[176:179], v[116:119], a[4:7]
    v_mfma_f32_16x16x32_bf16 a[8:11], a[176:179], v[120:123], a[8:11]
    v_mfma_f32_16x16x32_bf16 a[12:15], a[176:179], v[124:127], a[12:15]
    s_waitcnt lgkmcnt(12)
    v_mfma_f32_16x16x32_bf16 a[16:19], a[180:183], v[112:115], a[16:19]
    v_mfma_f32_16x16x32_bf16 a[20:23], a[180:183], v[116:119], a[20:23]
    v_mfma_f32_16x16x32_bf16 a[24:27], a[180:183], v[120:123], a[24:27]
    v_mfma_f32_16x16x32_bf16 a[28:31], a[180:183], v[124:127], a[28:31]
    s_waitcnt lgkmcnt(10)
    v_mfma_f32_16x16x32_bf16 a[32:35], a[184:187], v[112:115], a[32:35]
    v_mfma_f32_16x16x32_bf16 a[36:39], a[184:187], v[116:119], a[36:39]
    v_mfma_f32_16x16x32_bf16 a[40:43], a[184:187], v[120:123], a[40:43]
    v_mfma_f32_16x16x32_bf16 a[44:47], a[184:187], v[124:127], a[44:47]
    s_waitcnt lgkmcnt(7)
    v_mfma_f32_16x16x32_bf16 a[48:51], a[188:191], v[112:115], a[48:51]
    v_mfma_f32_16x16x32_bf16 a[52:55], a[188:191], v[116:119], a[52:55]
    v_mfma_f32_16x16x32_bf16 a[56:59], a[188:191], v[120:123], a[56:59]
    v_mfma_f32_16x16x32_bf16 a[60:63], a[188:191], v[124:127], a[60:63]
    s_waitcnt lgkmcnt(3)
    v_mfma_f32_16x16x32_bf16 a[64:67], a[192:195], v[112:115], a[64:67]
    v_mfma_f32_16x16x32_bf16 a[68:71], a[192:195], v[116:119], a[68:71]
    v_mfma_f32_16x16x32_bf16 a[72:75], a[192:195], v[120:123], a[72:75]
    v_mfma_f32_16x16x32_bf16 a[76:79], a[192:195], v[124:127], a[76:79]
    v_mfma_f32_16x16x32_bf16 a[80:83], a[196:199], v[112:115], a[80:83]
    v_mfma_f32_16x16x32_bf16 a[84:87], a[196:199], v[116:119], a[84:87]
    v_mfma_f32_16x16x32_bf16 a[88:91], a[196:199], v[120:123], a[88:91]
    v_mfma_f32_16x16x32_bf16 a[92:95], a[196:199], v[124:127], a[92:95]
    s_waitcnt lgkmcnt(0)
    v_mfma_f32_16x16x32_bf16 a[96:99], a[200:203], v[112:115], a[96:99]
    v_mfma_f32_16x16x32_bf16 a[100:103], a[200:203], v[116:119], a[100:103]
    v_mfma_f32_16x16x32_bf16 a[104:107], a[200:203], v[120:123], a[104:107]
    v_mfma_f32_16x16x32_bf16 a[108:111], a[200:203], v[124:127], a[108:111]
    v_mfma_f32_16x16x32_bf16 a[112:115], a[204:207], v[112:115], a[112:115]
    v_mfma_f32_16x16x32_bf16 a[116:119], a[204:207], v[116:119], a[116:119]
    v_mfma_f32_16x16x32_bf16 a[120:123], a[204:207], v[120:123], a[120:123]
    v_mfma_f32_16x16x32_bf16 a[124:127], a[204:207], v[124:127], a[124:127]
    v_mfma_f32_16x16x32_bf16 a[128:131], v[28:31], v[112:115], a[128:131]
    v_mfma_f32_16x16x32_bf16 a[132:135], v[28:31], v[116:119], a[132:135]
    v_mfma_f32_16x16x32_bf16 a[136:139], v[28:31], v[120:123], a[136:139]
    v_mfma_f32_16x16x32_bf16 a[140:143], v[28:31], v[124:127], a[140:143]
    s_add_u32 s57, s57, 16384
    s_sub_u32 s59, s59, 1
    s_cmp_lg_u32 s59, 0
    s_cbranch_scc1 KA_FLOOP
    s_nop 7
    v_accvgpr_read_b32 v4, a128
    v_accvgpr_read_b32 v5, a132
    v_accvgpr_read_b32 v6, a136
    v_accvgpr_read_b32 v7, a140
    v_rcp_f32 v4, v4
    v_rcp_f32 v5, v5
    v_rcp_f32 v6, v6
    v_rcp_f32 v7, v7
    s_lshl_b32 s55, s4, 12
    s_add_u32 s55, s55, s52
    v_accvgpr_read_b32 v32, a0
    v_accvgpr_read_b32 v33, a1
    v_accvgpr_read_b32 v34, a2
    v_accvgpr_read_b32 v35, a3
    v_accvgpr_read_b32 v36, a16
    v_accvgpr_read_b32 v37, a17
    v_accvgpr_read_b32 v38, a18
    v_accvgpr_read_b32 v39, a19
    v_pk_mul_f32 v[32:33], v[32:33], v[4:5] op_sel:[0,0] op_sel_hi:[1,0]
    v_pk_mul_f32 v[34:35], v[34:35], v[4:5] op_sel:[0,0] op_sel_hi:[1,0]
    v_pk_mul_f32 v[36:37], v[36:37], v[4:5] op_sel:[0,0] op_sel_hi:[1,0]
    v_pk_mul_f32 v[38:39], v[38:39], v[4:5] op_sel:[0,0] op_sel_hi:[1,0]
    v_cvt_pk_bf16_f32 v8, v32, v33
    v_cvt_pk_bf16_f32 v9, v34, v35
    v_cvt_pk_bf16_f32 v10, v36, v37
    v_cvt_pk_bf16_f32 v11, v38, v39
    buffer_store_dwordx4 v[8:11], v240, s[28:31], s55 offen offset:0 sc1
    v_accvgpr_read_b32 v40, a32
    v_accvgpr_read_b32 v41, a33
    v_accvgpr_read_b32 v42, a34
    v_accvgpr_read_b32 v43, a35
    v_accvgpr_read_b32 v44, a48
    v_accvgpr_read_b32 v45, a49
    v_accvgpr_read_b32 v46, a50
    v_accvgpr_read_b32 v47, a51
    v_pk_mul_f32 v[40:41], v[40:41], v[4:5] op_sel:[0,0] op_sel_hi:[1,0]
    v_pk_mul_f32 v[42:43], v[42:43], v[4:5] op_sel:[0,0] op_sel_hi:[1,0]
    v_pk_mul_f32 v[44:45], v[44:45], v[4:5] op_sel:[0,0] op_sel_hi:[1,0]
    v_pk_mul_f32 v[46:47], v[46:47], v[4:5] op_sel:[0,0] op_sel_hi:[1,0]
    v_cvt_pk_bf16_f32 v12, v40, v41
    v_cvt_pk_bf16_f32 v13, v42, v43
    v_cvt_pk_bf16_f32 v14, v44, v45
    v_cvt_pk_bf16_f32 v15, v46, v47
    buffer_store_dwordx4 v[12:15], v240, s[28:31], s55 offen offset:1024 sc1
    v_accvgpr_read_b32 v48, a64
    v_accvgpr_read_b32 v49, a65
    v_accvgpr_read_b32 v50, a66
    v_accvgpr_read_b32 v51, a67
    v_accvgpr_read_b32 v52, a80
    v_accvgpr_read_b32 v53, a81
    v_accvgpr_read_b32 v54, a82
    v_accvgpr_read_b32 v55, a83
    v_pk_mul_f32 v[48:49], v[48:49], v[4:5] op_sel:[0,0] op_sel_hi:[1,0]
    v_pk_mul_f32 v[50:51], v[50:51], v[4:5] op_sel:[0,0] op_sel_hi:[1,0]
    v_pk_mul_f32 v[52:53], v[52:53], v[4:5] op_sel:[0,0] op_sel_hi:[1,0]
    v_pk_mul_f32 v[54:55], v[54:55], v[4:5] op_sel:[0,0] op_sel_hi:[1,0]
    v_cvt_pk_bf16_f32 v16, v48, v49
    v_cvt_pk_bf16_f32 v17, v50, v51
    v_cvt_pk_bf16_f32 v18, v52, v53
    v_cvt_pk_bf16_f32 v19, v54, v55
    buffer_store_dwordx4 v[16:19], v240, s[28:31], s55 offen offset:2048 sc1
    v_accvgpr_read_b32 v56, a96
    v_accvgpr_read_b32 v57, a97
    v_accvgpr_read_b32 v58, a98
    v_accvgpr_read_b32 v59, a99
    v_accvgpr_read_b32 v60, a112
    v_accvgpr_read_b32 v61, a113
    v_accvgpr_read_b32 v62, a114
    v_accvgpr_read_b32 v63, a115
    v_pk_mul_f32 v[56:57], v[56:57], v[4:5] op_sel:[0,0] op_sel_hi:[1,0]
    v_pk_mul_f32 v[58:59], v[58:59], v[4:5] op_sel:[0,0] op_sel_hi:[1,0]
    v_pk_mul_f32 v[60:61], v[60:61], v[4:5] op_sel:[0,0] op_sel_hi:[1,0]
    v_pk_mul_f32 v[62:63], v[62:63], v[4:5] op_sel:[0,0] op_sel_hi:[1,0]
    v_cvt_pk_bf16_f32 v20, v56, v57
    v_cvt_pk_bf16_f32 v21, v58, v59
    v_cvt_pk_bf16_f32 v22, v60, v61
    v_cvt_pk_bf16_f32 v23, v62, v63
    buffer_store_dwordx4 v[20:23], v240, s[28:31], s55 offen offset:3072 sc1
    s_add_u32 s55, s55, 186368
    v_accvgpr_read_b32 v32, a4
    v_accvgpr_read_b32 v33, a5
    v_accvgpr_read_b32 v34, a6
    v_accvgpr_read_b32 v35, a7
    v_accvgpr_read_b32 v36, a20
    v_accvgpr_read_b32 v37, a21
    v_accvgpr_read_b32 v38, a22
    v_accvgpr_read_b32 v39, a23
    v_pk_mul_f32 v[32:33], v[32:33], v[4:5] op_sel:[0,1] op_sel_hi:[1,1]
    v_pk_mul_f32 v[34:35], v[34:35], v[4:5] op_sel:[0,1] op_sel_hi:[1,1]
    v_pk_mul_f32 v[36:37], v[36:37], v[4:5] op_sel:[0,1] op_sel_hi:[1,1]
    v_pk_mul_f32 v[38:39], v[38:39], v[4:5] op_sel:[0,1] op_sel_hi:[1,1]
    v_cvt_pk_bf16_f32 v8, v32, v33
    v_cvt_pk_bf16_f32 v9, v34, v35
    v_cvt_pk_bf16_f32 v10, v36, v37
    v_cvt_pk_bf16_f32 v11, v38, v39
    buffer_store_dwordx4 v[8:11], v240, s[28:31], s55 offen offset:0 sc1
    v_accvgpr_read_b32 v40, a36
    v_accvgpr_read_b32 v41, a37
    v_accvgpr_read_b32 v42, a38
    v_accvgpr_read_b32 v43, a39
    v_accvgpr_read_b32 v44, a52
    v_accvgpr_read_b32 v45, a53
    v_accvgpr_read_b32 v46, a54
    v_accvgpr_read_b32 v47, a55
    v_pk_mul_f32 v[40:41], v[40:41], v[4:5] op_sel:[0,1] op_sel_hi:[1,1]
    v_pk_mul_f32 v[42:43], v[42:43], v[4:5] op_sel:[0,1] op_sel_hi:[1,1]
    v_pk_mul_f32 v[44:45], v[44:45], v[4:5] op_sel:[0,1] op_sel_hi:[1,1]
    v_pk_mul_f32 v[46:47], v[46:47], v[4:5] op_sel:[0,1] op_sel_hi:[1,1]
    v_cvt_pk_bf16_f32 v12, v40, v41
    v_cvt_pk_bf16_f32 v13, v42, v43
    v_cvt_pk_bf16_f32 v14, v44, v45
    v_cvt_pk_bf16_f32 v15, v46, v47
    buffer_store_dwordx4 v[12:15], v240, s[28:31], s55 offen offset:1024 sc1
    v_accvgpr_read_b32 v48, a68
    v_accvgpr_read_b32 v49, a69
    v_accvgpr_read_b32 v50, a70
    v_accvgpr_read_b32 v51, a71
    v_accvgpr_read_b32 v52, a84
    v_accvgpr_read_b32 v53, a85
    v_accvgpr_read_b32 v54, a86
    v_accvgpr_read_b32 v55, a87
    v_pk_mul_f32 v[48:49], v[48:49], v[4:5] op_sel:[0,1] op_sel_hi:[1,1]
    v_pk_mul_f32 v[50:51], v[50:51], v[4:5] op_sel:[0,1] op_sel_hi:[1,1]
    v_pk_mul_f32 v[52:53], v[52:53], v[4:5] op_sel:[0,1] op_sel_hi:[1,1]
    v_pk_mul_f32 v[54:55], v[54:55], v[4:5] op_sel:[0,1] op_sel_hi:[1,1]
    v_cvt_pk_bf16_f32 v16, v48, v49
    v_cvt_pk_bf16_f32 v17, v50, v51
    v_cvt_pk_bf16_f32 v18, v52, v53
    v_cvt_pk_bf16_f32 v19, v54, v55
    buffer_store_dwordx4 v[16:19], v240, s[28:31], s55 offen offset:2048 sc1
    v_accvgpr_read_b32 v56, a100
    v_accvgpr_read_b32 v57, a101
    v_accvgpr_read_b32 v58, a102
    v_accvgpr_read_b32 v59, a103
    v_accvgpr_read_b32 v60, a116
    v_accvgpr_read_b32 v61, a117
    v_accvgpr_read_b32 v62, a118
    v_accvgpr_read_b32 v63, a119
    v_pk_mul_f32 v[56:57], v[56:57], v[4:5] op_sel:[0,1] op_sel_hi:[1,1]
    v_pk_mul_f32 v[58:59], v[58:59], v[4:5] op_sel:[0,1] op_sel_hi:[1,1]
    v_pk_mul_f32 v[60:61], v[60:61], v[4:5] op_sel:[0,1] op_sel_hi:[1,1]
    v_pk_mul_f32 v[62:63], v[62:63], v[4:5] op_sel:[0,1] op_sel_hi:[1,1]
    v_cvt_pk_bf16_f32 v20, v56, v57
    v_cvt_pk_bf16_f32 v21, v58, v59
    v_cvt_pk_bf16_f32 v22, v60, v61
    v_cvt_pk_bf16_f32 v23, v62, v63
    buffer_store_dwordx4 v[20:23], v240, s[28:31], s55 offen offset:3072 sc1
    s_add_u32 s55, s55, 186368
    v_accvgpr_read_b32 v32, a8
    v_accvgpr_read_b32 v33, a9
    v_accvgpr_read_b32 v34, a10
    v_accvgpr_read_b32 v35, a11
    v_accvgpr_read_b32 v36, a24
    v_accvgpr_read_b32 v37, a25
    v_accvgpr_read_b32 v38, a26
    v_accvgpr_read_b32 v39, a27
    v_pk_mul_f32 v[32:33], v[32:33], v[6:7] op_sel:[0,0] op_sel_hi:[1,0]
    v_pk_mul_f32 v[34:35], v[34:35], v[6:7] op_sel:[0,0] op_sel_hi:[1,0]
    v_pk_mul_f32 v[36:37], v[36:37], v[6:7] op_sel:[0,0] op_sel_hi:[1,0]
    v_pk_mul_f32 v[38:39], v[38:39], v[6:7] op_sel:[0,0] op_sel_hi:[1,0]
    v_cvt_pk_bf16_f32 v8, v32, v33
    v_cvt_pk_bf16_f32 v9, v34, v35
    v_cvt_pk_bf16_f32 v10, v36, v37
    v_cvt_pk_bf16_f32 v11, v38, v39
    buffer_store_dwordx4 v[8:11], v240, s[28:31], s55 offen offset:0 sc1
    v_accvgpr_read_b32 v40, a40
    v_accvgpr_read_b32 v41, a41
    v_accvgpr_read_b32 v42, a42
    v_accvgpr_read_b32 v43, a43
    v_accvgpr_read_b32 v44, a56
    v_accvgpr_read_b32 v45, a57
    v_accvgpr_read_b32 v46, a58
    v_accvgpr_read_b32 v47, a59
    v_pk_mul_f32 v[40:41], v[40:41], v[6:7] op_sel:[0,0] op_sel_hi:[1,0]
    v_pk_mul_f32 v[42:43], v[42:43], v[6:7] op_sel:[0,0] op_sel_hi:[1,0]
    v_pk_mul_f32 v[44:45], v[44:45], v[6:7] op_sel:[0,0] op_sel_hi:[1,0]
    v_pk_mul_f32 v[46:47], v[46:47], v[6:7] op_sel:[0,0] op_sel_hi:[1,0]
    v_cvt_pk_bf16_f32 v12, v40, v41
    v_cvt_pk_bf16_f32 v13, v42, v43
    v_cvt_pk_bf16_f32 v14, v44, v45
    v_cvt_pk_bf16_f32 v15, v46, v47
    buffer_store_dwordx4 v[12:15], v240, s[28:31], s55 offen offset:1024 sc1
    v_accvgpr_read_b32 v48, a72
    v_accvgpr_read_b32 v49, a73
    v_accvgpr_read_b32 v50, a74
    v_accvgpr_read_b32 v51, a75
    v_accvgpr_read_b32 v52, a88
    v_accvgpr_read_b32 v53, a89
    v_accvgpr_read_b32 v54, a90
    v_accvgpr_read_b32 v55, a91
    v_pk_mul_f32 v[48:49], v[48:49], v[6:7] op_sel:[0,0] op_sel_hi:[1,0]
    v_pk_mul_f32 v[50:51], v[50:51], v[6:7] op_sel:[0,0] op_sel_hi:[1,0]
    v_pk_mul_f32 v[52:53], v[52:53], v[6:7] op_sel:[0,0] op_sel_hi:[1,0]
    v_pk_mul_f32 v[54:55], v[54:55], v[6:7] op_sel:[0,0] op_sel_hi:[1,0]
    v_cvt_pk_bf16_f32 v16, v48, v49
    v_cvt_pk_bf16_f32 v17, v50, v51
    v_cvt_pk_bf16_f32 v18, v52, v53
    v_cvt_pk_bf16_f32 v19, v54, v55
    buffer_store_dwordx4 v[16:19], v240, s[28:31], s55 offen offset:2048 sc1
    v_accvgpr_read_b32 v56, a104
    v_accvgpr_read_b32 v57, a105
    v_accvgpr_read_b32 v58, a106
    v_accvgpr_read_b32 v59, a107
    v_accvgpr_read_b32 v60, a120
    v_accvgpr_read_b32 v61, a121
    v_accvgpr_read_b32 v62, a122
    v_accvgpr_read_b32 v63, a123
    v_pk_mul_f32 v[56:57], v[56:57], v[6:7] op_sel:[0,0] op_sel_hi:[1,0]
    v_pk_mul_f32 v[58:59], v[58:59], v[6:7] op_sel:[0,0] op_sel_hi:[1,0]
    v_pk_mul_f32 v[60:61], v[60:61], v[6:7] op_sel:[0,0] op_sel_hi:[1,0]
    v_pk_mul_f32 v[62:63], v[62:63], v[6:7] op_sel:[0,0] op_sel_hi:[1,0]
    v_cvt_pk_bf16_f32 v20, v56, v57
    v_cvt_pk_bf16_f32 v21, v58, v59
    v_cvt_pk_bf16_f32 v22, v60, v61
    v_cvt_pk_bf16_f32 v23, v62, v63
    buffer_store_dwordx4 v[20:23], v240, s[28:31], s55 offen offset:3072 sc1
    s_add_u32 s55, s55, 186368
    v_accvgpr_read_b32 v32, a12
    v_accvgpr_read_b32 v33, a13
    v_accvgpr_read_b32 v34, a14
    v_accvgpr_read_b32 v35, a15
    v_accvgpr_read_b32 v36, a28
    v_accvgpr_read_b32 v37, a29
    v_accvgpr_read_b32 v38, a30
    v_accvgpr_read_b32 v39, a31
    v_pk_mul_f32 v[32:33], v[32:33], v[6:7] op_sel:[0,1] op_sel_hi:[1,1]
    v_pk_mul_f32 v[34:35], v[34:35], v[6:7] op_sel:[0,1] op_sel_hi:[1,1]
    v_pk_mul_f32 v[36:37], v[36:37], v[6:7] op_sel:[0,1] op_sel_hi:[1,1]
    v_pk_mul_f32 v[38:39], v[38:39], v[6:7] op_sel:[0,1] op_sel_hi:[1,1]
    v_cvt_pk_bf16_f32 v8, v32, v33
    v_cvt_pk_bf16_f32 v9, v34, v35
    v_cvt_pk_bf16_f32 v10, v36, v37
    v_cvt_pk_bf16_f32 v11, v38, v39
    buffer_store_dwordx4 v[8:11], v240, s[28:31], s55 offen offset:0 sc1
    v_accvgpr_read_b32 v40, a44
    v_accvgpr_read_b32 v41, a45
    v_accvgpr_read_b32 v42, a46
    v_accvgpr_read_b32 v43, a47
    v_accvgpr_read_b32 v44, a60
    v_accvgpr_read_b32 v45, a61
    v_accvgpr_read_b32 v46, a62
    v_accvgpr_read_b32 v47, a63
    v_pk_mul_f32 v[40:41], v[40:41], v[6:7] op_sel:[0,1] op_sel_hi:[1,1]
    v_pk_mul_f32 v[42:43], v[42:43], v[6:7] op_sel:[0,1] op_sel_hi:[1,1]
    v_pk_mul_f32 v[44:45], v[44:45], v[6:7] op_sel:[0,1] op_sel_hi:[1,1]
    v_pk_mul_f32 v[46:47], v[46:47], v[6:7] op_sel:[0,1] op_sel_hi:[1,1]
    v_cvt_pk_bf16_f32 v12, v40, v41
    v_cvt_pk_bf16_f32 v13, v42, v43
    v_cvt_pk_bf16_f32 v14, v44, v45
    v_cvt_pk_bf16_f32 v15, v46, v47
    buffer_store_dwordx4 v[12:15], v240, s[28:31], s55 offen offset:1024 sc1
    v_accvgpr_read_b32 v48, a76
    v_accvgpr_read_b32 v49, a77
    v_accvgpr_read_b32 v50, a78
    v_accvgpr_read_b32 v51, a79
    v_accvgpr_read_b32 v52, a92
    v_accvgpr_read_b32 v53, a93
    v_accvgpr_read_b32 v54, a94
    v_accvgpr_read_b32 v55, a95
    v_pk_mul_f32 v[48:49], v[48:49], v[6:7] op_sel:[0,1] op_sel_hi:[1,1]
    v_pk_mul_f32 v[50:51], v[50:51], v[6:7] op_sel:[0,1] op_sel_hi:[1,1]
    v_pk_mul_f32 v[52:53], v[52:53], v[6:7] op_sel:[0,1] op_sel_hi:[1,1]
    v_pk_mul_f32 v[54:55], v[54:55], v[6:7] op_sel:[0,1] op_sel_hi:[1,1]
    v_cvt_pk_bf16_f32 v16, v48, v49
    v_cvt_pk_bf16_f32 v17, v50, v51
    v_cvt_pk_bf16_f32 v18, v52, v53
    v_cvt_pk_bf16_f32 v19, v54, v55
    buffer_store_dwordx4 v[16:19], v240, s[28:31], s55 offen offset:2048 sc1
    v_accvgpr_read_b32 v56, a108
    v_accvgpr_read_b32 v57, a109
    v_accvgpr_read_b32 v58, a110
    v_accvgpr_read_b32 v59, a111
    v_accvgpr_read_b32 v60, a124
    v_accvgpr_read_b32 v61, a125
    v_accvgpr_read_b32 v62, a126
    v_accvgpr_read_b32 v63, a127
    v_pk_mul_f32 v[56:57], v[56:57], v[6:7] op_sel:[0,1] op_sel_hi:[1,1]
    v_pk_mul_f32 v[58:59], v[58:59], v[6:7] op_sel:[0,1] op_sel_hi:[1,1]
    v_pk_mul_f32 v[60:61], v[60:61], v[6:7] op_sel:[0,1] op_sel_hi:[1,1]
    v_pk_mul_f32 v[62:63], v[62:63], v[6:7] op_sel:[0,1] op_sel_hi:[1,1]
    v_cvt_pk_bf16_f32 v20, v56, v57
    v_cvt_pk_bf16_f32 v21, v58, v59
    v_cvt_pk_bf16_f32 v22, v60, v61
    v_cvt_pk_bf16_f32 v23, v62, v63
    buffer_store_dwordx4 v[20:23], v240, s[28:31], s55 offen offset:3072 sc1
    s_add_u32 s55, s55, 186368
    s_endpgm

.globl out_kernel
.p2align 8
.type out_kernel,@function
out_kernel:
    s_load_dwordx2 s[4:5], s[0:1], 0
    s_load_dwordx2 s[6:7], s[0:1], 64
    s_load_dwordx2 s[10:11], s[0:1], 80
    v_lshrrev_b32 v1, 6, v0
    v_and_b32 v0, 63, v0
    s_nop 0
    v_readfirstlane_b32 s3, v1
    s_cmp_ge_u32 s2, 256
    s_cbranch_scc1 K3_END
    s_and_b32 s20, s2, 7
    s_lshr_b32 s21, s2, 3
    s_lshr_b32 s22, s21, 3
    s_lshl_b32 s20, s20, 2
    s_add_u32 s20, s20, s22
    s_and_b32 s21, s21, 7
    s_waitcnt lgkmcnt(0)
    s_add_u32 s12, s10, 0x280000
    s_addc_u32 s13, s11, 0
    s_mov_b32 s14, 0xfd80000
    s_mov_b32 s15, 0x00020000
    s_add_u32 s16, s10, 0xa00000
    s_addc_u32 s17, s11, 0
    s_mov_b32 s18, 0xf600000
    s_mov_b32 s19, 0x00020000
    s_mul_i32 s32, s21, 931840
    s_mul_i32 s33, s3, 5120
    s_add_u32 s32, s32, s33
    s_add_u32 s32, s32, 655360
    s_mul_i32 s33, s20, 745472
    s_lshl_b32 s34, s3, 10
    s_add_u32 s33, s33, s34
    s_add_u32 s33, s33, 131072
    v_lshlrev_b32 v1, 4, v0
    v_add_u32 v2, 0x1000, v1
    s_add_u32 s34, s3, 0
    s_and_b32 s34, s34, 3
    s_mul_i32 s35, s34, 186368
    v_add_u32 v3, s35, v1
    s_add_u32 s34, s3, 1
    s_and_b32 s34, s34, 3
    s_mul_i32 s35, s34, 186368
    v_add_u32 v4, s35, v1
    s_mul_i32 s35, s34, 15360
    s_add_u32 s35, s35, 0
    v_add_u32 v7, s35, v1
    s_add_u32 s34, s3, 2
    s_and_b32 s34, s34, 3
    s_mul_i32 s35, s34, 186368
    v_add_u32 v5, s35, v1
    s_mul_i32 s35, s34, 15360
    s_add_u32 s35, s35, 5120
    v_add_u32 v8, s35, v1
    s_add_u32 s34, s3, 3
    s_and_b32 s34, s34, 3
    s_mul_i32 s35, s34, 186368
    v_add_u32 v6, s35, v1
    s_mul_i32 s35, s34, 15360
    s_add_u32 s35, s35, 10240
    v_add_u32 v9, s35, v1
    s_mul_i32 s35, s3, 15360
    v_add_u32 v10, s35, v1
    buffer_load_dwordx4 v[16:19], v1, s[12:15], s32 offen offset:0
    buffer_load_dwordx4 v[20:23], v1, s[12:15], s32 offen offset:1024
    buffer_load_dwordx4 v[24:27], v1, s[12:15], s32 offen offset:2048
    buffer_load_dwordx4 v[28:31], v1, s[12:15], s32 offen offset:3072
    buffer_load_dwordx4 v[32:35], v2, s[12:15], s32 offen
    buffer_load_dwordx4 v[36:39], v3, s[16:19], s33 offen
    buffer_load_dwordx4 v[40:43], v4, s[16:19], s33 offen
    buffer_load_dwordx4 v[44:47], v5, s[16:19], s33 offen
    buffer_load_dwordx4 v[48:51], v6, s[16:19], s33 offen
    s_add_u32 s32, s32, 20480
    s_add_u32 s33, s33, 4096
    buffer_load_dwordx4 v[52:55], v1, s[12:15], s32 offen offset:0
    buffer_load_dwordx4 v[56:59], v1, s[12:15], s32 offen offset:1024
    buffer_load_dwordx4 v[60:63], v1, s[12:15], s32 offen offset:2048
    buffer_load_dwordx4 v[64:67], v1, s[12:15], s32 offen offset:3072
    buffer_load_dwordx4 v[68:71], v2, s[12:15], s32 offen
    buffer_load_dwordx4 v[72:75], v3, s[16:19], s33 offen
    buffer_load_dwordx4 v[76:79], v4, s[16:19], s33 offen
    buffer_load_dwordx4 v[80:83], v5, s[16:19], s33 offen
    buffer_load_dwordx4 v[84:87], v6, s[16:19], s33 offen
    s_add_u32 s32, s32, 20480
    s_add_u32 s33, s33, 4096
    buffer_load_dwordx4 v[88:91], v1, s[12:15], s32 offen offset:0
    buffer_load_dwordx4 v[92:95], v1, s[12:15], s32 offen offset:1024
    buffer_load_dwordx4 v[96:99], v1, s[12:15], s32 offen offset:2048
    buffer_load_dwordx4 v[100:103], v1, s[12:15], s32 offen offset:3072
    buffer_load_dwordx4 v[104:107], v2, s[12:15], s32 offen
    buffer_load_dwordx4 v[108:111], v3, s[16:19], s33 offen
    buffer_load_dwordx4 v[112:115], v4, s[16:19], s33 offen
    buffer_load_dwordx4 v[116:119], v5, s[16:19], s33 offen
    buffer_load_dwordx4 v[120:123], v6, s[16:19], s33 offen
    s_add_u32 s32, s32, 20480
    s_add_u32 s33, s33, 4096
    buffer_load_dwordx4 v[124:127], v1, s[12:15], s32 offen offset:0
    buffer_load_dwordx4 v[128:131], v1, s[12:15], s32 offen offset:1024
    buffer_load_dwordx4 v[132:135], v1, s[12:15], s32 offen offset:2048
    buffer_load_dwordx4 v[136:139], v1, s[12:15], s32 offen offset:3072
    buffer_load_dwordx4 v[140:143], v2, s[12:15], s32 offen
    buffer_load_dwordx4 v[144:147], v3, s[16:19], s33 offen
    buffer_load_dwordx4 v[148:151], v4, s[16:19], s33 offen
    buffer_load_dwordx4 v[152:155], v5, s[16:19], s33 offen
    buffer_load_dwordx4 v[156:159], v6, s[16:19], s33 offen
    s_add_u32 s32, s32, 20480
    s_add_u32 s33, s33, 4096
    s_mov_b32 s24, s4
    s_mov_b32 s25, s5
    s_mov_b32 s26, 0x280000
    s_mov_b32 s27, 0x00020000
    s_mov_b32 s28, s6
    s_mov_b32 s29, s7
    s_mov_b32 s30, 0x280000
    s_mov_b32 s31, 0x00020000
    s_lshl_b32 s34, s20, 6
    s_lshl_b32 s35, s3, 4
    s_add_u32 s34, s34, s35
    v_and_b32 v11, 15, v0
    v_add_u32 v11, s34, v11
    s_movk_i32 s35, 1280
    v_mul_lo_u32 v11, v11, s35
    v_lshrrev_b32 v12, 4, v0
    v_lshl_add_u32 v11, v12, 3, v11
    s_mul_i32 s35, s21, 160
    v_add_u32 v11, s35, v11
    buffer_load_dwordx4 v[160:163], v1, s[12:15], s32 offen offset:0
    buffer_load_dwordx4 v[164:167], v1, s[12:15], s32 offen offset:1024
    buffer_load_dwordx4 v[168:171], v1, s[12:15], s32 offen offset:2048
    buffer_load_dwordx4 v[172:175], v1, s[12:15], s32 offen offset:3072
    buffer_load_dwordx4 v[176:179], v2, s[12:15], s32 offen
    buffer_load_dwordx4 v[180:183], v3, s[16:19], s33 offen
    buffer_load_dwordx4 v[184:187], v4, s[16:19], s33 offen
    buffer_load_dwordx4 v[188:191], v5, s[16:19], s33 offen
    buffer_load_dwordx4 v[192:195], v6, s[16:19], s33 offen
    s_add_u32 s32, s32, 20480
    s_add_u32 s33, s33, 4096
    s_waitcnt vmcnt(36)
    v_mfma_f32_16x16x32_bf16 a[80:83], v[16:19], v[36:39], 0
    v_mfma_f32_16x16x32_bf16 a[84:87], v[20:23], v[36:39], 0
    v_mfma_f32_16x16x32_bf16 a[88:91], v[24:27], v[36:39], 0
    v_mfma_f32_16x16x32_bf16 a[92:95], v[28:31], v[36:39], 0
    v_mfma_f32_16x16x32_bf16 a[96:99], v[32:35], v[36:39], 0
    v_mfma_f32_16x16x32_bf16 a[100:103], v[16:19], v[40:43], 0
    v_mfma_f32_16x16x32_bf16 a[104:107], v[20:23], v[40:43], 0
    v_mfma_f32_16x16x32_bf16 a[108:111], v[24:27], v[40:43], 0
    v_mfma_f32_16x16x32_bf16 a[112:115], v[28:31], v[40:43], 0
    v_mfma_f32_16x16x32_bf16 a[116:119], v[32:35], v[40:43], 0
    v_mfma_f32_16x16x32_bf16 a[120:123], v[16:19], v[44:47], 0
    v_mfma_f32_16x16x32_bf16 a[124:127], v[20:23], v[44:47], 0
    v_mfma_f32_16x16x32_bf16 a[128:131], v[24:27], v[44:47], 0
    v_mfma_f32_16x16x32_bf16 a[132:135], v[28:31], v[44:47], 0
    v_mfma_f32_16x16x32_bf16 a[136:139], v[32:35], v[44:47], 0
    v_mfma_f32_16x16x32_bf16 a[140:143], v[16:19], v[48:51], 0
    v_mfma_f32_16x16x32_bf16 a[144:147], v[20:23], v[48:51], 0
    v_mfma_f32_16x16x32_bf16 a[148:151], v[24:27], v[48:51], 0
    v_mfma_f32_16x16x32_bf16 a[152:155], v[28:31], v[48:51], 0
    v_mfma_f32_16x16x32_bf16 a[156:159], v[32:35], v[48:51], 0
    buffer_load_dwordx4 v[16:19], v1, s[12:15], s32 offen offset:0
    buffer_load_dwordx4 v[20:23], v1, s[12:15], s32 offen offset:1024
    buffer_load_dwordx4 v[24:27], v1, s[12:15], s32 offen offset:2048
    buffer_load_dwordx4 v[28:31], v1, s[12:15], s32 offen offset:3072
    buffer_load_dwordx4 v[32:35], v2, s[12:15], s32 offen
    buffer_load_dwordx4 v[36:39], v3, s[16:19], s33 offen
    buffer_load_dwordx4 v[40:43], v4, s[16:19], s33 offen
    buffer_load_dwordx4 v[44:47], v5, s[16:19], s33 offen
    buffer_load_dwordx4 v[48:51], v6, s[16:19], s33 offen
    s_add_u32 s32, s32, 20480
    s_add_u32 s33, s33, 4096
    s_waitcnt vmcnt(36)
    v_mfma_f32_16x16x32_bf16 a[80:83], v[52:55], v[72:75], a[80:83]
    v_mfma_f32_16x16x32_bf16 a[84:87], v[56:59], v[72:75], a[84:87]
    v_mfma_f32_16x16x32_bf16 a[88:91], v[60:63], v[72:75], a[88:91]
    v_mfma_f32_16x16x32_bf16 a[92:95], v[64:67], v[72:75], a[92:95]
    v_mfma_f32_16x16x32_bf16 a[96:99], v[68:71], v[72:75], a[96:99]
    v_mfma_f32_16x16x32_bf16 a[100:103], v[52:55], v[76:79], a[100:103]
    v_mfma_f32_16x16x32_bf16 a[104:107], v[56:59], v[76:79], a[104:107]
    v_mfma_f32_16x16x32_bf16 a[108:111], v[60:63], v[76:79], a[108:111]
    v_mfma_f32_16x16x32_bf16 a[112:115], v[64:67], v[76:79], a[112:115]
    v_mfma_f32_16x16x32_bf16 a[116:119], v[68:71], v[76:79], a[116:119]
    v_mfma_f32_16x16x32_bf16 a[120:123], v[52:55], v[80:83], a[120:123]
    v_mfma_f32_16x16x32_bf16 a[124:127], v[56:59], v[80:83], a[124:127]
    v_mfma_f32_16x16x32_bf16 a[128:131], v[60:63], v[80:83], a[128:131]
    v_mfma_f32_16x16x32_bf16 a[132:135], v[64:67], v[80:83], a[132:135]
    v_mfma_f32_16x16x32_bf16 a[136:139], v[68:71], v[80:83], a[136:139]
    v_mfma_f32_16x16x32_bf16 a[140:143], v[52:55], v[84:87], a[140:143]
    v_mfma_f32_16x16x32_bf16 a[144:147], v[56:59], v[84:87], a[144:147]
    v_mfma_f32_16x16x32_bf16 a[148:151], v[60:63], v[84:87], a[148:151]
    v_mfma_f32_16x16x32_bf16 a[152:155], v[64:67], v[84:87], a[152:155]
    v_mfma_f32_16x16x32_bf16 a[156:159], v[68:71], v[84:87], a[156:159]
    buffer_load_dwordx4 v[52:55], v1, s[12:15], s32 offen offset:0
    buffer_load_dwordx4 v[56:59], v1, s[12:15], s32 offen offset:1024
    buffer_load_dwordx4 v[60:63], v1, s[12:15], s32 offen offset:2048
    buffer_load_dwordx4 v[64:67], v1, s[12:15], s32 offen offset:3072
    buffer_load_dwordx4 v[68:71], v2, s[12:15], s32 offen
    buffer_load_dwordx4 v[72:75], v3, s[16:19], s33 offen
    buffer_load_dwordx4 v[76:79], v4, s[16:19], s33 offen
    buffer_load_dwordx4 v[80:83], v5, s[16:19], s33 offen
    buffer_load_dwordx4 v[84:87], v6, s[16:19], s33 offen
    s_add_u32 s32, s32, 20480
    s_add_u32 s33, s33, 4096
    s_waitcnt vmcnt(36)
    v_mfma_f32_16x16x32_bf16 a[80:83], v[88:91], v[108:111], a[80:83]
    v_mfma_f32_16x16x32_bf16 a[84:87], v[92:95], v[108:111], a[84:87]
    v_mfma_f32_16x16x32_bf16 a[88:91], v[96:99], v[108:111], a[88:91]
    v_mfma_f32_16x16x32_bf16 a[92:95], v[100:103], v[108:111], a[92:95]
    v_mfma_f32_16x16x32_bf16 a[96:99], v[104:107], v[108:111], a[96:99]
    v_mfma_f32_16x16x32_bf16 a[100:103], v[88:91], v[112:115], a[100:103]
    v_mfma_f32_16x16x32_bf16 a[104:107], v[92:95], v[112:115], a[104:107]
    v_mfma_f32_16x16x32_bf16 a[108:111], v[96:99], v[112:115], a[108:111]
    v_mfma_f32_16x16x32_bf16 a[112:115], v[100:103], v[112:115], a[112:115]
    v_mfma_f32_16x16x32_bf16 a[116:119], v[104:107], v[112:115], a[116:119]
    v_mfma_f32_16x16x32_bf16 a[120:123], v[88:91], v[116:119], a[120:123]
    v_mfma_f32_16x16x32_bf16 a[124:127], v[92:95], v[116:119], a[124:127]
    v_mfma_f32_16x16x32_bf16 a[128:131], v[96:99], v[116:119], a[128:131]
    v_mfma_f32_16x16x32_bf16 a[132:135], v[100:103], v[116:119], a[132:135]
    v_mfma_f32_16x16x32_bf16 a[136:139], v[104:107], v[116:119], a[136:139]
    v_mfma_f32_16x16x32_bf16 a[140:143], v[88:91], v[120:123], a[140:143]
    v_mfma_f32_16x16x32_bf16 a[144:147], v[92:95], v[120:123], a[144:147]
    v_mfma_f32_16x16x32_bf16 a[148:151], v[96:99], v[120:123], a[148:151]
    v_mfma_f32_16x16x32_bf16 a[152:155], v[100:103], v[120:123], a[152:155]
    v_mfma_f32_16x16x32_bf16 a[156:159], v[104:107], v[120:123], a[156:159]
    buffer_load_dwordx4 v[88:91], v1, s[12:15], s32 offen offset:0
    buffer_load_dwordx4 v[92:95], v1, s[12:15], s32 offen offset:1024
    buffer_load_dwordx4 v[96:99], v1, s[12:15], s32 offen offset:2048
    buffer_load_dwordx4 v[100:103], v1, s[12:15], s32 offen offset:3072
    buffer_load_dwordx4 v[104:107], v2, s[12:15], s32 offen
    buffer_load_dwordx4 v[108:111], v3, s[16:19], s33 offen
    buffer_load_dwordx4 v[112:115], v4, s[16:19], s33 offen
    buffer_load_dwordx4 v[116:119], v5, s[16:19], s33 offen
    buffer_load_dwordx4 v[120:123], v6, s[16:19], s33 offen
    s_add_u32 s32, s32, 20480
    s_add_u32 s33, s33, 4096
    s_waitcnt vmcnt(36)
    v_mfma_f32_16x16x32_bf16 a[80:83], v[124:127], v[144:147], a[80:83]
    v_mfma_f32_16x16x32_bf16 a[84:87], v[128:131], v[144:147], a[84:87]
    v_mfma_f32_16x16x32_bf16 a[88:91], v[132:135], v[144:147], a[88:91]
    v_mfma_f32_16x16x32_bf16 a[92:95], v[136:139], v[144:147], a[92:95]
    v_mfma_f32_16x16x32_bf16 a[96:99], v[140:143], v[144:147], a[96:99]
    v_mfma_f32_16x16x32_bf16 a[100:103], v[124:127], v[148:151], a[100:103]
    v_mfma_f32_16x16x32_bf16 a[104:107], v[128:131], v[148:151], a[104:107]
    v_mfma_f32_16x16x32_bf16 a[108:111], v[132:135], v[148:151], a[108:111]
    v_mfma_f32_16x16x32_bf16 a[112:115], v[136:139], v[148:151], a[112:115]
    v_mfma_f32_16x16x32_bf16 a[116:119], v[140:143], v[148:151], a[116:119]
    v_mfma_f32_16x16x32_bf16 a[120:123], v[124:127], v[152:155], a[120:123]
    v_mfma_f32_16x16x32_bf16 a[124:127], v[128:131], v[152:155], a[124:127]
    v_mfma_f32_16x16x32_bf16 a[128:131], v[132:135], v[152:155], a[128:131]
    v_mfma_f32_16x16x32_bf16 a[132:135], v[136:139], v[152:155], a[132:135]
    v_mfma_f32_16x16x32_bf16 a[136:139], v[140:143], v[152:155], a[136:139]
    v_mfma_f32_16x16x32_bf16 a[140:143], v[124:127], v[156:159], a[140:143]
    v_mfma_f32_16x16x32_bf16 a[144:147], v[128:131], v[156:159], a[144:147]
    v_mfma_f32_16x16x32_bf16 a[148:151], v[132:135], v[156:159], a[148:151]
    v_mfma_f32_16x16x32_bf16 a[152:155], v[136:139], v[156:159], a[152:155]
    v_mfma_f32_16x16x32_bf16 a[156:159], v[140:143], v[156:159], a[156:159]
    buffer_load_dwordx4 v[124:127], v1, s[12:15], s32 offen offset:0
    buffer_load_dwordx4 v[128:131], v1, s[12:15], s32 offen offset:1024
    buffer_load_dwordx4 v[132:135], v1, s[12:15], s32 offen offset:2048
    buffer_load_dwordx4 v[136:139], v1, s[12:15], s32 offen offset:3072
    buffer_load_dwordx4 v[140:143], v2, s[12:15], s32 offen
    buffer_load_dwordx4 v[144:147], v3, s[16:19], s33 offen
    buffer_load_dwordx4 v[148:151], v4, s[16:19], s33 offen
    buffer_load_dwordx4 v[152:155], v5, s[16:19], s33 offen
    buffer_load_dwordx4 v[156:159], v6, s[16:19], s33 offen
    s_add_u32 s32, s32, 20480
    s_add_u32 s33, s33, 4096
    s_waitcnt vmcnt(36)
    v_mfma_f32_16x16x32_bf16 a[80:83], v[160:163], v[180:183], a[80:83]
    v_mfma_f32_16x16x32_bf16 a[84:87], v[164:167], v[180:183], a[84:87]
    v_mfma_f32_16x16x32_bf16 a[88:91], v[168:171], v[180:183], a[88:91]
    v_mfma_f32_16x16x32_bf16 a[92:95], v[172:175], v[180:183], a[92:95]
    v_mfma_f32_16x16x32_bf16 a[96:99], v[176:179], v[180:183], a[96:99]
    v_mfma_f32_16x16x32_bf16 a[100:103], v[160:163], v[184:187], a[100:103]
    v_mfma_f32_16x16x32_bf16 a[104:107], v[164:167], v[184:187], a[104:107]
    v_mfma_f32_16x16x32_bf16 a[108:111], v[168:171], v[184:187], a[108:111]
    v_mfma_f32_16x16x32_bf16 a[112:115], v[172:175], v[184:187], a[112:115]
    v_mfma_f32_16x16x32_bf16 a[116:119], v[176:179], v[184:187], a[116:119]
    v_mfma_f32_16x16x32_bf16 a[120:123], v[160:163], v[188:191], a[120:123]
    v_mfma_f32_16x16x32_bf16 a[124:127], v[164:167], v[188:191], a[124:127]
    v_mfma_f32_16x16x32_bf16 a[128:131], v[168:171], v[188:191], a[128:131]
    v_mfma_f32_16x16x32_bf16 a[132:135], v[172:175], v[188:191], a[132:135]
    v_mfma_f32_16x16x32_bf16 a[136:139], v[176:179], v[188:191], a[136:139]
    v_mfma_f32_16x16x32_bf16 a[140:143], v[160:163], v[192:195], a[140:143]
    v_mfma_f32_16x16x32_bf16 a[144:147], v[164:167], v[192:195], a[144:147]
    v_mfma_f32_16x16x32_bf16 a[148:151], v[168:171], v[192:195], a[148:151]
    v_mfma_f32_16x16x32_bf16 a[152:155], v[172:175], v[192:195], a[152:155]
    v_mfma_f32_16x16x32_bf16 a[156:159], v[176:179], v[192:195], a[156:159]
    buffer_load_dwordx4 v[160:163], v1, s[12:15], s32 offen offset:0
    buffer_load_dwordx4 v[164:167], v1, s[12:15], s32 offen offset:1024
    buffer_load_dwordx4 v[168:171], v1, s[12:15], s32 offen offset:2048
    buffer_load_dwordx4 v[172:175], v1, s[12:15], s32 offen offset:3072
    buffer_load_dwordx4 v[176:179], v2, s[12:15], s32 offen
    buffer_load_dwordx4 v[180:183], v3, s[16:19], s33 offen
    buffer_load_dwordx4 v[184:187], v4, s[16:19], s33 offen
    buffer_load_dwordx4 v[188:191], v5, s[16:19], s33 offen
    buffer_load_dwordx4 v[192:195], v6, s[16:19], s33 offen
    s_add_u32 s32, s32, 20480
    s_add_u32 s33, s33, 4096
    s_waitcnt vmcnt(36)
    v_mfma_f32_16x16x32_bf16 a[80:83], v[16:19], v[36:39], a[80:83]
    v_mfma_f32_16x16x32_bf16 a[84:87], v[20:23], v[36:39], a[84:87]
    v_mfma_f32_16x16x32_bf16 a[88:91], v[24:27], v[36:39], a[88:91]
    v_mfma_f32_16x16x32_bf16 a[92:95], v[28:31], v[36:39], a[92:95]
    v_mfma_f32_16x16x32_bf16 a[96:99], v[32:35], v[36:39], a[96:99]
    v_mfma_f32_16x16x32_bf16 a[100:103], v[16:19], v[40:43], a[100:103]
    v_mfma_f32_16x16x32_bf16 a[104:107], v[20:23], v[40:43], a[104:107]
    v_mfma_f32_16x16x32_bf16 a[108:111], v[24:27], v[40:43], a[108:111]
    v_mfma_f32_16x16x32_bf16 a[112:115], v[28:31], v[40:43], a[112:115]
    v_mfma_f32_16x16x32_bf16 a[116:119], v[32:35], v[40:43], a[116:119]
    v_mfma_f32_16x16x32_bf16 a[120:123], v[16:19], v[44:47], a[120:123]
    v_mfma_f32_16x16x32_bf16 a[124:127], v[20:23], v[44:47], a[124:127]
    v_mfma_f32_16x16x32_bf16 a[128:131], v[24:27], v[44:47], a[128:131]
    v_mfma_f32_16x16x32_bf16 a[132:135], v[28:31], v[44:47], a[132:135]
    v_mfma_f32_16x16x32_bf16 a[136:139], v[32:35], v[44:47], a[136:139]
    v_mfma_f32_16x16x32_bf16 a[140:143], v[16:19], v[48:51], a[140:143]
    v_mfma_f32_16x16x32_bf16 a[144:147], v[20:23], v[48:51], a[144:147]
    v_mfma_f32_16x16x32_bf16 a[148:151], v[24:27], v[48:51], a[148:151]
    v_mfma_f32_16x16x32_bf16 a[152:155], v[28:31], v[48:51], a[152:155]
    v_mfma_f32_16x16x32_bf16 a[156:159], v[32:35], v[48:51], a[156:159]
    buffer_load_dwordx4 v[16:19], v1, s[12:15], s32 offen offset:0
    buffer_load_dwordx4 v[20:23], v1, s[12:15], s32 offen offset:1024
    buffer_load_dwordx4 v[24:27], v1, s[12:15], s32 offen offset:2048
    buffer_load_dwordx4 v[28:31], v1, s[12:15], s32 offen offset:3072
    buffer_load_dwordx4 v[32:35], v2, s[12:15], s32 offen
    buffer_load_dwordx4 v[36:39], v3, s[16:19], s33 offen
    buffer_load_dwordx4 v[40:43], v4, s[16:19], s33 offen
    buffer_load_dwordx4 v[44:47], v5, s[16:19], s33 offen
    buffer_load_dwordx4 v[48:51], v6, s[16:19], s33 offen
    s_add_u32 s32, s32, 20480
    s_add_u32 s33, s33, 4096
    s_waitcnt vmcnt(36)
    v_mfma_f32_16x16x32_bf16 a[80:83], v[52:55], v[72:75], a[80:83]
    v_mfma_f32_16x16x32_bf16 a[84:87], v[56:59], v[72:75], a[84:87]
    v_mfma_f32_16x16x32_bf16 a[88:91], v[60:63], v[72:75], a[88:91]
    v_mfma_f32_16x16x32_bf16 a[92:95], v[64:67], v[72:75], a[92:95]
    v_mfma_f32_16x16x32_bf16 a[96:99], v[68:71], v[72:75], a[96:99]
    v_mfma_f32_16x16x32_bf16 a[100:103], v[52:55], v[76:79], a[100:103]
    v_mfma_f32_16x16x32_bf16 a[104:107], v[56:59], v[76:79], a[104:107]
    v_mfma_f32_16x16x32_bf16 a[108:111], v[60:63], v[76:79], a[108:111]
    v_mfma_f32_16x16x32_bf16 a[112:115], v[64:67], v[76:79], a[112:115]
    v_mfma_f32_16x16x32_bf16 a[116:119], v[68:71], v[76:79], a[116:119]
    v_mfma_f32_16x16x32_bf16 a[120:123], v[52:55], v[80:83], a[120:123]
    v_mfma_f32_16x16x32_bf16 a[124:127], v[56:59], v[80:83], a[124:127]
    v_mfma_f32_16x16x32_bf16 a[128:131], v[60:63], v[80:83], a[128:131]
    v_mfma_f32_16x16x32_bf16 a[132:135], v[64:67], v[80:83], a[132:135]
    v_mfma_f32_16x16x32_bf16 a[136:139], v[68:71], v[80:83], a[136:139]
    v_mfma_f32_16x16x32_bf16 a[140:143], v[52:55], v[84:87], a[140:143]
    v_mfma_f32_16x16x32_bf16 a[144:147], v[56:59], v[84:87], a[144:147]
    v_mfma_f32_16x16x32_bf16 a[148:151], v[60:63], v[84:87], a[148:151]
    v_mfma_f32_16x16x32_bf16 a[152:155], v[64:67], v[84:87], a[152:155]
    v_mfma_f32_16x16x32_bf16 a[156:159], v[68:71], v[84:87], a[156:159]
    buffer_load_dwordx4 v[52:55], v1, s[12:15], s32 offen offset:0
    buffer_load_dwordx4 v[56:59], v1, s[12:15], s32 offen offset:1024
    buffer_load_dwordx4 v[60:63], v1, s[12:15], s32 offen offset:2048
    buffer_load_dwordx4 v[64:67], v1, s[12:15], s32 offen offset:3072
    buffer_load_dwordx4 v[68:71], v2, s[12:15], s32 offen
    buffer_load_dwordx4 v[72:75], v3, s[16:19], s33 offen
    buffer_load_dwordx4 v[76:79], v4, s[16:19], s33 offen
    buffer_load_dwordx4 v[80:83], v5, s[16:19], s33 offen
    buffer_load_dwordx4 v[84:87], v6, s[16:19], s33 offen
    s_add_u32 s32, s32, 20480
    s_add_u32 s33, s33, 4096
    s_waitcnt vmcnt(36)
    v_mfma_f32_16x16x32_bf16 a[80:83], v[88:91], v[108:111], a[80:83]
    v_mfma_f32_16x16x32_bf16 a[84:87], v[92:95], v[108:111], a[84:87]
    v_mfma_f32_16x16x32_bf16 a[88:91], v[96:99], v[108:111], a[88:91]
    v_mfma_f32_16x16x32_bf16 a[92:95], v[100:103], v[108:111], a[92:95]
    v_mfma_f32_16x16x32_bf16 a[96:99], v[104:107], v[108:111], a[96:99]
    v_mfma_f32_16x16x32_bf16 a[100:103], v[88:91], v[112:115], a[100:103]
    v_mfma_f32_16x16x32_bf16 a[104:107], v[92:95], v[112:115], a[104:107]
    v_mfma_f32_16x16x32_bf16 a[108:111], v[96:99], v[112:115], a[108:111]
    v_mfma_f32_16x16x32_bf16 a[112:115], v[100:103], v[112:115], a[112:115]
    v_mfma_f32_16x16x32_bf16 a[116:119], v[104:107], v[112:115], a[116:119]
    v_mfma_f32_16x16x32_bf16 a[120:123], v[88:91], v[116:119], a[120:123]
    v_mfma_f32_16x16x32_bf16 a[124:127], v[92:95], v[116:119], a[124:127]
    v_mfma_f32_16x16x32_bf16 a[128:131], v[96:99], v[116:119], a[128:131]
    v_mfma_f32_16x16x32_bf16 a[132:135], v[100:103], v[116:119], a[132:135]
    v_mfma_f32_16x16x32_bf16 a[136:139], v[104:107], v[116:119], a[136:139]
    v_mfma_f32_16x16x32_bf16 a[140:143], v[88:91], v[120:123], a[140:143]
    v_mfma_f32_16x16x32_bf16 a[144:147], v[92:95], v[120:123], a[144:147]
    v_mfma_f32_16x16x32_bf16 a[148:151], v[96:99], v[120:123], a[148:151]
    v_mfma_f32_16x16x32_bf16 a[152:155], v[100:103], v[120:123], a[152:155]
    v_mfma_f32_16x16x32_bf16 a[156:159], v[104:107], v[120:123], a[156:159]
    buffer_load_dwordx4 v[88:91], v1, s[12:15], s32 offen offset:0
    buffer_load_dwordx4 v[92:95], v1, s[12:15], s32 offen offset:1024
    buffer_load_dwordx4 v[96:99], v1, s[12:15], s32 offen offset:2048
    buffer_load_dwordx4 v[100:103], v1, s[12:15], s32 offen offset:3072
    buffer_load_dwordx4 v[104:107], v2, s[12:15], s32 offen
    buffer_load_dwordx4 v[108:111], v3, s[16:19], s33 offen
    buffer_load_dwordx4 v[112:115], v4, s[16:19], s33 offen
    buffer_load_dwordx4 v[116:119], v5, s[16:19], s33 offen
    buffer_load_dwordx4 v[120:123], v6, s[16:19], s33 offen
    s_add_u32 s32, s32, 20480
    s_add_u32 s33, s33, 4096
    s_waitcnt vmcnt(36)
    v_mfma_f32_16x16x32_bf16 a[80:83], v[124:127], v[144:147], a[80:83]
    v_mfma_f32_16x16x32_bf16 a[84:87], v[128:131], v[144:147], a[84:87]
    v_mfma_f32_16x16x32_bf16 a[88:91], v[132:135], v[144:147], a[88:91]
    v_mfma_f32_16x16x32_bf16 a[92:95], v[136:139], v[144:147], a[92:95]
    v_mfma_f32_16x16x32_bf16 a[96:99], v[140:143], v[144:147], a[96:99]
    v_mfma_f32_16x16x32_bf16 a[100:103], v[124:127], v[148:151], a[100:103]
    v_mfma_f32_16x16x32_bf16 a[104:107], v[128:131], v[148:151], a[104:107]
    v_mfma_f32_16x16x32_bf16 a[108:111], v[132:135], v[148:151], a[108:111]
    v_mfma_f32_16x16x32_bf16 a[112:115], v[136:139], v[148:151], a[112:115]
    v_mfma_f32_16x16x32_bf16 a[116:119], v[140:143], v[148:151], a[116:119]
    v_mfma_f32_16x16x32_bf16 a[120:123], v[124:127], v[152:155], a[120:123]
    v_mfma_f32_16x16x32_bf16 a[124:127], v[128:131], v[152:155], a[124:127]
    v_mfma_f32_16x16x32_bf16 a[128:131], v[132:135], v[152:155], a[128:131]
    v_mfma_f32_16x16x32_bf16 a[132:135], v[136:139], v[152:155], a[132:135]
    v_mfma_f32_16x16x32_bf16 a[136:139], v[140:143], v[152:155], a[136:139]
    v_mfma_f32_16x16x32_bf16 a[140:143], v[124:127], v[156:159], a[140:143]
    v_mfma_f32_16x16x32_bf16 a[144:147], v[128:131], v[156:159], a[144:147]
    v_mfma_f32_16x16x32_bf16 a[148:151], v[132:135], v[156:159], a[148:151]
    v_mfma_f32_16x16x32_bf16 a[152:155], v[136:139], v[156:159], a[152:155]
    v_mfma_f32_16x16x32_bf16 a[156:159], v[140:143], v[156:159], a[156:159]
    buffer_load_dwordx4 v[124:127], v1, s[12:15], s32 offen offset:0
    buffer_load_dwordx4 v[128:131], v1, s[12:15], s32 offen offset:1024
    buffer_load_dwordx4 v[132:135], v1, s[12:15], s32 offen offset:2048
    buffer_load_dwordx4 v[136:139], v1, s[12:15], s32 offen offset:3072
    buffer_load_dwordx4 v[140:143], v2, s[12:15], s32 offen
    buffer_load_dwordx4 v[144:147], v3, s[16:19], s33 offen
    buffer_load_dwordx4 v[148:151], v4, s[16:19], s33 offen
    buffer_load_dwordx4 v[152:155], v5, s[16:19], s33 offen
    buffer_load_dwordx4 v[156:159], v6, s[16:19], s33 offen
    s_sub_u32 s32, s32, 921600
    s_sub_u32 s33, s33, 184320
    s_waitcnt vmcnt(36)
    v_mfma_f32_16x16x32_bf16 a[80:83], v[160:163], v[180:183], a[80:83]
    v_mfma_f32_16x16x32_bf16 a[84:87], v[164:167], v[180:183], a[84:87]
    v_mfma_f32_16x16x32_bf16 a[88:91], v[168:171], v[180:183], a[88:91]
    v_mfma_f32_16x16x32_bf16 a[92:95], v[172:175], v[180:183], a[92:95]
    v_mfma_f32_16x16x32_bf16 a[96:99], v[176:179], v[180:183], a[96:99]
    v_mfma_f32_16x16x32_bf16 a[100:103], v[160:163], v[184:187], a[100:103]
    v_mfma_f32_16x16x32_bf16 a[104:107], v[164:167], v[184:187], a[104:107]
    v_mfma_f32_16x16x32_bf16 a[108:111], v[168:171], v[184:187], a[108:111]
    v_mfma_f32_16x16x32_bf16 a[112:115], v[172:175], v[184:187], a[112:115]
    v_mfma_f32_16x16x32_bf16 a[116:119], v[176:179], v[184:187], a[116:119]
    v_mfma_f32_16x16x32_bf16 a[120:123], v[160:163], v[188:191], a[120:123]
    v_mfma_f32_16x16x32_bf16 a[124:127], v[164:167], v[188:191], a[124:127]
    v_mfma_f32_16x16x32_bf16 a[128:131], v[168:171], v[188:191], a[128:131]
    v_mfma_f32_16x16x32_bf16 a[132:135], v[172:175], v[188:191], a[132:135]
    v_mfma_f32_16x16x32_bf16 a[136:139], v[176:179], v[188:191], a[136:139]
    v_mfma_f32_16x16x32_bf16 a[140:143], v[160:163], v[192:195], a[140:143]
    v_mfma_f32_16x16x32_bf16 a[144:147], v[164:167], v[192:195], a[144:147]
    v_mfma_f32_16x16x32_bf16 a[148:151], v[168:171], v[192:195], a[148:151]
    v_mfma_f32_16x16x32_bf16 a[152:155], v[172:175], v[192:195], a[152:155]
    v_mfma_f32_16x16x32_bf16 a[156:159], v[176:179], v[192:195], a[156:159]
    buffer_load_dwordx4 v[160:163], v1, s[12:15], s32 offen offset:0
    buffer_load_dwordx4 v[164:167], v1, s[12:15], s32 offen offset:1024
    buffer_load_dwordx4 v[168:171], v1, s[12:15], s32 offen offset:2048
    buffer_load_dwordx4 v[172:175], v1, s[12:15], s32 offen offset:3072
    buffer_load_dwordx4 v[176:179], v2, s[12:15], s32 offen
    buffer_load_dwordx4 v[180:183], v3, s[16:19], s33 offen
    buffer_load_dwordx4 v[184:187], v4, s[16:19], s33 offen
    buffer_load_dwordx4 v[188:191], v5, s[16:19], s33 offen
    buffer_load_dwordx4 v[192:195], v6, s[16:19], s33 offen
    s_add_u32 s32, s32, 20480
    s_add_u32 s33, s33, 4096
    s_waitcnt vmcnt(36)
    v_mfma_f32_16x16x32_bf16 a[80:83], v[16:19], v[36:39], a[80:83]
    v_mfma_f32_16x16x32_bf16 a[84:87], v[20:23], v[36:39], a[84:87]
    v_mfma_f32_16x16x32_bf16 a[88:91], v[24:27], v[36:39], a[88:91]
    v_mfma_f32_16x16x32_bf16 a[92:95], v[28:31], v[36:39], a[92:95]
    v_mfma_f32_16x16x32_bf16 a[96:99], v[32:35], v[36:39], a[96:99]
    v_mfma_f32_16x16x32_bf16 a[100:103], v[16:19], v[40:43], a[100:103]
    v_mfma_f32_16x16x32_bf16 a[104:107], v[20:23], v[40:43], a[104:107]
    v_mfma_f32_16x16x32_bf16 a[108:111], v[24:27], v[40:43], a[108:111]
    v_mfma_f32_16x16x32_bf16 a[112:115], v[28:31], v[40:43], a[112:115]
    v_mfma_f32_16x16x32_bf16 a[116:119], v[32:35], v[40:43], a[116:119]
    v_mfma_f32_16x16x32_bf16 a[120:123], v[16:19], v[44:47], a[120:123]
    v_mfma_f32_16x16x32_bf16 a[124:127], v[20:23], v[44:47], a[124:127]
    v_mfma_f32_16x16x32_bf16 a[128:131], v[24:27], v[44:47], a[128:131]
    v_mfma_f32_16x16x32_bf16 a[132:135], v[28:31], v[44:47], a[132:135]
    v_mfma_f32_16x16x32_bf16 a[136:139], v[32:35], v[44:47], a[136:139]
    v_mfma_f32_16x16x32_bf16 a[140:143], v[16:19], v[48:51], a[140:143]
    v_mfma_f32_16x16x32_bf16 a[144:147], v[20:23], v[48:51], a[144:147]
    v_mfma_f32_16x16x32_bf16 a[148:151], v[24:27], v[48:51], a[148:151]
    v_mfma_f32_16x16x32_bf16 a[152:155], v[28:31], v[48:51], a[152:155]
    v_mfma_f32_16x16x32_bf16 a[156:159], v[32:35], v[48:51], a[156:159]
    buffer_load_dwordx4 v[16:19], v1, s[12:15], s32 offen offset:0
    buffer_load_dwordx4 v[20:23], v1, s[12:15], s32 offen offset:1024
    buffer_load_dwordx4 v[24:27], v1, s[12:15], s32 offen offset:2048
    buffer_load_dwordx4 v[28:31], v1, s[12:15], s32 offen offset:3072
    buffer_load_dwordx4 v[32:35], v2, s[12:15], s32 offen
    buffer_load_dwordx4 v[36:39], v3, s[16:19], s33 offen
    buffer_load_dwordx4 v[40:43], v4, s[16:19], s33 offen
    buffer_load_dwordx4 v[44:47], v5, s[16:19], s33 offen
    buffer_load_dwordx4 v[48:51], v6, s[16:19], s33 offen
    s_add_u32 s32, s32, 20480
    s_add_u32 s33, s33, 4096
    s_waitcnt vmcnt(36)
    v_mfma_f32_16x16x32_bf16 a[80:83], v[52:55], v[72:75], a[80:83]
    v_mfma_f32_16x16x32_bf16 a[84:87], v[56:59], v[72:75], a[84:87]
    v_mfma_f32_16x16x32_bf16 a[88:91], v[60:63], v[72:75], a[88:91]
    v_mfma_f32_16x16x32_bf16 a[92:95], v[64:67], v[72:75], a[92:95]
    v_mfma_f32_16x16x32_bf16 a[96:99], v[68:71], v[72:75], a[96:99]
    v_mfma_f32_16x16x32_bf16 a[100:103], v[52:55], v[76:79], a[100:103]
    v_mfma_f32_16x16x32_bf16 a[104:107], v[56:59], v[76:79], a[104:107]
    v_mfma_f32_16x16x32_bf16 a[108:111], v[60:63], v[76:79], a[108:111]
    v_mfma_f32_16x16x32_bf16 a[112:115], v[64:67], v[76:79], a[112:115]
    v_mfma_f32_16x16x32_bf16 a[116:119], v[68:71], v[76:79], a[116:119]
    v_mfma_f32_16x16x32_bf16 a[120:123], v[52:55], v[80:83], a[120:123]
    v_mfma_f32_16x16x32_bf16 a[124:127], v[56:59], v[80:83], a[124:127]
    v_mfma_f32_16x16x32_bf16 a[128:131], v[60:63], v[80:83], a[128:131]
    v_mfma_f32_16x16x32_bf16 a[132:135], v[64:67], v[80:83], a[132:135]
    v_mfma_f32_16x16x32_bf16 a[136:139], v[68:71], v[80:83], a[136:139]
    v_mfma_f32_16x16x32_bf16 a[140:143], v[52:55], v[84:87], a[140:143]
    v_mfma_f32_16x16x32_bf16 a[144:147], v[56:59], v[84:87], a[144:147]
    v_mfma_f32_16x16x32_bf16 a[148:151], v[60:63], v[84:87], a[148:151]
    v_mfma_f32_16x16x32_bf16 a[152:155], v[64:67], v[84:87], a[152:155]
    v_mfma_f32_16x16x32_bf16 a[156:159], v[68:71], v[84:87], a[156:159]
    buffer_load_dwordx4 v[52:55], v1, s[12:15], s32 offen offset:0
    buffer_load_dwordx4 v[56:59], v1, s[12:15], s32 offen offset:1024
    buffer_load_dwordx4 v[60:63], v1, s[12:15], s32 offen offset:2048
    buffer_load_dwordx4 v[64:67], v1, s[12:15], s32 offen offset:3072
    buffer_load_dwordx4 v[68:71], v2, s[12:15], s32 offen
    buffer_load_dwordx4 v[72:75], v3, s[16:19], s33 offen
    buffer_load_dwordx4 v[76:79], v4, s[16:19], s33 offen
    buffer_load_dwordx4 v[80:83], v5, s[16:19], s33 offen
    buffer_load_dwordx4 v[84:87], v6, s[16:19], s33 offen
    s_add_u32 s32, s32, 20480
    s_add_u32 s33, s33, 4096
    s_waitcnt vmcnt(36)
    v_mfma_f32_16x16x32_bf16 a[80:83], v[88:91], v[108:111], a[80:83]
    v_mfma_f32_16x16x32_bf16 a[84:87], v[92:95], v[108:111], a[84:87]
    v_mfma_f32_16x16x32_bf16 a[88:91], v[96:99], v[108:111], a[88:91]
    v_mfma_f32_16x16x32_bf16 a[92:95], v[100:103], v[108:111], a[92:95]
    v_mfma_f32_16x16x32_bf16 a[96:99], v[104:107], v[108:111], a[96:99]
    v_mfma_f32_16x16x32_bf16 a[100:103], v[88:91], v[112:115], a[100:103]
    v_mfma_f32_16x16x32_bf16 a[104:107], v[92:95], v[112:115], a[104:107]
    v_mfma_f32_16x16x32_bf16 a[108:111], v[96:99], v[112:115], a[108:111]
    v_mfma_f32_16x16x32_bf16 a[112:115], v[100:103], v[112:115], a[112:115]
    v_mfma_f32_16x16x32_bf16 a[116:119], v[104:107], v[112:115], a[116:119]
    v_mfma_f32_16x16x32_bf16 a[120:123], v[88:91], v[116:119], a[120:123]
    v_mfma_f32_16x16x32_bf16 a[124:127], v[92:95], v[116:119], a[124:127]
    v_mfma_f32_16x16x32_bf16 a[128:131], v[96:99], v[116:119], a[128:131]
    v_mfma_f32_16x16x32_bf16 a[132:135], v[100:103], v[116:119], a[132:135]
    v_mfma_f32_16x16x32_bf16 a[136:139], v[104:107], v[116:119], a[136:139]
    v_mfma_f32_16x16x32_bf16 a[140:143], v[88:91], v[120:123], a[140:143]
    v_mfma_f32_16x16x32_bf16 a[144:147], v[92:95], v[120:123], a[144:147]
    v_mfma_f32_16x16x32_bf16 a[148:151], v[96:99], v[120:123], a[148:151]
    v_mfma_f32_16x16x32_bf16 a[152:155], v[100:103], v[120:123], a[152:155]
    v_mfma_f32_16x16x32_bf16 a[156:159], v[104:107], v[120:123], a[156:159]
    buffer_load_dwordx4 v[88:91], v1, s[12:15], s32 offen offset:0
    buffer_load_dwordx4 v[92:95], v1, s[12:15], s32 offen offset:1024
    buffer_load_dwordx4 v[96:99], v1, s[12:15], s32 offen offset:2048
    buffer_load_dwordx4 v[100:103], v1, s[12:15], s32 offen offset:3072
    buffer_load_dwordx4 v[104:107], v2, s[12:15], s32 offen
    buffer_load_dwordx4 v[108:111], v3, s[16:19], s33 offen
    buffer_load_dwordx4 v[112:115], v4, s[16:19], s33 offen
    buffer_load_dwordx4 v[116:119], v5, s[16:19], s33 offen
    buffer_load_dwordx4 v[120:123], v6, s[16:19], s33 offen
    s_add_u32 s32, s32, 20480
    s_add_u32 s33, s33, 4096
    s_waitcnt vmcnt(36)
    s_cmp_ge_u32 s3, 2
    s_cbranch_scc1 K3_SKIP
    v_mfma_f32_16x16x32_bf16 a[80:83], v[124:127], v[144:147], a[80:83]
    v_mfma_f32_16x16x32_bf16 a[84:87], v[128:131], v[144:147], a[84:87]
    v_mfma_f32_16x16x32_bf16 a[88:91], v[132:135], v[144:147], a[88:91]
    v_mfma_f32_16x16x32_bf16 a[92:95], v[136:139], v[144:147], a[92:95]
    v_mfma_f32_16x16x32_bf16 a[96:99], v[140:143], v[144:147], a[96:99]
    v_mfma_f32_16x16x32_bf16 a[100:103], v[124:127], v[148:151], a[100:103]
    v_mfma_f32_16x16x32_bf16 a[104:107], v[128:131], v[148:151], a[104:107]
    v_mfma_f32_16x16x32_bf16 a[108:111], v[132:135], v[148:151], a[108:111]
    v_mfma_f32_16x16x32_bf16 a[112:115], v[136:139], v[148:151], a[112:115]
    v_mfma_f32_16x16x32_bf16 a[116:119], v[140:143], v[148:151], a[116:119]
    v_mfma_f32_16x16x32_bf16 a[120:123], v[124:127], v[152:155], a[120:123]
    v_mfma_f32_16x16x32_bf16 a[124:127], v[128:131], v[152:155], a[124:127]
    v_mfma_f32_16x16x32_bf16 a[128:131], v[132:135], v[152:155], a[128:131]
    v_mfma_f32_16x16x32_bf16 a[132:135], v[136:139], v[152:155], a[132:135]
    v_mfma_f32_16x16x32_bf16 a[136:139], v[140:143], v[152:155], a[136:139]
    v_mfma_f32_16x16x32_bf16 a[140:143], v[124:127], v[156:159], a[140:143]
    v_mfma_f32_16x16x32_bf16 a[144:147], v[128:131], v[156:159], a[144:147]
    v_mfma_f32_16x16x32_bf16 a[148:151], v[132:135], v[156:159], a[148:151]
    v_mfma_f32_16x16x32_bf16 a[152:155], v[136:139], v[156:159], a[152:155]
    v_mfma_f32_16x16x32_bf16 a[156:159], v[140:143], v[156:159], a[156:159]
K3_SKIP:
    buffer_load_dwordx4 v[124:127], v1, s[12:15], s32 offen offset:0
    buffer_load_dwordx4 v[128:131], v1, s[12:15], s32 offen offset:1024
    buffer_load_dwordx4 v[132:135], v1, s[12:15], s32 offen offset:2048
    buffer_load_dwordx4 v[136:139], v1, s[12:15], s32 offen offset:3072
    buffer_load_dwordx4 v[140:143], v2, s[12:15], s32 offen
    buffer_load_dwordx4 v[144:147], v3, s[16:19], s33 offen
    buffer_load_dwordx4 v[148:151], v4, s[16:19], s33 offen
    buffer_load_dwordx4 v[152:155], v5, s[16:19], s33 offen
    buffer_load_dwordx4 v[156:159], v6, s[16:19], s33 offen
    s_add_u32 s32, s32, 20480
    s_add_u32 s33, s33, 4096
    s_waitcnt vmcnt(36)
    v_mfma_f32_16x16x32_bf16 a[0:3], v[160:163], v[180:183], 0
    v_mfma_f32_16x16x32_bf16 a[4:7], v[164:167], v[180:183], 0
    v_mfma_f32_16x16x32_bf16 a[8:11], v[168:171], v[180:183], 0
    v_mfma_f32_16x16x32_bf16 a[12:15], v[172:175], v[180:183], 0
    v_mfma_f32_16x16x32_bf16 a[16:19], v[176:179], v[180:183], 0
    v_mfma_f32_16x16x32_bf16 a[20:23], v[160:163], v[184:187], 0
    v_mfma_f32_16x16x32_bf16 a[24:27], v[164:167], v[184:187], 0
    v_mfma_f32_16x16x32_bf16 a[28:31], v[168:171], v[184:187], 0
    v_mfma_f32_16x16x32_bf16 a[32:35], v[172:175], v[184:187], 0
    v_mfma_f32_16x16x32_bf16 a[36:39], v[176:179], v[184:187], 0
    v_mfma_f32_16x16x32_bf16 a[40:43], v[160:163], v[188:191], 0
    v_mfma_f32_16x16x32_bf16 a[44:47], v[164:167], v[188:191], 0
    v_mfma_f32_16x16x32_bf16 a[48:51], v[168:171], v[188:191], 0
    v_mfma_f32_16x16x32_bf16 a[52:55], v[172:175], v[188:191], 0
    v_mfma_f32_16x16x32_bf16 a[56:59], v[176:179], v[188:191], 0
    v_mfma_f32_16x16x32_bf16 a[60:63], v[160:163], v[192:195], 0
    v_mfma_f32_16x16x32_bf16 a[64:67], v[164:167], v[192:195], 0
    v_mfma_f32_16x16x32_bf16 a[68:71], v[168:171], v[192:195], 0
    v_mfma_f32_16x16x32_bf16 a[72:75], v[172:175], v[192:195], 0
    v_mfma_f32_16x16x32_bf16 a[76:79], v[176:179], v[192:195], 0
    buffer_load_dwordx4 v[160:163], v1, s[12:15], s32 offen offset:0
    buffer_load_dwordx4 v[164:167], v1, s[12:15], s32 offen offset:1024
    buffer_load_dwordx4 v[168:171], v1, s[12:15], s32 offen offset:2048
    buffer_load_dwordx4 v[172:175], v1, s[12:15], s32 offen offset:3072
    buffer_load_dwordx4 v[176:179], v2, s[12:15], s32 offen
    buffer_load_dwordx4 v[180:183], v3, s[16:19], s33 offen
    buffer_load_dwordx4 v[184:187], v4, s[16:19], s33 offen
    buffer_load_dwordx4 v[188:191], v5, s[16:19], s33 offen
    buffer_load_dwordx4 v[192:195], v6, s[16:19], s33 offen
    s_add_u32 s32, s32, 20480
    s_add_u32 s33, s33, 4096
    s_waitcnt vmcnt(36)
    v_mfma_f32_16x16x32_bf16 a[0:3], v[16:19], v[36:39], a[0:3]
    v_mfma_f32_16x16x32_bf16 a[4:7], v[20:23], v[36:39], a[4:7]
    v_mfma_f32_16x16x32_bf16 a[8:11], v[24:27], v[36:39], a[8:11]
    v_mfma_f32_16x16x32_bf16 a[12:15], v[28:31], v[36:39], a[12:15]
    v_mfma_f32_16x16x32_bf16 a[16:19], v[32:35], v[36:39], a[16:19]
    v_mfma_f32_16x16x32_bf16 a[20:23], v[16:19], v[40:43], a[20:23]
    v_mfma_f32_16x16x32_bf16 a[24:27], v[20:23], v[40:43], a[24:27]
    v_mfma_f32_16x16x32_bf16 a[28:31], v[24:27], v[40:43], a[28:31]
    v_mfma_f32_16x16x32_bf16 a[32:35], v[28:31], v[40:43], a[32:35]
    v_mfma_f32_16x16x32_bf16 a[36:39], v[32:35], v[40:43], a[36:39]
    v_mfma_f32_16x16x32_bf16 a[40:43], v[16:19], v[44:47], a[40:43]
    v_mfma_f32_16x16x32_bf16 a[44:47], v[20:23], v[44:47], a[44:47]
    v_mfma_f32_16x16x32_bf16 a[48:51], v[24:27], v[44:47], a[48:51]
    v_mfma_f32_16x16x32_bf16 a[52:55], v[28:31], v[44:47], a[52:55]
    v_mfma_f32_16x16x32_bf16 a[56:59], v[32:35], v[44:47], a[56:59]
    v_mfma_f32_16x16x32_bf16 a[60:63], v[16:19], v[48:51], a[60:63]
    v_mfma_f32_16x16x32_bf16 a[64:67], v[20:23], v[48:51], a[64:67]
    v_mfma_f32_16x16x32_bf16 a[68:71], v[24:27], v[48:51], a[68:71]
    v_mfma_f32_16x16x32_bf16 a[72:75], v[28:31], v[48:51], a[72:75]
    v_mfma_f32_16x16x32_bf16 a[76:79], v[32:35], v[48:51], a[76:79]
    ds_write_b128 v7, a[100:103] offset:0
    ds_write_b128 v7, a[104:107] offset:1024
    ds_write_b128 v7, a[108:111] offset:2048
    ds_write_b128 v7, a[112:115] offset:3072
    ds_write_b128 v7, a[116:119] offset:4096
    ds_write_b128 v8, a[120:123] offset:0
    ds_write_b128 v8, a[124:127] offset:1024
    ds_write_b128 v8, a[128:131] offset:2048
    buffer_load_dwordx4 v[16:19], v1, s[12:15], s32 offen offset:0
    buffer_load_dwordx4 v[20:23], v1, s[12:15], s32 offen offset:1024
    buffer_load_dwordx4 v[24:27], v1, s[12:15], s32 offen offset:2048
    buffer_load_dwordx4 v[28:31], v1, s[12:15], s32 offen offset:3072
    buffer_load_dwordx4 v[32:35], v2, s[12:15], s32 offen
    buffer_load_dwordx4 v[36:39], v3, s[16:19], s33 offen
    buffer_load_dwordx4 v[40:43], v4, s[16:19], s33 offen
    buffer_load_dwordx4 v[44:47], v5, s[16:19], s33 offen
    buffer_load_dwordx4 v[48:51], v6, s[16:19], s33 offen
    s_add_u32 s32, s32, 20480
    s_add_u32 s33, s33, 4096
    s_waitcnt vmcnt(36)
    v_mfma_f32_16x16x32_bf16 a[0:3], v[52:55], v[72:75], a[0:3]
    v_mfma_f32_16x16x32_bf16 a[4:7], v[56:59], v[72:75], a[4:7]
    v_mfma_f32_16x16x32_bf16 a[8:11], v[60:63], v[72:75], a[8:11]
    v_mfma_f32_16x16x32_bf16 a[12:15], v[64:67], v[72:75], a[12:15]
    v_mfma_f32_16x16x32_bf16 a[16:19], v[68:71], v[72:75], a[16:19]
    v_mfma_f32_16x16x32_bf16 a[20:23], v[52:55], v[76:79], a[20:23]
    v_mfma_f32_16x16x32_bf16 a[24:27], v[56:59], v[76:79], a[24:27]
    v_mfma_f32_16x16x32_bf16 a[28:31], v[60:63], v[76:79], a[28:31]
    v_mfma_f32_16x16x32_bf16 a[32:35], v[64:67], v[76:79], a[32:35]
    v_mfma_f32_16x16x32_bf16 a[36:39], v[68:71], v[76:79], a[36:39]
    v_mfma_f32_16x16x32_bf16 a[40:43], v[52:55], v[80:83], a[40:43]
    v_mfma_f32_16x16x32_bf16 a[44:47], v[56:59], v[80:83], a[44:47]
    v_mfma_f32_16x16x32_bf16 a[48:51], v[60:63], v[80:83], a[48:51]
    v_mfma_f32_16x16x32_bf16 a[52:55], v[64:67], v[80:83], a[52:55]
    v_mfma_f32_16x16x32_bf16 a[56:59], v[68:71], v[80:83], a[56:59]
    v_mfma_f32_16x16x32_bf16 a[60:63], v[52:55], v[84:87], a[60:63]
    v_mfma_f32_16x16x32_bf16 a[64:67], v[56:59], v[84:87], a[64:67]
    v_mfma_f32_16x16x32_bf16 a[68:71], v[60:63], v[84:87], a[68:71]
    v_mfma_f32_16x16x32_bf16 a[72:75], v[64:67], v[84:87], a[72:75]
    v_mfma_f32_16x16x32_bf16 a[76:79], v[68:71], v[84:87], a[76:79]
    ds_write_b128 v8, a[132:135] offset:3072
    ds_write_b128 v8, a[136:139] offset:4096
    ds_write_b128 v9, a[140:143] offset:0
    ds_write_b128 v9, a[144:147] offset:1024
    ds_write_b128 v9, a[148:151] offset:2048
    ds_write_b128 v9, a[152:155] offset:3072
    ds_write_b128 v9, a[156:159] offset:4096
    v_accvgpr_read_b32 v206, a80
    v_accvgpr_read_b32 v207, a81
    v_accvgpr_read_b32 v208, a82
    v_accvgpr_read_b32 v209, a83
    v_accvgpr_read_b32 v210, a84
    v_accvgpr_read_b32 v211, a85
    v_accvgpr_read_b32 v212, a86
    v_accvgpr_read_b32 v213, a87
    v_accvgpr_read_b32 v214, a88
    v_accvgpr_read_b32 v215, a89
    v_accvgpr_read_b32 v216, a90
    v_accvgpr_read_b32 v217, a91
    v_accvgpr_read_b32 v218, a92
    v_accvgpr_read_b32 v219, a93
    v_accvgpr_read_b32 v220, a94
    v_accvgpr_read_b32 v221, a95
    v_accvgpr_read_b32 v222, a96
    v_accvgpr_read_b32 v223, a97
    v_accvgpr_read_b32 v224, a98
    v_accvgpr_read_b32 v225, a99
    buffer_load_dwordx4 v[52:55], v1, s[12:15], s32 offen offset:0
    buffer_load_dwordx4 v[56:59], v1, s[12:15], s32 offen offset:1024
    buffer_load_dwordx4 v[60:63], v1, s[12:15], s32 offen offset:2048
    buffer_load_dwordx4 v[64:67], v1, s[12:15], s32 offen offset:3072
    buffer_load_dwordx4 v[68:71], v2, s[12:15], s32 offen
    buffer_load_dwordx4 v[72:75], v3, s[16:19], s33 offen
    buffer_load_dwordx4 v[76:79], v4, s[16:19], s33 offen
    buffer_load_dwordx4 v[80:83], v5, s[16:19], s33 offen
    buffer_load_dwordx4 v[84:87], v6, s[16:19], s33 offen
    s_add_u32 s32, s32, 20480
    s_add_u32 s33, s33, 4096
    s_waitcnt vmcnt(36)
    v_mfma_f32_16x16x32_bf16 a[0:3], v[88:91], v[108:111], a[0:3]
    v_mfma_f32_16x16x32_bf16 a[4:7], v[92:95], v[108:111], a[4:7]
    v_mfma_f32_16x16x32_bf16 a[8:11], v[96:99], v[108:111], a[8:11]
    v_mfma_f32_16x16x32_bf16 a[12:15], v[100:103], v[108:111], a[12:15]
    v_mfma_f32_16x16x32_bf16 a[16:19], v[104:107], v[108:111], a[16:19]
    v_mfma_f32_16x16x32_bf16 a[20:23], v[88:91], v[112:115], a[20:23]
    v_mfma_f32_16x16x32_bf16 a[24:27], v[92:95], v[112:115], a[24:27]
    v_mfma_f32_16x16x32_bf16 a[28:31], v[96:99], v[112:115], a[28:31]
    v_mfma_f32_16x16x32_bf16 a[32:35], v[100:103], v[112:115], a[32:35]
    v_mfma_f32_16x16x32_bf16 a[36:39], v[104:107], v[112:115], a[36:39]
    v_mfma_f32_16x16x32_bf16 a[40:43], v[88:91], v[116:119], a[40:43]
    v_mfma_f32_16x16x32_bf16 a[44:47], v[92:95], v[116:119], a[44:47]
    v_mfma_f32_16x16x32_bf16 a[48:51], v[96:99], v[116:119], a[48:51]
    v_mfma_f32_16x16x32_bf16 a[52:55], v[100:103], v[116:119], a[52:55]
    v_mfma_f32_16x16x32_bf16 a[56:59], v[104:107], v[116:119], a[56:59]
    v_mfma_f32_16x16x32_bf16 a[60:63], v[88:91], v[120:123], a[60:63]
    v_mfma_f32_16x16x32_bf16 a[64:67], v[92:95], v[120:123], a[64:67]
    v_mfma_f32_16x16x32_bf16 a[68:71], v[96:99], v[120:123], a[68:71]
    v_mfma_f32_16x16x32_bf16 a[72:75], v[100:103], v[120:123], a[72:75]
    v_mfma_f32_16x16x32_bf16 a[76:79], v[104:107], v[120:123], a[76:79]
    s_waitcnt lgkmcnt(0)
    s_barrier
    buffer_load_dwordx4 v[88:91], v1, s[12:15], s32 offen offset:0
    buffer_load_dwordx4 v[92:95], v1, s[12:15], s32 offen offset:1024
    buffer_load_dwordx4 v[96:99], v1, s[12:15], s32 offen offset:2048
    buffer_load_dwordx4 v[100:103], v1, s[12:15], s32 offen offset:3072
    buffer_load_dwordx4 v[104:107], v2, s[12:15], s32 offen
    buffer_load_dwordx4 v[108:111], v3, s[16:19], s33 offen
    buffer_load_dwordx4 v[112:115], v4, s[16:19], s33 offen
    buffer_load_dwordx4 v[116:119], v5, s[16:19], s33 offen
    buffer_load_dwordx4 v[120:123], v6, s[16:19], s33 offen
    s_add_u32 s32, s32, 20480
    s_add_u32 s33, s33, 4096
    s_waitcnt vmcnt(36)
    v_mfma_f32_16x16x32_bf16 a[0:3], v[124:127], v[144:147], a[0:3]
    v_mfma_f32_16x16x32_bf16 a[4:7], v[128:131], v[144:147], a[4:7]
    v_mfma_f32_16x16x32_bf16 a[8:11], v[132:135], v[144:147], a[8:11]
    v_mfma_f32_16x16x32_bf16 a[12:15], v[136:139], v[144:147], a[12:15]
    v_mfma_f32_16x16x32_bf16 a[16:19], v[140:143], v[144:147], a[16:19]
    v_mfma_f32_16x16x32_bf16 a[20:23], v[124:127], v[148:151], a[20:23]
    v_mfma_f32_16x16x32_bf16 a[24:27], v[128:131], v[148:151], a[24:27]
    v_mfma_f32_16x16x32_bf16 a[28:31], v[132:135], v[148:151], a[28:31]
    v_mfma_f32_16x16x32_bf16 a[32:35], v[136:139], v[148:151], a[32:35]
    v_mfma_f32_16x16x32_bf16 a[36:39], v[140:143], v[148:151], a[36:39]
    v_mfma_f32_16x16x32_bf16 a[40:43], v[124:127], v[152:155], a[40:43]
    v_mfma_f32_16x16x32_bf16 a[44:47], v[128:131], v[152:155], a[44:47]
    v_mfma_f32_16x16x32_bf16 a[48:51], v[132:135], v[152:155], a[48:51]
    v_mfma_f32_16x16x32_bf16 a[52:55], v[136:139], v[152:155], a[52:55]
    v_mfma_f32_16x16x32_bf16 a[56:59], v[140:143], v[152:155], a[56:59]
    v_mfma_f32_16x16x32_bf16 a[60:63], v[124:127], v[156:159], a[60:63]
    v_mfma_f32_16x16x32_bf16 a[64:67], v[128:131], v[156:159], a[64:67]
    v_mfma_f32_16x16x32_bf16 a[68:71], v[132:135], v[156:159], a[68:71]
    v_mfma_f32_16x16x32_bf16 a[72:75], v[136:139], v[156:159], a[72:75]
    v_mfma_f32_16x16x32_bf16 a[76:79], v[140:143], v[156:159], a[76:79]
    ds_read_b128 v[226:229], v10 offset:0
    ds_read_b128 v[230:233], v10 offset:1024
    ds_read_b128 v[234:237], v10 offset:2048
    ds_read_b128 v[238:241], v10 offset:3072
    ds_read_b128 v[242:245], v10 offset:4096
    s_waitcnt lgkmcnt(4)
    v_add_f32 v206, v206, v226
    v_add_f32 v207, v207, v227
    v_add_f32 v208, v208, v228
    v_add_f32 v209, v209, v229
    s_waitcnt lgkmcnt(3)
    v_add_f32 v210, v210, v230
    v_add_f32 v211, v211, v231
    v_add_f32 v212, v212, v232
    v_add_f32 v213, v213, v233
    s_waitcnt lgkmcnt(2)
    v_add_f32 v214, v214, v234
    v_add_f32 v215, v215, v235
    v_add_f32 v216, v216, v236
    v_add_f32 v217, v217, v237
    s_waitcnt lgkmcnt(1)
    v_add_f32 v218, v218, v238
    v_add_f32 v219, v219, v239
    v_add_f32 v220, v220, v240
    v_add_f32 v221, v221, v241
    s_waitcnt lgkmcnt(0)
    v_add_f32 v222, v222, v242
    v_add_f32 v223, v223, v243
    v_add_f32 v224, v224, v244
    v_add_f32 v225, v225, v245
    buffer_load_dwordx4 v[124:127], v1, s[12:15], s32 offen offset:0
    buffer_load_dwordx4 v[128:131], v1, s[12:15], s32 offen offset:1024
    buffer_load_dwordx4 v[132:135], v1, s[12:15], s32 offen offset:2048
    buffer_load_dwordx4 v[136:139], v1, s[12:15], s32 offen offset:3072
    buffer_load_dwordx4 v[140:143], v2, s[12:15], s32 offen
    buffer_load_dwordx4 v[144:147], v3, s[16:19], s33 offen
    buffer_load_dwordx4 v[148:151], v4, s[16:19], s33 offen
    buffer_load_dwordx4 v[152:155], v5, s[16:19], s33 offen
    buffer_load_dwordx4 v[156:159], v6, s[16:19], s33 offen
    s_add_u32 s32, s32, 20480
    s_add_u32 s33, s33, 4096
    s_waitcnt vmcnt(36)
    v_mfma_f32_16x16x32_bf16 a[0:3], v[160:163], v[180:183], a[0:3]
    v_mfma_f32_16x16x32_bf16 a[4:7], v[164:167], v[180:183], a[4:7]
    v_mfma_f32_16x16x32_bf16 a[8:11], v[168:171], v[180:183], a[8:11]
    v_mfma_f32_16x16x32_bf16 a[12:15], v[172:175], v[180:183], a[12:15]
    v_mfma_f32_16x16x32_bf16 a[16:19], v[176:179], v[180:183], a[16:19]
    v_mfma_f32_16x16x32_bf16 a[20:23], v[160:163], v[184:187], a[20:23]
    v_mfma_f32_16x16x32_bf16 a[24:27], v[164:167], v[184:187], a[24:27]
    v_mfma_f32_16x16x32_bf16 a[28:31], v[168:171], v[184:187], a[28:31]
    v_mfma_f32_16x16x32_bf16 a[32:35], v[172:175], v[184:187], a[32:35]
    v_mfma_f32_16x16x32_bf16 a[36:39], v[176:179], v[184:187], a[36:39]
    v_mfma_f32_16x16x32_bf16 a[40:43], v[160:163], v[188:191], a[40:43]
    v_mfma_f32_16x16x32_bf16 a[44:47], v[164:167], v[188:191], a[44:47]
    v_mfma_f32_16x16x32_bf16 a[48:51], v[168:171], v[188:191], a[48:51]
    v_mfma_f32_16x16x32_bf16 a[52:55], v[172:175], v[188:191], a[52:55]
    v_mfma_f32_16x16x32_bf16 a[56:59], v[176:179], v[188:191], a[56:59]
    v_mfma_f32_16x16x32_bf16 a[60:63], v[160:163], v[192:195], a[60:63]
    v_mfma_f32_16x16x32_bf16 a[64:67], v[164:167], v[192:195], a[64:67]
    v_mfma_f32_16x16x32_bf16 a[68:71], v[168:171], v[192:195], a[68:71]
    v_mfma_f32_16x16x32_bf16 a[72:75], v[172:175], v[192:195], a[72:75]
    v_mfma_f32_16x16x32_bf16 a[76:79], v[176:179], v[192:195], a[76:79]
    ds_read_b128 v[226:229], v10 offset:5120
    ds_read_b128 v[230:233], v10 offset:6144
    ds_read_b128 v[234:237], v10 offset:7168
    ds_read_b128 v[238:241], v10 offset:8192
    ds_read_b128 v[242:245], v10 offset:9216
    s_waitcnt lgkmcnt(4)
    v_add_f32 v206, v206, v226
    v_add_f32 v207, v207, v227
    v_add_f32 v208, v208, v228
    v_add_f32 v209, v209, v229
    s_waitcnt lgkmcnt(3)
    v_add_f32 v210, v210, v230
    v_add_f32 v211, v211, v231
    v_add_f32 v212, v212, v232
    v_add_f32 v213, v213, v233
    s_waitcnt lgkmcnt(2)
    v_add_f32 v214, v214, v234
    v_add_f32 v215, v215, v235
    v_add_f32 v216, v216, v236
    v_add_f32 v217, v217, v237
    s_waitcnt lgkmcnt(1)
    v_add_f32 v218, v218, v238
    v_add_f32 v219, v219, v239
    v_add_f32 v220, v220, v240
    v_add_f32 v221, v221, v241
    s_waitcnt lgkmcnt(0)
    v_add_f32 v222, v222, v242
    v_add_f32 v223, v223, v243
    v_add_f32 v224, v224, v244
    v_add_f32 v225, v225, v245
    buffer_load_dwordx4 v[160:163], v1, s[12:15], s32 offen offset:0
    buffer_load_dwordx4 v[164:167], v1, s[12:15], s32 offen offset:1024
    buffer_load_dwordx4 v[168:171], v1, s[12:15], s32 offen offset:2048
    buffer_load_dwordx4 v[172:175], v1, s[12:15], s32 offen offset:3072
    buffer_load_dwordx4 v[176:179], v2, s[12:15], s32 offen
    buffer_load_dwordx4 v[180:183], v3, s[16:19], s33 offen
    buffer_load_dwordx4 v[184:187], v4, s[16:19], s33 offen
    buffer_load_dwordx4 v[188:191], v5, s[16:19], s33 offen
    buffer_load_dwordx4 v[192:195], v6, s[16:19], s33 offen
    s_add_u32 s32, s32, 20480
    s_add_u32 s33, s33, 4096
    s_waitcnt vmcnt(36)
    v_mfma_f32_16x16x32_bf16 a[0:3], v[16:19], v[36:39], a[0:3]
    v_mfma_f32_16x16x32_bf16 a[4:7], v[20:23], v[36:39], a[4:7]
    v_mfma_f32_16x16x32_bf16 a[8:11], v[24:27], v[36:39], a[8:11]
    v_mfma_f32_16x16x32_bf16 a[12:15], v[28:31], v[36:39], a[12:15]
    v_mfma_f32_16x16x32_bf16 a[16:19], v[32:35], v[36:39], a[16:19]
    v_mfma_f32_16x16x32_bf16 a[20:23], v[16:19], v[40:43], a[20:23]
    v_mfma_f32_16x16x32_bf16 a[24:27], v[20:23], v[40:43], a[24:27]
    v_mfma_f32_16x16x32_bf16 a[28:31], v[24:27], v[40:43], a[28:31]
    v_mfma_f32_16x16x32_bf16 a[32:35], v[28:31], v[40:43], a[32:35]
    v_mfma_f32_16x16x32_bf16 a[36:39], v[32:35], v[40:43], a[36:39]
    v_mfma_f32_16x16x32_bf16 a[40:43], v[16:19], v[44:47], a[40:43]
    v_mfma_f32_16x16x32_bf16 a[44:47], v[20:23], v[44:47], a[44:47]
    v_mfma_f32_16x16x32_bf16 a[48:51], v[24:27], v[44:47], a[48:51]
    v_mfma_f32_16x16x32_bf16 a[52:55], v[28:31], v[44:47], a[52:55]
    v_mfma_f32_16x16x32_bf16 a[56:59], v[32:35], v[44:47], a[56:59]
    v_mfma_f32_16x16x32_bf16 a[60:63], v[16:19], v[48:51], a[60:63]
    v_mfma_f32_16x16x32_bf16 a[64:67], v[20:23], v[48:51], a[64:67]
    v_mfma_f32_16x16x32_bf16 a[68:71], v[24:27], v[48:51], a[68:71]
    v_mfma_f32_16x16x32_bf16 a[72:75], v[28:31], v[48:51], a[72:75]
    v_mfma_f32_16x16x32_bf16 a[76:79], v[32:35], v[48:51], a[76:79]
    ds_read_b128 v[226:229], v10 offset:10240
    ds_read_b128 v[230:233], v10 offset:11264
    ds_read_b128 v[234:237], v10 offset:12288
    ds_read_b128 v[238:241], v10 offset:13312
    ds_read_b128 v[242:245], v10 offset:14336
    s_waitcnt lgkmcnt(4)
    v_add_f32 v206, v206, v226
    v_add_f32 v207, v207, v227
    v_add_f32 v208, v208, v228
    v_add_f32 v209, v209, v229
    s_waitcnt lgkmcnt(3)
    v_add_f32 v210, v210, v230
    v_add_f32 v211, v211, v231
    v_add_f32 v212, v212, v232
    v_add_f32 v213, v213, v233
    s_waitcnt lgkmcnt(2)
    v_add_f32 v214, v214, v234
    v_add_f32 v215, v215, v235
    v_add_f32 v216, v216, v236
    v_add_f32 v217, v217, v237
    s_waitcnt lgkmcnt(1)
    v_add_f32 v218, v218, v238
    v_add_f32 v219, v219, v239
    v_add_f32 v220, v220, v240
    v_add_f32 v221, v221, v241
    s_waitcnt lgkmcnt(0)
    v_add_f32 v222, v222, v242
    v_add_f32 v223, v223, v243
    v_add_f32 v224, v224, v244
    v_add_f32 v225, v225, v245
    buffer_load_dwordx4 v[16:19], v1, s[12:15], s32 offen offset:0
    buffer_load_dwordx4 v[20:23], v1, s[12:15], s32 offen offset:1024
    buffer_load_dwordx4 v[24:27], v1, s[12:15], s32 offen offset:2048
    buffer_load_dwordx4 v[28:31], v1, s[12:15], s32 offen offset:3072
    buffer_load_dwordx4 v[32:35], v2, s[12:15], s32 offen
    buffer_load_dwordx4 v[36:39], v3, s[16:19], s33 offen
    buffer_load_dwordx4 v[40:43], v4, s[16:19], s33 offen
    buffer_load_dwordx4 v[44:47], v5, s[16:19], s33 offen
    buffer_load_dwordx4 v[48:51], v6, s[16:19], s33 offen
    s_add_u32 s32, s32, 20480
    s_add_u32 s33, s33, 4096
    s_waitcnt vmcnt(36)
    v_mfma_f32_16x16x32_bf16 a[0:3], v[52:55], v[72:75], a[0:3]
    v_mfma_f32_16x16x32_bf16 a[4:7], v[56:59], v[72:75], a[4:7]
    v_mfma_f32_16x16x32_bf16 a[8:11], v[60:63], v[72:75], a[8:11]
    v_mfma_f32_16x16x32_bf16 a[12:15], v[64:67], v[72:75], a[12:15]
    v_mfma_f32_16x16x32_bf16 a[16:19], v[68:71], v[72:75], a[16:19]
    v_mfma_f32_16x16x32_bf16 a[20:23], v[52:55], v[76:79], a[20:23]
    v_mfma_f32_16x16x32_bf16 a[24:27], v[56:59], v[76:79], a[24:27]
    v_mfma_f32_16x16x32_bf16 a[28:31], v[60:63], v[76:79], a[28:31]
    v_mfma_f32_16x16x32_bf16 a[32:35], v[64:67], v[76:79], a[32:35]
    v_mfma_f32_16x16x32_bf16 a[36:39], v[68:71], v[76:79], a[36:39]
    v_mfma_f32_16x16x32_bf16 a[40:43], v[52:55], v[80:83], a[40:43]
    v_mfma_f32_16x16x32_bf16 a[44:47], v[56:59], v[80:83], a[44:47]
    v_mfma_f32_16x16x32_bf16 a[48:51], v[60:63], v[80:83], a[48:51]
    v_mfma_f32_16x16x32_bf16 a[52:55], v[64:67], v[80:83], a[52:55]
    v_mfma_f32_16x16x32_bf16 a[56:59], v[68:71], v[80:83], a[56:59]
    v_mfma_f32_16x16x32_bf16 a[60:63], v[52:55], v[84:87], a[60:63]
    v_mfma_f32_16x16x32_bf16 a[64:67], v[56:59], v[84:87], a[64:67]
    v_mfma_f32_16x16x32_bf16 a[68:71], v[60:63], v[84:87], a[68:71]
    v_mfma_f32_16x16x32_bf16 a[72:75], v[64:67], v[84:87], a[72:75]
    v_mfma_f32_16x16x32_bf16 a[76:79], v[68:71], v[84:87], a[76:79]
    v_mul_f32 v226, 0xbfb8aa3b, v206
    v_mul_f32 v227, 0xbfb8aa3b, v207
    v_mul_f32 v228, 0xbfb8aa3b, v208
    v_mul_f32 v229, 0xbfb8aa3b, v209
    v_mul_f32 v230, 0xbfb8aa3b, v210
    v_mul_f32 v231, 0xbfb8aa3b, v211
    v_mul_f32 v232, 0xbfb8aa3b, v212
    v_mul_f32 v233, 0xbfb8aa3b, v213
    v_mul_f32 v234, 0xbfb8aa3b, v214
    v_mul_f32 v235, 0xbfb8aa3b, v215
    v_mul_f32 v236, 0xbfb8aa3b, v216
    v_mul_f32 v237, 0xbfb8aa3b, v217
    v_mul_f32 v238, 0xbfb8aa3b, v218
    v_mul_f32 v239, 0xbfb8aa3b, v219
    v_mul_f32 v240, 0xbfb8aa3b, v220
    v_mul_f32 v241, 0xbfb8aa3b, v221
    v_mul_f32 v242, 0xbfb8aa3b, v222
    v_mul_f32 v243, 0xbfb8aa3b, v223
    v_mul_f32 v244, 0xbfb8aa3b, v224
    v_mul_f32 v245, 0xbfb8aa3b, v225
    v_exp_f32 v226, v226
    v_exp_f32 v227, v227
    v_exp_f32 v228, v228
    v_exp_f32 v229, v229
    v_exp_f32 v230, v230
    v_exp_f32 v231, v231
    v_exp_f32 v232, v232
    v_exp_f32 v233, v233
    v_exp_f32 v234, v234
    v_exp_f32 v235, v235
    v_exp_f32 v236, v236
    v_exp_f32 v237, v237
    v_exp_f32 v238, v238
    v_exp_f32 v239, v239
    v_exp_f32 v240, v240
    v_exp_f32 v241, v241
    v_exp_f32 v242, v242
    v_exp_f32 v243, v243
    v_exp_f32 v244, v244
    v_exp_f32 v245, v245
    v_add_f32 v226, 1.0, v226
    v_add_f32 v227, 1.0, v227
    v_add_f32 v228, 1.0, v228
    v_add_f32 v229, 1.0, v229
    v_add_f32 v230, 1.0, v230
    v_add_f32 v231, 1.0, v231
    v_add_f32 v232, 1.0, v232
    v_add_f32 v233, 1.0, v233
    v_add_f32 v234, 1.0, v234
    v_add_f32 v235, 1.0, v235
    v_add_f32 v236, 1.0, v236
    v_add_f32 v237, 1.0, v237
    v_add_f32 v238, 1.0, v238
    v_add_f32 v239, 1.0, v239
    v_add_f32 v240, 1.0, v240
    v_add_f32 v241, 1.0, v241
    v_add_f32 v242, 1.0, v242
    v_add_f32 v243, 1.0, v243
    v_add_f32 v244, 1.0, v244
    v_add_f32 v245, 1.0, v245
    buffer_load_dwordx4 v[52:55], v1, s[12:15], s32 offen offset:0
    buffer_load_dwordx4 v[56:59], v1, s[12:15], s32 offen offset:1024
    buffer_load_dwordx4 v[60:63], v1, s[12:15], s32 offen offset:2048
    buffer_load_dwordx4 v[64:67], v1, s[12:15], s32 offen offset:3072
    buffer_load_dwordx4 v[68:71], v2, s[12:15], s32 offen
    buffer_load_dwordx4 v[72:75], v3, s[16:19], s33 offen
    buffer_load_dwordx4 v[76:79], v4, s[16:19], s33 offen
    buffer_load_dwordx4 v[80:83], v5, s[16:19], s33 offen
    buffer_load_dwordx4 v[84:87], v6, s[16:19], s33 offen
    s_add_u32 s32, s32, 20480
    s_add_u32 s33, s33, 4096
    s_waitcnt vmcnt(36)
    v_mfma_f32_16x16x32_bf16 a[0:3], v[88:91], v[108:111], a[0:3]
    v_mfma_f32_16x16x32_bf16 a[4:7], v[92:95], v[108:111], a[4:7]
    v_mfma_f32_16x16x32_bf16 a[8:11], v[96:99], v[108:111], a[8:11]
    v_mfma_f32_16x16x32_bf16 a[12:15], v[100:103], v[108:111], a[12:15]
    v_mfma_f32_16x16x32_bf16 a[16:19], v[104:107], v[108:111], a[16:19]
    v_mfma_f32_16x16x32_bf16 a[20:23], v[88:91], v[112:115], a[20:23]
    v_mfma_f32_16x16x32_bf16 a[24:27], v[92:95], v[112:115], a[24:27]
    v_mfma_f32_16x16x32_bf16 a[28:31], v[96:99], v[112:115], a[28:31]
    v_mfma_f32_16x16x32_bf16 a[32:35], v[100:103], v[112:115], a[32:35]
    v_mfma_f32_16x16x32_bf16 a[36:39], v[104:107], v[112:115], a[36:39]
    v_mfma_f32_16x16x32_bf16 a[40:43], v[88:91], v[116:119], a[40:43]
    v_mfma_f32_16x16x32_bf16 a[44:47], v[92:95], v[116:119], a[44:47]
    v_mfma_f32_16x16x32_bf16 a[48:51], v[96:99], v[116:119], a[48:51]
    v_mfma_f32_16x16x32_bf16 a[52:55], v[100:103], v[116:119], a[52:55]
    v_mfma_f32_16x16x32_bf16 a[56:59], v[104:107], v[116:119], a[56:59]
    v_mfma_f32_16x16x32_bf16 a[60:63], v[88:91], v[120:123], a[60:63]
    v_mfma_f32_16x16x32_bf16 a[64:67], v[92:95], v[120:123], a[64:67]
    v_mfma_f32_16x16x32_bf16 a[68:71], v[96:99], v[120:123], a[68:71]
    v_mfma_f32_16x16x32_bf16 a[72:75], v[100:103], v[120:123], a[72:75]
    v_mfma_f32_16x16x32_bf16 a[76:79], v[104:107], v[120:123], a[76:79]
    v_rcp_f32 v226, v226
    v_rcp_f32 v227, v227
    v_rcp_f32 v228, v228
    v_rcp_f32 v229, v229
    v_rcp_f32 v230, v230
    v_rcp_f32 v231, v231
    v_rcp_f32 v232, v232
    v_rcp_f32 v233, v233
    v_rcp_f32 v234, v234
    v_rcp_f32 v235, v235
    v_rcp_f32 v236, v236
    v_rcp_f32 v237, v237
    v_rcp_f32 v238, v238
    v_rcp_f32 v239, v239
    v_rcp_f32 v240, v240
    v_rcp_f32 v241, v241
    v_rcp_f32 v242, v242
    v_rcp_f32 v243, v243
    v_rcp_f32 v244, v244
    v_rcp_f32 v245, v245
    v_mul_f32 v206, v206, v226
    v_mul_f32 v207, v207, v227
    v_mul_f32 v208, v208, v228
    v_mul_f32 v209, v209, v229
    v_mul_f32 v210, v210, v230
    v_mul_f32 v211, v211, v231
    v_mul_f32 v212, v212, v232
    v_mul_f32 v213, v213, v233
    v_mul_f32 v214, v214, v234
    v_mul_f32 v215, v215, v235
    v_mul_f32 v216, v216, v236
    v_mul_f32 v217, v217, v237
    v_mul_f32 v218, v218, v238
    v_mul_f32 v219, v219, v239
    v_mul_f32 v220, v220, v240
    v_mul_f32 v221, v221, v241
    v_mul_f32 v222, v222, v242
    v_mul_f32 v223, v223, v243
    v_mul_f32 v224, v224, v244
    v_mul_f32 v225, v225, v245
    buffer_load_dwordx4 v[88:91], v1, s[12:15], s32 offen offset:0
    buffer_load_dwordx4 v[92:95], v1, s[12:15], s32 offen offset:1024
    buffer_load_dwordx4 v[96:99], v1, s[12:15], s32 offen offset:2048
    buffer_load_dwordx4 v[100:103], v1, s[12:15], s32 offen offset:3072
    buffer_load_dwordx4 v[104:107], v2, s[12:15], s32 offen
    buffer_load_dwordx4 v[108:111], v3, s[16:19], s33 offen
    buffer_load_dwordx4 v[112:115], v4, s[16:19], s33 offen
    buffer_load_dwordx4 v[116:119], v5, s[16:19], s33 offen
    buffer_load_dwordx4 v[120:123], v6, s[16:19], s33 offen
    s_add_u32 s32, s32, 20480
    s_add_u32 s33, s33, 4096
    s_waitcnt vmcnt(36)
    v_mfma_f32_16x16x32_bf16 a[0:3], v[124:127], v[144:147], a[0:3]
    v_mfma_f32_16x16x32_bf16 a[4:7], v[128:131], v[144:147], a[4:7]
    v_mfma_f32_16x16x32_bf16 a[8:11], v[132:135], v[144:147], a[8:11]
    v_mfma_f32_16x16x32_bf16 a[12:15], v[136:139], v[144:147], a[12:15]
    v_mfma_f32_16x16x32_bf16 a[16:19], v[140:143], v[144:147], a[16:19]
    v_mfma_f32_16x16x32_bf16 a[20:23], v[124:127], v[148:151], a[20:23]
    v_mfma_f32_16x16x32_bf16 a[24:27], v[128:131], v[148:151], a[24:27]
    v_mfma_f32_16x16x32_bf16 a[28:31], v[132:135], v[148:151], a[28:31]
    v_mfma_f32_16x16x32_bf16 a[32:35], v[136:139], v[148:151], a[32:35]
    v_mfma_f32_16x16x32_bf16 a[36:39], v[140:143], v[148:151], a[36:39]
    v_mfma_f32_16x16x32_bf16 a[40:43], v[124:127], v[152:155], a[40:43]
    v_mfma_f32_16x16x32_bf16 a[44:47], v[128:131], v[152:155], a[44:47]
    v_mfma_f32_16x16x32_bf16 a[48:51], v[132:135], v[152:155], a[48:51]
    v_mfma_f32_16x16x32_bf16 a[52:55], v[136:139], v[152:155], a[52:55]
    v_mfma_f32_16x16x32_bf16 a[56:59], v[140:143], v[152:155], a[56:59]
    v_mfma_f32_16x16x32_bf16 a[60:63], v[124:127], v[156:159], a[60:63]
    v_mfma_f32_16x16x32_bf16 a[64:67], v[128:131], v[156:159], a[64:67]
    v_mfma_f32_16x16x32_bf16 a[68:71], v[132:135], v[156:159], a[68:71]
    v_mfma_f32_16x16x32_bf16 a[72:75], v[136:139], v[156:159], a[72:75]
    v_mfma_f32_16x16x32_bf16 a[76:79], v[140:143], v[156:159], a[76:79]
    buffer_load_dwordx4 v[124:127], v1, s[12:15], s32 offen offset:0
    buffer_load_dwordx4 v[128:131], v1, s[12:15], s32 offen offset:1024
    buffer_load_dwordx4 v[132:135], v1, s[12:15], s32 offen offset:2048
    buffer_load_dwordx4 v[136:139], v1, s[12:15], s32 offen offset:3072
    buffer_load_dwordx4 v[140:143], v2, s[12:15], s32 offen
    buffer_load_dwordx4 v[144:147], v3, s[16:19], s33 offen
    buffer_load_dwordx4 v[148:151], v4, s[16:19], s33 offen
    buffer_load_dwordx4 v[152:155], v5, s[16:19], s33 offen
    buffer_load_dwordx4 v[156:159], v6, s[16:19], s33 offen
    s_add_u32 s32, s32, 20480
    s_add_u32 s33, s33, 4096
    s_waitcnt vmcnt(36)
    v_mfma_f32_16x16x32_bf16 a[0:3], v[160:163], v[180:183], a[0:3]
    v_mfma_f32_16x16x32_bf16 a[4:7], v[164:167], v[180:183], a[4:7]
    v_mfma_f32_16x16x32_bf16 a[8:11], v[168:171], v[180:183], a[8:11]
    v_mfma_f32_16x16x32_bf16 a[12:15], v[172:175], v[180:183], a[12:15]
    v_mfma_f32_16x16x32_bf16 a[16:19], v[176:179], v[180:183], a[16:19]
    v_mfma_f32_16x16x32_bf16 a[20:23], v[160:163], v[184:187], a[20:23]
    v_mfma_f32_16x16x32_bf16 a[24:27], v[164:167], v[184:187], a[24:27]
    v_mfma_f32_16x16x32_bf16 a[28:31], v[168:171], v[184:187], a[28:31]
    v_mfma_f32_16x16x32_bf16 a[32:35], v[172:175], v[184:187], a[32:35]
    v_mfma_f32_16x16x32_bf16 a[36:39], v[176:179], v[184:187], a[36:39]
    v_mfma_f32_16x16x32_bf16 a[40:43], v[160:163], v[188:191], a[40:43]
    v_mfma_f32_16x16x32_bf16 a[44:47], v[164:167], v[188:191], a[44:47]
    v_mfma_f32_16x16x32_bf16 a[48:51], v[168:171], v[188:191], a[48:51]
    v_mfma_f32_16x16x32_bf16 a[52:55], v[172:175], v[188:191], a[52:55]
    v_mfma_f32_16x16x32_bf16 a[56:59], v[176:179], v[188:191], a[56:59]
    v_mfma_f32_16x16x32_bf16 a[60:63], v[160:163], v[192:195], a[60:63]
    v_mfma_f32_16x16x32_bf16 a[64:67], v[164:167], v[192:195], a[64:67]
    v_mfma_f32_16x16x32_bf16 a[68:71], v[168:171], v[192:195], a[68:71]
    v_mfma_f32_16x16x32_bf16 a[72:75], v[172:175], v[192:195], a[72:75]
    v_mfma_f32_16x16x32_bf16 a[76:79], v[176:179], v[192:195], a[76:79]
    buffer_load_dwordx4 v[160:163], v1, s[12:15], s32 offen offset:0
    buffer_load_dwordx4 v[164:167], v1, s[12:15], s32 offen offset:1024
    buffer_load_dwordx4 v[168:171], v1, s[12:15], s32 offen offset:2048
    buffer_load_dwordx4 v[172:175], v1, s[12:15], s32 offen offset:3072
    buffer_load_dwordx4 v[176:179], v2, s[12:15], s32 offen
    buffer_load_dwordx4 v[180:183], v3, s[16:19], s33 offen
    buffer_load_dwordx4 v[184:187], v4, s[16:19], s33 offen
    buffer_load_dwordx4 v[188:191], v5, s[16:19], s33 offen
    buffer_load_dwordx4 v[192:195], v6, s[16:19], s33 offen
    s_add_u32 s32, s32, 20480
    s_add_u32 s33, s33, 4096
    s_waitcnt vmcnt(36)
    v_mfma_f32_16x16x32_bf16 a[0:3], v[16:19], v[36:39], a[0:3]
    v_mfma_f32_16x16x32_bf16 a[4:7], v[20:23], v[36:39], a[4:7]
    v_mfma_f32_16x16x32_bf16 a[8:11], v[24:27], v[36:39], a[8:11]
    v_mfma_f32_16x16x32_bf16 a[12:15], v[28:31], v[36:39], a[12:15]
    v_mfma_f32_16x16x32_bf16 a[16:19], v[32:35], v[36:39], a[16:19]
    v_mfma_f32_16x16x32_bf16 a[20:23], v[16:19], v[40:43], a[20:23]
    v_mfma_f32_16x16x32_bf16 a[24:27], v[20:23], v[40:43], a[24:27]
    v_mfma_f32_16x16x32_bf16 a[28:31], v[24:27], v[40:43], a[28:31]
    v_mfma_f32_16x16x32_bf16 a[32:35], v[28:31], v[40:43], a[32:35]
    v_mfma_f32_16x16x32_bf16 a[36:39], v[32:35], v[40:43], a[36:39]
    v_mfma_f32_16x16x32_bf16 a[40:43], v[16:19], v[44:47], a[40:43]
    v_mfma_f32_16x16x32_bf16 a[44:47], v[20:23], v[44:47], a[44:47]
    v_mfma_f32_16x16x32_bf16 a[48:51], v[24:27], v[44:47], a[48:51]
    v_mfma_f32_16x16x32_bf16 a[52:55], v[28:31], v[44:47], a[52:55]
    v_mfma_f32_16x16x32_bf16 a[56:59], v[32:35], v[44:47], a[56:59]
    v_mfma_f32_16x16x32_bf16 a[60:63], v[16:19], v[48:51], a[60:63]
    v_mfma_f32_16x16x32_bf16 a[64:67], v[20:23], v[48:51], a[64:67]
    v_mfma_f32_16x16x32_bf16 a[68:71], v[24:27], v[48:51], a[68:71]
    v_mfma_f32_16x16x32_bf16 a[72:75], v[28:31], v[48:51], a[72:75]
    v_mfma_f32_16x16x32_bf16 a[76:79], v[32:35], v[48:51], a[76:79]
    buffer_load_dwordx4 v[16:19], v1, s[12:15], s32 offen offset:0
    buffer_load_dwordx4 v[20:23], v1, s[12:15], s32 offen offset:1024
    buffer_load_dwordx4 v[24:27], v1, s[12:15], s32 offen offset:2048
    buffer_load_dwordx4 v[28:31], v1, s[12:15], s32 offen offset:3072
    buffer_load_dwordx4 v[32:35], v2, s[12:15], s32 offen
    buffer_load_dwordx4 v[36:39], v3, s[16:19], s33 offen
    buffer_load_dwordx4 v[40:43], v4, s[16:19], s33 offen
    buffer_load_dwordx4 v[44:47], v5, s[16:19], s33 offen
    buffer_load_dwordx4 v[48:51], v6, s[16:19], s33 offen
    s_add_u32 s32, s32, 20480
    s_add_u32 s33, s33, 4096
    s_waitcnt vmcnt(36)
    v_mfma_f32_16x16x32_bf16 a[0:3], v[52:55], v[72:75], a[0:3]
    v_mfma_f32_16x16x32_bf16 a[4:7], v[56:59], v[72:75], a[4:7]
    v_mfma_f32_16x16x32_bf16 a[8:11], v[60:63], v[72:75], a[8:11]
    v_mfma_f32_16x16x32_bf16 a[12:15], v[64:67], v[72:75], a[12:15]
    v_mfma_f32_16x16x32_bf16 a[16:19], v[68:71], v[72:75], a[16:19]
    v_mfma_f32_16x16x32_bf16 a[20:23], v[52:55], v[76:79], a[20:23]
    v_mfma_f32_16x16x32_bf16 a[24:27], v[56:59], v[76:79], a[24:27]
    v_mfma_f32_16x16x32_bf16 a[28:31], v[60:63], v[76:79], a[28:31]
    v_mfma_f32_16x16x32_bf16 a[32:35], v[64:67], v[76:79], a[32:35]
    v_mfma_f32_16x16x32_bf16 a[36:39], v[68:71], v[76:79], a[36:39]
    v_mfma_f32_16x16x32_bf16 a[40:43], v[52:55], v[80:83], a[40:43]
    v_mfma_f32_16x16x32_bf16 a[44:47], v[56:59], v[80:83], a[44:47]
    v_mfma_f32_16x16x32_bf16 a[48:51], v[60:63], v[80:83], a[48:51]
    v_mfma_f32_16x16x32_bf16 a[52:55], v[64:67], v[80:83], a[52:55]
    v_mfma_f32_16x16x32_bf16 a[56:59], v[68:71], v[80:83], a[56:59]
    v_mfma_f32_16x16x32_bf16 a[60:63], v[52:55], v[84:87], a[60:63]
    v_mfma_f32_16x16x32_bf16 a[64:67], v[56:59], v[84:87], a[64:67]
    v_mfma_f32_16x16x32_bf16 a[68:71], v[60:63], v[84:87], a[68:71]
    v_mfma_f32_16x16x32_bf16 a[72:75], v[64:67], v[84:87], a[72:75]
    v_mfma_f32_16x16x32_bf16 a[76:79], v[68:71], v[84:87], a[76:79]
    buffer_load_dwordx4 v[52:55], v1, s[12:15], s32 offen offset:0
    buffer_load_dwordx4 v[56:59], v1, s[12:15], s32 offen offset:1024
    buffer_load_dwordx4 v[60:63], v1, s[12:15], s32 offen offset:2048
    buffer_load_dwordx4 v[64:67], v1, s[12:15], s32 offen offset:3072
    buffer_load_dwordx4 v[68:71], v2, s[12:15], s32 offen
    buffer_load_dwordx4 v[72:75], v3, s[16:19], s33 offen
    buffer_load_dwordx4 v[76:79], v4, s[16:19], s33 offen
    buffer_load_dwordx4 v[80:83], v5, s[16:19], s33 offen
    buffer_load_dwordx4 v[84:87], v6, s[16:19], s33 offen
    s_add_u32 s32, s32, 20480
    s_add_u32 s33, s33, 4096
    s_waitcnt vmcnt(36)
    v_mfma_f32_16x16x32_bf16 a[0:3], v[88:91], v[108:111], a[0:3]
    v_mfma_f32_16x16x32_bf16 a[4:7], v[92:95], v[108:111], a[4:7]
    v_mfma_f32_16x16x32_bf16 a[8:11], v[96:99], v[108:111], a[8:11]
    v_mfma_f32_16x16x32_bf16 a[12:15], v[100:103], v[108:111], a[12:15]
    v_mfma_f32_16x16x32_bf16 a[16:19], v[104:107], v[108:111], a[16:19]
    v_mfma_f32_16x16x32_bf16 a[20:23], v[88:91], v[112:115], a[20:23]
    v_mfma_f32_16x16x32_bf16 a[24:27], v[92:95], v[112:115], a[24:27]
    v_mfma_f32_16x16x32_bf16 a[28:31], v[96:99], v[112:115], a[28:31]
    v_mfma_f32_16x16x32_bf16 a[32:35], v[100:103], v[112:115], a[32:35]
    v_mfma_f32_16x16x32_bf16 a[36:39], v[104:107], v[112:115], a[36:39]
    v_mfma_f32_16x16x32_bf16 a[40:43], v[88:91], v[116:119], a[40:43]
    v_mfma_f32_16x16x32_bf16 a[44:47], v[92:95], v[116:119], a[44:47]
    v_mfma_f32_16x16x32_bf16 a[48:51], v[96:99], v[116:119], a[48:51]
    v_mfma_f32_16x16x32_bf16 a[52:55], v[100:103], v[116:119], a[52:55]
    v_mfma_f32_16x16x32_bf16 a[56:59], v[104:107], v[116:119], a[56:59]
    v_mfma_f32_16x16x32_bf16 a[60:63], v[88:91], v[120:123], a[60:63]
    v_mfma_f32_16x16x32_bf16 a[64:67], v[92:95], v[120:123], a[64:67]
    v_mfma_f32_16x16x32_bf16 a[68:71], v[96:99], v[120:123], a[68:71]
    v_mfma_f32_16x16x32_bf16 a[72:75], v[100:103], v[120:123], a[72:75]
    v_mfma_f32_16x16x32_bf16 a[76:79], v[104:107], v[120:123], a[76:79]
    buffer_load_dwordx4 v[88:91], v1, s[12:15], s32 offen offset:0
    buffer_load_dwordx4 v[92:95], v1, s[12:15], s32 offen offset:1024
    buffer_load_dwordx4 v[96:99], v1, s[12:15], s32 offen offset:2048
    buffer_load_dwordx4 v[100:103], v1, s[12:15], s32 offen offset:3072
    buffer_load_dwordx4 v[104:107], v2, s[12:15], s32 offen
    buffer_load_dwordx4 v[108:111], v3, s[16:19], s33 offen
    buffer_load_dwordx4 v[112:115], v4, s[16:19], s33 offen
    buffer_load_dwordx4 v[116:119], v5, s[16:19], s33 offen
    buffer_load_dwordx4 v[120:123], v6, s[16:19], s33 offen
    s_add_u32 s32, s32, 20480
    s_add_u32 s33, s33, 4096
    s_waitcnt vmcnt(36)
    v_mfma_f32_16x16x32_bf16 a[0:3], v[124:127], v[144:147], a[0:3]
    v_mfma_f32_16x16x32_bf16 a[4:7], v[128:131], v[144:147], a[4:7]
    v_mfma_f32_16x16x32_bf16 a[8:11], v[132:135], v[144:147], a[8:11]
    v_mfma_f32_16x16x32_bf16 a[12:15], v[136:139], v[144:147], a[12:15]
    v_mfma_f32_16x16x32_bf16 a[16:19], v[140:143], v[144:147], a[16:19]
    v_mfma_f32_16x16x32_bf16 a[20:23], v[124:127], v[148:151], a[20:23]
    v_mfma_f32_16x16x32_bf16 a[24:27], v[128:131], v[148:151], a[24:27]
    v_mfma_f32_16x16x32_bf16 a[28:31], v[132:135], v[148:151], a[28:31]
    v_mfma_f32_16x16x32_bf16 a[32:35], v[136:139], v[148:151], a[32:35]
    v_mfma_f32_16x16x32_bf16 a[36:39], v[140:143], v[148:151], a[36:39]
    v_mfma_f32_16x16x32_bf16 a[40:43], v[124:127], v[152:155], a[40:43]
    v_mfma_f32_16x16x32_bf16 a[44:47], v[128:131], v[152:155], a[44:47]
    v_mfma_f32_16x16x32_bf16 a[48:51], v[132:135], v[152:155], a[48:51]
    v_mfma_f32_16x16x32_bf16 a[52:55], v[136:139], v[152:155], a[52:55]
    v_mfma_f32_16x16x32_bf16 a[56:59], v[140:143], v[152:155], a[56:59]
    v_mfma_f32_16x16x32_bf16 a[60:63], v[124:127], v[156:159], a[60:63]
    v_mfma_f32_16x16x32_bf16 a[64:67], v[128:131], v[156:159], a[64:67]
    v_mfma_f32_16x16x32_bf16 a[68:71], v[132:135], v[156:159], a[68:71]
    v_mfma_f32_16x16x32_bf16 a[72:75], v[136:139], v[156:159], a[72:75]
    v_mfma_f32_16x16x32_bf16 a[76:79], v[140:143], v[156:159], a[76:79]
    buffer_load_dwordx4 v[124:127], v1, s[12:15], s32 offen offset:0
    buffer_load_dwordx4 v[128:131], v1, s[12:15], s32 offen offset:1024
    buffer_load_dwordx4 v[132:135], v1, s[12:15], s32 offen offset:2048
    buffer_load_dwordx4 v[136:139], v1, s[12:15], s32 offen offset:3072
    buffer_load_dwordx4 v[140:143], v2, s[12:15], s32 offen
    buffer_load_dwordx4 v[144:147], v3, s[16:19], s33 offen
    buffer_load_dwordx4 v[148:151], v4, s[16:19], s33 offen
    buffer_load_dwordx4 v[152:155], v5, s[16:19], s33 offen
    buffer_load_dwordx4 v[156:159], v6, s[16:19], s33 offen
    s_add_u32 s32, s32, 20480
    s_add_u32 s33, s33, 4096
    s_waitcnt vmcnt(36)
    v_mfma_f32_16x16x32_bf16 a[0:3], v[160:163], v[180:183], a[0:3]
    v_mfma_f32_16x16x32_bf16 a[4:7], v[164:167], v[180:183], a[4:7]
    v_mfma_f32_16x16x32_bf16 a[8:11], v[168:171], v[180:183], a[8:11]
    v_mfma_f32_16x16x32_bf16 a[12:15], v[172:175], v[180:183], a[12:15]
    v_mfma_f32_16x16x32_bf16 a[16:19], v[176:179], v[180:183], a[16:19]
    v_mfma_f32_16x16x32_bf16 a[20:23], v[160:163], v[184:187], a[20:23]
    v_mfma_f32_16x16x32_bf16 a[24:27], v[164:167], v[184:187], a[24:27]
    v_mfma_f32_16x16x32_bf16 a[28:31], v[168:171], v[184:187], a[28:31]
    v_mfma_f32_16x16x32_bf16 a[32:35], v[172:175], v[184:187], a[32:35]
    v_mfma_f32_16x16x32_bf16 a[36:39], v[176:179], v[184:187], a[36:39]
    v_mfma_f32_16x16x32_bf16 a[40:43], v[160:163], v[188:191], a[40:43]
    v_mfma_f32_16x16x32_bf16 a[44:47], v[164:167], v[188:191], a[44:47]
    v_mfma_f32_16x16x32_bf16 a[48:51], v[168:171], v[188:191], a[48:51]
    v_mfma_f32_16x16x32_bf16 a[52:55], v[172:175], v[188:191], a[52:55]
    v_mfma_f32_16x16x32_bf16 a[56:59], v[176:179], v[188:191], a[56:59]
    v_mfma_f32_16x16x32_bf16 a[60:63], v[160:163], v[192:195], a[60:63]
    v_mfma_f32_16x16x32_bf16 a[64:67], v[164:167], v[192:195], a[64:67]
    v_mfma_f32_16x16x32_bf16 a[68:71], v[168:171], v[192:195], a[68:71]
    v_mfma_f32_16x16x32_bf16 a[72:75], v[172:175], v[192:195], a[72:75]
    v_mfma_f32_16x16x32_bf16 a[76:79], v[176:179], v[192:195], a[76:79]
    buffer_load_dwordx4 v[160:163], v1, s[12:15], s32 offen offset:0
    buffer_load_dwordx4 v[164:167], v1, s[12:15], s32 offen offset:1024
    buffer_load_dwordx4 v[168:171], v1, s[12:15], s32 offen offset:2048
    buffer_load_dwordx4 v[172:175], v1, s[12:15], s32 offen offset:3072
    buffer_load_dwordx4 v[176:179], v2, s[12:15], s32 offen
    buffer_load_dwordx4 v[180:183], v3, s[16:19], s33 offen
    buffer_load_dwordx4 v[184:187], v4, s[16:19], s33 offen
    buffer_load_dwordx4 v[188:191], v5, s[16:19], s33 offen
    buffer_load_dwordx4 v[192:195], v6, s[16:19], s33 offen
    s_add_u32 s32, s32, 20480
    s_add_u32 s33, s33, 4096
    s_waitcnt vmcnt(36)
    v_mfma_f32_16x16x32_bf16 a[0:3], v[16:19], v[36:39], a[0:3]
    v_mfma_f32_16x16x32_bf16 a[4:7], v[20:23], v[36:39], a[4:7]
    v_mfma_f32_16x16x32_bf16 a[8:11], v[24:27], v[36:39], a[8:11]
    v_mfma_f32_16x16x32_bf16 a[12:15], v[28:31], v[36:39], a[12:15]
    v_mfma_f32_16x16x32_bf16 a[16:19], v[32:35], v[36:39], a[16:19]
    v_mfma_f32_16x16x32_bf16 a[20:23], v[16:19], v[40:43], a[20:23]
    v_mfma_f32_16x16x32_bf16 a[24:27], v[20:23], v[40:43], a[24:27]
    v_mfma_f32_16x16x32_bf16 a[28:31], v[24:27], v[40:43], a[28:31]
    v_mfma_f32_16x16x32_bf16 a[32:35], v[28:31], v[40:43], a[32:35]
    v_mfma_f32_16x16x32_bf16 a[36:39], v[32:35], v[40:43], a[36:39]
    v_mfma_f32_16x16x32_bf16 a[40:43], v[16:19], v[44:47], a[40:43]
    v_mfma_f32_16x16x32_bf16 a[44:47], v[20:23], v[44:47], a[44:47]
    v_mfma_f32_16x16x32_bf16 a[48:51], v[24:27], v[44:47], a[48:51]
    v_mfma_f32_16x16x32_bf16 a[52:55], v[28:31], v[44:47], a[52:55]
    v_mfma_f32_16x16x32_bf16 a[56:59], v[32:35], v[44:47], a[56:59]
    v_mfma_f32_16x16x32_bf16 a[60:63], v[16:19], v[48:51], a[60:63]
    v_mfma_f32_16x16x32_bf16 a[64:67], v[20:23], v[48:51], a[64:67]
    v_mfma_f32_16x16x32_bf16 a[68:71], v[24:27], v[48:51], a[68:71]
    v_mfma_f32_16x16x32_bf16 a[72:75], v[28:31], v[48:51], a[72:75]
    v_mfma_f32_16x16x32_bf16 a[76:79], v[32:35], v[48:51], a[76:79]
    buffer_load_dwordx4 v[16:19], v1, s[12:15], s32 offen offset:0
    buffer_load_dwordx4 v[20:23], v1, s[12:15], s32 offen offset:1024
    buffer_load_dwordx4 v[24:27], v1, s[12:15], s32 offen offset:2048
    buffer_load_dwordx4 v[28:31], v1, s[12:15], s32 offen offset:3072
    buffer_load_dwordx4 v[32:35], v2, s[12:15], s32 offen
    buffer_load_dwordx4 v[36:39], v3, s[16:19], s33 offen
    buffer_load_dwordx4 v[40:43], v4, s[16:19], s33 offen
    buffer_load_dwordx4 v[44:47], v5, s[16:19], s33 offen
    buffer_load_dwordx4 v[48:51], v6, s[16:19], s33 offen
    s_add_u32 s32, s32, 20480
    s_add_u32 s33, s33, 4096
    s_waitcnt vmcnt(36)
    v_mfma_f32_16x16x32_bf16 a[0:3], v[52:55], v[72:75], a[0:3]
    v_mfma_f32_16x16x32_bf16 a[4:7], v[56:59], v[72:75], a[4:7]
    v_mfma_f32_16x16x32_bf16 a[8:11], v[60:63], v[72:75], a[8:11]
    v_mfma_f32_16x16x32_bf16 a[12:15], v[64:67], v[72:75], a[12:15]
    v_mfma_f32_16x16x32_bf16 a[16:19], v[68:71], v[72:75], a[16:19]
    v_mfma_f32_16x16x32_bf16 a[20:23], v[52:55], v[76:79], a[20:23]
    v_mfma_f32_16x16x32_bf16 a[24:27], v[56:59], v[76:79], a[24:27]
    v_mfma_f32_16x16x32_bf16 a[28:31], v[60:63], v[76:79], a[28:31]
    v_mfma_f32_16x16x32_bf16 a[32:35], v[64:67], v[76:79], a[32:35]
    v_mfma_f32_16x16x32_bf16 a[36:39], v[68:71], v[76:79], a[36:39]
    v_mfma_f32_16x16x32_bf16 a[40:43], v[52:55], v[80:83], a[40:43]
    v_mfma_f32_16x16x32_bf16 a[44:47], v[56:59], v[80:83], a[44:47]
    v_mfma_f32_16x16x32_bf16 a[48:51], v[60:63], v[80:83], a[48:51]
    v_mfma_f32_16x16x32_bf16 a[52:55], v[64:67], v[80:83], a[52:55]
    v_mfma_f32_16x16x32_bf16 a[56:59], v[68:71], v[80:83], a[56:59]
    v_mfma_f32_16x16x32_bf16 a[60:63], v[52:55], v[84:87], a[60:63]
    v_mfma_f32_16x16x32_bf16 a[64:67], v[56:59], v[84:87], a[64:67]
    v_mfma_f32_16x16x32_bf16 a[68:71], v[60:63], v[84:87], a[68:71]
    v_mfma_f32_16x16x32_bf16 a[72:75], v[64:67], v[84:87], a[72:75]
    v_mfma_f32_16x16x32_bf16 a[76:79], v[68:71], v[84:87], a[76:79]
    buffer_load_dwordx4 v[52:55], v1, s[12:15], s32 offen offset:0
    buffer_load_dwordx4 v[56:59], v1, s[12:15], s32 offen offset:1024
    buffer_load_dwordx4 v[60:63], v1, s[12:15], s32 offen offset:2048
    buffer_load_dwordx4 v[64:67], v1, s[12:15], s32 offen offset:3072
    buffer_load_dwordx4 v[68:71], v2, s[12:15], s32 offen
    buffer_load_dwordx4 v[72:75], v3, s[16:19], s33 offen
    buffer_load_dwordx4 v[76:79], v4, s[16:19], s33 offen
    buffer_load_dwordx4 v[80:83], v5, s[16:19], s33 offen
    buffer_load_dwordx4 v[84:87], v6, s[16:19], s33 offen
    s_add_u32 s32, s32, 20480
    s_add_u32 s33, s33, 4096
    s_waitcnt vmcnt(36)
    v_mfma_f32_16x16x32_bf16 a[0:3], v[88:91], v[108:111], a[0:3]
    v_mfma_f32_16x16x32_bf16 a[4:7], v[92:95], v[108:111], a[4:7]
    v_mfma_f32_16x16x32_bf16 a[8:11], v[96:99], v[108:111], a[8:11]
    v_mfma_f32_16x16x32_bf16 a[12:15], v[100:103], v[108:111], a[12:15]
    v_mfma_f32_16x16x32_bf16 a[16:19], v[104:107], v[108:111], a[16:19]
    v_mfma_f32_16x16x32_bf16 a[20:23], v[88:91], v[112:115], a[20:23]
    v_mfma_f32_16x16x32_bf16 a[24:27], v[92:95], v[112:115], a[24:27]
    v_mfma_f32_16x16x32_bf16 a[28:31], v[96:99], v[112:115], a[28:31]
    v_mfma_f32_16x16x32_bf16 a[32:35], v[100:103], v[112:115], a[32:35]
    v_mfma_f32_16x16x32_bf16 a[36:39], v[104:107], v[112:115], a[36:39]
    v_mfma_f32_16x16x32_bf16 a[40:43], v[88:91], v[116:119], a[40:43]
    v_mfma_f32_16x16x32_bf16 a[44:47], v[92:95], v[116:119], a[44:47]
    v_mfma_f32_16x16x32_bf16 a[48:51], v[96:99], v[116:119], a[48:51]
    v_mfma_f32_16x16x32_bf16 a[52:55], v[100:103], v[116:119], a[52:55]
    v_mfma_f32_16x16x32_bf16 a[56:59], v[104:107], v[116:119], a[56:59]
    v_mfma_f32_16x16x32_bf16 a[60:63], v[88:91], v[120:123], a[60:63]
    v_mfma_f32_16x16x32_bf16 a[64:67], v[92:95], v[120:123], a[64:67]
    v_mfma_f32_16x16x32_bf16 a[68:71], v[96:99], v[120:123], a[68:71]
    v_mfma_f32_16x16x32_bf16 a[72:75], v[100:103], v[120:123], a[72:75]
    v_mfma_f32_16x16x32_bf16 a[76:79], v[104:107], v[120:123], a[76:79]
    buffer_load_dwordx4 v[88:91], v1, s[12:15], s32 offen offset:0
    buffer_load_dwordx4 v[92:95], v1, s[12:15], s32 offen offset:1024
    buffer_load_dwordx4 v[96:99], v1, s[12:15], s32 offen offset:2048
    buffer_load_dwordx4 v[100:103], v1, s[12:15], s32 offen offset:3072
    buffer_load_dwordx4 v[104:107], v2, s[12:15], s32 offen
    buffer_load_dwordx4 v[108:111], v3, s[16:19], s33 offen
    buffer_load_dwordx4 v[112:115], v4, s[16:19], s33 offen
    buffer_load_dwordx4 v[116:119], v5, s[16:19], s33 offen
    buffer_load_dwordx4 v[120:123], v6, s[16:19], s33 offen
    s_add_u32 s32, s32, 20480
    s_add_u32 s33, s33, 4096
    s_waitcnt vmcnt(36)
    v_mfma_f32_16x16x32_bf16 a[0:3], v[124:127], v[144:147], a[0:3]
    v_mfma_f32_16x16x32_bf16 a[4:7], v[128:131], v[144:147], a[4:7]
    v_mfma_f32_16x16x32_bf16 a[8:11], v[132:135], v[144:147], a[8:11]
    v_mfma_f32_16x16x32_bf16 a[12:15], v[136:139], v[144:147], a[12:15]
    v_mfma_f32_16x16x32_bf16 a[16:19], v[140:143], v[144:147], a[16:19]
    v_mfma_f32_16x16x32_bf16 a[20:23], v[124:127], v[148:151], a[20:23]
    v_mfma_f32_16x16x32_bf16 a[24:27], v[128:131], v[148:151], a[24:27]
    v_mfma_f32_16x16x32_bf16 a[28:31], v[132:135], v[148:151], a[28:31]
    v_mfma_f32_16x16x32_bf16 a[32:35], v[136:139], v[148:151], a[32:35]
    v_mfma_f32_16x16x32_bf16 a[36:39], v[140:143], v[148:151], a[36:39]
    v_mfma_f32_16x16x32_bf16 a[40:43], v[124:127], v[152:155], a[40:43]
    v_mfma_f32_16x16x32_bf16 a[44:47], v[128:131], v[152:155], a[44:47]
    v_mfma_f32_16x16x32_bf16 a[48:51], v[132:135], v[152:155], a[48:51]
    v_mfma_f32_16x16x32_bf16 a[52:55], v[136:139], v[152:155], a[52:55]
    v_mfma_f32_16x16x32_bf16 a[56:59], v[140:143], v[152:155], a[56:59]
    v_mfma_f32_16x16x32_bf16 a[60:63], v[124:127], v[156:159], a[60:63]
    v_mfma_f32_16x16x32_bf16 a[64:67], v[128:131], v[156:159], a[64:67]
    v_mfma_f32_16x16x32_bf16 a[68:71], v[132:135], v[156:159], a[68:71]
    v_mfma_f32_16x16x32_bf16 a[72:75], v[136:139], v[156:159], a[72:75]
    v_mfma_f32_16x16x32_bf16 a[76:79], v[140:143], v[156:159], a[76:79]
    buffer_load_dwordx4 v[124:127], v1, s[12:15], s32 offen offset:0
    buffer_load_dwordx4 v[128:131], v1, s[12:15], s32 offen offset:1024
    buffer_load_dwordx4 v[132:135], v1, s[12:15], s32 offen offset:2048
    buffer_load_dwordx4 v[136:139], v1, s[12:15], s32 offen offset:3072
    buffer_load_dwordx4 v[140:143], v2, s[12:15], s32 offen
    buffer_load_dwordx4 v[144:147], v3, s[16:19], s33 offen
    buffer_load_dwordx4 v[148:151], v4, s[16:19], s33 offen
    buffer_load_dwordx4 v[152:155], v5, s[16:19], s33 offen
    buffer_load_dwordx4 v[156:159], v6, s[16:19], s33 offen
    s_add_u32 s32, s32, 20480
    s_add_u32 s33, s33, 4096
    s_waitcnt vmcnt(36)
    v_mfma_f32_16x16x32_bf16 a[0:3], v[160:163], v[180:183], a[0:3]
    v_mfma_f32_16x16x32_bf16 a[4:7], v[164:167], v[180:183], a[4:7]
    v_mfma_f32_16x16x32_bf16 a[8:11], v[168:171], v[180:183], a[8:11]
    v_mfma_f32_16x16x32_bf16 a[12:15], v[172:175], v[180:183], a[12:15]
    v_mfma_f32_16x16x32_bf16 a[16:19], v[176:179], v[180:183], a[16:19]
    v_mfma_f32_16x16x32_bf16 a[20:23], v[160:163], v[184:187], a[20:23]
    v_mfma_f32_16x16x32_bf16 a[24:27], v[164:167], v[184:187], a[24:27]
    v_mfma_f32_16x16x32_bf16 a[28:31], v[168:171], v[184:187], a[28:31]
    v_mfma_f32_16x16x32_bf16 a[32:35], v[172:175], v[184:187], a[32:35]
    v_mfma_f32_16x16x32_bf16 a[36:39], v[176:179], v[184:187], a[36:39]
    v_mfma_f32_16x16x32_bf16 a[40:43], v[160:163], v[188:191], a[40:43]
    v_mfma_f32_16x16x32_bf16 a[44:47], v[164:167], v[188:191], a[44:47]
    v_mfma_f32_16x16x32_bf16 a[48:51], v[168:171], v[188:191], a[48:51]
    v_mfma_f32_16x16x32_bf16 a[52:55], v[172:175], v[188:191], a[52:55]
    v_mfma_f32_16x16x32_bf16 a[56:59], v[176:179], v[188:191], a[56:59]
    v_mfma_f32_16x16x32_bf16 a[60:63], v[160:163], v[192:195], a[60:63]
    v_mfma_f32_16x16x32_bf16 a[64:67], v[164:167], v[192:195], a[64:67]
    v_mfma_f32_16x16x32_bf16 a[68:71], v[168:171], v[192:195], a[68:71]
    v_mfma_f32_16x16x32_bf16 a[72:75], v[172:175], v[192:195], a[72:75]
    v_mfma_f32_16x16x32_bf16 a[76:79], v[176:179], v[192:195], a[76:79]
    buffer_load_dwordx4 v[160:163], v1, s[12:15], s32 offen offset:0
    buffer_load_dwordx4 v[164:167], v1, s[12:15], s32 offen offset:1024
    buffer_load_dwordx4 v[168:171], v1, s[12:15], s32 offen offset:2048
    buffer_load_dwordx4 v[172:175], v1, s[12:15], s32 offen offset:3072
    buffer_load_dwordx4 v[176:179], v2, s[12:15], s32 offen
    buffer_load_dwordx4 v[180:183], v3, s[16:19], s33 offen
    buffer_load_dwordx4 v[184:187], v4, s[16:19], s33 offen
    buffer_load_dwordx4 v[188:191], v5, s[16:19], s33 offen
    buffer_load_dwordx4 v[192:195], v6, s[16:19], s33 offen
    s_add_u32 s32, s32, 20480
    s_add_u32 s33, s33, 4096
    s_waitcnt vmcnt(36)
    v_mfma_f32_16x16x32_bf16 a[0:3], v[16:19], v[36:39], a[0:3]
    v_mfma_f32_16x16x32_bf16 a[4:7], v[20:23], v[36:39], a[4:7]
    v_mfma_f32_16x16x32_bf16 a[8:11], v[24:27], v[36:39], a[8:11]
    v_mfma_f32_16x16x32_bf16 a[12:15], v[28:31], v[36:39], a[12:15]
    v_mfma_f32_16x16x32_bf16 a[16:19], v[32:35], v[36:39], a[16:19]
    v_mfma_f32_16x16x32_bf16 a[20:23], v[16:19], v[40:43], a[20:23]
    v_mfma_f32_16x16x32_bf16 a[24:27], v[20:23], v[40:43], a[24:27]
    v_mfma_f32_16x16x32_bf16 a[28:31], v[24:27], v[40:43], a[28:31]
    v_mfma_f32_16x16x32_bf16 a[32:35], v[28:31], v[40:43], a[32:35]
    v_mfma_f32_16x16x32_bf16 a[36:39], v[32:35], v[40:43], a[36:39]
    v_mfma_f32_16x16x32_bf16 a[40:43], v[16:19], v[44:47], a[40:43]
    v_mfma_f32_16x16x32_bf16 a[44:47], v[20:23], v[44:47], a[44:47]
    v_mfma_f32_16x16x32_bf16 a[48:51], v[24:27], v[44:47], a[48:51]
    v_mfma_f32_16x16x32_bf16 a[52:55], v[28:31], v[44:47], a[52:55]
    v_mfma_f32_16x16x32_bf16 a[56:59], v[32:35], v[44:47], a[56:59]
    v_mfma_f32_16x16x32_bf16 a[60:63], v[16:19], v[48:51], a[60:63]
    v_mfma_f32_16x16x32_bf16 a[64:67], v[20:23], v[48:51], a[64:67]
    v_mfma_f32_16x16x32_bf16 a[68:71], v[24:27], v[48:51], a[68:71]
    v_mfma_f32_16x16x32_bf16 a[72:75], v[28:31], v[48:51], a[72:75]
    v_mfma_f32_16x16x32_bf16 a[76:79], v[32:35], v[48:51], a[76:79]
    buffer_load_dwordx4 v[16:19], v1, s[12:15], s32 offen offset:0
    buffer_load_dwordx4 v[20:23], v1, s[12:15], s32 offen offset:1024
    buffer_load_dwordx4 v[24:27], v1, s[12:15], s32 offen offset:2048
    buffer_load_dwordx4 v[28:31], v1, s[12:15], s32 offen offset:3072
    buffer_load_dwordx4 v[32:35], v2, s[12:15], s32 offen
    buffer_load_dwordx4 v[36:39], v3, s[16:19], s33 offen
    buffer_load_dwordx4 v[40:43], v4, s[16:19], s33 offen
    buffer_load_dwordx4 v[44:47], v5, s[16:19], s33 offen
    buffer_load_dwordx4 v[48:51], v6, s[16:19], s33 offen
    s_add_u32 s32, s32, 20480
    s_add_u32 s33, s33, 4096
    s_waitcnt vmcnt(36)
    v_mfma_f32_16x16x32_bf16 a[0:3], v[52:55], v[72:75], a[0:3]
    v_mfma_f32_16x16x32_bf16 a[4:7], v[56:59], v[72:75], a[4:7]
    v_mfma_f32_16x16x32_bf16 a[8:11], v[60:63], v[72:75], a[8:11]
    v_mfma_f32_16x16x32_bf16 a[12:15], v[64:67], v[72:75], a[12:15]
    v_mfma_f32_16x16x32_bf16 a[16:19], v[68:71], v[72:75], a[16:19]
    v_mfma_f32_16x16x32_bf16 a[20:23], v[52:55], v[76:79], a[20:23]
    v_mfma_f32_16x16x32_bf16 a[24:27], v[56:59], v[76:79], a[24:27]
    v_mfma_f32_16x16x32_bf16 a[28:31], v[60:63], v[76:79], a[28:31]
    v_mfma_f32_16x16x32_bf16 a[32:35], v[64:67], v[76:79], a[32:35]
    v_mfma_f32_16x16x32_bf16 a[36:39], v[68:71], v[76:79], a[36:39]
    v_mfma_f32_16x16x32_bf16 a[40:43], v[52:55], v[80:83], a[40:43]
    v_mfma_f32_16x16x32_bf16 a[44:47], v[56:59], v[80:83], a[44:47]
    v_mfma_f32_16x16x32_bf16 a[48:51], v[60:63], v[80:83], a[48:51]
    v_mfma_f32_16x16x32_bf16 a[52:55], v[64:67], v[80:83], a[52:55]
    v_mfma_f32_16x16x32_bf16 a[56:59], v[68:71], v[80:83], a[56:59]
    v_mfma_f32_16x16x32_bf16 a[60:63], v[52:55], v[84:87], a[60:63]
    v_mfma_f32_16x16x32_bf16 a[64:67], v[56:59], v[84:87], a[64:67]
    v_mfma_f32_16x16x32_bf16 a[68:71], v[60:63], v[84:87], a[68:71]
    v_mfma_f32_16x16x32_bf16 a[72:75], v[64:67], v[84:87], a[72:75]
    v_mfma_f32_16x16x32_bf16 a[76:79], v[68:71], v[84:87], a[76:79]
    buffer_load_dwordx4 v[52:55], v1, s[12:15], s32 offen offset:0
    buffer_load_dwordx4 v[56:59], v1, s[12:15], s32 offen offset:1024
    buffer_load_dwordx4 v[60:63], v1, s[12:15], s32 offen offset:2048
    buffer_load_dwordx4 v[64:67], v1, s[12:15], s32 offen offset:3072
    buffer_load_dwordx4 v[68:71], v2, s[12:15], s32 offen
    buffer_load_dwordx4 v[72:75], v3, s[16:19], s33 offen
    buffer_load_dwordx4 v[76:79], v4, s[16:19], s33 offen
    buffer_load_dwordx4 v[80:83], v5, s[16:19], s33 offen
    buffer_load_dwordx4 v[84:87], v6, s[16:19], s33 offen
    s_add_u32 s32, s32, 20480
    s_add_u32 s33, s33, 4096
    s_waitcnt vmcnt(36)
    v_mfma_f32_16x16x32_bf16 a[0:3], v[88:91], v[108:111], a[0:3]
    v_mfma_f32_16x16x32_bf16 a[4:7], v[92:95], v[108:111], a[4:7]
    v_mfma_f32_16x16x32_bf16 a[8:11], v[96:99], v[108:111], a[8:11]
    v_mfma_f32_16x16x32_bf16 a[12:15], v[100:103], v[108:111], a[12:15]
    v_mfma_f32_16x16x32_bf16 a[16:19], v[104:107], v[108:111], a[16:19]
    v_mfma_f32_16x16x32_bf16 a[20:23], v[88:91], v[112:115], a[20:23]
    v_mfma_f32_16x16x32_bf16 a[24:27], v[92:95], v[112:115], a[24:27]
    v_mfma_f32_16x16x32_bf16 a[28:31], v[96:99], v[112:115], a[28:31]
    v_mfma_f32_16x16x32_bf16 a[32:35], v[100:103], v[112:115], a[32:35]
    v_mfma_f32_16x16x32_bf16 a[36:39], v[104:107], v[112:115], a[36:39]
    v_mfma_f32_16x16x32_bf16 a[40:43], v[88:91], v[116:119], a[40:43]
    v_mfma_f32_16x16x32_bf16 a[44:47], v[92:95], v[116:119], a[44:47]
    v_mfma_f32_16x16x32_bf16 a[48:51], v[96:99], v[116:119], a[48:51]
    v_mfma_f32_16x16x32_bf16 a[52:55], v[100:103], v[116:119], a[52:55]
    v_mfma_f32_16x16x32_bf16 a[56:59], v[104:107], v[116:119], a[56:59]
    v_mfma_f32_16x16x32_bf16 a[60:63], v[88:91], v[120:123], a[60:63]
    v_mfma_f32_16x16x32_bf16 a[64:67], v[92:95], v[120:123], a[64:67]
    v_mfma_f32_16x16x32_bf16 a[68:71], v[96:99], v[120:123], a[68:71]
    v_mfma_f32_16x16x32_bf16 a[72:75], v[100:103], v[120:123], a[72:75]
    v_mfma_f32_16x16x32_bf16 a[76:79], v[104:107], v[120:123], a[76:79]
    buffer_load_dwordx4 v[88:91], v1, s[12:15], s32 offen offset:0
    buffer_load_dwordx4 v[92:95], v1, s[12:15], s32 offen offset:1024
    buffer_load_dwordx4 v[96:99], v1, s[12:15], s32 offen offset:2048
    buffer_load_dwordx4 v[100:103], v1, s[12:15], s32 offen offset:3072
    buffer_load_dwordx4 v[104:107], v2, s[12:15], s32 offen
    buffer_load_dwordx4 v[108:111], v3, s[16:19], s33 offen
    buffer_load_dwordx4 v[112:115], v4, s[16:19], s33 offen
    buffer_load_dwordx4 v[116:119], v5, s[16:19], s33 offen
    buffer_load_dwordx4 v[120:123], v6, s[16:19], s33 offen
    s_add_u32 s32, s32, 20480
    s_add_u32 s33, s33, 4096
    s_waitcnt vmcnt(36)
    v_mfma_f32_16x16x32_bf16 a[0:3], v[124:127], v[144:147], a[0:3]
    v_mfma_f32_16x16x32_bf16 a[4:7], v[128:131], v[144:147], a[4:7]
    v_mfma_f32_16x16x32_bf16 a[8:11], v[132:135], v[144:147], a[8:11]
    v_mfma_f32_16x16x32_bf16 a[12:15], v[136:139], v[144:147], a[12:15]
    v_mfma_f32_16x16x32_bf16 a[16:19], v[140:143], v[144:147], a[16:19]
    v_mfma_f32_16x16x32_bf16 a[20:23], v[124:127], v[148:151], a[20:23]
    v_mfma_f32_16x16x32_bf16 a[24:27], v[128:131], v[148:151], a[24:27]
    v_mfma_f32_16x16x32_bf16 a[28:31], v[132:135], v[148:151], a[28:31]
    v_mfma_f32_16x16x32_bf16 a[32:35], v[136:139], v[148:151], a[32:35]
    v_mfma_f32_16x16x32_bf16 a[36:39], v[140:143], v[148:151], a[36:39]
    v_mfma_f32_16x16x32_bf16 a[40:43], v[124:127], v[152:155], a[40:43]
    v_mfma_f32_16x16x32_bf16 a[44:47], v[128:131], v[152:155], a[44:47]
    v_mfma_f32_16x16x32_bf16 a[48:51], v[132:135], v[152:155], a[48:51]
    v_mfma_f32_16x16x32_bf16 a[52:55], v[136:139], v[152:155], a[52:55]
    v_mfma_f32_16x16x32_bf16 a[56:59], v[140:143], v[152:155], a[56:59]
    v_mfma_f32_16x16x32_bf16 a[60:63], v[124:127], v[156:159], a[60:63]
    v_mfma_f32_16x16x32_bf16 a[64:67], v[128:131], v[156:159], a[64:67]
    v_mfma_f32_16x16x32_bf16 a[68:71], v[132:135], v[156:159], a[68:71]
    v_mfma_f32_16x16x32_bf16 a[72:75], v[136:139], v[156:159], a[72:75]
    v_mfma_f32_16x16x32_bf16 a[76:79], v[140:143], v[156:159], a[76:79]
    buffer_load_dwordx4 v[124:127], v1, s[12:15], s32 offen offset:0
    buffer_load_dwordx4 v[128:131], v1, s[12:15], s32 offen offset:1024
    buffer_load_dwordx4 v[132:135], v1, s[12:15], s32 offen offset:2048
    buffer_load_dwordx4 v[136:139], v1, s[12:15], s32 offen offset:3072
    buffer_load_dwordx4 v[140:143], v2, s[12:15], s32 offen
    buffer_load_dwordx4 v[144:147], v3, s[16:19], s33 offen
    buffer_load_dwordx4 v[148:151], v4, s[16:19], s33 offen
    buffer_load_dwordx4 v[152:155], v5, s[16:19], s33 offen
    buffer_load_dwordx4 v[156:159], v6, s[16:19], s33 offen
    s_add_u32 s32, s32, 20480
    s_add_u32 s33, s33, 4096
    s_waitcnt vmcnt(36)
    v_mfma_f32_16x16x32_bf16 a[0:3], v[160:163], v[180:183], a[0:3]
    v_mfma_f32_16x16x32_bf16 a[4:7], v[164:167], v[180:183], a[4:7]
    v_mfma_f32_16x16x32_bf16 a[8:11], v[168:171], v[180:183], a[8:11]
    v_mfma_f32_16x16x32_bf16 a[12:15], v[172:175], v[180:183], a[12:15]
    v_mfma_f32_16x16x32_bf16 a[16:19], v[176:179], v[180:183], a[16:19]
    v_mfma_f32_16x16x32_bf16 a[20:23], v[160:163], v[184:187], a[20:23]
    v_mfma_f32_16x16x32_bf16 a[24:27], v[164:167], v[184:187], a[24:27]
    v_mfma_f32_16x16x32_bf16 a[28:31], v[168:171], v[184:187], a[28:31]
    v_mfma_f32_16x16x32_bf16 a[32:35], v[172:175], v[184:187], a[32:35]
    v_mfma_f32_16x16x32_bf16 a[36:39], v[176:179], v[184:187], a[36:39]
    v_mfma_f32_16x16x32_bf16 a[40:43], v[160:163], v[188:191], a[40:43]
    v_mfma_f32_16x16x32_bf16 a[44:47], v[164:167], v[188:191], a[44:47]
    v_mfma_f32_16x16x32_bf16 a[48:51], v[168:171], v[188:191], a[48:51]
    v_mfma_f32_16x16x32_bf16 a[52:55], v[172:175], v[188:191], a[52:55]
    v_mfma_f32_16x16x32_bf16 a[56:59], v[176:179], v[188:191], a[56:59]
    v_mfma_f32_16x16x32_bf16 a[60:63], v[160:163], v[192:195], a[60:63]
    v_mfma_f32_16x16x32_bf16 a[64:67], v[164:167], v[192:195], a[64:67]
    v_mfma_f32_16x16x32_bf16 a[68:71], v[168:171], v[192:195], a[68:71]
    v_mfma_f32_16x16x32_bf16 a[72:75], v[172:175], v[192:195], a[72:75]
    v_mfma_f32_16x16x32_bf16 a[76:79], v[176:179], v[192:195], a[76:79]
    buffer_load_dwordx4 v[160:163], v1, s[12:15], s32 offen offset:0
    buffer_load_dwordx4 v[164:167], v1, s[12:15], s32 offen offset:1024
    buffer_load_dwordx4 v[168:171], v1, s[12:15], s32 offen offset:2048
    buffer_load_dwordx4 v[172:175], v1, s[12:15], s32 offen offset:3072
    buffer_load_dwordx4 v[176:179], v2, s[12:15], s32 offen
    buffer_load_dwordx4 v[180:183], v3, s[16:19], s33 offen
    buffer_load_dwordx4 v[184:187], v4, s[16:19], s33 offen
    buffer_load_dwordx4 v[188:191], v5, s[16:19], s33 offen
    buffer_load_dwordx4 v[192:195], v6, s[16:19], s33 offen
    s_add_u32 s32, s32, 20480
    s_add_u32 s33, s33, 4096
    s_waitcnt vmcnt(36)
    v_mfma_f32_16x16x32_bf16 a[0:3], v[16:19], v[36:39], a[0:3]
    v_mfma_f32_16x16x32_bf16 a[4:7], v[20:23], v[36:39], a[4:7]
    v_mfma_f32_16x16x32_bf16 a[8:11], v[24:27], v[36:39], a[8:11]
    v_mfma_f32_16x16x32_bf16 a[12:15], v[28:31], v[36:39], a[12:15]
    v_mfma_f32_16x16x32_bf16 a[16:19], v[32:35], v[36:39], a[16:19]
    v_mfma_f32_16x16x32_bf16 a[20:23], v[16:19], v[40:43], a[20:23]
    v_mfma_f32_16x16x32_bf16 a[24:27], v[20:23], v[40:43], a[24:27]
    v_mfma_f32_16x16x32_bf16 a[28:31], v[24:27], v[40:43], a[28:31]
    v_mfma_f32_16x16x32_bf16 a[32:35], v[28:31], v[40:43], a[32:35]
    v_mfma_f32_16x16x32_bf16 a[36:39], v[32:35], v[40:43], a[36:39]
    v_mfma_f32_16x16x32_bf16 a[40:43], v[16:19], v[44:47], a[40:43]
    v_mfma_f32_16x16x32_bf16 a[44:47], v[20:23], v[44:47], a[44:47]
    v_mfma_f32_16x16x32_bf16 a[48:51], v[24:27], v[44:47], a[48:51]
    v_mfma_f32_16x16x32_bf16 a[52:55], v[28:31], v[44:47], a[52:55]
    v_mfma_f32_16x16x32_bf16 a[56:59], v[32:35], v[44:47], a[56:59]
    v_mfma_f32_16x16x32_bf16 a[60:63], v[16:19], v[48:51], a[60:63]
    v_mfma_f32_16x16x32_bf16 a[64:67], v[20:23], v[48:51], a[64:67]
    v_mfma_f32_16x16x32_bf16 a[68:71], v[24:27], v[48:51], a[68:71]
    v_mfma_f32_16x16x32_bf16 a[72:75], v[28:31], v[48:51], a[72:75]
    v_mfma_f32_16x16x32_bf16 a[76:79], v[32:35], v[48:51], a[76:79]
    buffer_load_dwordx2 v[196:197], v11, s[24:27], 0 offen offset:0
    buffer_load_dwordx2 v[198:199], v11, s[24:27], 0 offen offset:32
    buffer_load_dwordx2 v[200:201], v11, s[24:27], 0 offen offset:64
    buffer_load_dwordx2 v[202:203], v11, s[24:27], 0 offen offset:96
    buffer_load_dwordx2 v[204:205], v11, s[24:27], 0 offen offset:128
    buffer_load_dwordx4 v[16:19], v1, s[12:15], s32 offen offset:0
    buffer_load_dwordx4 v[20:23], v1, s[12:15], s32 offen offset:1024
    buffer_load_dwordx4 v[24:27], v1, s[12:15], s32 offen offset:2048
    buffer_load_dwordx4 v[28:31], v1, s[12:15], s32 offen offset:3072
    buffer_load_dwordx4 v[32:35], v2, s[12:15], s32 offen
    buffer_load_dwordx4 v[36:39], v3, s[16:19], s33 offen
    buffer_load_dwordx4 v[40:43], v4, s[16:19], s33 offen
    buffer_load_dwordx4 v[44:47], v5, s[16:19], s33 offen
    buffer_load_dwordx4 v[48:51], v6, s[16:19], s33 offen
    s_add_u32 s32, s32, 20480
    s_add_u32 s33, s33, 4096
    s_waitcnt vmcnt(41)
    v_mfma_f32_16x16x32_bf16 a[0:3], v[52:55], v[72:75], a[0:3]
    v_mfma_f32_16x16x32_bf16 a[4:7], v[56:59], v[72:75], a[4:7]
    v_mfma_f32_16x16x32_bf16 a[8:11], v[60:63], v[72:75], a[8:11]
    v_mfma_f32_16x16x32_bf16 a[12:15], v[64:67], v[72:75], a[12:15]
    v_mfma_f32_16x16x32_bf16 a[16:19], v[68:71], v[72:75], a[16:19]
    v_mfma_f32_16x16x32_bf16 a[20:23], v[52:55], v[76:79], a[20:23]
    v_mfma_f32_16x16x32_bf16 a[24:27], v[56:59], v[76:79], a[24:27]
    v_mfma_f32_16x16x32_bf16 a[28:31], v[60:63], v[76:79], a[28:31]
    v_mfma_f32_16x16x32_bf16 a[32:35], v[64:67], v[76:79], a[32:35]
    v_mfma_f32_16x16x32_bf16 a[36:39], v[68:71], v[76:79], a[36:39]
    v_mfma_f32_16x16x32_bf16 a[40:43], v[52:55], v[80:83], a[40:43]
    v_mfma_f32_16x16x32_bf16 a[44:47], v[56:59], v[80:83], a[44:47]
    v_mfma_f32_16x16x32_bf16 a[48:51], v[60:63], v[80:83], a[48:51]
    v_mfma_f32_16x16x32_bf16 a[52:55], v[64:67], v[80:83], a[52:55]
    v_mfma_f32_16x16x32_bf16 a[56:59], v[68:71], v[80:83], a[56:59]
    v_mfma_f32_16x16x32_bf16 a[60:63], v[52:55], v[84:87], a[60:63]
    v_mfma_f32_16x16x32_bf16 a[64:67], v[56:59], v[84:87], a[64:67]
    v_mfma_f32_16x16x32_bf16 a[68:71], v[60:63], v[84:87], a[68:71]
    v_mfma_f32_16x16x32_bf16 a[72:75], v[64:67], v[84:87], a[72:75]
    v_mfma_f32_16x16x32_bf16 a[76:79], v[68:71], v[84:87], a[76:79]
    s_waitcnt vmcnt(32)
    v_mfma_f32_16x16x32_bf16 a[0:3], v[88:91], v[108:111], a[0:3]
    v_mfma_f32_16x16x32_bf16 a[4:7], v[92:95], v[108:111], a[4:7]
    v_mfma_f32_16x16x32_bf16 a[8:11], v[96:99], v[108:111], a[8:11]
    v_mfma_f32_16x16x32_bf16 a[12:15], v[100:103], v[108:111], a[12:15]
    v_mfma_f32_16x16x32_bf16 a[16:19], v[104:107], v[108:111], a[16:19]
    v_mfma_f32_16x16x32_bf16 a[20:23], v[88:91], v[112:115], a[20:23]
    v_mfma_f32_16x16x32_bf16 a[24:27], v[92:95], v[112:115], a[24:27]
    v_mfma_f32_16x16x32_bf16 a[28:31], v[96:99], v[112:115], a[28:31]
    v_mfma_f32_16x16x32_bf16 a[32:35], v[100:103], v[112:115], a[32:35]
    v_mfma_f32_16x16x32_bf16 a[36:39], v[104:107], v[112:115], a[36:39]
    v_mfma_f32_16x16x32_bf16 a[40:43], v[88:91], v[116:119], a[40:43]
    v_mfma_f32_16x16x32_bf16 a[44:47], v[92:95], v[116:119], a[44:47]
    v_mfma_f32_16x16x32_bf16 a[48:51], v[96:99], v[116:119], a[48:51]
    v_mfma_f32_16x16x32_bf16 a[52:55], v[100:103], v[116:119], a[52:55]
    v_mfma_f32_16x16x32_bf16 a[56:59], v[104:107], v[116:119], a[56:59]
    v_mfma_f32_16x16x32_bf16 a[60:63], v[88:91], v[120:123], a[60:63]
    v_mfma_f32_16x16x32_bf16 a[64:67], v[92:95], v[120:123], a[64:67]
    v_mfma_f32_16x16x32_bf16 a[68:71], v[96:99], v[120:123], a[68:71]
    v_mfma_f32_16x16x32_bf16 a[72:75], v[100:103], v[120:123], a[72:75]
    v_mfma_f32_16x16x32_bf16 a[76:79], v[104:107], v[120:123], a[76:79]
    s_waitcnt vmcnt(23)
    v_mfma_f32_16x16x32_bf16 a[0:3], v[124:127], v[144:147], a[0:3]
    v_mfma_f32_16x16x32_bf16 a[4:7], v[128:131], v[144:147], a[4:7]
    v_mfma_f32_16x16x32_bf16 a[8:11], v[132:135], v[144:147], a[8:11]
    v_mfma_f32_16x16x32_bf16 a[12:15], v[136:139], v[144:147], a[12:15]
    v_mfma_f32_16x16x32_bf16 a[16:19], v[140:143], v[144:147], a[16:19]
    v_mfma_f32_16x16x32_bf16 a[20:23], v[124:127], v[148:151], a[20:23]
    v_mfma_f32_16x16x32_bf16 a[24:27], v[128:131], v[148:151], a[24:27]
    v_mfma_f32_16x16x32_bf16 a[28:31], v[132:135], v[148:151], a[28:31]
    v_mfma_f32_16x16x32_bf16 a[32:35], v[136:139], v[148:151], a[32:35]
    v_mfma_f32_16x16x32_bf16 a[36:39], v[140:143], v[148:151], a[36:39]
    v_mfma_f32_16x16x32_bf16 a[40:43], v[124:127], v[152:155], a[40:43]
    v_mfma_f32_16x16x32_bf16 a[44:47], v[128:131], v[152:155], a[44:47]
    v_mfma_f32_16x16x32_bf16 a[48:51], v[132:135], v[152:155], a[48:51]
    v_mfma_f32_16x16x32_bf16 a[52:55], v[136:139], v[152:155], a[52:55]
    v_mfma_f32_16x16x32_bf16 a[56:59], v[140:143], v[152:155], a[56:59]
    v_mfma_f32_16x16x32_bf16 a[60:63], v[124:127], v[156:159], a[60:63]
    v_mfma_f32_16x16x32_bf16 a[64:67], v[128:131], v[156:159], a[64:67]
    v_mfma_f32_16x16x32_bf16 a[68:71], v[132:135], v[156:159], a[68:71]
    v_mfma_f32_16x16x32_bf16 a[72:75], v[136:139], v[156:159], a[72:75]
    v_mfma_f32_16x16x32_bf16 a[76:79], v[140:143], v[156:159], a[76:79]
    s_waitcnt vmcnt(14)
    v_mfma_f32_16x16x32_bf16 a[0:3], v[160:163], v[180:183], a[0:3]
    v_mfma_f32_16x16x32_bf16 a[4:7], v[164:167], v[180:183], a[4:7]
    v_mfma_f32_16x16x32_bf16 a[8:11], v[168:171], v[180:183], a[8:11]
    v_mfma_f32_16x16x32_bf16 a[12:15], v[172:175], v[180:183], a[12:15]
    v_mfma_f32_16x16x32_bf16 a[16:19], v[176:179], v[180:183], a[16:19]
    v_mfma_f32_16x16x32_bf16 a[20:23], v[160:163], v[184:187], a[20:23]
    v_mfma_f32_16x16x32_bf16 a[24:27], v[164:167], v[184:187], a[24:27]
    v_mfma_f32_16x16x32_bf16 a[28:31], v[168:171], v[184:187], a[28:31]
    v_mfma_f32_16x16x32_bf16 a[32:35], v[172:175], v[184:187], a[32:35]
    v_mfma_f32_16x16x32_bf16 a[36:39], v[176:179], v[184:187], a[36:39]
    v_mfma_f32_16x16x32_bf16 a[40:43], v[160:163], v[188:191], a[40:43]
    v_mfma_f32_16x16x32_bf16 a[44:47], v[164:167], v[188:191], a[44:47]
    v_mfma_f32_16x16x32_bf16 a[48:51], v[168:171], v[188:191], a[48:51]
    v_mfma_f32_16x16x32_bf16 a[52:55], v[172:175], v[188:191], a[52:55]
    v_mfma_f32_16x16x32_bf16 a[56:59], v[176:179], v[188:191], a[56:59]
    v_mfma_f32_16x16x32_bf16 a[60:63], v[160:163], v[192:195], a[60:63]
    v_mfma_f32_16x16x32_bf16 a[64:67], v[164:167], v[192:195], a[64:67]
    v_mfma_f32_16x16x32_bf16 a[68:71], v[168:171], v[192:195], a[68:71]
    v_mfma_f32_16x16x32_bf16 a[72:75], v[172:175], v[192:195], a[72:75]
    v_mfma_f32_16x16x32_bf16 a[76:79], v[176:179], v[192:195], a[76:79]
    s_waitcnt vmcnt(0)
    v_mfma_f32_16x16x32_bf16 a[0:3], v[16:19], v[36:39], a[0:3]
    v_mfma_f32_16x16x32_bf16 a[4:7], v[20:23], v[36:39], a[4:7]
    v_mfma_f32_16x16x32_bf16 a[8:11], v[24:27], v[36:39], a[8:11]
    v_mfma_f32_16x16x32_bf16 a[12:15], v[28:31], v[36:39], a[12:15]
    v_mfma_f32_16x16x32_bf16 a[16:19], v[32:35], v[36:39], a[16:19]
    v_mfma_f32_16x16x32_bf16 a[20:23], v[16:19], v[40:43], a[20:23]
    v_mfma_f32_16x16x32_bf16 a[24:27], v[20:23], v[40:43], a[24:27]
    v_mfma_f32_16x16x32_bf16 a[28:31], v[24:27], v[40:43], a[28:31]
    v_mfma_f32_16x16x32_bf16 a[32:35], v[28:31], v[40:43], a[32:35]
    v_mfma_f32_16x16x32_bf16 a[36:39], v[32:35], v[40:43], a[36:39]
    v_mfma_f32_16x16x32_bf16 a[40:43], v[16:19], v[44:47], a[40:43]
    v_mfma_f32_16x16x32_bf16 a[44:47], v[20:23], v[44:47], a[44:47]
    v_mfma_f32_16x16x32_bf16 a[48:51], v[24:27], v[44:47], a[48:51]
    v_mfma_f32_16x16x32_bf16 a[52:55], v[28:31], v[44:47], a[52:55]
    v_mfma_f32_16x16x32_bf16 a[56:59], v[32:35], v[44:47], a[56:59]
    v_mfma_f32_16x16x32_bf16 a[60:63], v[16:19], v[48:51], a[60:63]
    v_mfma_f32_16x16x32_bf16 a[64:67], v[20:23], v[48:51], a[64:67]
    v_mfma_f32_16x16x32_bf16 a[68:71], v[24:27], v[48:51], a[68:71]
    v_mfma_f32_16x16x32_bf16 a[72:75], v[28:31], v[48:51], a[72:75]
    v_mfma_f32_16x16x32_bf16 a[76:79], v[32:35], v[48:51], a[76:79]
    s_nop 7
    v_add_u32 v7, 61440, v7
    v_add_u32 v8, 61440, v8
    v_add_u32 v9, 61440, v9
    v_add_u32 v10, 61440, v10
    ds_write_b128 v7, a[20:23] offset:0
    ds_write_b128 v7, a[24:27] offset:1024
    ds_write_b128 v7, a[28:31] offset:2048
    ds_write_b128 v7, a[32:35] offset:3072
    ds_write_b128 v7, a[36:39] offset:4096
    ds_write_b128 v8, a[40:43] offset:0
    ds_write_b128 v8, a[44:47] offset:1024
    ds_write_b128 v8, a[48:51] offset:2048
    ds_write_b128 v8, a[52:55] offset:3072
    ds_write_b128 v8, a[56:59] offset:4096
    ds_write_b128 v9, a[60:63] offset:0
    ds_write_b128 v9, a[64:67] offset:1024
    ds_write_b128 v9, a[68:71] offset:2048
    ds_write_b128 v9, a[72:75] offset:3072
    ds_write_b128 v9, a[76:79] offset:4096
    v_accvgpr_read_b32 v16, a0
    v_accvgpr_read_b32 v17, a1
    v_accvgpr_read_b32 v18, a2
    v_accvgpr_read_b32 v19, a3
    v_accvgpr_read_b32 v20, a4
    v_accvgpr_read_b32 v21, a5
    v_accvgpr_read_b32 v22, a6
    v_accvgpr_read_b32 v23, a7
    v_accvgpr_read_b32 v24, a8
    v_accvgpr_read_b32 v25, a9
    v_accvgpr_read_b32 v26, a10
    v_accvgpr_read_b32 v27, a11
    v_accvgpr_read_b32 v28, a12
    v_accvgpr_read_b32 v29, a13
    v_accvgpr_read_b32 v30, a14
    v_accvgpr_read_b32 v31, a15
    v_accvgpr_read_b32 v32, a16
    v_accvgpr_read_b32 v33, a17
    v_accvgpr_read_b32 v34, a18
    v_accvgpr_read_b32 v35, a19
    s_waitcnt lgkmcnt(0)
    s_barrier
    ds_read_b128 v[36:39], v10 offset:0
    ds_read_b128 v[40:43], v10 offset:1024
    ds_read_b128 v[44:47], v10 offset:2048
    ds_read_b128 v[48:51], v10 offset:3072
    ds_read_b128 v[52:55], v10 offset:4096
    ds_read_b128 v[56:59], v10 offset:5120
    ds_read_b128 v[60:63], v10 offset:6144
    ds_read_b128 v[64:67], v10 offset:7168
    ds_read_b128 v[68:71], v10 offset:8192
    ds_read_b128 v[72:75], v10 offset:9216
    ds_read_b128 v[76:79], v10 offset:10240
    ds_read_b128 v[80:83], v10 offset:11264
    ds_read_b128 v[84:87], v10 offset:12288
    ds_read_b128 v[88:91], v10 offset:13312
    ds_read_b128 v[92:95], v10 offset:14336
    s_waitcnt lgkmcnt(14)
    v_add_f32 v16, v16, v36
    v_add_f32 v17, v17, v37
    v_add_f32 v18, v18, v38
    v_add_f32 v19, v19, v39
    s_waitcnt lgkmcnt(13)
    v_add_f32 v20, v20, v40
    v_add_f32 v21, v21, v41
    v_add_f32 v22, v22, v42
    v_add_f32 v23, v23, v43
    s_waitcnt lgkmcnt(11)
    v_add_f32 v24, v24, v44
    v_add_f32 v25, v25, v45
    v_add_f32 v26, v26, v46
    v_add_f32 v27, v27, v47
    v_add_f32 v28, v28, v48
    v_add_f32 v29, v29, v49
    v_add_f32 v30, v30, v50
    v_add_f32 v31, v31, v51
    s_waitcnt lgkmcnt(3)
    v_add_f32 v32, v32, v52
    v_add_f32 v33, v33, v53
    v_add_f32 v34, v34, v54
    v_add_f32 v35, v35, v55
    v_add_f32 v16, v16, v56
    v_add_f32 v17, v17, v57
    v_add_f32 v18, v18, v58
    v_add_f32 v19, v19, v59
    v_add_f32 v20, v20, v60
    v_add_f32 v21, v21, v61
    v_add_f32 v22, v22, v62
    v_add_f32 v23, v23, v63
    v_add_f32 v24, v24, v64
    v_add_f32 v25, v25, v65
    v_add_f32 v26, v26, v66
    v_add_f32 v27, v27, v67
    v_add_f32 v28, v28, v68
    v_add_f32 v29, v29, v69
    v_add_f32 v30, v30, v70
    v_add_f32 v31, v31, v71
    v_add_f32 v32, v32, v72
    v_add_f32 v33, v33, v73
    v_add_f32 v34, v34, v74
    v_add_f32 v35, v35, v75
    v_add_f32 v16, v16, v76
    v_add_f32 v17, v17, v77
    v_add_f32 v18, v18, v78
    v_add_f32 v19, v19, v79
    v_add_f32 v20, v20, v80
    v_add_f32 v21, v21, v81
    v_add_f32 v22, v22, v82
    v_add_f32 v23, v23, v83
    s_waitcnt lgkmcnt(0)
    v_add_f32 v24, v24, v84
    v_add_f32 v25, v25, v85
    v_add_f32 v26, v26, v86
    v_add_f32 v27, v27, v87
    v_add_f32 v28, v28, v88
    v_add_f32 v29, v29, v89
    v_add_f32 v30, v30, v90
    v_add_f32 v31, v31, v91
    v_add_f32 v32, v32, v92
    v_add_f32 v33, v33, v93
    v_add_f32 v34, v34, v94
    v_add_f32 v35, v35, v95
    s_waitcnt vmcnt(0)
    v_lshlrev_b32 v36, 16, v196
    v_fmac_f32 v36, v16, v206
    v_and_b32 v37, 0xffff0000, v196
    v_fmac_f32 v37, v17, v207
    v_lshlrev_b32 v38, 16, v197
    v_fmac_f32 v38, v18, v208
    v_and_b32 v39, 0xffff0000, v197
    v_fmac_f32 v39, v19, v209
    v_cvt_pk_bf16_f32 v196, v36, v37
    v_cvt_pk_bf16_f32 v197, v38, v39
    buffer_store_dwordx2 v[196:197], v11, s[28:31], 0 offen offset:0
    v_lshlrev_b32 v40, 16, v198
    v_fmac_f32 v40, v20, v210
    v_and_b32 v41, 0xffff0000, v198
    v_fmac_f32 v41, v21, v211
    v_lshlrev_b32 v42, 16, v199
    v_fmac_f32 v42, v22, v212
    v_and_b32 v43, 0xffff0000, v199
    v_fmac_f32 v43, v23, v213
    v_cvt_pk_bf16_f32 v198, v40, v41
    v_cvt_pk_bf16_f32 v199, v42, v43
    buffer_store_dwordx2 v[198:199], v11, s[28:31], 0 offen offset:32
    v_lshlrev_b32 v44, 16, v200
    v_fmac_f32 v44, v24, v214
    v_and_b32 v45, 0xffff0000, v200
    v_fmac_f32 v45, v25, v215
    v_lshlrev_b32 v46, 16, v201
    v_fmac_f32 v46, v26, v216
    v_and_b32 v47, 0xffff0000, v201
    v_fmac_f32 v47, v27, v217
    v_cvt_pk_bf16_f32 v200, v44, v45
    v_cvt_pk_bf16_f32 v201, v46, v47
    buffer_store_dwordx2 v[200:201], v11, s[28:31], 0 offen offset:64
    v_lshlrev_b32 v48, 16, v202
    v_fmac_f32 v48, v28, v218
    v_and_b32 v49, 0xffff0000, v202
    v_fmac_f32 v49, v29, v219
    v_lshlrev_b32 v50, 16, v203
    v_fmac_f32 v50, v30, v220
    v_and_b32 v51, 0xffff0000, v203
    v_fmac_f32 v51, v31, v221
    v_cvt_pk_bf16_f32 v202, v48, v49
    v_cvt_pk_bf16_f32 v203, v50, v51
    buffer_store_dwordx2 v[202:203], v11, s[28:31], 0 offen offset:96
    v_lshlrev_b32 v52, 16, v204
    v_fmac_f32 v52, v32, v222
    v_and_b32 v53, 0xffff0000, v204
    v_fmac_f32 v53, v33, v223
    v_lshlrev_b32 v54, 16, v205
    v_fmac_f32 v54, v34, v224
    v_and_b32 v55, 0xffff0000, v205
    v_fmac_f32 v55, v35, v225
    v_cvt_pk_bf16_f32 v204, v52, v53
    v_cvt_pk_bf16_f32 v205, v54, v55
    buffer_store_dwordx2 v[204:205], v11, s[28:31], 0 offen offset:128
K3_END:
    s_endpgm

.section .rodata,"a"
.p2align 6
.amdhsa_kernel pre_kernel
  .amdhsa_next_free_vgpr 72
  .amdhsa_next_free_sgpr 100
  .amdhsa_accum_offset 72
  .amdhsa_group_segment_fixed_size 0
  .amdhsa_kernarg_size 88
  .amdhsa_user_sgpr_count 2
  .amdhsa_user_sgpr_kernarg_segment_ptr 1
  .amdhsa_system_sgpr_workgroup_id_x 1
.end_amdhsa_kernel
.p2align 6
.amdhsa_kernel attn_kernel
  .amdhsa_next_free_vgpr 512
  .amdhsa_next_free_sgpr 100
  .amdhsa_accum_offset 256
  .amdhsa_group_segment_fixed_size 0
  .amdhsa_kernarg_size 88
  .amdhsa_user_sgpr_count 2
  .amdhsa_user_sgpr_kernarg_segment_ptr 1
  .amdhsa_system_sgpr_workgroup_id_x 1
.end_amdhsa_kernel
.p2align 6
.amdhsa_kernel out_kernel
  .amdhsa_next_free_vgpr 512
  .amdhsa_next_free_sgpr 100
  .amdhsa_accum_offset 256
  .amdhsa_group_segment_fixed_size 0
  .amdhsa_kernarg_size 88
  .amdhsa_user_sgpr_count 2
  .amdhsa_user_sgpr_kernarg_segment_ptr 1
  .amdhsa_system_sgpr_workgroup_id_x 1
.end_amdhsa_kernel
```
